```python
import torch

def _softmax(x, axis=-1):
    return torch.softmax(x, dim=axis)

def _gelu(x):
    return torch.nn.functional.gelu(x, approximate='tanh')

def _silu(x):
    return torch.nn.functional.silu(x)

def _sigmoid(x):
    return torch.sigmoid(x)

def _layernorm(x, axis=-1, eps=1e-05):
    m = x.mean(dim=axis, keepdim=True)
    v = x.var(dim=axis, keepdim=True, unbiased=False)
    return (x - m) / torch.sqrt(v + eps)

def _scatter_add(tgt, idx, src, axis=0):
    return tgt.clone().index_add_(axis, idx, src)

def _segment_sum(src, seg, n):
    out = torch.zeros((n,) + src.shape[1:], dtype=src.dtype)
    return out.index_add_(0, seg, src)

def _pad(x, pw):
    flat = tuple((v for pair in reversed(pw) for v in pair))
    return torch.nn.functional.pad(x, flat)
kernel_name = 'gated_mix__memory_aug_recurrent_mem_tr__moe_arch_mod__prompt'

def setup_inputs():

    _w = lambda a: (lambda t: t.to(torch.bfloat16) if t.is_floating_point() else t)(torch.as_tensor(a))

    def _A_setup():
        B, S, Dm = (1, 2048, 448)
        H, Dh = (16, 256)
        M, seg = (8, 32)
        seg = min(seg, S)
        S = S // seg * seg
        return {'x': _w((lambda *s: torch.randn(*s, dtype=torch.bfloat16) * 0.05)(B, S, Dm)), 'mem0': _w((lambda *s: torch.randn(*s, dtype=torch.bfloat16) * 0.8)(B, M, Dm)), 'Wq': _w((lambda *s: torch.randn(*s, dtype=torch.bfloat16) * 1.6)(Dm, H, Dh) * Dm ** (-0.5)), 'Wk': _w((lambda *s: torch.randn(*s, dtype=torch.bfloat16) * 1.6)(Dm, H, Dh) * Dm ** (-0.5)), 'Wv': _w((lambda *s: torch.randn(*s, dtype=torch.bfloat16) * 0.8)(Dm, H, Dh) * Dm ** (-0.5)), 'Wo': _w((lambda *s: torch.randn(*s, dtype=torch.bfloat16) * 0.8)(H, Dh, Dm) * (H * Dh) ** (-0.5)), 'seg_len': seg}
    _A_in = _A_setup()

    def _B_setup():
        B, S, D, F, C = (1, 2048, 448, 1792, 1)
        return {'x': _w((lambda *s: torch.randn(*s, dtype=torch.bfloat16) * 0.05)(B, S, D)), 'w_r': _w((lambda *s: torch.randn(*s, dtype=torch.bfloat16) * 1.6)(D)), 'w_gate': _w((lambda *s: torch.randn(*s, dtype=torch.bfloat16) * 0.2)(D, F)), 'w_up': _w((lambda *s: torch.randn(*s, dtype=torch.bfloat16) * 0.2)(D, F)), 'w_down': _w((lambda *s: torch.randn(*s, dtype=torch.bfloat16) * 0.2)(F, D))}
    _B_in = _B_setup()
    return {'A_x': _A_in['x'], 'A_mem0': _A_in['mem0'], 'A_Wq': _A_in['Wq'], 'A_Wk': _A_in['Wk'], 'A_Wv': _A_in['Wv'], 'A_Wo': _A_in['Wo'], 'A_seg_len': _A_in['seg_len'], 'B_x': _B_in['x'], 'B_w_r': _B_in['w_r'], 'B_w_gate': _B_in['w_gate'], 'B_w_up': _B_in['w_up'], 'B_w_down': _B_in['w_down'], 'gate_w': _w((lambda *s: torch.randn(*s, dtype=torch.bfloat16) * 0.05)(448) * 16.0)}

def reference(A_x, A_mem0, A_Wq, A_Wk, A_Wv, A_Wo, A_seg_len, B_x, B_w_r, B_w_gate, B_w_up, B_w_down, gate_w):

    def _A_ref(x, mem0, Wq, Wk, Wv, Wo, seg_len):
        B, S, Dm = x.shape
        H, Dh = (Wq.shape[1], Wq.shape[2])
        M = mem0.shape[1]
        scale = Dh ** (-0.5)
        n_seg = S // seg_len
        L = M + seg_len
        idx = torch.arange(L)
        mask = (idx[:, None] < M) | (idx[:, None] >= idx[None, :])
        mem = mem0
        outs = []
        for s in range(n_seg):
            xs = x[:, s * seg_len:(s + 1) * seg_len, :].clone()
            h = torch.concatenate([mem, xs], axis=1)
            q = torch.einsum('btd,dhe->bhte', h, Wq)
            k = torch.einsum('btd,dhe->bhte', h, Wk)
            v = torch.einsum('btd,dhe->bhte', h, Wv)
            scores = torch.einsum('bhqe,bhke->bhqk', q, k) * scale
            scores = torch.where(mask[None, None], scores, -1000000000.0)
            p = _softmax(scores, axis=-1)
            o = torch.einsum('bhqk,bhke->bhqe', p, v)
            o = torch.einsum('bhte,hed->btd', o, Wo)
            mem = o[:, :M, :].clone()
            outs.append(o[:, M:, :])
        return torch.concatenate(outs, axis=1)

    def _B_ref(x, w_r, w_gate, w_up, w_down):
        B, S, D = x.shape
        C = 1
        r = x @ w_r
        idx = torch.argsort(-r, axis=-1)[:, :C]
        idx_e = (lambda x, n, axis: torch.repeat_interleave(x, n, dim=axis))(idx.reshape(B, C, 1), D, axis=2)
        x_sel = (lambda x, i, axis: torch.take_along_dim(x, i, dim=axis))(x, idx_e, axis=1)
        g = _silu(x_sel @ w_gate)
        u = x_sel @ w_up
        y = g * u @ w_down
        r_sel = _sigmoid((lambda x, i, axis: torch.take_along_dim(x, i, dim=axis))(r, idx, axis=1))
        y = y * r_sel.reshape(B, C, 1)
        b_off = (torch.arange(B) * S).reshape(B, 1)
        flat_idx = (idx + b_off).reshape(B * C)
        zero = (x * 0.0).reshape(B * S, D)
        upd = _scatter_add(zero, flat_idx, y.reshape(B * C, D), axis=0)
        return x + upd.reshape(B, S, D)
    x = A_x
    g = _sigmoid((x * gate_w).sum(-1, keepdims=True))
    a = _A_ref(x, A_mem0, A_Wq, A_Wk, A_Wv, A_Wo, A_seg_len)
    b = _B_ref(x, B_w_r, B_w_gate, B_w_up, B_w_down)
    return g * a + (1 - g) * b
```

```asm
; @launch grid=(256,1,1) block=(256,1,1) lds=163840
.amdgcn_target "amdgcn-amd-amdhsa--gfx950"
.text
.globl gated_mix__memory_aug_recurrent_mem_tr__moe_arch_mod__prompt_kernel
.p2align 8
.type gated_mix__memory_aug_recurrent_mem_tr__moe_arch_mod__prompt_kernel,@function
gated_mix__memory_aug_recurrent_mem_tr__moe_arch_mod__prompt_kernel:
  s_cmp_ge_u32 s2, 256
  s_cbranch_scc1 mk_end
  s_load_dwordx2 s[4:5], s[0:1], 120
  s_load_dwordx2 s[6:7], s[0:1], 112
  s_memrealtime s[16:17]
  s_load_dwordx4 s[8:11], s[0:1], 16
  s_load_dwordx4 s[12:15], s[0:1], 32
  s_getreg_b32 s23, hwreg(HW_REG_XCC_ID)
  s_and_b32 s23, s23, 7
  v_lshrrev_b32 v2, 6, v0
  s_nop 0
  v_readfirstlane_b32 s22, v2
  s_waitcnt lgkmcnt(0)
  s_cmp_lg_u32 s22, 0
  s_cbranch_scc1 mk_noat
  s_mov_b64 exec, 1
  s_and_b32 s24, s23, 3
  s_lshl_b32 s24, s24, 6
  s_lshr_b32 s25, s23, 2
  s_lshl_b32 s25, s25, 2
  s_add_u32 s24, s24, s25
  v_mov_b32 v1, s24
  v_mov_b32 v2, 1
  global_atomic_add v3, v1, v2, s[6:7] sc0
  s_mov_b64 exec, -1
mk_noat:
  s_waitcnt vmcnt(0)
  s_cmp_lg_u32 s22, 0
  s_cbranch_scc1 mk_wait
  s_mov_b64 exec, 1
  v_readfirstlane_b32 s24, v3
  v_mov_b32 v1, 0
  s_cmp_lg_u32 s24, 0
  s_cbranch_scc1 mk_notag
  s_or_b32 s20, s16, 1
  v_mov_b32 v6, s20
  v_mov_b32 v7, 0
  global_atomic_cmpswap v1, v[6:7], s[6:7] offset:8
mk_notag:
  s_lshl_b32 s25, s23, 5
  s_add_u32 s25, s25, s24
  v_mov_b32 v3, s25
  s_cmp_lt_u32 s24, 32
  s_cbranch_scc1 mk_pub
  global_atomic_add v3, v1, v2, s[6:7] offset:72 sc0
  s_mov_b32 s40, 1000000
  v_mov_b32 v7, 0
mk_o_aw_1:
  global_load_dwordx2 v[8:9], v7, s[6:7] offset:0 sc1
  global_load_dwordx2 v[10:11], v7, s[6:7] offset:64 sc1
  global_load_dwordx2 v[12:13], v7, s[6:7] offset:128 sc1
  global_load_dwordx2 v[14:15], v7, s[6:7] offset:192 sc1
  s_waitcnt vmcnt(0)
  v_add3_u32 v16, v8, v9, v10
  v_add3_u32 v16, v16, v11, v12
  v_add3_u32 v16, v16, v13, v14
  v_add_u32 v16, v16, v15
  s_nop 0
  v_readfirstlane_b32 s25, v16
  s_nop 0
  s_cmp_ge_u32 s25, 256
  s_cbranch_scc1 mk_o_ad_2
  s_sleep 4
  s_sub_u32 s40, s40, 1
  s_cbranch_scc0 mk_o_aw_1
  s_mov_b32 s40, 0
mk_o_ad_2:
  v_readfirstlane_b32 s24, v3
  s_mov_b32 s26, 255
  v_readfirstlane_b32 s25, v8
  s_nop 0
  s_min_u32 s25, s25, 32
  s_sub_u32 s27, 32, s25
  s_cmp_lt_u32 s24, s27
  s_cbranch_scc0 ovf_3
  s_add_u32 s26, s24, s25
  s_add_u32 s26, s26, 0
  s_branch mk_ovd
ovf_3:
  s_sub_u32 s24, s24, s27
  v_readfirstlane_b32 s25, v10
  s_nop 0
  s_min_u32 s25, s25, 32
  s_sub_u32 s27, 32, s25
  s_cmp_lt_u32 s24, s27
  s_cbranch_scc0 ovf_4
  s_add_u32 s26, s24, s25
  s_add_u32 s26, s26, 32
  s_branch mk_ovd
ovf_4:
  s_sub_u32 s24, s24, s27
  v_readfirstlane_b32 s25, v12
  s_nop 0
  s_min_u32 s25, s25, 32
  s_sub_u32 s27, 32, s25
  s_cmp_lt_u32 s24, s27
  s_cbranch_scc0 ovf_5
  s_add_u32 s26, s24, s25
  s_add_u32 s26, s26, 64
  s_branch mk_ovd
ovf_5:
  s_sub_u32 s24, s24, s27
  v_readfirstlane_b32 s25, v14
  s_nop 0
  s_min_u32 s25, s25, 32
  s_sub_u32 s27, 32, s25
  s_cmp_lt_u32 s24, s27
  s_cbranch_scc0 ovf_6
  s_add_u32 s26, s24, s25
  s_add_u32 s26, s26, 96
  s_branch mk_ovd
ovf_6:
  s_sub_u32 s24, s24, s27
  v_readfirstlane_b32 s25, v9
  s_nop 0
  s_min_u32 s25, s25, 32
  s_sub_u32 s27, 32, s25
  s_cmp_lt_u32 s24, s27
  s_cbranch_scc0 ovf_7
  s_add_u32 s26, s24, s25
  s_add_u32 s26, s26, 128
  s_branch mk_ovd
ovf_7:
  s_sub_u32 s24, s24, s27
  v_readfirstlane_b32 s25, v11
  s_nop 0
  s_min_u32 s25, s25, 32
  s_sub_u32 s27, 32, s25
  s_cmp_lt_u32 s24, s27
  s_cbranch_scc0 ovf_8
  s_add_u32 s26, s24, s25
  s_add_u32 s26, s26, 160
  s_branch mk_ovd
ovf_8:
  s_sub_u32 s24, s24, s27
  v_readfirstlane_b32 s25, v13
  s_nop 0
  s_min_u32 s25, s25, 32
  s_sub_u32 s27, 32, s25
  s_cmp_lt_u32 s24, s27
  s_cbranch_scc0 ovf_9
  s_add_u32 s26, s24, s25
  s_add_u32 s26, s26, 192
  s_branch mk_ovd
ovf_9:
  s_sub_u32 s24, s24, s27
  v_readfirstlane_b32 s25, v15
  s_nop 0
  s_min_u32 s25, s25, 32
  s_sub_u32 s27, 32, s25
  s_cmp_lt_u32 s24, s27
  s_cbranch_scc0 ovf_10
  s_add_u32 s26, s24, s25
  s_add_u32 s26, s26, 224
  s_branch mk_ovd
ovf_10:
  s_sub_u32 s24, s24, s27
mk_ovd:
  v_mov_b32 v3, s26
mk_pub:
  v_mov_b32 v1, 37888
  ds_write_b32 v1, v3
  s_waitcnt lgkmcnt(0)
  s_mov_b64 exec, -1
mk_wait:
  s_barrier
  v_mov_b32 v1, 37888
  ds_read_b32 v2, v1
  s_waitcnt lgkmcnt(0)
  v_readfirstlane_b32 s24, v2
  s_nop 0
  s_cmp_ge_u32 s24, 32
  s_cbranch_scc1 mk_helper
  s_mov_b32 s40, 2000000
  s_load_dwordx2 s[14:15], s[0:1], 8
  v_and_b32 v3, 63, v0
  v_mov_b32 v4, -1
  v_mov_b32 v5, -1
  v_mov_b32 v6, -1
  v_mov_b32 v7, -1
  s_lshl_b32 s25, s24, 12
  s_add_u32 s25, s25, 15728640
  v_lshlrev_b32 v1, 4, v0
  v_add_u32 v1, s25, v1
  global_store_dwordx4 v1, v[4:7], s[4:5] sc1
  v_add_u32 v1, 0x20000, v1
  global_store_dwordx4 v1, v[4:7], s[4:5] sc1
  v_add_u32 v1, 0x20000, v1
  global_store_dwordx4 v1, v[4:7], s[4:5] sc1
  v_add_u32 v1, 0x20000, v1
  global_store_dwordx4 v1, v[4:7], s[4:5] sc1
  v_add_u32 v1, 0x20000, v1
  global_store_dwordx4 v1, v[4:7], s[4:5] sc1
  v_add_u32 v1, 0x20000, v1
  s_cmp_ge_u32 s24, 20
  s_cbranch_scc1 mk_c_rf
  global_store_dwordx4 v1, v[4:7], s[4:5] sc1
mk_c_rf:
  s_lshl_b32 s25, s24, 12
  s_add_u32 s25, s25, 16784384
  v_lshlrev_b32 v1, 4, v0
  v_add_u32 v1, s25, v1
  global_store_dwordx4 v1, v[4:7], s[4:5] sc1
  v_add_u32 v1, 0x20000, v1
  global_store_dwordx4 v1, v[4:7], s[4:5] sc1
  v_add_u32 v1, 0x20000, v1
  global_store_dwordx4 v1, v[4:7], s[4:5] sc1
  v_add_u32 v1, 0x20000, v1
  s_cmp_ge_u32 s24, 15
  s_cbranch_scc1 mk_c_mf
  global_store_dwordx4 v1, v[4:7], s[4:5] sc1
mk_c_mf:
  s_waitcnt lgkmcnt(0)
  s_cmp_lg_u32 s24, 0
  s_cbranch_scc1 mk_c_nm0
  v_bfe_u32 v8, v0, 1, 3
  v_mul_u32_u24 v8, 896, v8
  v_lshrrev_b32 v9, 4, v0
  v_lshl_add_u32 v8, v9, 5, v8
  v_and_b32 v9, 1, v0
  v_lshl_add_u32 v8, v9, 4, v8
  v_lshlrev_b32 v9, 4, v0
  v_add_u32 v9, 16777216, v9
  v_add_u32 v10, 4096, v9
  global_load_dwordx4 v[12:15], v8, s[14:15]
  s_waitcnt vmcnt(0)
  global_store_dwordx4 v9, v[12:15], s[4:5] sc1
  s_cmp_eq_u32 s22, 3
  s_cbranch_scc1 mk_c_nm0
  global_load_dwordx4 v[16:19], v8, s[14:15] offset:512
  s_waitcnt vmcnt(0)
  global_store_dwordx4 v10, v[16:19], s[4:5] sc1
  s_nop 1
mk_c_nm0:
  v_mov_b32 v1, 0
mk_c_gt_11:
  global_load_dword v2, v1, s[6:7] offset:8 sc1
  s_waitcnt vmcnt(0)
  v_readfirstlane_b32 s20, v2
  s_nop 0
  s_cmp_lg_u32 s20, 0
  s_cbranch_scc1 mk_c_gd_12
  s_sleep 2
  s_sub_u32 s40, s40, 1
  s_cbranch_scc0 mk_c_gt_11
  s_mov_b32 s40, 0
mk_c_gd_12:
  s_lshl_b32 s36, s24, 2
  s_add_u32 s36, s36, s22
  s_lshl_b32 s36, s36, 2
  s_add_u32 s36, s36, 14946816
  s_waitcnt vmcnt(0)
  v_mov_b32 v1, s36
  v_mov_b32 v2, s20
  s_mov_b64 exec, 1
  global_store_dword v1, v2, s[4:5] sc1
  s_mov_b64 exec, -1
  v_mov_b32 v7, 0
mk_c_aw_13:
  global_load_dwordx2 v[8:9], v7, s[6:7] offset:0 sc1
  global_load_dwordx2 v[10:11], v7, s[6:7] offset:64 sc1
  global_load_dwordx2 v[12:13], v7, s[6:7] offset:128 sc1
  global_load_dwordx2 v[14:15], v7, s[6:7] offset:192 sc1
  s_waitcnt vmcnt(0)
  v_add3_u32 v16, v8, v9, v10
  v_add3_u32 v16, v16, v11, v12
  v_add3_u32 v16, v16, v13, v14
  v_add_u32 v16, v16, v15
  s_nop 0
  v_readfirstlane_b32 s25, v16
  s_nop 0
  s_cmp_ge_u32 s25, 256
  s_cbranch_scc1 mk_c_ad_14
  s_sleep 4
  s_sub_u32 s40, s40, 1
  s_cbranch_scc0 mk_c_aw_13
  s_mov_b32 s40, 0
mk_c_ad_14:
  v_readfirstlane_b32 s21, v8
  v_and_b32 v0, 63, v0
  v_and_b32 v0, 63, v0
  v_lshlrev_b32 v1, 4, v0
  s_and_b32 s25, s24, 15
  s_lshr_b32 s26, s24, 4
  s_lshl_b32 s29, s22, 1
  s_cmp_ge_u32 s24, 30
  s_cbranch_scc1 mk_c_spare
  s_lshr_b32 s37, s25, 1
  s_cmp_lg_u32 s22, 0
  s_cbranch_scc1 wgw_15
  v_lshlrev_b32 v16, 2, v0
  v_add_u32 v16, 14946816, v16
mk_c_wf_16:
  global_load_dword v17, v16, s[4:5] offset:0 sc1
  global_load_dword v18, v16, s[4:5] offset:256 sc1
  s_waitcnt vmcnt(0)
  v_xor_b32 v17, s20, v17
  v_xor_b32 v18, s20, v18
  v_or_b32 v17, v17, v18
  v_cmp_ne_u32 vcc, 0, v17
  s_cbranch_vccz mk_c_wd_17
  s_sleep 8
  s_sub_u32 s40, s40, 1
  s_cbranch_scc0 mk_c_wf_16
  s_mov_b32 s40, 0
mk_c_wd_17:
wgw_15:
  s_barrier
  s_waitcnt vmcnt(0)
  v_and_b32 v8, 15, v0
  v_lshrrev_b32 v9, 4, v0
  v_and_b32 v10, 1, v0
  v_cmp_eq_u32 vcc, 1, v10
  v_mov_b32 v112, 0x4444
  v_mov_b32 v10, 0xeeee
  v_cndmask_b32 v112, v112, v10, vcc
  v_add_u32 v3, 4096, v1
  v_add_u32 v4, 8192, v1
  v_mov_b32 v5, v1
  v_mov_b32 v6, v1
  v_mov_b32 v7, v1
  v_mov_b32 v100, v1
  v_mov_b32 v101, v1
  v_mov_b32 v102, v1
  v_mov_b32 v103, v1
  v_mov_b32 v105, v1
  v_mov_b32 v113, v1
  v_mov_b32 v114, v1
  v_mov_b32 v115, v1
  v_mov_b32 v116, v1
  s_lshl_b32 s30, s24, 2
  s_add_u32 s30, s30, s22
  s_mul_i32 s30, s30, 4608
  s_add_u32 s30, s30, 15732736
  v_add_u32 v10, s30, v1
  global_load_dwordx4 v[16:19], v10, s[4:5] offset:-4096 sc1
  global_load_dwordx4 v[20:23], v10, s[4:5] offset:-3072 sc1
  global_load_dwordx4 v[24:27], v10, s[4:5] offset:-2048 sc1
  global_load_dwordx4 v[28:31], v10, s[4:5] offset:-1024 sc1
  global_load_dwordx4 v[32:35], v10, s[4:5] offset:-512 sc1
  s_add_u32 s8, s4, 16318464
  s_addc_u32 s9, s5, 0
  s_add_u32 s10, s4, 16318464
  s_addc_u32 s11, s5, 0
  s_add_u32 s12, s4, 16318464
  s_addc_u32 s13, s5, 0
  s_add_u32 s14, s4, 16318464
  s_addc_u32 s15, s5, 0
  s_add_u32 s52, s4, 16318464
  s_addc_u32 s53, s5, 0
  s_add_u32 s54, s4, 16318464
  s_addc_u32 s55, s5, 0
  s_add_u32 s56, s4, 16318464
  s_addc_u32 s57, s5, 0
  s_add_u32 s58, s4, 16318464
  s_addc_u32 s59, s5, 0
  s_add_u32 s44, s4, 16777216
  s_addc_u32 s45, s5, 0
  s_add_u32 s46, s4, 15728640
  s_addc_u32 s47, s5, 0
  s_add_u32 s48, s4, 16171008
  s_addc_u32 s49, s5, 0
  s_add_u32 s50, s4, 15876096
  s_addc_u32 s51, s5, 0
  s_mov_b32 s38, 294912
  s_mov_b32 s36, 0
  s_and_b32 s31, s24, 3
  s_lshl_b32 s31, s31, 8
  s_add_u32 s31, s31, 21504
  v_min_u32 v2, 27, v0
  v_lshlrev_b32 v2, 2, v2
  v_add_u32 v2, s31, v2
  s_cmp_eq_u32 s26, 1
  s_cbranch_scc1 mk_c_vsetup
  s_lshl_b32 s30, s22, 12
  s_add_u32 s30, s30, 49152
  v_lshlrev_b32 v5, 5, v8
  v_lshrrev_b32 v10, 2, v8
  v_lshrrev_b32 v11, 1, v9
  v_xor_b32 v10, v10, v11
  v_lshl_add_u32 v5, v10, 3, v5
  v_and_b32 v11, 1, v9
  v_lshl_add_u32 v5, v11, 2, v5
  v_add_u32 v5, s30, v5
  v_add_u32 v10, s30, v1
  v_mov_b32 v16, 0
  v_mov_b32 v17, 0
  v_mov_b32 v18, 0
  v_mov_b32 v19, 0
  s_waitcnt vmcnt(0)
  v_mov_b32 v16, 0
  v_mov_b32 v17, 0
  v_mov_b32 v18, 0
  v_mov_b32 v19, 0
  ds_write_b128 v10, v[16:19] offset:0
  ds_write_b128 v10, v[16:19] offset:1024
  ds_write_b128 v10, v[16:19] offset:2048
  ds_write_b128 v10, v[16:19] offset:3072
  v_and_b32 v10, 3, v0
  v_xor_b32 v10, v10, v9
  v_lshrrev_b32 v6, 2, v0
  v_lshlrev_b32 v6, 5, v6
  v_lshl_add_u32 v6, v10, 3, v6
  v_add_u32 v6, s30, v6
  v_lshrrev_b32 v10, 1, v9
  v_and_b32 v11, 1, v9
  v_lshlrev_b32 v7, 4, v10
  v_lshl_add_u32 v7, v11, 3, v7
  v_and_b32 v12, 7, v0
  v_lshl_add_u32 v7, v12, 5, v7
  s_mul_i32 s30, s22, 14
  s_and_b32 s30, s30, 7
  s_lshl_b32 s30, s30, 7
  s_mul_i32 s31, s22, 3072
  s_add_u32 s30, s30, s31
  v_add_u32 v7, s30, v7
  v_mul_u32_u24 v115, 208, v8
  v_lshl_add_u32 v115, v9, 4, v115
  s_mul_i32 s30, s22, 3328
  s_add_u32 s30, s30, 24576
  v_add_u32 v115, s30, v115
  v_lshrrev_b32 v10, 5, v0
  v_add_u32 v10, s29, v10
  v_and_b32 v11, 31, v0
  v_mul_u32_u24 v113, 208, v10
  v_lshl_add_u32 v113, v11, 3, v113
  v_add_u32 v113, 24576, v113
  v_lshrrev_b32 v114, 3, v11
  v_lshlrev_b32 v114, 8, v114
  v_and_b32 v12, 7, v11
  v_lshl_add_u32 v114, v12, 2, v114
  s_lshl_b32 s30, s25, 9
  v_add_u32 v114, s30, v114
  v_and_b32 v8, 3, v11
  v_lshlrev_b32 v8, 2, v8
  s_lshr_b32 s30, s25, 1
  s_lshl_b32 s30, s30, 8
  s_and_b32 s31, s25, 1
  s_lshl_b32 s32, s31, 4
  s_add_u32 s30, s30, s32
  s_add_u32 s30, s30, 8192
  v_add_u32 v8, s30, v8
  v_cmp_lt_u32 vcc, 15, v11
  s_nop 1
  v_cndmask_b32 v114, v114, v8, vcc
  v_lshl_add_u32 v114, v10, 5, v114
  v_cmp_gt_u32 vcc, 20, v11
  s_nop 0
  s_mov_b64 s[42:43], vcc
  s_lshl_b32 s31, s25, 2
  s_add_u32 s31, s31, 17408
  v_lshlrev_b32 v0, 8, v0
  v_add_u32 v0, s31, v0
  s_lshl_b32 s30, s22, 13
  s_add_u32 s30, s30, 29360128
  s_add_u32 s54, s4, s30
  s_addc_u32 s55, s5, 0
  s_lshl_b32 s30, s25, 2
  s_add_u32 s30, s30, s22
  s_mul_i32 s30, s30, 7168
  s_add_u32 s30, s30, 34471936
  s_add_u32 s8, s4, s30
  s_addc_u32 s9, s5, 0
  s_branch mk_c_go
mk_c_vsetup:
  s_and_b32 s33, s22, 1
  s_lshl_b32 s30, s25, 1
  s_add_u32 s33, s33, s30
  s_and_b32 s30, s22, 1
  s_lshl_b32 s31, s30, 14
  s_add_u32 s31, s31, 98304
  v_add_u32 v100, s31, v1
  s_lshl_b32 s31, s30, 12
  s_add_u32 s31, s31, 8192
  v_add_u32 v101, s31, v1
  v_lshrrev_b32 v102, 3, v8
  v_lshlrev_b32 v102, 4, v102
  v_lshl_add_u32 v102, v9, 6, v102
  v_and_b32 v12, 1, v8
  v_lshl_add_u32 v102, v12, 5, v102
  v_bfe_u32 v103, v8, 1, 2
  v_lshl_add_u32 v102, v103, 2, v102
  s_lshl_b32 s30, s33, 8
  s_add_u32 s30, s30, 10240
  v_add_u32 v102, s30, v102
  v_cmp_eq_u32 vcc, 1, v12
  v_mov_b32 v103, 0x01000504
  v_mov_b32 v12, 0x07060302
  v_cndmask_b32 v103, v103, v12, vcc
  v_lshrrev_b32 v10, 1, v9
  v_lshlrev_b32 v114, 8, v10
  v_lshl_add_u32 v114, v8, 4, v114
  v_and_b32 v10, 1, v9
  v_lshl_add_u32 v114, v10, 3, v114
  s_lshl_b32 s30, s22, 10
  s_add_u32 s30, s30, 8192
  v_add_u32 v114, s30, v114
  s_mul_i32 s30, s22, 14336
  s_add_u32 s30, s30, 16384
  v_add_u32 v113, s30, v1
  s_add_u32 s30, s29, 0
  s_add_u32 s30, s30, s37
  s_cmp_ge_u32 s30, 7
  s_cselect_b32 s31, 7, 0
  s_sub_u32 s30, s30, s31
  s_cmp_ge_u32 s30, 7
  s_cselect_b32 s31, 7, 0
  s_sub_u32 s30, s30, s31
  s_lshl_b32 s30, s30, 10
  v_add_u32 v5, s30, v1
  s_add_u32 s30, s29, 1
  s_add_u32 s30, s30, s37
  s_cmp_ge_u32 s30, 7
  s_cselect_b32 s31, 7, 0
  s_sub_u32 s30, s30, s31
  s_cmp_ge_u32 s30, 7
  s_cselect_b32 s31, 7, 0
  s_sub_u32 s30, s30, s31
  s_lshl_b32 s30, s30, 10
  v_add_u32 v6, s30, v1
  s_add_u32 s30, s29, 2
  s_add_u32 s30, s30, s37
  s_cmp_ge_u32 s30, 7
  s_cselect_b32 s31, 7, 0
  s_sub_u32 s30, s30, s31
  s_cmp_ge_u32 s30, 7
  s_cselect_b32 s31, 7, 0
  s_sub_u32 s30, s30, s31
  s_lshl_b32 s30, s30, 10
  v_add_u32 v7, s30, v1
  v_mov_b32 v104, -1
  v_mov_b32 v115, s20
  v_min_u32 v105, 7, v0
  v_lshlrev_b32 v105, 2, v105
  s_cmp_ge_u32 s22, 2
  s_cbranch_scc1 mk_c_npv
  s_and_b32 s30, s33, 3
  s_lshl_b32 s30, s30, 8
  s_add_u32 s30, s30, 17408
  v_min_u32 v2, 16, v0
  v_lshlrev_b32 v2, 2, v2
  v_add_u32 v2, s30, v2
mk_c_npv:
  v_mov_b32 v20, v0
  s_lshl_b32 s30, s33, 2
  s_add_u32 s30, s30, 21504
  v_lshlrev_b32 v0, 8, v0
  v_add_u32 v0, s30, v0
  s_add_u32 s10, s4, 16318464
  s_addc_u32 s11, s5, 0
  s_lshl_b32 s31, s25, 5
  s_add_u32 s31, s31, 14950400
  s_add_u32 s12, s4, s31
  s_addc_u32 s13, s5, 0
  s_mov_b32 s39, s31
  s_lshl_b32 s30, s25, 15
  s_lshl_b32 s31, s22, 13
  s_add_u32 s30, s30, s31
  s_add_u32 s30, s30, 33554432
  s_add_u32 s56, s4, s30
  s_addc_u32 s57, s5, 0
  s_add_u32 s35, s31, 98304
mk_c_go:
  v_lshrrev_b32 v68, 4, v1
  s_mul_i32 s30, s22, 7
  s_lshr_b32 s30, s30, 2
  s_lshl_b32 s30, s30, 2
  v_min_u32 v64, 11, v68
  s_cmp_eq_u32 s22, 0
  s_cselect_b32 s31, 7, 27
  v_add_u32 v64, s30, v64
  v_min_u32 v64, s31, v64
  s_mul_i32 s30, s24, 28
  v_add_u32 v64, s30, v64
  v_bfe_u32 v65, v68, 2, 2
  v_mul_u32_u24 v65, 28, v65
  v_and_b32 v66, 3, v68
  v_add_u32 v65, v65, v66
  s_lshr_b32 s37, s25, 1
  s_lshl_b32 s30, s37, 2
  s_mul_i32 s31, s22, 112
  s_add_u32 s30, s30, s31
  s_add_u32 s30, s30, 448
  v_add_u32 v65, s30, v65
  s_cmp_eq_u32 s26, 1
  s_cselect_b64 vcc, -1, 0
  v_cndmask_b32 v64, v64, v65, vcc
  s_waitcnt vmcnt(0)
  v_lshlrev_b32 v65, 2, v64
  v_add_u32 v65, 15069184, v65
mk_c_wf_18:
  global_load_dword v66, v65, s[4:5] offset:0 sc1
  s_waitcnt vmcnt(0)
  v_xor_b32 v66, s20, v66
  v_cmp_ne_u32 vcc, 0, v66
  s_cbranch_vccz mk_c_wd_19
  s_sleep 3
  s_sub_u32 s40, s40, 1
  s_cbranch_scc0 mk_c_wf_18
  s_mov_b32 s40, 0
mk_c_wd_19:
  s_cmp_eq_u32 s26, 1
  s_cbranch_scc1 mk_c_vw
  s_mul_i32 s27, s25, 28
  s_mul_i32 s28, s22, 7
  s_add_u32 s27, s27, s28
  s_mul_i32 s27, s27, 14336
  s_cmp_lg_u32 s22, 0
  s_cbranch_scc1 mk_c_wl01
  s_add_u32 s30, s27, 0
  v_add_u32 v67, s30, v1
  global_load_dwordx4 a[0:3], v67, s[4:5] offset:0 sc1
  global_load_dwordx4 a[4:7], v67, s[4:5] offset:1024 sc1
  s_add_u32 s30, s27, 2048
  v_add_u32 v67, s30, v1
  global_load_dwordx4 a[8:11], v67, s[4:5] offset:0 sc1
  global_load_dwordx4 a[12:15], v67, s[4:5] offset:1024 sc1
  s_add_u32 s30, s27, 4096
  v_add_u32 v67, s30, v1
  global_load_dwordx4 a[16:19], v67, s[4:5] offset:0 sc1
  global_load_dwordx4 a[20:23], v67, s[4:5] offset:1024 sc1
  s_add_u32 s30, s27, 14336
  v_add_u32 v67, s30, v1
  global_load_dwordx4 a[56:59], v67, s[4:5] offset:0 sc1
  global_load_dwordx4 a[60:63], v67, s[4:5] offset:1024 sc1
  s_add_u32 s30, s27, 16384
  v_add_u32 v67, s30, v1
  global_load_dwordx4 a[64:67], v67, s[4:5] offset:0 sc1
  global_load_dwordx4 a[68:71], v67, s[4:5] offset:1024 sc1
  s_add_u32 s30, s27, 18432
  v_add_u32 v67, s30, v1
  global_load_dwordx4 a[72:75], v67, s[4:5] offset:0 sc1
  global_load_dwordx4 a[76:79], v67, s[4:5] offset:1024 sc1
  s_add_u32 s30, s27, 28672
  v_add_u32 v67, s30, v1
  global_load_dwordx4 a[112:115], v67, s[4:5] offset:0 sc1
  global_load_dwordx4 a[116:119], v67, s[4:5] offset:1024 sc1
  s_add_u32 s30, s27, 30720
  v_add_u32 v67, s30, v1
  global_load_dwordx4 a[120:123], v67, s[4:5] offset:0 sc1
  global_load_dwordx4 a[124:127], v67, s[4:5] offset:1024 sc1
  s_add_u32 s30, s27, 32768
  v_add_u32 v67, s30, v1
  global_load_dwordx4 a[128:131], v67, s[4:5] offset:0 sc1
  global_load_dwordx4 a[132:135], v67, s[4:5] offset:1024 sc1
  s_add_u32 s30, s27, 43008
  v_add_u32 v67, s30, v1
  global_load_dwordx4 a[168:171], v67, s[4:5] offset:0 sc1
  global_load_dwordx4 a[172:175], v67, s[4:5] offset:1024 sc1
  s_add_u32 s30, s27, 45056
  v_add_u32 v67, s30, v1
  global_load_dwordx4 a[176:179], v67, s[4:5] offset:0 sc1
  global_load_dwordx4 a[180:183], v67, s[4:5] offset:1024 sc1
  s_add_u32 s30, s27, 47104
  v_add_u32 v67, s30, v1
  global_load_dwordx4 a[184:187], v67, s[4:5] offset:0 sc1
  global_load_dwordx4 a[188:191], v67, s[4:5] offset:1024 sc1
  s_add_u32 s30, s27, 59392
  v_add_u32 v67, s30, v1
  global_load_dwordx4 a[232:235], v67, s[4:5] offset:0 sc1
  global_load_dwordx4 a[236:239], v67, s[4:5] offset:1024 sc1
  s_add_u32 s30, s27, 61440
  v_add_u32 v67, s30, v1
  global_load_dwordx4 a[240:243], v67, s[4:5] offset:0 sc1
  global_load_dwordx4 a[244:247], v67, s[4:5] offset:1024 sc1
  s_add_u32 s30, s27, 63488
  v_add_u32 v67, s30, v1
  global_load_dwordx4 a[248:251], v67, s[4:5] offset:0 sc1
  global_load_dwordx4 a[252:255], v67, s[4:5] offset:1024 sc1
  s_add_u32 s30, s27, 73728
  v_add_u32 v67, s30, v1
  global_load_dwordx4 v[152:155], v67, s[4:5] offset:0 sc1
  global_load_dwordx4 v[156:159], v67, s[4:5] offset:1024 sc1
  s_add_u32 s30, s27, 75776
  v_add_u32 v67, s30, v1
  global_load_dwordx4 v[160:163], v67, s[4:5] offset:0 sc1
  global_load_dwordx4 v[164:167], v67, s[4:5] offset:1024 sc1
  s_add_u32 s30, s27, 77824
  v_add_u32 v67, s30, v1
  global_load_dwordx4 v[168:171], v67, s[4:5] offset:0 sc1
  global_load_dwordx4 v[172:175], v67, s[4:5] offset:1024 sc1
  s_add_u32 s30, s27, 88064
  v_add_u32 v67, s30, v1
  global_load_dwordx4 v[208:211], v67, s[4:5] offset:0 sc1
  global_load_dwordx4 v[212:215], v67, s[4:5] offset:1024 sc1
  s_add_u32 s30, s27, 90112
  v_add_u32 v67, s30, v1
  global_load_dwordx4 v[216:219], v67, s[4:5] offset:0 sc1
  global_load_dwordx4 v[220:223], v67, s[4:5] offset:1024 sc1
  s_add_u32 s30, s27, 92160
  v_add_u32 v67, s30, v1
  global_load_dwordx4 v[224:227], v67, s[4:5] offset:0 sc1
  global_load_dwordx4 v[228:231], v67, s[4:5] offset:1024 sc1
  s_branch mk_c_wld0
mk_c_wl01:
  s_cmp_lg_u32 s22, 1
  s_cbranch_scc1 mk_c_wl02
  s_add_u32 s30, s27, 2048
  v_add_u32 v67, s30, v1
  global_load_dwordx4 a[8:11], v67, s[4:5] offset:0 sc1
  global_load_dwordx4 a[12:15], v67, s[4:5] offset:1024 sc1
  s_add_u32 s30, s27, 4096
  v_add_u32 v67, s30, v1
  global_load_dwordx4 a[16:19], v67, s[4:5] offset:0 sc1
  global_load_dwordx4 a[20:23], v67, s[4:5] offset:1024 sc1
  s_add_u32 s30, s27, 6144
  v_add_u32 v67, s30, v1
  global_load_dwordx4 a[24:27], v67, s[4:5] offset:0 sc1
  global_load_dwordx4 a[28:31], v67, s[4:5] offset:1024 sc1
  s_add_u32 s30, s27, 18432
  v_add_u32 v67, s30, v1
  global_load_dwordx4 a[72:75], v67, s[4:5] offset:0 sc1
  global_load_dwordx4 a[76:79], v67, s[4:5] offset:1024 sc1
  s_add_u32 s30, s27, 20480
  v_add_u32 v67, s30, v1
  global_load_dwordx4 a[80:83], v67, s[4:5] offset:0 sc1
  global_load_dwordx4 a[84:87], v67, s[4:5] offset:1024 sc1
  s_add_u32 s30, s27, 22528
  v_add_u32 v67, s30, v1
  global_load_dwordx4 a[88:91], v67, s[4:5] offset:0 sc1
  global_load_dwordx4 a[92:95], v67, s[4:5] offset:1024 sc1
  s_add_u32 s30, s27, 32768
  v_add_u32 v67, s30, v1
  global_load_dwordx4 a[128:131], v67, s[4:5] offset:0 sc1
  global_load_dwordx4 a[132:135], v67, s[4:5] offset:1024 sc1
  s_add_u32 s30, s27, 34816
  v_add_u32 v67, s30, v1
  global_load_dwordx4 a[136:139], v67, s[4:5] offset:0 sc1
  global_load_dwordx4 a[140:143], v67, s[4:5] offset:1024 sc1
  s_add_u32 s30, s27, 36864
  v_add_u32 v67, s30, v1
  global_load_dwordx4 a[144:147], v67, s[4:5] offset:0 sc1
  global_load_dwordx4 a[148:151], v67, s[4:5] offset:1024 sc1
  s_add_u32 s30, s27, 47104
  v_add_u32 v67, s30, v1
  global_load_dwordx4 a[184:187], v67, s[4:5] offset:0 sc1
  global_load_dwordx4 a[188:191], v67, s[4:5] offset:1024 sc1
  s_add_u32 s30, s27, 49152
  v_add_u32 v67, s30, v1
  global_load_dwordx4 a[192:195], v67, s[4:5] offset:0 sc1
  global_load_dwordx4 a[196:199], v67, s[4:5] offset:1024 sc1
  s_add_u32 s30, s27, 51200
  v_add_u32 v67, s30, v1
  global_load_dwordx4 a[200:203], v67, s[4:5] offset:0 sc1
  global_load_dwordx4 a[204:207], v67, s[4:5] offset:1024 sc1
  s_add_u32 s30, s27, 61440
  v_add_u32 v67, s30, v1
  global_load_dwordx4 a[240:243], v67, s[4:5] offset:0 sc1
  global_load_dwordx4 a[244:247], v67, s[4:5] offset:1024 sc1
  s_add_u32 s30, s27, 63488
  v_add_u32 v67, s30, v1
  global_load_dwordx4 a[248:251], v67, s[4:5] offset:0 sc1
  global_load_dwordx4 a[252:255], v67, s[4:5] offset:1024 sc1
  s_add_u32 s30, s27, 65536
  v_add_u32 v67, s30, v1
  global_load_dwordx4 v[120:123], v67, s[4:5] offset:0 sc1
  global_load_dwordx4 v[124:127], v67, s[4:5] offset:1024 sc1
  s_add_u32 s30, s27, 77824
  v_add_u32 v67, s30, v1
  global_load_dwordx4 v[168:171], v67, s[4:5] offset:0 sc1
  global_load_dwordx4 v[172:175], v67, s[4:5] offset:1024 sc1
  s_add_u32 s30, s27, 79872
  v_add_u32 v67, s30, v1
  global_load_dwordx4 v[176:179], v67, s[4:5] offset:0 sc1
  global_load_dwordx4 v[180:183], v67, s[4:5] offset:1024 sc1
  s_add_u32 s30, s27, 81920
  v_add_u32 v67, s30, v1
  global_load_dwordx4 v[184:187], v67, s[4:5] offset:0 sc1
  global_load_dwordx4 v[188:191], v67, s[4:5] offset:1024 sc1
  s_add_u32 s30, s27, 92160
  v_add_u32 v67, s30, v1
  global_load_dwordx4 v[224:227], v67, s[4:5] offset:0 sc1
  global_load_dwordx4 v[228:231], v67, s[4:5] offset:1024 sc1
  s_add_u32 s30, s27, 94208
  v_add_u32 v67, s30, v1
  global_load_dwordx4 v[232:235], v67, s[4:5] offset:0 sc1
  global_load_dwordx4 v[236:239], v67, s[4:5] offset:1024 sc1
  s_add_u32 s30, s27, 96256
  v_add_u32 v67, s30, v1
  global_load_dwordx4 v[240:243], v67, s[4:5] offset:0 sc1
  global_load_dwordx4 v[244:247], v67, s[4:5] offset:1024 sc1
  s_branch mk_c_wld0
mk_c_wl02:
  s_cmp_lg_u32 s22, 2
  s_cbranch_scc1 mk_c_wl03
  s_add_u32 s30, s27, 6144
  v_add_u32 v67, s30, v1
  global_load_dwordx4 a[24:27], v67, s[4:5] offset:0 sc1
  global_load_dwordx4 a[28:31], v67, s[4:5] offset:1024 sc1
  s_add_u32 s30, s27, 8192
  v_add_u32 v67, s30, v1
  global_load_dwordx4 a[32:35], v67, s[4:5] offset:0 sc1
  global_load_dwordx4 a[36:39], v67, s[4:5] offset:1024 sc1
  s_add_u32 s30, s27, 10240
  v_add_u32 v67, s30, v1
  global_load_dwordx4 a[40:43], v67, s[4:5] offset:0 sc1
  global_load_dwordx4 a[44:47], v67, s[4:5] offset:1024 sc1
  s_add_u32 s30, s27, 20480
  v_add_u32 v67, s30, v1
  global_load_dwordx4 a[80:83], v67, s[4:5] offset:0 sc1
  global_load_dwordx4 a[84:87], v67, s[4:5] offset:1024 sc1
  s_add_u32 s30, s27, 22528
  v_add_u32 v67, s30, v1
  global_load_dwordx4 a[88:91], v67, s[4:5] offset:0 sc1
  global_load_dwordx4 a[92:95], v67, s[4:5] offset:1024 sc1
  s_add_u32 s30, s27, 24576
  v_add_u32 v67, s30, v1
  global_load_dwordx4 a[96:99], v67, s[4:5] offset:0 sc1
  global_load_dwordx4 a[100:103], v67, s[4:5] offset:1024 sc1
  s_add_u32 s30, s27, 36864
  v_add_u32 v67, s30, v1
  global_load_dwordx4 a[144:147], v67, s[4:5] offset:0 sc1
  global_load_dwordx4 a[148:151], v67, s[4:5] offset:1024 sc1
  s_add_u32 s30, s27, 38912
  v_add_u32 v67, s30, v1
  global_load_dwordx4 a[152:155], v67, s[4:5] offset:0 sc1
  global_load_dwordx4 a[156:159], v67, s[4:5] offset:1024 sc1
  s_add_u32 s30, s27, 40960
  v_add_u32 v67, s30, v1
  global_load_dwordx4 a[160:163], v67, s[4:5] offset:0 sc1
  global_load_dwordx4 a[164:167], v67, s[4:5] offset:1024 sc1
  s_add_u32 s30, s27, 51200
  v_add_u32 v67, s30, v1
  global_load_dwordx4 a[200:203], v67, s[4:5] offset:0 sc1
  global_load_dwordx4 a[204:207], v67, s[4:5] offset:1024 sc1
  s_add_u32 s30, s27, 53248
  v_add_u32 v67, s30, v1
  global_load_dwordx4 a[208:211], v67, s[4:5] offset:0 sc1
  global_load_dwordx4 a[212:215], v67, s[4:5] offset:1024 sc1
  s_add_u32 s30, s27, 55296
  v_add_u32 v67, s30, v1
  global_load_dwordx4 a[216:219], v67, s[4:5] offset:0 sc1
  global_load_dwordx4 a[220:223], v67, s[4:5] offset:1024 sc1
  s_add_u32 s30, s27, 65536
  v_add_u32 v67, s30, v1
  global_load_dwordx4 v[120:123], v67, s[4:5] offset:0 sc1
  global_load_dwordx4 v[124:127], v67, s[4:5] offset:1024 sc1
  s_add_u32 s30, s27, 67584
  v_add_u32 v67, s30, v1
  global_load_dwordx4 v[128:131], v67, s[4:5] offset:0 sc1
  global_load_dwordx4 v[132:135], v67, s[4:5] offset:1024 sc1
  s_add_u32 s30, s27, 69632
  v_add_u32 v67, s30, v1
  global_load_dwordx4 v[136:139], v67, s[4:5] offset:0 sc1
  global_load_dwordx4 v[140:143], v67, s[4:5] offset:1024 sc1
  s_add_u32 s30, s27, 79872
  v_add_u32 v67, s30, v1
  global_load_dwordx4 v[176:179], v67, s[4:5] offset:0 sc1
  global_load_dwordx4 v[180:183], v67, s[4:5] offset:1024 sc1
  s_add_u32 s30, s27, 81920
  v_add_u32 v67, s30, v1
  global_load_dwordx4 v[184:187], v67, s[4:5] offset:0 sc1
  global_load_dwordx4 v[188:191], v67, s[4:5] offset:1024 sc1
  s_add_u32 s30, s27, 83968
  v_add_u32 v67, s30, v1
  global_load_dwordx4 v[192:195], v67, s[4:5] offset:0 sc1
  global_load_dwordx4 v[196:199], v67, s[4:5] offset:1024 sc1
  s_add_u32 s30, s27, 86016
  v_add_u32 v67, s30, v1
  global_load_dwordx4 v[200:203], v67, s[4:5] offset:0 sc1
  global_load_dwordx4 v[204:207], v67, s[4:5] offset:1024 sc1
  s_add_u32 s30, s27, 96256
  v_add_u32 v67, s30, v1
  global_load_dwordx4 v[240:243], v67, s[4:5] offset:0 sc1
  global_load_dwordx4 v[244:247], v67, s[4:5] offset:1024 sc1
  s_add_u32 s30, s27, 98304
  v_add_u32 v67, s30, v1
  global_load_dwordx4 v[248:251], v67, s[4:5] offset:0 sc1
  global_load_dwordx4 v[252:255], v67, s[4:5] offset:1024 sc1
  s_branch mk_c_wld0
mk_c_wl03:
  s_add_u32 s30, s27, 0
  v_add_u32 v67, s30, v1
  global_load_dwordx4 a[0:3], v67, s[4:5] offset:0 sc1
  global_load_dwordx4 a[4:7], v67, s[4:5] offset:1024 sc1
  s_add_u32 s30, s27, 10240
  v_add_u32 v67, s30, v1
  global_load_dwordx4 a[40:43], v67, s[4:5] offset:0 sc1
  global_load_dwordx4 a[44:47], v67, s[4:5] offset:1024 sc1
  s_add_u32 s30, s27, 12288
  v_add_u32 v67, s30, v1
  global_load_dwordx4 a[48:51], v67, s[4:5] offset:0 sc1
  global_load_dwordx4 a[52:55], v67, s[4:5] offset:1024 sc1
  s_add_u32 s30, s27, 14336
  v_add_u32 v67, s30, v1
  global_load_dwordx4 a[56:59], v67, s[4:5] offset:0 sc1
  global_load_dwordx4 a[60:63], v67, s[4:5] offset:1024 sc1
  s_add_u32 s30, s27, 24576
  v_add_u32 v67, s30, v1
  global_load_dwordx4 a[96:99], v67, s[4:5] offset:0 sc1
  global_load_dwordx4 a[100:103], v67, s[4:5] offset:1024 sc1
  s_add_u32 s30, s27, 26624
  v_add_u32 v67, s30, v1
  global_load_dwordx4 a[104:107], v67, s[4:5] offset:0 sc1
  global_load_dwordx4 a[108:111], v67, s[4:5] offset:1024 sc1
  s_add_u32 s30, s27, 28672
  v_add_u32 v67, s30, v1
  global_load_dwordx4 a[112:115], v67, s[4:5] offset:0 sc1
  global_load_dwordx4 a[116:119], v67, s[4:5] offset:1024 sc1
  s_add_u32 s30, s27, 38912
  v_add_u32 v67, s30, v1
  global_load_dwordx4 a[152:155], v67, s[4:5] offset:0 sc1
  global_load_dwordx4 a[156:159], v67, s[4:5] offset:1024 sc1
  s_add_u32 s30, s27, 40960
  v_add_u32 v67, s30, v1
  global_load_dwordx4 a[160:163], v67, s[4:5] offset:0 sc1
  global_load_dwordx4 a[164:167], v67, s[4:5] offset:1024 sc1
  s_add_u32 s30, s27, 43008
  v_add_u32 v67, s30, v1
  global_load_dwordx4 a[168:171], v67, s[4:5] offset:0 sc1
  global_load_dwordx4 a[172:175], v67, s[4:5] offset:1024 sc1
  s_add_u32 s30, s27, 45056
  v_add_u32 v67, s30, v1
  global_load_dwordx4 a[176:179], v67, s[4:5] offset:0 sc1
  global_load_dwordx4 a[180:183], v67, s[4:5] offset:1024 sc1
  s_add_u32 s30, s27, 55296
  v_add_u32 v67, s30, v1
  global_load_dwordx4 a[216:219], v67, s[4:5] offset:0 sc1
  global_load_dwordx4 a[220:223], v67, s[4:5] offset:1024 sc1
  s_add_u32 s30, s27, 57344
  v_add_u32 v67, s30, v1
  global_load_dwordx4 a[224:227], v67, s[4:5] offset:0 sc1
  global_load_dwordx4 a[228:231], v67, s[4:5] offset:1024 sc1
  s_add_u32 s30, s27, 59392
  v_add_u32 v67, s30, v1
  global_load_dwordx4 a[232:235], v67, s[4:5] offset:0 sc1
  global_load_dwordx4 a[236:239], v67, s[4:5] offset:1024 sc1
  s_add_u32 s30, s27, 69632
  v_add_u32 v67, s30, v1
  global_load_dwordx4 v[136:139], v67, s[4:5] offset:0 sc1
  global_load_dwordx4 v[140:143], v67, s[4:5] offset:1024 sc1
  s_add_u32 s30, s27, 71680
  v_add_u32 v67, s30, v1
  global_load_dwordx4 v[144:147], v67, s[4:5] offset:0 sc1
  global_load_dwordx4 v[148:151], v67, s[4:5] offset:1024 sc1
  s_add_u32 s30, s27, 73728
  v_add_u32 v67, s30, v1
  global_load_dwordx4 v[152:155], v67, s[4:5] offset:0 sc1
  global_load_dwordx4 v[156:159], v67, s[4:5] offset:1024 sc1
  s_add_u32 s30, s27, 83968
  v_add_u32 v67, s30, v1
  global_load_dwordx4 v[192:195], v67, s[4:5] offset:0 sc1
  global_load_dwordx4 v[196:199], v67, s[4:5] offset:1024 sc1
  s_add_u32 s30, s27, 86016
  v_add_u32 v67, s30, v1
  global_load_dwordx4 v[200:203], v67, s[4:5] offset:0 sc1
  global_load_dwordx4 v[204:207], v67, s[4:5] offset:1024 sc1
  s_add_u32 s30, s27, 88064
  v_add_u32 v67, s30, v1
  global_load_dwordx4 v[208:211], v67, s[4:5] offset:0 sc1
  global_load_dwordx4 v[212:215], v67, s[4:5] offset:1024 sc1
  s_add_u32 s30, s27, 98304
  v_add_u32 v67, s30, v1
  global_load_dwordx4 v[248:251], v67, s[4:5] offset:0 sc1
  global_load_dwordx4 v[252:255], v67, s[4:5] offset:1024 sc1
mk_c_wld0:
  v_and_b32 v69, 3, v68
  v_add_u32 v69, 1024, v69
  v_cmp_lt_u32 vcc, 15, v68
  s_nop 1
  v_cndmask_b32 v69, v64, v69, vcc
  v_lshlrev_b32 v65, 2, v69
  v_add_u32 v65, 14942208, v65
mk_c_wf_20:
  global_load_dword v66, v65, s[4:5] offset:0 sc1
  s_waitcnt vmcnt(0)
  v_xor_b32 v66, s20, v66
  v_cmp_ne_u32 vcc, 0, v66
  s_cbranch_vccz mk_c_wd_21
  s_sleep 3
  s_sub_u32 s40, s40, 1
  s_cbranch_scc0 mk_c_wf_20
  s_mov_b32 s40, 0
mk_c_wd_21:
  s_cmp_lg_u32 s22, 0
  s_cbranch_scc1 mk_c_wl11
  s_add_u32 s30, s27, 6144
  v_add_u32 v67, s30, v1
  global_load_dwordx4 a[24:27], v67, s[4:5] offset:0 sc1
  global_load_dwordx4 a[28:31], v67, s[4:5] offset:1024 sc1
  s_add_u32 s30, s27, 8192
  v_add_u32 v67, s30, v1
  global_load_dwordx4 a[32:35], v67, s[4:5] offset:0 sc1
  global_load_dwordx4 a[36:39], v67, s[4:5] offset:1024 sc1
  s_add_u32 s30, s27, 10240
  v_add_u32 v67, s30, v1
  global_load_dwordx4 a[40:43], v67, s[4:5] offset:0 sc1
  global_load_dwordx4 a[44:47], v67, s[4:5] offset:1024 sc1
  s_add_u32 s30, s27, 12288
  v_add_u32 v67, s30, v1
  global_load_dwordx4 a[48:51], v67, s[4:5] offset:0 sc1
  global_load_dwordx4 a[52:55], v67, s[4:5] offset:1024 sc1
  s_add_u32 s30, s27, 20480
  v_add_u32 v67, s30, v1
  global_load_dwordx4 a[80:83], v67, s[4:5] offset:0 sc1
  global_load_dwordx4 a[84:87], v67, s[4:5] offset:1024 sc1
  s_add_u32 s30, s27, 22528
  v_add_u32 v67, s30, v1
  global_load_dwordx4 a[88:91], v67, s[4:5] offset:0 sc1
  global_load_dwordx4 a[92:95], v67, s[4:5] offset:1024 sc1
  s_add_u32 s30, s27, 24576
  v_add_u32 v67, s30, v1
  global_load_dwordx4 a[96:99], v67, s[4:5] offset:0 sc1
  global_load_dwordx4 a[100:103], v67, s[4:5] offset:1024 sc1
  s_add_u32 s30, s27, 26624
  v_add_u32 v67, s30, v1
  global_load_dwordx4 a[104:107], v67, s[4:5] offset:0 sc1
  global_load_dwordx4 a[108:111], v67, s[4:5] offset:1024 sc1
  s_add_u32 s30, s27, 34816
  v_add_u32 v67, s30, v1
  global_load_dwordx4 a[136:139], v67, s[4:5] offset:0 sc1
  global_load_dwordx4 a[140:143], v67, s[4:5] offset:1024 sc1
  s_add_u32 s30, s27, 36864
  v_add_u32 v67, s30, v1
  global_load_dwordx4 a[144:147], v67, s[4:5] offset:0 sc1
  global_load_dwordx4 a[148:151], v67, s[4:5] offset:1024 sc1
  s_add_u32 s30, s27, 38912
  v_add_u32 v67, s30, v1
  global_load_dwordx4 a[152:155], v67, s[4:5] offset:0 sc1
  global_load_dwordx4 a[156:159], v67, s[4:5] offset:1024 sc1
  s_add_u32 s30, s27, 40960
  v_add_u32 v67, s30, v1
  global_load_dwordx4 a[160:163], v67, s[4:5] offset:0 sc1
  global_load_dwordx4 a[164:167], v67, s[4:5] offset:1024 sc1
  s_add_u32 s30, s27, 49152
  v_add_u32 v67, s30, v1
  global_load_dwordx4 a[192:195], v67, s[4:5] offset:0 sc1
  global_load_dwordx4 a[196:199], v67, s[4:5] offset:1024 sc1
  s_add_u32 s30, s27, 51200
  v_add_u32 v67, s30, v1
  global_load_dwordx4 a[200:203], v67, s[4:5] offset:0 sc1
  global_load_dwordx4 a[204:207], v67, s[4:5] offset:1024 sc1
  s_add_u32 s30, s27, 53248
  v_add_u32 v67, s30, v1
  global_load_dwordx4 a[208:211], v67, s[4:5] offset:0 sc1
  global_load_dwordx4 a[212:215], v67, s[4:5] offset:1024 sc1
  s_add_u32 s30, s27, 55296
  v_add_u32 v67, s30, v1
  global_load_dwordx4 a[216:219], v67, s[4:5] offset:0 sc1
  global_load_dwordx4 a[220:223], v67, s[4:5] offset:1024 sc1
  s_add_u32 s30, s27, 57344
  v_add_u32 v67, s30, v1
  global_load_dwordx4 a[224:227], v67, s[4:5] offset:0 sc1
  global_load_dwordx4 a[228:231], v67, s[4:5] offset:1024 sc1
  s_add_u32 s30, s27, 65536
  v_add_u32 v67, s30, v1
  global_load_dwordx4 v[120:123], v67, s[4:5] offset:0 sc1
  global_load_dwordx4 v[124:127], v67, s[4:5] offset:1024 sc1
  s_add_u32 s30, s27, 67584
  v_add_u32 v67, s30, v1
  global_load_dwordx4 v[128:131], v67, s[4:5] offset:0 sc1
  global_load_dwordx4 v[132:135], v67, s[4:5] offset:1024 sc1
  s_add_u32 s30, s27, 69632
  v_add_u32 v67, s30, v1
  global_load_dwordx4 v[136:139], v67, s[4:5] offset:0 sc1
  global_load_dwordx4 v[140:143], v67, s[4:5] offset:1024 sc1
  s_add_u32 s30, s27, 71680
  v_add_u32 v67, s30, v1
  global_load_dwordx4 v[144:147], v67, s[4:5] offset:0 sc1
  global_load_dwordx4 v[148:151], v67, s[4:5] offset:1024 sc1
  s_add_u32 s30, s27, 79872
  v_add_u32 v67, s30, v1
  global_load_dwordx4 v[176:179], v67, s[4:5] offset:0 sc1
  global_load_dwordx4 v[180:183], v67, s[4:5] offset:1024 sc1
  s_add_u32 s30, s27, 81920
  v_add_u32 v67, s30, v1
  global_load_dwordx4 v[184:187], v67, s[4:5] offset:0 sc1
  global_load_dwordx4 v[188:191], v67, s[4:5] offset:1024 sc1
  s_add_u32 s30, s27, 83968
  v_add_u32 v67, s30, v1
  global_load_dwordx4 v[192:195], v67, s[4:5] offset:0 sc1
  global_load_dwordx4 v[196:199], v67, s[4:5] offset:1024 sc1
  s_add_u32 s30, s27, 86016
  v_add_u32 v67, s30, v1
  global_load_dwordx4 v[200:203], v67, s[4:5] offset:0 sc1
  global_load_dwordx4 v[204:207], v67, s[4:5] offset:1024 sc1
  s_add_u32 s30, s27, 94208
  v_add_u32 v67, s30, v1
  global_load_dwordx4 v[232:235], v67, s[4:5] offset:0 sc1
  global_load_dwordx4 v[236:239], v67, s[4:5] offset:1024 sc1
  s_add_u32 s30, s27, 96256
  v_add_u32 v67, s30, v1
  global_load_dwordx4 v[240:243], v67, s[4:5] offset:0 sc1
  global_load_dwordx4 v[244:247], v67, s[4:5] offset:1024 sc1
  s_add_u32 s30, s27, 98304
  v_add_u32 v67, s30, v1
  global_load_dwordx4 v[248:251], v67, s[4:5] offset:0 sc1
  global_load_dwordx4 v[252:255], v67, s[4:5] offset:1024 sc1
  s_branch mk_c_wld1
mk_c_wl11:
  s_cmp_lg_u32 s22, 1
  s_cbranch_scc1 mk_c_wl12
  s_add_u32 s30, s27, 0
  v_add_u32 v67, s30, v1
  global_load_dwordx4 a[0:3], v67, s[4:5] offset:0 sc1
  global_load_dwordx4 a[4:7], v67, s[4:5] offset:1024 sc1
  s_add_u32 s30, s27, 8192
  v_add_u32 v67, s30, v1
  global_load_dwordx4 a[32:35], v67, s[4:5] offset:0 sc1
  global_load_dwordx4 a[36:39], v67, s[4:5] offset:1024 sc1
  s_add_u32 s30, s27, 10240
  v_add_u32 v67, s30, v1
  global_load_dwordx4 a[40:43], v67, s[4:5] offset:0 sc1
  global_load_dwordx4 a[44:47], v67, s[4:5] offset:1024 sc1
  s_add_u32 s30, s27, 12288
  v_add_u32 v67, s30, v1
  global_load_dwordx4 a[48:51], v67, s[4:5] offset:0 sc1
  global_load_dwordx4 a[52:55], v67, s[4:5] offset:1024 sc1
  s_add_u32 s30, s27, 14336
  v_add_u32 v67, s30, v1
  global_load_dwordx4 a[56:59], v67, s[4:5] offset:0 sc1
  global_load_dwordx4 a[60:63], v67, s[4:5] offset:1024 sc1
  s_add_u32 s30, s27, 16384
  v_add_u32 v67, s30, v1
  global_load_dwordx4 a[64:67], v67, s[4:5] offset:0 sc1
  global_load_dwordx4 a[68:71], v67, s[4:5] offset:1024 sc1
  s_add_u32 s30, s27, 24576
  v_add_u32 v67, s30, v1
  global_load_dwordx4 a[96:99], v67, s[4:5] offset:0 sc1
  global_load_dwordx4 a[100:103], v67, s[4:5] offset:1024 sc1
  s_add_u32 s30, s27, 26624
  v_add_u32 v67, s30, v1
  global_load_dwordx4 a[104:107], v67, s[4:5] offset:0 sc1
  global_load_dwordx4 a[108:111], v67, s[4:5] offset:1024 sc1
  s_add_u32 s30, s27, 28672
  v_add_u32 v67, s30, v1
  global_load_dwordx4 a[112:115], v67, s[4:5] offset:0 sc1
  global_load_dwordx4 a[116:119], v67, s[4:5] offset:1024 sc1
  s_add_u32 s30, s27, 30720
  v_add_u32 v67, s30, v1
  global_load_dwordx4 a[120:123], v67, s[4:5] offset:0 sc1
  global_load_dwordx4 a[124:127], v67, s[4:5] offset:1024 sc1
  s_add_u32 s30, s27, 38912
  v_add_u32 v67, s30, v1
  global_load_dwordx4 a[152:155], v67, s[4:5] offset:0 sc1
  global_load_dwordx4 a[156:159], v67, s[4:5] offset:1024 sc1
  s_add_u32 s30, s27, 40960
  v_add_u32 v67, s30, v1
  global_load_dwordx4 a[160:163], v67, s[4:5] offset:0 sc1
  global_load_dwordx4 a[164:167], v67, s[4:5] offset:1024 sc1
  s_add_u32 s30, s27, 43008
  v_add_u32 v67, s30, v1
  global_load_dwordx4 a[168:171], v67, s[4:5] offset:0 sc1
  global_load_dwordx4 a[172:175], v67, s[4:5] offset:1024 sc1
  s_add_u32 s30, s27, 45056
  v_add_u32 v67, s30, v1
  global_load_dwordx4 a[176:179], v67, s[4:5] offset:0 sc1
  global_load_dwordx4 a[180:183], v67, s[4:5] offset:1024 sc1
  s_add_u32 s30, s27, 53248
  v_add_u32 v67, s30, v1
  global_load_dwordx4 a[208:211], v67, s[4:5] offset:0 sc1
  global_load_dwordx4 a[212:215], v67, s[4:5] offset:1024 sc1
  s_add_u32 s30, s27, 55296
  v_add_u32 v67, s30, v1
  global_load_dwordx4 a[216:219], v67, s[4:5] offset:0 sc1
  global_load_dwordx4 a[220:223], v67, s[4:5] offset:1024 sc1
  s_add_u32 s30, s27, 57344
  v_add_u32 v67, s30, v1
  global_load_dwordx4 a[224:227], v67, s[4:5] offset:0 sc1
  global_load_dwordx4 a[228:231], v67, s[4:5] offset:1024 sc1
  s_add_u32 s30, s27, 59392
  v_add_u32 v67, s30, v1
  global_load_dwordx4 a[232:235], v67, s[4:5] offset:0 sc1
  global_load_dwordx4 a[236:239], v67, s[4:5] offset:1024 sc1
  s_add_u32 s30, s27, 67584
  v_add_u32 v67, s30, v1
  global_load_dwordx4 v[128:131], v67, s[4:5] offset:0 sc1
  global_load_dwordx4 v[132:135], v67, s[4:5] offset:1024 sc1
  s_add_u32 s30, s27, 69632
  v_add_u32 v67, s30, v1
  global_load_dwordx4 v[136:139], v67, s[4:5] offset:0 sc1
  global_load_dwordx4 v[140:143], v67, s[4:5] offset:1024 sc1
  s_add_u32 s30, s27, 71680
  v_add_u32 v67, s30, v1
  global_load_dwordx4 v[144:147], v67, s[4:5] offset:0 sc1
  global_load_dwordx4 v[148:151], v67, s[4:5] offset:1024 sc1
  s_add_u32 s30, s27, 73728
  v_add_u32 v67, s30, v1
  global_load_dwordx4 v[152:155], v67, s[4:5] offset:0 sc1
  global_load_dwordx4 v[156:159], v67, s[4:5] offset:1024 sc1
  s_add_u32 s30, s27, 75776
  v_add_u32 v67, s30, v1
  global_load_dwordx4 v[160:163], v67, s[4:5] offset:0 sc1
  global_load_dwordx4 v[164:167], v67, s[4:5] offset:1024 sc1
  s_add_u32 s30, s27, 83968
  v_add_u32 v67, s30, v1
  global_load_dwordx4 v[192:195], v67, s[4:5] offset:0 sc1
  global_load_dwordx4 v[196:199], v67, s[4:5] offset:1024 sc1
  s_add_u32 s30, s27, 86016
  v_add_u32 v67, s30, v1
  global_load_dwordx4 v[200:203], v67, s[4:5] offset:0 sc1
  global_load_dwordx4 v[204:207], v67, s[4:5] offset:1024 sc1
  s_add_u32 s30, s27, 88064
  v_add_u32 v67, s30, v1
  global_load_dwordx4 v[208:211], v67, s[4:5] offset:0 sc1
  global_load_dwordx4 v[212:215], v67, s[4:5] offset:1024 sc1
  s_add_u32 s30, s27, 90112
  v_add_u32 v67, s30, v1
  global_load_dwordx4 v[216:219], v67, s[4:5] offset:0 sc1
  global_load_dwordx4 v[220:223], v67, s[4:5] offset:1024 sc1
  s_add_u32 s30, s27, 98304
  v_add_u32 v67, s30, v1
  global_load_dwordx4 v[248:251], v67, s[4:5] offset:0 sc1
  global_load_dwordx4 v[252:255], v67, s[4:5] offset:1024 sc1
  s_branch mk_c_wld1
mk_c_wl12:
  s_cmp_lg_u32 s22, 2
  s_cbranch_scc1 mk_c_wl13
  s_add_u32 s30, s27, 0
  v_add_u32 v67, s30, v1
  global_load_dwordx4 a[0:3], v67, s[4:5] offset:0 sc1
  global_load_dwordx4 a[4:7], v67, s[4:5] offset:1024 sc1
  s_add_u32 s30, s27, 2048
  v_add_u32 v67, s30, v1
  global_load_dwordx4 a[8:11], v67, s[4:5] offset:0 sc1
  global_load_dwordx4 a[12:15], v67, s[4:5] offset:1024 sc1
  s_add_u32 s30, s27, 4096
  v_add_u32 v67, s30, v1
  global_load_dwordx4 a[16:19], v67, s[4:5] offset:0 sc1
  global_load_dwordx4 a[20:23], v67, s[4:5] offset:1024 sc1
  s_add_u32 s30, s27, 12288
  v_add_u32 v67, s30, v1
  global_load_dwordx4 a[48:51], v67, s[4:5] offset:0 sc1
  global_load_dwordx4 a[52:55], v67, s[4:5] offset:1024 sc1
  s_add_u32 s30, s27, 14336
  v_add_u32 v67, s30, v1
  global_load_dwordx4 a[56:59], v67, s[4:5] offset:0 sc1
  global_load_dwordx4 a[60:63], v67, s[4:5] offset:1024 sc1
  s_add_u32 s30, s27, 16384
  v_add_u32 v67, s30, v1
  global_load_dwordx4 a[64:67], v67, s[4:5] offset:0 sc1
  global_load_dwordx4 a[68:71], v67, s[4:5] offset:1024 sc1
  s_add_u32 s30, s27, 18432
  v_add_u32 v67, s30, v1
  global_load_dwordx4 a[72:75], v67, s[4:5] offset:0 sc1
  global_load_dwordx4 a[76:79], v67, s[4:5] offset:1024 sc1
  s_add_u32 s30, s27, 26624
  v_add_u32 v67, s30, v1
  global_load_dwordx4 a[104:107], v67, s[4:5] offset:0 sc1
  global_load_dwordx4 a[108:111], v67, s[4:5] offset:1024 sc1
  s_add_u32 s30, s27, 28672
  v_add_u32 v67, s30, v1
  global_load_dwordx4 a[112:115], v67, s[4:5] offset:0 sc1
  global_load_dwordx4 a[116:119], v67, s[4:5] offset:1024 sc1
  s_add_u32 s30, s27, 30720
  v_add_u32 v67, s30, v1
  global_load_dwordx4 a[120:123], v67, s[4:5] offset:0 sc1
  global_load_dwordx4 a[124:127], v67, s[4:5] offset:1024 sc1
  s_add_u32 s30, s27, 32768
  v_add_u32 v67, s30, v1
  global_load_dwordx4 a[128:131], v67, s[4:5] offset:0 sc1
  global_load_dwordx4 a[132:135], v67, s[4:5] offset:1024 sc1
  s_add_u32 s30, s27, 34816
  v_add_u32 v67, s30, v1
  global_load_dwordx4 a[136:139], v67, s[4:5] offset:0 sc1
  global_load_dwordx4 a[140:143], v67, s[4:5] offset:1024 sc1
  s_add_u32 s30, s27, 43008
  v_add_u32 v67, s30, v1
  global_load_dwordx4 a[168:171], v67, s[4:5] offset:0 sc1
  global_load_dwordx4 a[172:175], v67, s[4:5] offset:1024 sc1
  s_add_u32 s30, s27, 45056
  v_add_u32 v67, s30, v1
  global_load_dwordx4 a[176:179], v67, s[4:5] offset:0 sc1
  global_load_dwordx4 a[180:183], v67, s[4:5] offset:1024 sc1
  s_add_u32 s30, s27, 47104
  v_add_u32 v67, s30, v1
  global_load_dwordx4 a[184:187], v67, s[4:5] offset:0 sc1
  global_load_dwordx4 a[188:191], v67, s[4:5] offset:1024 sc1
  s_add_u32 s30, s27, 49152
  v_add_u32 v67, s30, v1
  global_load_dwordx4 a[192:195], v67, s[4:5] offset:0 sc1
  global_load_dwordx4 a[196:199], v67, s[4:5] offset:1024 sc1
  s_add_u32 s30, s27, 57344
  v_add_u32 v67, s30, v1
  global_load_dwordx4 a[224:227], v67, s[4:5] offset:0 sc1
  global_load_dwordx4 a[228:231], v67, s[4:5] offset:1024 sc1
  s_add_u32 s30, s27, 59392
  v_add_u32 v67, s30, v1
  global_load_dwordx4 a[232:235], v67, s[4:5] offset:0 sc1
  global_load_dwordx4 a[236:239], v67, s[4:5] offset:1024 sc1
  s_add_u32 s30, s27, 61440
  v_add_u32 v67, s30, v1
  global_load_dwordx4 a[240:243], v67, s[4:5] offset:0 sc1
  global_load_dwordx4 a[244:247], v67, s[4:5] offset:1024 sc1
  s_add_u32 s30, s27, 63488
  v_add_u32 v67, s30, v1
  global_load_dwordx4 a[248:251], v67, s[4:5] offset:0 sc1
  global_load_dwordx4 a[252:255], v67, s[4:5] offset:1024 sc1
  s_add_u32 s30, s27, 71680
  v_add_u32 v67, s30, v1
  global_load_dwordx4 v[144:147], v67, s[4:5] offset:0 sc1
  global_load_dwordx4 v[148:151], v67, s[4:5] offset:1024 sc1
  s_add_u32 s30, s27, 73728
  v_add_u32 v67, s30, v1
  global_load_dwordx4 v[152:155], v67, s[4:5] offset:0 sc1
  global_load_dwordx4 v[156:159], v67, s[4:5] offset:1024 sc1
  s_add_u32 s30, s27, 75776
  v_add_u32 v67, s30, v1
  global_load_dwordx4 v[160:163], v67, s[4:5] offset:0 sc1
  global_load_dwordx4 v[164:167], v67, s[4:5] offset:1024 sc1
  s_add_u32 s30, s27, 77824
  v_add_u32 v67, s30, v1
  global_load_dwordx4 v[168:171], v67, s[4:5] offset:0 sc1
  global_load_dwordx4 v[172:175], v67, s[4:5] offset:1024 sc1
  s_add_u32 s30, s27, 88064
  v_add_u32 v67, s30, v1
  global_load_dwordx4 v[208:211], v67, s[4:5] offset:0 sc1
  global_load_dwordx4 v[212:215], v67, s[4:5] offset:1024 sc1
  s_add_u32 s30, s27, 90112
  v_add_u32 v67, s30, v1
  global_load_dwordx4 v[216:219], v67, s[4:5] offset:0 sc1
  global_load_dwordx4 v[220:223], v67, s[4:5] offset:1024 sc1
  s_add_u32 s30, s27, 92160
  v_add_u32 v67, s30, v1
  global_load_dwordx4 v[224:227], v67, s[4:5] offset:0 sc1
  global_load_dwordx4 v[228:231], v67, s[4:5] offset:1024 sc1
  s_add_u32 s30, s27, 94208
  v_add_u32 v67, s30, v1
  global_load_dwordx4 v[232:235], v67, s[4:5] offset:0 sc1
  global_load_dwordx4 v[236:239], v67, s[4:5] offset:1024 sc1
  s_branch mk_c_wld1
mk_c_wl13:
  s_add_u32 s30, s27, 2048
  v_add_u32 v67, s30, v1
  global_load_dwordx4 a[8:11], v67, s[4:5] offset:0 sc1
  global_load_dwordx4 a[12:15], v67, s[4:5] offset:1024 sc1
  s_add_u32 s30, s27, 4096
  v_add_u32 v67, s30, v1
  global_load_dwordx4 a[16:19], v67, s[4:5] offset:0 sc1
  global_load_dwordx4 a[20:23], v67, s[4:5] offset:1024 sc1
  s_add_u32 s30, s27, 6144
  v_add_u32 v67, s30, v1
  global_load_dwordx4 a[24:27], v67, s[4:5] offset:0 sc1
  global_load_dwordx4 a[28:31], v67, s[4:5] offset:1024 sc1
  s_add_u32 s30, s27, 8192
  v_add_u32 v67, s30, v1
  global_load_dwordx4 a[32:35], v67, s[4:5] offset:0 sc1
  global_load_dwordx4 a[36:39], v67, s[4:5] offset:1024 sc1
  s_add_u32 s30, s27, 16384
  v_add_u32 v67, s30, v1
  global_load_dwordx4 a[64:67], v67, s[4:5] offset:0 sc1
  global_load_dwordx4 a[68:71], v67, s[4:5] offset:1024 sc1
  s_add_u32 s30, s27, 18432
  v_add_u32 v67, s30, v1
  global_load_dwordx4 a[72:75], v67, s[4:5] offset:0 sc1
  global_load_dwordx4 a[76:79], v67, s[4:5] offset:1024 sc1
  s_add_u32 s30, s27, 20480
  v_add_u32 v67, s30, v1
  global_load_dwordx4 a[80:83], v67, s[4:5] offset:0 sc1
  global_load_dwordx4 a[84:87], v67, s[4:5] offset:1024 sc1
  s_add_u32 s30, s27, 22528
  v_add_u32 v67, s30, v1
  global_load_dwordx4 a[88:91], v67, s[4:5] offset:0 sc1
  global_load_dwordx4 a[92:95], v67, s[4:5] offset:1024 sc1
  s_add_u32 s30, s27, 30720
  v_add_u32 v67, s30, v1
  global_load_dwordx4 a[120:123], v67, s[4:5] offset:0 sc1
  global_load_dwordx4 a[124:127], v67, s[4:5] offset:1024 sc1
  s_add_u32 s30, s27, 32768
  v_add_u32 v67, s30, v1
  global_load_dwordx4 a[128:131], v67, s[4:5] offset:0 sc1
  global_load_dwordx4 a[132:135], v67, s[4:5] offset:1024 sc1
  s_add_u32 s30, s27, 34816
  v_add_u32 v67, s30, v1
  global_load_dwordx4 a[136:139], v67, s[4:5] offset:0 sc1
  global_load_dwordx4 a[140:143], v67, s[4:5] offset:1024 sc1
  s_add_u32 s30, s27, 36864
  v_add_u32 v67, s30, v1
  global_load_dwordx4 a[144:147], v67, s[4:5] offset:0 sc1
  global_load_dwordx4 a[148:151], v67, s[4:5] offset:1024 sc1
  s_add_u32 s30, s27, 47104
  v_add_u32 v67, s30, v1
  global_load_dwordx4 a[184:187], v67, s[4:5] offset:0 sc1
  global_load_dwordx4 a[188:191], v67, s[4:5] offset:1024 sc1
  s_add_u32 s30, s27, 49152
  v_add_u32 v67, s30, v1
  global_load_dwordx4 a[192:195], v67, s[4:5] offset:0 sc1
  global_load_dwordx4 a[196:199], v67, s[4:5] offset:1024 sc1
  s_add_u32 s30, s27, 51200
  v_add_u32 v67, s30, v1
  global_load_dwordx4 a[200:203], v67, s[4:5] offset:0 sc1
  global_load_dwordx4 a[204:207], v67, s[4:5] offset:1024 sc1
  s_add_u32 s30, s27, 53248
  v_add_u32 v67, s30, v1
  global_load_dwordx4 a[208:211], v67, s[4:5] offset:0 sc1
  global_load_dwordx4 a[212:215], v67, s[4:5] offset:1024 sc1
  s_add_u32 s30, s27, 61440
  v_add_u32 v67, s30, v1
  global_load_dwordx4 a[240:243], v67, s[4:5] offset:0 sc1
  global_load_dwordx4 a[244:247], v67, s[4:5] offset:1024 sc1
  s_add_u32 s30, s27, 63488
  v_add_u32 v67, s30, v1
  global_load_dwordx4 a[248:251], v67, s[4:5] offset:0 sc1
  global_load_dwordx4 a[252:255], v67, s[4:5] offset:1024 sc1
  s_add_u32 s30, s27, 65536
  v_add_u32 v67, s30, v1
  global_load_dwordx4 v[120:123], v67, s[4:5] offset:0 sc1
  global_load_dwordx4 v[124:127], v67, s[4:5] offset:1024 sc1
  s_add_u32 s30, s27, 67584
  v_add_u32 v67, s30, v1
  global_load_dwordx4 v[128:131], v67, s[4:5] offset:0 sc1
  global_load_dwordx4 v[132:135], v67, s[4:5] offset:1024 sc1
  s_add_u32 s30, s27, 75776
  v_add_u32 v67, s30, v1
  global_load_dwordx4 v[160:163], v67, s[4:5] offset:0 sc1
  global_load_dwordx4 v[164:167], v67, s[4:5] offset:1024 sc1
  s_add_u32 s30, s27, 77824
  v_add_u32 v67, s30, v1
  global_load_dwordx4 v[168:171], v67, s[4:5] offset:0 sc1
  global_load_dwordx4 v[172:175], v67, s[4:5] offset:1024 sc1
  s_add_u32 s30, s27, 79872
  v_add_u32 v67, s30, v1
  global_load_dwordx4 v[176:179], v67, s[4:5] offset:0 sc1
  global_load_dwordx4 v[180:183], v67, s[4:5] offset:1024 sc1
  s_add_u32 s30, s27, 81920
  v_add_u32 v67, s30, v1
  global_load_dwordx4 v[184:187], v67, s[4:5] offset:0 sc1
  global_load_dwordx4 v[188:191], v67, s[4:5] offset:1024 sc1
  s_add_u32 s30, s27, 90112
  v_add_u32 v67, s30, v1
  global_load_dwordx4 v[216:219], v67, s[4:5] offset:0 sc1
  global_load_dwordx4 v[220:223], v67, s[4:5] offset:1024 sc1
  s_add_u32 s30, s27, 92160
  v_add_u32 v67, s30, v1
  global_load_dwordx4 v[224:227], v67, s[4:5] offset:0 sc1
  global_load_dwordx4 v[228:231], v67, s[4:5] offset:1024 sc1
  s_add_u32 s30, s27, 94208
  v_add_u32 v67, s30, v1
  global_load_dwordx4 v[232:235], v67, s[4:5] offset:0 sc1
  global_load_dwordx4 v[236:239], v67, s[4:5] offset:1024 sc1
  s_add_u32 s30, s27, 96256
  v_add_u32 v67, s30, v1
  global_load_dwordx4 v[240:243], v67, s[4:5] offset:0 sc1
  global_load_dwordx4 v[244:247], v67, s[4:5] offset:1024 sc1
mk_c_wld1:
  s_lshl_b32 s30, s22, 11
  global_load_dwordx4 v[88:91], v1, s[54:55] sc1
  s_add_u32 m0, s30, 39936
  s_nop 0
  global_load_lds_dwordx4 v1, s[54:55] offset:1024 sc1
  global_load_dwordx4 v[100:103], v1, s[54:55] offset:2048 sc1
  global_load_dwordx2 v[86:87], v1, s[54:55] offset:3072 sc1
  global_load_dwordx4 v[92:95], v3, s[54:55] sc1
  s_add_u32 m0, s30, 40960
  s_nop 0
  global_load_lds_dwordx4 v3, s[54:55] offset:1024 sc1
  global_load_dwordx4 v[104:107], v3, s[54:55] offset:2048 sc1
  global_load_dwordx2 v[110:111], v3, s[54:55] offset:3072 sc1
  s_add_u32 s54, s54, 32768
  s_addc_u32 s55, s55, 0
  s_branch mk_c_wdone
mk_c_vw:
  s_mul_i32 s27, s22, 112
  s_lshl_b32 s28, s25, 1
  s_add_u32 s27, s27, s28
  s_mul_i32 s27, s27, 14336
  s_add_u32 s27, s27, 6422528
  s_mul_i32 s34, s22, 14336
  s_add_u32 s34, s34, 16384
  s_add_u32 s31, s37, 0
  s_cmp_ge_u32 s31, 7
  s_cselect_b32 s32, 7, 0
  s_sub_u32 s31, s31, s32
  s_lshl_b32 s31, s31, 11
  s_add_u32 s31, s31, s27
  s_add_u32 s30, s31, 0
  v_add_u32 v67, s30, v1
  global_load_dwordx4 a[0:3], v67, s[4:5] offset:0 sc1
  global_load_dwordx4 a[4:7], v67, s[4:5] offset:1024 sc1
  s_add_u32 s30, s31, 14336
  v_add_u32 v67, s30, v1
  global_load_dwordx4 a[56:59], v67, s[4:5] offset:0 sc1
  global_load_dwordx4 a[60:63], v67, s[4:5] offset:1024 sc1
  s_add_u32 s30, s31, 401408
  v_add_u32 v67, s30, v1
  global_load_dwordx4 a[112:115], v67, s[4:5] offset:0 sc1
  global_load_dwordx4 a[116:119], v67, s[4:5] offset:1024 sc1
  s_add_u32 s30, s31, 415744
  v_add_u32 v67, s30, v1
  global_load_dwordx4 a[168:171], v67, s[4:5] offset:0 sc1
  global_load_dwordx4 a[172:175], v67, s[4:5] offset:1024 sc1
  s_add_u32 s30, s31, 802816
  v_add_u32 v67, s30, v1
  global_load_dwordx4 a[224:227], v67, s[4:5] offset:0 sc1
  global_load_dwordx4 a[228:231], v67, s[4:5] offset:1024 sc1
  s_add_u32 s30, s31, 817152
  v_add_u32 v67, s30, v1
  global_load_dwordx4 v[144:147], v67, s[4:5] offset:0 sc1
  global_load_dwordx4 v[148:151], v67, s[4:5] offset:1024 sc1
  s_add_u32 s30, s31, 1204224
  v_add_u32 v67, s30, v1
  global_load_dwordx4 v[200:203], v67, s[4:5] offset:0 sc1
  global_load_dwordx4 v[204:207], v67, s[4:5] offset:1024 sc1
  s_add_u32 s30, s31, 1218560
  v_add_u32 v67, s30, v1
  s_add_u32 m0, s34, 0
  s_nop 0
  global_load_lds_dwordx4 v67, s[4:5] offset:0 sc1
  global_load_lds_dwordx4 v67, s[4:5] offset:1024 sc1
  s_add_u32 s31, s37, 1
  s_cmp_ge_u32 s31, 7
  s_cselect_b32 s32, 7, 0
  s_sub_u32 s31, s31, s32
  s_lshl_b32 s31, s31, 11
  s_add_u32 s31, s31, s27
  s_add_u32 s30, s31, 0
  v_add_u32 v67, s30, v1
  global_load_dwordx4 a[8:11], v67, s[4:5] offset:0 sc1
  global_load_dwordx4 a[12:15], v67, s[4:5] offset:1024 sc1
  s_add_u32 s30, s31, 14336
  v_add_u32 v67, s30, v1
  global_load_dwordx4 a[64:67], v67, s[4:5] offset:0 sc1
  global_load_dwordx4 a[68:71], v67, s[4:5] offset:1024 sc1
  s_add_u32 s30, s31, 401408
  v_add_u32 v67, s30, v1
  global_load_dwordx4 a[120:123], v67, s[4:5] offset:0 sc1
  global_load_dwordx4 a[124:127], v67, s[4:5] offset:1024 sc1
  s_add_u32 s30, s31, 415744
  v_add_u32 v67, s30, v1
  global_load_dwordx4 a[176:179], v67, s[4:5] offset:0 sc1
  global_load_dwordx4 a[180:183], v67, s[4:5] offset:1024 sc1
  s_add_u32 s30, s31, 802816
  v_add_u32 v67, s30, v1
  global_load_dwordx4 a[232:235], v67, s[4:5] offset:0 sc1
  global_load_dwordx4 a[236:239], v67, s[4:5] offset:1024 sc1
  s_add_u32 s30, s31, 817152
  v_add_u32 v67, s30, v1
  global_load_dwordx4 v[152:155], v67, s[4:5] offset:0 sc1
  global_load_dwordx4 v[156:159], v67, s[4:5] offset:1024 sc1
  s_add_u32 s30, s31, 1204224
  v_add_u32 v67, s30, v1
  global_load_dwordx4 v[208:211], v67, s[4:5] offset:0 sc1
  global_load_dwordx4 v[212:215], v67, s[4:5] offset:1024 sc1
  s_add_u32 s30, s31, 1218560
  v_add_u32 v67, s30, v1
  s_add_u32 m0, s34, 2048
  s_nop 0
  global_load_lds_dwordx4 v67, s[4:5] offset:0 sc1
  global_load_lds_dwordx4 v67, s[4:5] offset:1024 sc1
  s_add_u32 s31, s37, 2
  s_cmp_ge_u32 s31, 7
  s_cselect_b32 s32, 7, 0
  s_sub_u32 s31, s31, s32
  s_lshl_b32 s31, s31, 11
  s_add_u32 s31, s31, s27
  s_add_u32 s30, s31, 0
  v_add_u32 v67, s30, v1
  global_load_dwordx4 a[16:19], v67, s[4:5] offset:0 sc1
  global_load_dwordx4 a[20:23], v67, s[4:5] offset:1024 sc1
  s_add_u32 s30, s31, 14336
  v_add_u32 v67, s30, v1
  global_load_dwordx4 a[72:75], v67, s[4:5] offset:0 sc1
  global_load_dwordx4 a[76:79], v67, s[4:5] offset:1024 sc1
  s_add_u32 s30, s31, 401408
  v_add_u32 v67, s30, v1
  global_load_dwordx4 a[128:131], v67, s[4:5] offset:0 sc1
  global_load_dwordx4 a[132:135], v67, s[4:5] offset:1024 sc1
  s_add_u32 s30, s31, 415744
  v_add_u32 v67, s30, v1
  global_load_dwordx4 a[184:187], v67, s[4:5] offset:0 sc1
  global_load_dwordx4 a[188:191], v67, s[4:5] offset:1024 sc1
  s_add_u32 s30, s31, 802816
  v_add_u32 v67, s30, v1
  global_load_dwordx4 a[240:243], v67, s[4:5] offset:0 sc1
  global_load_dwordx4 a[244:247], v67, s[4:5] offset:1024 sc1
  s_add_u32 s30, s31, 817152
  v_add_u32 v67, s30, v1
  global_load_dwordx4 v[160:163], v67, s[4:5] offset:0 sc1
  global_load_dwordx4 v[164:167], v67, s[4:5] offset:1024 sc1
  s_add_u32 s30, s31, 1204224
  v_add_u32 v67, s30, v1
  global_load_dwordx4 v[216:219], v67, s[4:5] offset:0 sc1
  global_load_dwordx4 v[220:223], v67, s[4:5] offset:1024 sc1
  s_add_u32 s30, s31, 1218560
  v_add_u32 v67, s30, v1
  s_add_u32 m0, s34, 4096
  s_nop 0
  global_load_lds_dwordx4 v67, s[4:5] offset:0 sc1
  global_load_lds_dwordx4 v67, s[4:5] offset:1024 sc1
  v_lshlrev_b32 v65, 2, v64
  v_add_u32 v65, 14942208, v65
mk_c_wf_22:
  global_load_dword v66, v65, s[4:5] offset:0 sc1
  s_waitcnt vmcnt(0)
  v_xor_b32 v66, s20, v66
  v_cmp_ne_u32 vcc, 0, v66
  s_cbranch_vccz mk_c_wd_23
  s_sleep 3
  s_sub_u32 s40, s40, 1
  s_cbranch_scc0 mk_c_wf_22
  s_mov_b32 s40, 0
mk_c_wd_23:
  s_add_u32 s31, s37, 3
  s_cmp_ge_u32 s31, 7
  s_cselect_b32 s32, 7, 0
  s_sub_u32 s31, s31, s32
  s_lshl_b32 s31, s31, 11
  s_add_u32 s31, s31, s27
  s_add_u32 s30, s31, 0
  v_add_u32 v67, s30, v1
  global_load_dwordx4 a[24:27], v67, s[4:5] offset:0 sc1
  global_load_dwordx4 a[28:31], v67, s[4:5] offset:1024 sc1
  s_add_u32 s30, s31, 14336
  v_add_u32 v67, s30, v1
  global_load_dwordx4 a[80:83], v67, s[4:5] offset:0 sc1
  global_load_dwordx4 a[84:87], v67, s[4:5] offset:1024 sc1
  s_add_u32 s30, s31, 401408
  v_add_u32 v67, s30, v1
  global_load_dwordx4 a[136:139], v67, s[4:5] offset:0 sc1
  global_load_dwordx4 a[140:143], v67, s[4:5] offset:1024 sc1
  s_add_u32 s30, s31, 415744
  v_add_u32 v67, s30, v1
  global_load_dwordx4 a[192:195], v67, s[4:5] offset:0 sc1
  global_load_dwordx4 a[196:199], v67, s[4:5] offset:1024 sc1
  s_add_u32 s30, s31, 802816
  v_add_u32 v67, s30, v1
  global_load_dwordx4 a[248:251], v67, s[4:5] offset:0 sc1
  global_load_dwordx4 a[252:255], v67, s[4:5] offset:1024 sc1
  s_add_u32 s30, s31, 817152
  v_add_u32 v67, s30, v1
  global_load_dwordx4 v[168:171], v67, s[4:5] offset:0 sc1
  global_load_dwordx4 v[172:175], v67, s[4:5] offset:1024 sc1
  s_add_u32 s30, s31, 1204224
  v_add_u32 v67, s30, v1
  global_load_dwordx4 v[224:227], v67, s[4:5] offset:0 sc1
  global_load_dwordx4 v[228:231], v67, s[4:5] offset:1024 sc1
  s_add_u32 s30, s31, 1218560
  v_add_u32 v67, s30, v1
  s_add_u32 m0, s34, 6144
  s_nop 0
  global_load_lds_dwordx4 v67, s[4:5] offset:0 sc1
  global_load_lds_dwordx4 v67, s[4:5] offset:1024 sc1
  s_add_u32 s31, s37, 4
  s_cmp_ge_u32 s31, 7
  s_cselect_b32 s32, 7, 0
  s_sub_u32 s31, s31, s32
  s_lshl_b32 s31, s31, 11
  s_add_u32 s31, s31, s27
  s_add_u32 s30, s31, 0
  v_add_u32 v67, s30, v1
  global_load_dwordx4 a[32:35], v67, s[4:5] offset:0 sc1
  global_load_dwordx4 a[36:39], v67, s[4:5] offset:1024 sc1
  s_add_u32 s30, s31, 14336
  v_add_u32 v67, s30, v1
  global_load_dwordx4 a[88:91], v67, s[4:5] offset:0 sc1
  global_load_dwordx4 a[92:95], v67, s[4:5] offset:1024 sc1
  s_add_u32 s30, s31, 401408
  v_add_u32 v67, s30, v1
  global_load_dwordx4 a[144:147], v67, s[4:5] offset:0 sc1
  global_load_dwordx4 a[148:151], v67, s[4:5] offset:1024 sc1
  s_add_u32 s30, s31, 415744
  v_add_u32 v67, s30, v1
  global_load_dwordx4 a[200:203], v67, s[4:5] offset:0 sc1
  global_load_dwordx4 a[204:207], v67, s[4:5] offset:1024 sc1
  s_add_u32 s30, s31, 802816
  v_add_u32 v67, s30, v1
  global_load_dwordx4 v[120:123], v67, s[4:5] offset:0 sc1
  global_load_dwordx4 v[124:127], v67, s[4:5] offset:1024 sc1
  s_add_u32 s30, s31, 817152
  v_add_u32 v67, s30, v1
  global_load_dwordx4 v[176:179], v67, s[4:5] offset:0 sc1
  global_load_dwordx4 v[180:183], v67, s[4:5] offset:1024 sc1
  s_add_u32 s30, s31, 1204224
  v_add_u32 v67, s30, v1
  global_load_dwordx4 v[232:235], v67, s[4:5] offset:0 sc1
  global_load_dwordx4 v[236:239], v67, s[4:5] offset:1024 sc1
  s_add_u32 s30, s31, 1218560
  v_add_u32 v67, s30, v1
  s_add_u32 m0, s34, 8192
  s_nop 0
  global_load_lds_dwordx4 v67, s[4:5] offset:0 sc1
  global_load_lds_dwordx4 v67, s[4:5] offset:1024 sc1
  s_add_u32 s31, s37, 5
  s_cmp_ge_u32 s31, 7
  s_cselect_b32 s32, 7, 0
  s_sub_u32 s31, s31, s32
  s_lshl_b32 s31, s31, 11
  s_add_u32 s31, s31, s27
  s_add_u32 s30, s31, 0
  v_add_u32 v67, s30, v1
  global_load_dwordx4 a[40:43], v67, s[4:5] offset:0 sc1
  global_load_dwordx4 a[44:47], v67, s[4:5] offset:1024 sc1
  s_add_u32 s30, s31, 14336
  v_add_u32 v67, s30, v1
  global_load_dwordx4 a[96:99], v67, s[4:5] offset:0 sc1
  global_load_dwordx4 a[100:103], v67, s[4:5] offset:1024 sc1
  s_add_u32 s30, s31, 401408
  v_add_u32 v67, s30, v1
  global_load_dwordx4 a[152:155], v67, s[4:5] offset:0 sc1
  global_load_dwordx4 a[156:159], v67, s[4:5] offset:1024 sc1
  s_add_u32 s30, s31, 415744
  v_add_u32 v67, s30, v1
  global_load_dwordx4 a[208:211], v67, s[4:5] offset:0 sc1
  global_load_dwordx4 a[212:215], v67, s[4:5] offset:1024 sc1
  s_add_u32 s30, s31, 802816
  v_add_u32 v67, s30, v1
  global_load_dwordx4 v[128:131], v67, s[4:5] offset:0 sc1
  global_load_dwordx4 v[132:135], v67, s[4:5] offset:1024 sc1
  s_add_u32 s30, s31, 817152
  v_add_u32 v67, s30, v1
  global_load_dwordx4 v[184:187], v67, s[4:5] offset:0 sc1
  global_load_dwordx4 v[188:191], v67, s[4:5] offset:1024 sc1
  s_add_u32 s30, s31, 1204224
  v_add_u32 v67, s30, v1
  global_load_dwordx4 v[240:243], v67, s[4:5] offset:0 sc1
  global_load_dwordx4 v[244:247], v67, s[4:5] offset:1024 sc1
  s_add_u32 s30, s31, 1218560
  v_add_u32 v67, s30, v1
  s_add_u32 m0, s34, 10240
  s_nop 0
  global_load_lds_dwordx4 v67, s[4:5] offset:0 sc1
  global_load_lds_dwordx4 v67, s[4:5] offset:1024 sc1
  s_add_u32 s31, s37, 6
  s_cmp_ge_u32 s31, 7
  s_cselect_b32 s32, 7, 0
  s_sub_u32 s31, s31, s32
  s_lshl_b32 s31, s31, 11
  s_add_u32 s31, s31, s27
  s_add_u32 s30, s31, 0
  v_add_u32 v67, s30, v1
  global_load_dwordx4 a[48:51], v67, s[4:5] offset:0 sc1
  global_load_dwordx4 a[52:55], v67, s[4:5] offset:1024 sc1
  s_add_u32 s30, s31, 14336
  v_add_u32 v67, s30, v1
  global_load_dwordx4 a[104:107], v67, s[4:5] offset:0 sc1
  global_load_dwordx4 a[108:111], v67, s[4:5] offset:1024 sc1
  s_add_u32 s30, s31, 401408
  v_add_u32 v67, s30, v1
  global_load_dwordx4 a[160:163], v67, s[4:5] offset:0 sc1
  global_load_dwordx4 a[164:167], v67, s[4:5] offset:1024 sc1
  s_add_u32 s30, s31, 415744
  v_add_u32 v67, s30, v1
  global_load_dwordx4 a[216:219], v67, s[4:5] offset:0 sc1
  global_load_dwordx4 a[220:223], v67, s[4:5] offset:1024 sc1
  s_add_u32 s30, s31, 802816
  v_add_u32 v67, s30, v1
  global_load_dwordx4 v[136:139], v67, s[4:5] offset:0 sc1
  global_load_dwordx4 v[140:143], v67, s[4:5] offset:1024 sc1
  s_add_u32 s30, s31, 817152
  v_add_u32 v67, s30, v1
  global_load_dwordx4 v[192:195], v67, s[4:5] offset:0 sc1
  global_load_dwordx4 v[196:199], v67, s[4:5] offset:1024 sc1
  s_add_u32 s30, s31, 1204224
  v_add_u32 v67, s30, v1
  global_load_dwordx4 v[248:251], v67, s[4:5] offset:0 sc1
  global_load_dwordx4 v[252:255], v67, s[4:5] offset:1024 sc1
  s_add_u32 s30, s31, 1218560
  v_add_u32 v67, s30, v1
  s_add_u32 m0, s34, 12288
  s_nop 0
  global_load_lds_dwordx4 v67, s[4:5] offset:0 sc1
  global_load_lds_dwordx4 v67, s[4:5] offset:1024 sc1
mk_c_wdone:
  s_cmp_eq_u32 s26, 0
  s_cbranch_scc1 mk_c_go2
  s_waitcnt vmcnt(0)
  v_bfe_u32 v20, v1, 4, 3
  v_bfe_u32 v21, v1, 7, 1
  v_mul_u32_u24 v21, 112, v21
  v_add_u32 v20, v20, v21
  v_lshlrev_b32 v16, 2, v20
  v_add_u32 v16, s39, v16
mk_c_wf_24:
  global_load_dword v17, v16, s[4:5] offset:0 sc1
  s_waitcnt vmcnt(0)
  v_xor_b32 v17, s20, v17
  v_cmp_ne_u32 vcc, 0, v17
  s_cbranch_vccz mk_c_wd_25
  s_sleep 4
  s_sub_u32 s40, s40, 1
  s_cbranch_scc0 mk_c_wf_24
  s_mov_b32 s40, 0
mk_c_wd_25:
  s_add_u32 m0, s35, 0
  s_nop 0
  global_load_lds_dwordx4 v1, s[56:57] offset:0 sc1
  s_add_u32 m0, s35, 0
  s_nop 0
  global_load_lds_dwordx4 v1, s[56:57] offset:1024 sc1
  s_add_u32 m0, s35, 0
  s_nop 0
  global_load_lds_dwordx4 v1, s[56:57] offset:2048 sc1
  s_add_u32 m0, s35, 0
  s_nop 0
  global_load_lds_dwordx4 v1, s[56:57] offset:3072 sc1
  s_add_u32 m0, s35, 4096
  s_nop 0
  global_load_lds_dwordx4 v3, s[56:57] offset:0 sc1
  s_add_u32 m0, s35, 4096
  s_nop 0
  global_load_lds_dwordx4 v3, s[56:57] offset:1024 sc1
  s_add_u32 m0, s35, 4096
  s_nop 0
  global_load_lds_dwordx4 v3, s[56:57] offset:2048 sc1
  s_add_u32 m0, s35, 4096
  s_nop 0
  global_load_lds_dwordx4 v3, s[56:57] offset:3072 sc1
  s_add_u32 s56, s56, 458752
  s_addc_u32 s57, s57, 0
  s_add_u32 s12, s12, 896
  s_addc_u32 s13, s13, 0
  s_xor_b32 s35, s35, 0x38000
mk_c_go2:
  v_mov_b32 v36, 0
  v_mov_b32 v37, 0
  v_mov_b32 v38, 0
  v_mov_b32 v39, 0
  v_mov_b32 v40, 0
  v_mov_b32 v41, 0
  v_mov_b32 v42, 0
  v_mov_b32 v43, 0
  v_mov_b32 v44, 0
  v_mov_b32 v45, 0
  v_mov_b32 v46, 0
  v_mov_b32 v47, 0
  v_mov_b32 v48, 0
  v_mov_b32 v49, 0
  v_mov_b32 v50, 0
  v_mov_b32 v51, 0
  v_mov_b32 v52, 0
  v_mov_b32 v53, 0
  v_mov_b32 v54, 0
  v_mov_b32 v55, 0
  v_mov_b32 v56, 0
  v_mov_b32 v57, 0
  v_mov_b32 v58, 0
  v_mov_b32 v59, 0
  v_mov_b32 v60, 0
  v_mov_b32 v61, 0
  v_mov_b32 v62, 0
  v_mov_b32 v63, 0
  v_mov_b32 v64, 0
  v_mov_b32 v65, 0
  v_mov_b32 v66, 0
  v_mov_b32 v67, 0
  s_waitcnt lgkmcnt(0)
  s_lshl_b32 s30, s26, 2
  s_add_u32 s30, s30, s22
  s_cmp_lt_u32 s21, 32
  s_cselect_b32 s31, 8, 0
  s_add_u32 s30, s30, s31
  s_cmp_eq_u32 s30, 0
  s_cbranch_scc1 mk_c_fs0_entry
  s_cmp_eq_u32 s30, 1
  s_cbranch_scc1 mk_c_fs1_entry
  s_cmp_eq_u32 s30, 2
  s_cbranch_scc1 mk_c_fs2_entry
  s_cmp_eq_u32 s30, 3
  s_cbranch_scc1 mk_c_fs3_entry
  s_cmp_eq_u32 s30, 4
  s_cbranch_scc1 mk_c_fv0_entry
  s_cmp_eq_u32 s30, 5
  s_cbranch_scc1 mk_c_fv1_entry
  s_cmp_eq_u32 s30, 6
  s_cbranch_scc1 mk_c_fv2_entry
  s_cmp_eq_u32 s30, 7
  s_cbranch_scc1 mk_c_fv3_entry
  s_cmp_eq_u32 s30, 8
  s_cbranch_scc1 mk_c_ss0_entry
  s_cmp_eq_u32 s30, 9
  s_cbranch_scc1 mk_c_ss1_entry
  s_cmp_eq_u32 s30, 10
  s_cbranch_scc1 mk_c_ss2_entry
  s_cmp_eq_u32 s30, 11
  s_cbranch_scc1 mk_c_ss3_entry
  s_cmp_eq_u32 s30, 12
  s_cbranch_scc1 mk_c_sv0_entry
  s_cmp_eq_u32 s30, 13
  s_cbranch_scc1 mk_c_sv1_entry
  s_cmp_eq_u32 s30, 14
  s_cbranch_scc1 mk_c_sv2_entry
  s_cmp_eq_u32 s30, 15
  s_cbranch_scc1 mk_c_sv3_entry
mk_c_fs0_loop:
  s_barrier
mk_c_fs0_mem:
  global_load_dwordx4 v[8:11], v1, s[44:45] offset:0 sc1
  s_nop 11
  global_load_dwordx4 v[12:15], v1, s[44:45] offset:1024 sc1
  s_nop 11
  global_load_dwordx4 v[16:19], v1, s[44:45] offset:2048 sc1
  s_nop 11
  global_load_dwordx4 v[20:23], v1, s[44:45] offset:3072 sc1
  s_waitcnt vmcnt(3)
  v_smfmac_f32_16x16x64_bf16 v[36:39], v[8:11], a[0:7], v112
  ds_write_b128 v1, v[8:11] offset:0
  v_smfmac_f32_16x16x64_bf16 v[40:43], v[8:11], a[56:63], v112
  global_load_dwordx4 v[24:27], v3, s[44:45] offset:0 sc1
  v_smfmac_f32_16x16x64_bf16 v[44:47], v[8:11], a[112:119], v112
  v_max3_u32 v119, v8, v9, v10
  v_smfmac_f32_16x16x64_bf16 v[48:51], v[8:11], a[168:175], v112
  global_load_dwordx4 v[28:31], v3, s[44:45] offset:1024 sc1
  v_smfmac_f32_16x16x64_bf16 v[52:55], v[8:11], a[224:231], v112
  v_max_u32 v119, v119, v11
  v_smfmac_f32_16x16x64_bf16 v[56:59], v[8:11], v[144:151], v112
  global_load_dwordx4 v[32:35], v3, s[44:45] offset:2048 sc1
  v_smfmac_f32_16x16x64_bf16 v[60:63], v[8:11], v[200:207], v112
  s_waitcnt vmcnt(5)
  v_smfmac_f32_16x16x64_bf16 v[36:39], v[12:15], a[8:15], v112
  ds_write_b128 v1, v[12:15] offset:1024
  v_smfmac_f32_16x16x64_bf16 v[40:43], v[12:15], a[64:71], v112
  v_smfmac_f32_16x16x64_bf16 v[44:47], v[12:15], a[120:127], v112
  v_max3_u32 v119, v119, v12, v13
  v_smfmac_f32_16x16x64_bf16 v[48:51], v[12:15], a[176:183], v112
  v_smfmac_f32_16x16x64_bf16 v[52:55], v[12:15], a[232:239], v112
  v_max3_u32 v119, v119, v14, v15
  v_smfmac_f32_16x16x64_bf16 v[56:59], v[12:15], v[152:159], v112
  v_smfmac_f32_16x16x64_bf16 v[60:63], v[12:15], v[208:215], v112
  s_waitcnt vmcnt(4)
  v_smfmac_f32_16x16x64_bf16 v[36:39], v[16:19], a[16:23], v112
  ds_read_b128 v[8:11], v1 offset:40960
  v_smfmac_f32_16x16x64_bf16 v[40:43], v[16:19], a[72:79], v112
  ds_read_b128 v[12:15], v1 offset:41984
  v_smfmac_f32_16x16x64_bf16 v[44:47], v[16:19], a[128:135], v112
  v_max3_u32 v119, v119, v16, v17
  v_smfmac_f32_16x16x64_bf16 v[48:51], v[16:19], a[184:191], v112
  v_max3_u32 v119, v119, v18, v19
  v_smfmac_f32_16x16x64_bf16 v[52:55], v[16:19], a[240:247], v112
  v_cmp_eq_u32 vcc, -1, v119
  v_smfmac_f32_16x16x64_bf16 v[56:59], v[16:19], v[160:167], v112
  v_smfmac_f32_16x16x64_bf16 v[60:63], v[16:19], v[216:223], v112
  s_cbranch_vccnz mk_c_fs0_redo
mk_c_fs0_cont:
  s_waitcnt vmcnt(3)
  v_smfmac_f32_16x16x64_bf16 v[36:39], v[20:23], a[24:31], v112
  s_waitcnt vmcnt(2)
  v_smfmac_f32_16x16x64_bf16 v[36:39], v[24:27], a[32:39], v112
  s_waitcnt vmcnt(1)
  v_smfmac_f32_16x16x64_bf16 v[36:39], v[28:31], a[40:47], v112
  s_waitcnt vmcnt(0)
  v_smfmac_f32_16x16x64_bf16 v[36:39], v[32:35], a[48:55], v112
  v_smfmac_f32_16x16x64_bf16 v[40:43], v[20:23], a[80:87], v112
  ds_read2_b64 v[96:99], v7 offset0:0 offset1:32
  ds_read2_b64 v[116:119], v7 offset0:64 offset1:96
  v_smfmac_f32_16x16x64_bf16 v[40:43], v[24:27], a[88:95], v112
  v_add_f32 v108, v36, v37
  v_smfmac_f32_16x16x64_bf16 v[40:43], v[28:31], a[96:103], v112
  v_add_f32 v109, v38, v39
  v_smfmac_f32_16x16x64_bf16 v[40:43], v[32:35], a[104:111], v112
  v_cvt_pk_bf16_f32 v108, v108, v109
  v_smfmac_f32_16x16x64_bf16 v[44:47], v[20:23], a[136:143], v112
  ds_write_b32 v5, v108 offset:0
  v_smfmac_f32_16x16x64_bf16 v[44:47], v[24:27], a[144:151], v112
  v_add_f32 v108, v40, v41
  v_smfmac_f32_16x16x64_bf16 v[44:47], v[28:31], a[152:159], v112
  v_add_f32 v109, v42, v43
  v_smfmac_f32_16x16x64_bf16 v[44:47], v[32:35], a[160:167], v112
  v_cvt_pk_bf16_f32 v108, v108, v109
  v_smfmac_f32_16x16x64_bf16 v[48:51], v[20:23], a[192:199], v112
  ds_write_b32 v5, v108 offset:512
  ds_read_b64_tr_b16 v[76:77], v6 offset:0
  v_smfmac_f32_16x16x64_bf16 v[48:51], v[24:27], a[200:207], v112
  v_add_f32 v108, v44, v45
  ds_read_b64_tr_b16 v[78:79], v6 offset:512
  v_smfmac_f32_16x16x64_bf16 v[48:51], v[28:31], a[208:215], v112
  v_add_f32 v109, v46, v47
  v_smfmac_f32_16x16x64_bf16 v[48:51], v[32:35], a[216:223], v112
  v_cvt_pk_bf16_f32 v108, v108, v109
  v_smfmac_f32_16x16x64_bf16 v[52:55], v[20:23], a[248:255], v112
  ds_write_b32 v5, v108 offset:1024
  v_smfmac_f32_16x16x64_bf16 v[52:55], v[24:27], v[120:127], v112
  v_add_f32 v108, v48, v49
  v_smfmac_f32_16x16x64_bf16 v[52:55], v[28:31], v[128:135], v112
  v_add_f32 v109, v50, v51
  v_smfmac_f32_16x16x64_bf16 v[52:55], v[32:35], v[136:143], v112
  v_cvt_pk_bf16_f32 v108, v108, v109
  s_waitcnt lgkmcnt(1)
  v_mfma_f32_16x16x32_bf16 v[64:67], v[88:91], v[76:79], 0
  v_mfma_f32_16x16x32_bf16 v[68:71], v[92:95], v[76:79], 0
  v_mfma_f32_16x16x32_bf16 v[72:75], v[96:99], v[76:79], 0
  ds_read2_b64 v[96:99], v7 offset0:128 offset1:160
  v_smfmac_f32_16x16x64_bf16 v[56:59], v[20:23], v[168:175], v112
  ds_write_b32 v5, v108 offset:1536
  ds_read_b64_tr_b16 v[80:81], v6 offset:1024
  v_smfmac_f32_16x16x64_bf16 v[56:59], v[24:27], v[176:183], v112
  v_add_f32 v108, v52, v53
  ds_read_b64_tr_b16 v[82:83], v6 offset:1536
  v_smfmac_f32_16x16x64_bf16 v[56:59], v[28:31], v[184:191], v112
  v_add_f32 v109, v54, v55
  v_smfmac_f32_16x16x64_bf16 v[56:59], v[32:35], v[192:199], v112
  v_cvt_pk_bf16_f32 v108, v108, v109
  v_smfmac_f32_16x16x64_bf16 v[60:63], v[20:23], v[224:231], v112
  ds_write_b32 v5, v108 offset:2048
  v_smfmac_f32_16x16x64_bf16 v[60:63], v[24:27], v[232:239], v112
  v_add_f32 v108, v56, v57
  v_smfmac_f32_16x16x64_bf16 v[60:63], v[28:31], v[240:247], v112
  v_add_f32 v109, v58, v59
  v_smfmac_f32_16x16x64_bf16 v[60:63], v[32:35], v[248:255], v112
  v_cvt_pk_bf16_f32 v108, v108, v109
  ds_write_b32 v5, v108 offset:2560
  s_waitcnt lgkmcnt(2)
  v_mfma_f32_16x16x32_bf16 v[64:67], v[8:11], v[80:83], v[64:67]
  ds_read_b64_tr_b16 v[76:77], v6 offset:2048
  ds_read_b64_tr_b16 v[78:79], v6 offset:2560
  v_mfma_f32_16x16x32_bf16 v[68:71], v[12:15], v[80:83], v[68:71]
  v_add_f32 v108, v60, v61
  v_add_f32 v109, v62, v63
  v_mfma_f32_16x16x32_bf16 v[72:75], v[116:119], v[80:83], v[72:75]
  v_cvt_pk_bf16_f32 v108, v108, v109
  ds_write_b32 v5, v108 offset:3072
  ds_read_b64_tr_b16 v[84:85], v6 offset:3072
  ds_read_b64 v[116:117], v7 offset:1536
  s_waitcnt lgkmcnt(3)
  v_mfma_f32_16x16x32_bf16 v[64:67], v[100:103], v[76:79], v[64:67]
  v_mfma_f32_16x16x32_bf16 v[68:71], v[104:107], v[76:79], v[68:71]
  v_mfma_f32_16x16x32_bf16 v[72:75], v[96:99], v[76:79], v[72:75]
  s_waitcnt lgkmcnt(0)
  v_mfma_f32_16x16x16_bf16 v[64:67], v[86:87], v[84:85], v[64:67]
  v_mfma_f32_16x16x16_bf16 v[68:71], v[110:111], v[84:85], v[68:71]
  v_mfma_f32_16x16x16_bf16 v[72:75], v[116:117], v[84:85], v[72:75]
  s_nop 3
  ds_write_b128 v115, v[64:67] offset:0
  v_cmp_u_f32 vcc, v64, v64
  ds_write_b128 v115, v[68:71] offset:64
  s_nop 0
  ds_write_b128 v115, v[72:75] offset:128
  s_cbranch_vccnz mk_c_fs0_redo2
mk_c_fs0_cont2:
  s_waitcnt lgkmcnt(0)
  s_barrier
  ds_read_b64 v[8:9], v113 offset:0
  ds_read_b64 v[10:11], v113 offset:3328
  ds_read_b64 v[12:13], v113 offset:6656
  ds_read_b64 v[14:15], v113 offset:9984
  s_mov_b32 s30, 0x42800000
  s_waitcnt lgkmcnt(2)
  v_pk_add_f32 v[8:9], v[8:9], v[10:11]
  s_waitcnt lgkmcnt(0)
  v_pk_add_f32 v[12:13], v[12:13], v[14:15]
  v_pk_add_f32 v[8:9], v[8:9], v[12:13]
  v_max_f32 v12, |v8|, |v9|
  v_exp_f32 v10, v8
  v_cmp_nge_f32 vcc, s30, v12
  v_exp_f32 v11, v9
  s_and_b64 vcc, vcc, s[42:43]
  s_cbranch_vccnz mk_c_fs0_smax
mk_c_fs0_smax_ret:
  v_add_f32 v12, v10, v11
  v_cndmask_b32 v12, 0, v12, s[42:43]
  s_nop 1
  v_add_f32_dpp v12, v12, v12 row_ror:8 row_mask:0xf bank_mask:0xf
  s_nop 1
  v_add_f32_dpp v12, v12, v12 row_ror:4 row_mask:0xf bank_mask:0xf
  s_nop 1
  v_add_f32_dpp v12, v12, v12 row_ror:2 row_mask:0xf bank_mask:0xf
  s_nop 1
  v_add_f32_dpp v12, v12, v12 row_ror:1 row_mask:0xf bank_mask:0xf
  v_mov_b32 v13, v12
  s_mov_b64 exec, 15
  global_store_dword v0, v112, s[46:47]
  s_mov_b64 exec, -1
  v_permlane16_swap_b32 v12, v13
  v_add_f32 v12, v12, v13
  v_rcp_f32 v12, v12
  s_nop 0
  v_mul_f32 v8, v10, v12
  v_mul_f32 v9, v11, v12
  v_cvt_pk_bf16_f32 v8, v8, v9
  s_mov_b64 exec, s[42:43]
  global_store_dword v114, v8, s[46:47]
  s_mov_b64 exec, -1
  global_load_dwordx4 v[88:91], v1, s[54:55] offset:0 sc1
  global_load_dwordx4 v[92:95], v3, s[54:55] offset:0 sc1
  s_mov_b32 m0, 39936
  s_nop 0
  global_load_lds_dwordx4 v1, s[54:55] offset:1024 sc1
  s_mov_b32 m0, 40960
  s_nop 0
  global_load_lds_dwordx4 v3, s[54:55] offset:1024 sc1
  global_load_dwordx4 v[100:103], v1, s[54:55] offset:2048 sc1
  global_load_dwordx4 v[104:107], v3, s[54:55] offset:2048 sc1
  global_load_dwordx2 v[86:87], v1, s[54:55] offset:3072 sc1
  global_load_dwordx2 v[110:111], v3, s[54:55] offset:3072 sc1
  s_add_u32 s54, s54, 32768
  s_addc_u32 s55, s55, 0
  v_mov_b32 v108, -1
  global_store_dword v114, v108, s[48:49]
  s_mov_b64 exec, 15
  global_store_dword v0, v108, s[48:49]
  s_mov_b64 exec, -1
  s_mov_b64 s[48:49], s[46:47]
  s_mov_b64 s[46:47], s[50:51]
  s_add_u32 s44, s46, 10240
  s_addc_u32 s45, s47, 0
  s_add_u32 s36, s36, 1
  s_add_u32 s30, s38, 15728640
  s_add_u32 s50, s4, s30
  s_addc_u32 s51, s5, 0
  s_add_u32 s38, s38, 147456
  s_cmp_eq_u32 s38, 589824
  s_cselect_b32 s38, 0, s38
  s_add_u32 s8, s8, 458752
  s_addc_u32 s9, s9, 0
  v_mov_b32 v36, 0
  v_mov_b32 v37, 0
  v_mov_b32 v38, 0
  v_mov_b32 v39, 0
  v_mov_b32 v40, 0
  v_mov_b32 v41, 0
  v_mov_b32 v42, 0
  v_mov_b32 v43, 0
  v_mov_b32 v44, 0
  v_mov_b32 v45, 0
  v_mov_b32 v46, 0
  v_mov_b32 v47, 0
  v_mov_b32 v48, 0
  v_mov_b32 v49, 0
  v_mov_b32 v50, 0
  v_mov_b32 v51, 0
  v_mov_b32 v52, 0
  v_mov_b32 v53, 0
  v_mov_b32 v54, 0
  v_mov_b32 v55, 0
  v_mov_b32 v56, 0
  v_mov_b32 v57, 0
  v_mov_b32 v58, 0
  v_mov_b32 v59, 0
  v_mov_b32 v60, 0
  v_mov_b32 v61, 0
  v_mov_b32 v62, 0
  v_mov_b32 v63, 0
  s_cmp_lt_u32 s36, 63
  s_cbranch_scc1 mk_c_fs0_loop
  s_branch mk_c_done
mk_c_fs0_entry:
  s_branch mk_c_fs0_mem
mk_c_fs0_smax:
  v_mov_b32 v24, 0xff800000
  v_max_f32 v12, v8, v9
  v_cndmask_b32 v12, v24, v12, s[42:43]
  s_nop 1
  v_max_f32_dpp v12, v12, v12 row_ror:8 row_mask:0xf bank_mask:0xf
  s_nop 1
  v_max_f32_dpp v12, v12, v12 row_ror:4 row_mask:0xf bank_mask:0xf
  s_nop 1
  v_max_f32_dpp v12, v12, v12 row_ror:2 row_mask:0xf bank_mask:0xf
  s_nop 1
  v_max_f32_dpp v12, v12, v12 row_ror:1 row_mask:0xf bank_mask:0xf
  v_mov_b32 v13, v12
  s_nop 1
  v_permlane16_swap_b32 v12, v13
  v_max_f32 v12, v12, v13
  v_sub_f32 v10, v8, v12
  v_sub_f32 v11, v9, v12
  v_exp_f32 v10, v10
  v_exp_f32 v11, v11
  s_branch mk_c_fs0_smax_ret
mk_c_fs0_redo2:
  s_nop 7
  s_sub_u32 s40, s40, 2000
  s_cbranch_scc0 mk_c_fs0_redo3
  s_mov_b32 s40, 0
  s_branch mk_c_fs0_cont2
mk_c_fs0_redo:
  s_nop 7
  s_sub_u32 s40, s40, 1
  s_cbranch_scc1 mk_c_fs0_giveup
mk_c_fs0_redo3:
  v_mov_b32 v36, 0
  v_mov_b32 v37, 0
  v_mov_b32 v38, 0
  v_mov_b32 v39, 0
  v_mov_b32 v40, 0
  v_mov_b32 v41, 0
  v_mov_b32 v42, 0
  v_mov_b32 v43, 0
  v_mov_b32 v44, 0
  v_mov_b32 v45, 0
  v_mov_b32 v46, 0
  v_mov_b32 v47, 0
  v_mov_b32 v48, 0
  v_mov_b32 v49, 0
  v_mov_b32 v50, 0
  v_mov_b32 v51, 0
  v_mov_b32 v52, 0
  v_mov_b32 v53, 0
  v_mov_b32 v54, 0
  v_mov_b32 v55, 0
  v_mov_b32 v56, 0
  v_mov_b32 v57, 0
  v_mov_b32 v58, 0
  v_mov_b32 v59, 0
  v_mov_b32 v60, 0
  v_mov_b32 v61, 0
  v_mov_b32 v62, 0
  v_mov_b32 v63, 0
  s_waitcnt lgkmcnt(0)
  s_branch mk_c_fs0_mem
mk_c_fs0_giveup:
  s_mov_b32 s40, 0
  s_branch mk_c_fs0_cont
mk_c_fs1_loop:
  global_load_dword v96, v2, s[46:47] sc1
  s_nop 11
  global_load_dword v97, v2, s[46:47] sc1
  s_nop 11
  global_load_dword v98, v2, s[46:47] sc1
  s_nop 11
  global_load_dword v99, v2, s[46:47] sc1
  s_nop 11
mk_c_fs1_fp_26:
  global_load_dword v117, v2, s[46:47] sc1
  s_waitcnt vmcnt(4)
  v_cmp_eq_u32 vcc, -1, v96
  s_cbranch_vccz mk_c_fs1_fd_27
  global_load_dword v96, v2, s[46:47] sc1
  s_waitcnt vmcnt(4)
  v_cmp_eq_u32 vcc, -1, v97
  s_cbranch_vccz mk_c_fs1_fd_27
  global_load_dword v97, v2, s[46:47] sc1
  s_waitcnt vmcnt(4)
  v_cmp_eq_u32 vcc, -1, v98
  s_cbranch_vccz mk_c_fs1_fd_27
  global_load_dword v98, v2, s[46:47] sc1
  s_waitcnt vmcnt(4)
  v_cmp_eq_u32 vcc, -1, v99
  s_cbranch_vccz mk_c_fs1_fd_27
  global_load_dword v99, v2, s[46:47] sc1
  s_waitcnt vmcnt(4)
  v_cmp_eq_u32 vcc, -1, v117
  s_cbranch_vccz mk_c_fs1_fd_27
  s_sub_u32 s40, s40, 1
  s_cbranch_scc0 mk_c_fs1_fp_26
  s_mov_b32 s40, 0
mk_c_fs1_fd_27:
  s_barrier
mk_c_fs1_mem:
  global_load_dwordx4 v[16:19], v1, s[44:45] offset:2048 sc1
  s_nop 11
  global_load_dwordx4 v[20:23], v1, s[44:45] offset:3072 sc1
  s_nop 11
  global_load_dwordx4 v[24:27], v3, s[44:45] offset:0 sc1
  s_nop 11
  global_load_dwordx4 v[28:31], v3, s[44:45] offset:1024 sc1
  s_waitcnt vmcnt(3)
  v_smfmac_f32_16x16x64_bf16 v[36:39], v[16:19], a[16:23], v112
  ds_write_b128 v1, v[16:19] offset:4096
  v_smfmac_f32_16x16x64_bf16 v[40:43], v[16:19], a[72:79], v112
  global_load_dwordx4 v[32:35], v3, s[44:45] offset:2048 sc1
  v_smfmac_f32_16x16x64_bf16 v[44:47], v[16:19], a[128:135], v112
  v_max3_u32 v119, v16, v17, v18
  v_smfmac_f32_16x16x64_bf16 v[48:51], v[16:19], a[184:191], v112
  global_load_dwordx4 v[8:11], v1, s[44:45] offset:0 sc1
  v_smfmac_f32_16x16x64_bf16 v[52:55], v[16:19], a[240:247], v112
  v_max_u32 v119, v119, v19
  v_smfmac_f32_16x16x64_bf16 v[56:59], v[16:19], v[160:167], v112
  global_load_dwordx4 v[12:15], v1, s[44:45] offset:1024 sc1
  v_smfmac_f32_16x16x64_bf16 v[60:63], v[16:19], v[216:223], v112
  s_waitcnt vmcnt(5)
  v_smfmac_f32_16x16x64_bf16 v[36:39], v[20:23], a[24:31], v112
  ds_write_b128 v1, v[20:23] offset:5120
  v_smfmac_f32_16x16x64_bf16 v[40:43], v[20:23], a[80:87], v112
  v_smfmac_f32_16x16x64_bf16 v[44:47], v[20:23], a[136:143], v112
  v_max3_u32 v119, v119, v20, v21
  v_smfmac_f32_16x16x64_bf16 v[48:51], v[20:23], a[192:199], v112
  v_smfmac_f32_16x16x64_bf16 v[52:55], v[20:23], a[248:255], v112
  v_max3_u32 v119, v119, v22, v23
  v_smfmac_f32_16x16x64_bf16 v[56:59], v[20:23], v[168:175], v112
  v_smfmac_f32_16x16x64_bf16 v[60:63], v[20:23], v[224:231], v112
  s_waitcnt vmcnt(4)
  v_smfmac_f32_16x16x64_bf16 v[36:39], v[24:27], a[32:39], v112
  ds_read_b128 v[16:19], v1 offset:43008
  v_smfmac_f32_16x16x64_bf16 v[40:43], v[24:27], a[88:95], v112
  ds_read_b128 v[20:23], v1 offset:44032
  v_smfmac_f32_16x16x64_bf16 v[44:47], v[24:27], a[144:151], v112
  v_max3_u32 v119, v119, v24, v25
  v_smfmac_f32_16x16x64_bf16 v[48:51], v[24:27], a[200:207], v112
  v_max3_u32 v119, v119, v26, v27
  v_smfmac_f32_16x16x64_bf16 v[52:55], v[24:27], v[120:127], v112
  v_cmp_eq_u32 vcc, -1, v119
  v_smfmac_f32_16x16x64_bf16 v[56:59], v[24:27], v[176:183], v112
  v_smfmac_f32_16x16x64_bf16 v[60:63], v[24:27], v[232:239], v112
  s_cbranch_vccnz mk_c_fs1_redo
mk_c_fs1_cont:
  s_waitcnt vmcnt(3)
  v_smfmac_f32_16x16x64_bf16 v[36:39], v[28:31], a[40:47], v112
  s_waitcnt vmcnt(2)
  v_smfmac_f32_16x16x64_bf16 v[36:39], v[32:35], a[48:55], v112
  s_waitcnt vmcnt(1)
  v_smfmac_f32_16x16x64_bf16 v[36:39], v[8:11], a[0:7], v112
  s_waitcnt vmcnt(0)
  v_smfmac_f32_16x16x64_bf16 v[36:39], v[12:15], a[8:15], v112
  ds_write_b128 v1, v[12:15] offset:3072
  v_smfmac_f32_16x16x64_bf16 v[40:43], v[28:31], a[96:103], v112
  ds_read2_b64 v[96:99], v7 offset0:0 offset1:32
  ds_read2_b64 v[116:119], v7 offset0:64 offset1:96
  v_smfmac_f32_16x16x64_bf16 v[40:43], v[32:35], a[104:111], v112
  v_add_f32 v108, v36, v37
  v_smfmac_f32_16x16x64_bf16 v[40:43], v[8:11], a[56:63], v112
  v_add_f32 v109, v38, v39
  v_smfmac_f32_16x16x64_bf16 v[40:43], v[12:15], a[64:71], v112
  v_cvt_pk_bf16_f32 v108, v108, v109
  v_smfmac_f32_16x16x64_bf16 v[44:47], v[28:31], a[152:159], v112
  ds_write_b32 v5, v108 offset:0
  v_smfmac_f32_16x16x64_bf16 v[44:47], v[32:35], a[160:167], v112
  v_add_f32 v108, v40, v41
  v_smfmac_f32_16x16x64_bf16 v[44:47], v[8:11], a[112:119], v112
  v_add_f32 v109, v42, v43
  v_smfmac_f32_16x16x64_bf16 v[44:47], v[12:15], a[120:127], v112
  v_cvt_pk_bf16_f32 v108, v108, v109
  v_smfmac_f32_16x16x64_bf16 v[48:51], v[28:31], a[208:215], v112
  ds_write_b32 v5, v108 offset:512
  ds_read_b64_tr_b16 v[76:77], v6 offset:0
  v_smfmac_f32_16x16x64_bf16 v[48:51], v[32:35], a[216:223], v112
  v_add_f32 v108, v44, v45
  ds_read_b64_tr_b16 v[78:79], v6 offset:512
  v_smfmac_f32_16x16x64_bf16 v[48:51], v[8:11], a[168:175], v112
  v_add_f32 v109, v46, v47
  v_smfmac_f32_16x16x64_bf16 v[48:51], v[12:15], a[176:183], v112
  v_cvt_pk_bf16_f32 v108, v108, v109
  v_smfmac_f32_16x16x64_bf16 v[52:55], v[28:31], v[128:135], v112
  ds_write_b32 v5, v108 offset:1024
  v_smfmac_f32_16x16x64_bf16 v[52:55], v[32:35], v[136:143], v112
  v_add_f32 v108, v48, v49
  v_smfmac_f32_16x16x64_bf16 v[52:55], v[8:11], a[224:231], v112
  v_add_f32 v109, v50, v51
  v_smfmac_f32_16x16x64_bf16 v[52:55], v[12:15], a[232:239], v112
  v_cvt_pk_bf16_f32 v108, v108, v109
  s_waitcnt lgkmcnt(1)
  v_mfma_f32_16x16x32_bf16 v[64:67], v[88:91], v[76:79], 0
  v_mfma_f32_16x16x32_bf16 v[68:71], v[92:95], v[76:79], 0
  v_mfma_f32_16x16x32_bf16 v[72:75], v[96:99], v[76:79], 0
  ds_read2_b64 v[96:99], v7 offset0:128 offset1:160
  v_smfmac_f32_16x16x64_bf16 v[56:59], v[28:31], v[184:191], v112
  ds_write_b32 v5, v108 offset:1536
  ds_read_b64_tr_b16 v[80:81], v6 offset:1024
  v_smfmac_f32_16x16x64_bf16 v[56:59], v[32:35], v[192:199], v112
  v_add_f32 v108, v52, v53
  ds_read_b64_tr_b16 v[82:83], v6 offset:1536
  v_smfmac_f32_16x16x64_bf16 v[56:59], v[8:11], v[144:151], v112
  v_add_f32 v109, v54, v55
  v_smfmac_f32_16x16x64_bf16 v[56:59], v[12:15], v[152:159], v112
  v_cvt_pk_bf16_f32 v108, v108, v109
  v_smfmac_f32_16x16x64_bf16 v[60:63], v[28:31], v[240:247], v112
  ds_write_b32 v5, v108 offset:2048
  v_smfmac_f32_16x16x64_bf16 v[60:63], v[32:35], v[248:255], v112
  v_add_f32 v108, v56, v57
  v_smfmac_f32_16x16x64_bf16 v[60:63], v[8:11], v[200:207], v112
  v_add_f32 v109, v58, v59
  v_smfmac_f32_16x16x64_bf16 v[60:63], v[12:15], v[208:215], v112
  v_cvt_pk_bf16_f32 v108, v108, v109
  ds_write_b32 v5, v108 offset:2560
  s_waitcnt lgkmcnt(2)
  v_mfma_f32_16x16x32_bf16 v[64:67], v[16:19], v[80:83], v[64:67]
  ds_read_b64_tr_b16 v[76:77], v6 offset:2048
  ds_read_b64_tr_b16 v[78:79], v6 offset:2560
  v_mfma_f32_16x16x32_bf16 v[68:71], v[20:23], v[80:83], v[68:71]
  v_add_f32 v108, v60, v61
  v_add_f32 v109, v62, v63
  v_mfma_f32_16x16x32_bf16 v[72:75], v[116:119], v[80:83], v[72:75]
  v_cvt_pk_bf16_f32 v108, v108, v109
  ds_write_b32 v5, v108 offset:3072
  ds_read_b64_tr_b16 v[84:85], v6 offset:3072
  ds_read_b64 v[116:117], v7 offset:1536
  s_waitcnt lgkmcnt(3)
  v_mfma_f32_16x16x32_bf16 v[64:67], v[100:103], v[76:79], v[64:67]
  v_mfma_f32_16x16x32_bf16 v[68:71], v[104:107], v[76:79], v[68:71]
  v_mfma_f32_16x16x32_bf16 v[72:75], v[96:99], v[76:79], v[72:75]
  s_waitcnt lgkmcnt(0)
  v_mfma_f32_16x16x16_bf16 v[64:67], v[86:87], v[84:85], v[64:67]
  v_mfma_f32_16x16x16_bf16 v[68:71], v[110:111], v[84:85], v[68:71]
  v_mfma_f32_16x16x16_bf16 v[72:75], v[116:117], v[84:85], v[72:75]
  s_nop 3
  ds_write_b128 v115, v[64:67] offset:0
  v_cmp_u_f32 vcc, v64, v64
  ds_write_b128 v115, v[68:71] offset:64
  s_nop 0
  ds_write_b128 v115, v[72:75] offset:128
  s_cbranch_vccnz mk_c_fs1_redo2
mk_c_fs1_cont2:
  s_waitcnt lgkmcnt(0)
  s_barrier
  ds_read_b64 v[8:9], v113 offset:0
  ds_read_b64 v[10:11], v113 offset:3328
  ds_read_b64 v[12:13], v113 offset:6656
  ds_read_b64 v[14:15], v113 offset:9984
  s_mov_b32 s30, 0x42800000
  s_waitcnt lgkmcnt(2)
  v_pk_add_f32 v[8:9], v[8:9], v[10:11]
  s_waitcnt lgkmcnt(0)
  v_pk_add_f32 v[12:13], v[12:13], v[14:15]
  v_pk_add_f32 v[8:9], v[8:9], v[12:13]
  v_max_f32 v12, |v8|, |v9|
  v_exp_f32 v10, v8
  v_cmp_nge_f32 vcc, s30, v12
  v_exp_f32 v11, v9
  s_and_b64 vcc, vcc, s[42:43]
  s_cbranch_vccnz mk_c_fs1_smax
mk_c_fs1_smax_ret:
  v_add_f32 v12, v10, v11
  v_cndmask_b32 v12, 0, v12, s[42:43]
  s_nop 1
  v_add_f32_dpp v12, v12, v12 row_ror:8 row_mask:0xf bank_mask:0xf
  s_nop 1
  v_add_f32_dpp v12, v12, v12 row_ror:4 row_mask:0xf bank_mask:0xf
  s_nop 1
  v_add_f32_dpp v12, v12, v12 row_ror:2 row_mask:0xf bank_mask:0xf
  s_nop 1
  v_add_f32_dpp v12, v12, v12 row_ror:1 row_mask:0xf bank_mask:0xf
  v_mov_b32 v13, v12
  s_nop 1
  v_permlane16_swap_b32 v12, v13
  v_add_f32 v12, v12, v13
  v_rcp_f32 v12, v12
  s_nop 0
  v_mul_f32 v8, v10, v12
  v_mul_f32 v9, v11, v12
  v_cvt_pk_bf16_f32 v8, v8, v9
  s_mov_b64 exec, s[42:43]
  global_store_dword v114, v8, s[46:47]
  s_mov_b64 exec, -1
  global_load_dwordx4 v[88:91], v1, s[54:55] offset:0 sc1
  global_load_dwordx4 v[92:95], v3, s[54:55] offset:0 sc1
  s_mov_b32 m0, 41984
  s_nop 0
  global_load_lds_dwordx4 v1, s[54:55] offset:1024 sc1
  s_mov_b32 m0, 43008
  s_nop 0
  global_load_lds_dwordx4 v3, s[54:55] offset:1024 sc1
  global_load_dwordx4 v[100:103], v1, s[54:55] offset:2048 sc1
  global_load_dwordx4 v[104:107], v3, s[54:55] offset:2048 sc1
  global_load_dwordx2 v[86:87], v1, s[54:55] offset:3072 sc1
  global_load_dwordx2 v[110:111], v3, s[54:55] offset:3072 sc1
  s_add_u32 s54, s54, 32768
  s_addc_u32 s55, s55, 0
  v_mov_b32 v108, -1
  global_store_dword v114, v108, s[48:49]
  s_mov_b64 s[48:49], s[46:47]
  s_mov_b64 s[46:47], s[50:51]
  s_add_u32 s44, s46, 10240
  s_addc_u32 s45, s47, 0
  s_add_u32 s36, s36, 1
  s_add_u32 s30, s38, 15728640
  s_add_u32 s50, s4, s30
  s_addc_u32 s51, s5, 0
  s_add_u32 s38, s38, 147456
  s_cmp_eq_u32 s38, 589824
  s_cselect_b32 s38, 0, s38
  s_add_u32 s8, s8, 458752
  s_addc_u32 s9, s9, 0
  v_mov_b32 v36, 0
  v_mov_b32 v37, 0
  v_mov_b32 v38, 0
  v_mov_b32 v39, 0
  v_mov_b32 v40, 0
  v_mov_b32 v41, 0
  v_mov_b32 v42, 0
  v_mov_b32 v43, 0
  v_mov_b32 v44, 0
  v_mov_b32 v45, 0
  v_mov_b32 v46, 0
  v_mov_b32 v47, 0
  v_mov_b32 v48, 0
  v_mov_b32 v49, 0
  v_mov_b32 v50, 0
  v_mov_b32 v51, 0
  v_mov_b32 v52, 0
  v_mov_b32 v53, 0
  v_mov_b32 v54, 0
  v_mov_b32 v55, 0
  v_mov_b32 v56, 0
  v_mov_b32 v57, 0
  v_mov_b32 v58, 0
  v_mov_b32 v59, 0
  v_mov_b32 v60, 0
  v_mov_b32 v61, 0
  v_mov_b32 v62, 0
  v_mov_b32 v63, 0
  s_cmp_lt_u32 s36, 63
  s_cbranch_scc1 mk_c_fs1_loop
  s_branch mk_c_done
mk_c_fs1_entry:
  s_branch mk_c_fs1_mem
mk_c_fs1_smax:
  v_mov_b32 v24, 0xff800000
  v_max_f32 v12, v8, v9
  v_cndmask_b32 v12, v24, v12, s[42:43]
  s_nop 1
  v_max_f32_dpp v12, v12, v12 row_ror:8 row_mask:0xf bank_mask:0xf
  s_nop 1
  v_max_f32_dpp v12, v12, v12 row_ror:4 row_mask:0xf bank_mask:0xf
  s_nop 1
  v_max_f32_dpp v12, v12, v12 row_ror:2 row_mask:0xf bank_mask:0xf
  s_nop 1
  v_max_f32_dpp v12, v12, v12 row_ror:1 row_mask:0xf bank_mask:0xf
  v_mov_b32 v13, v12
  s_nop 1
  v_permlane16_swap_b32 v12, v13
  v_max_f32 v12, v12, v13
  v_sub_f32 v10, v8, v12
  v_sub_f32 v11, v9, v12
  v_exp_f32 v10, v10
  v_exp_f32 v11, v11
  s_branch mk_c_fs1_smax_ret
mk_c_fs1_redo2:
  s_nop 7
  s_sub_u32 s40, s40, 2000
  s_cbranch_scc0 mk_c_fs1_redo3
  s_mov_b32 s40, 0
  s_branch mk_c_fs1_cont2
mk_c_fs1_redo:
  s_nop 7
  s_sub_u32 s40, s40, 1
  s_cbranch_scc1 mk_c_fs1_giveup
mk_c_fs1_redo3:
  v_mov_b32 v36, 0
  v_mov_b32 v37, 0
  v_mov_b32 v38, 0
  v_mov_b32 v39, 0
  v_mov_b32 v40, 0
  v_mov_b32 v41, 0
  v_mov_b32 v42, 0
  v_mov_b32 v43, 0
  v_mov_b32 v44, 0
  v_mov_b32 v45, 0
  v_mov_b32 v46, 0
  v_mov_b32 v47, 0
  v_mov_b32 v48, 0
  v_mov_b32 v49, 0
  v_mov_b32 v50, 0
  v_mov_b32 v51, 0
  v_mov_b32 v52, 0
  v_mov_b32 v53, 0
  v_mov_b32 v54, 0
  v_mov_b32 v55, 0
  v_mov_b32 v56, 0
  v_mov_b32 v57, 0
  v_mov_b32 v58, 0
  v_mov_b32 v59, 0
  v_mov_b32 v60, 0
  v_mov_b32 v61, 0
  v_mov_b32 v62, 0
  v_mov_b32 v63, 0
  s_waitcnt lgkmcnt(0)
  s_branch mk_c_fs1_mem
mk_c_fs1_giveup:
  s_mov_b32 s40, 0
  s_branch mk_c_fs1_cont
mk_c_fs2_loop:
  s_barrier
mk_c_fs2_mem:
  global_load_dwordx4 v[24:27], v3, s[44:45] offset:0 sc1
  s_nop 11
  global_load_dwordx4 v[28:31], v3, s[44:45] offset:1024 sc1
  s_nop 11
  global_load_dwordx4 v[32:35], v3, s[44:45] offset:2048 sc1
  s_nop 11
  global_load_dwordx4 v[8:11], v1, s[44:45] offset:0 sc1
  s_waitcnt vmcnt(3)
  v_smfmac_f32_16x16x64_bf16 v[36:39], v[24:27], a[32:39], v112
  ds_write_b128 v1, v[24:27] offset:7168
  v_smfmac_f32_16x16x64_bf16 v[40:43], v[24:27], a[88:95], v112
  global_load_dwordx4 v[12:15], v1, s[44:45] offset:1024 sc1
  v_smfmac_f32_16x16x64_bf16 v[44:47], v[24:27], a[144:151], v112
  v_max3_u32 v119, v24, v25, v26
  v_smfmac_f32_16x16x64_bf16 v[48:51], v[24:27], a[200:207], v112
  global_load_dwordx4 v[16:19], v1, s[44:45] offset:2048 sc1
  v_smfmac_f32_16x16x64_bf16 v[52:55], v[24:27], v[120:127], v112
  v_max_u32 v119, v119, v27
  v_smfmac_f32_16x16x64_bf16 v[56:59], v[24:27], v[176:183], v112
  global_load_dwordx4 v[20:23], v1, s[44:45] offset:3072 sc1
  v_smfmac_f32_16x16x64_bf16 v[60:63], v[24:27], v[232:239], v112
  s_waitcnt vmcnt(5)
  v_smfmac_f32_16x16x64_bf16 v[36:39], v[28:31], a[40:47], v112
  ds_write_b128 v1, v[28:31] offset:8192
  v_smfmac_f32_16x16x64_bf16 v[40:43], v[28:31], a[96:103], v112
  v_smfmac_f32_16x16x64_bf16 v[44:47], v[28:31], a[152:159], v112
  v_max3_u32 v119, v119, v28, v29
  v_smfmac_f32_16x16x64_bf16 v[48:51], v[28:31], a[208:215], v112
  v_smfmac_f32_16x16x64_bf16 v[52:55], v[28:31], v[128:135], v112
  v_max3_u32 v119, v119, v30, v31
  v_smfmac_f32_16x16x64_bf16 v[56:59], v[28:31], v[184:191], v112
  v_smfmac_f32_16x16x64_bf16 v[60:63], v[28:31], v[240:247], v112
  s_waitcnt vmcnt(4)
  v_smfmac_f32_16x16x64_bf16 v[36:39], v[32:35], a[48:55], v112
  ds_read_b128 v[24:27], v1 offset:45056
  v_smfmac_f32_16x16x64_bf16 v[40:43], v[32:35], a[104:111], v112
  ds_read_b128 v[28:31], v1 offset:46080
  v_smfmac_f32_16x16x64_bf16 v[44:47], v[32:35], a[160:167], v112
  v_max3_u32 v119, v119, v32, v33
  v_smfmac_f32_16x16x64_bf16 v[48:51], v[32:35], a[216:223], v112
  v_max3_u32 v119, v119, v34, v35
  v_smfmac_f32_16x16x64_bf16 v[52:55], v[32:35], v[136:143], v112
  v_cmp_eq_u32 vcc, -1, v119
  v_smfmac_f32_16x16x64_bf16 v[56:59], v[32:35], v[192:199], v112
  v_smfmac_f32_16x16x64_bf16 v[60:63], v[32:35], v[248:255], v112
  s_cbranch_vccnz mk_c_fs2_redo
mk_c_fs2_cont:
  s_waitcnt vmcnt(3)
  v_smfmac_f32_16x16x64_bf16 v[36:39], v[8:11], a[0:7], v112
  s_waitcnt vmcnt(2)
  v_smfmac_f32_16x16x64_bf16 v[36:39], v[12:15], a[8:15], v112
  s_waitcnt vmcnt(1)
  v_smfmac_f32_16x16x64_bf16 v[36:39], v[16:19], a[16:23], v112
  s_waitcnt vmcnt(0)
  v_smfmac_f32_16x16x64_bf16 v[36:39], v[20:23], a[24:31], v112
  ds_write_b128 v1, v[20:23] offset:6144
  v_smfmac_f32_16x16x64_bf16 v[40:43], v[8:11], a[56:63], v112
  ds_read2_b64 v[96:99], v7 offset0:0 offset1:32
  ds_read2_b64 v[116:119], v7 offset0:64 offset1:96
  v_smfmac_f32_16x16x64_bf16 v[40:43], v[12:15], a[64:71], v112
  v_add_f32 v108, v36, v37
  v_smfmac_f32_16x16x64_bf16 v[40:43], v[16:19], a[72:79], v112
  v_add_f32 v109, v38, v39
  v_smfmac_f32_16x16x64_bf16 v[40:43], v[20:23], a[80:87], v112
  v_cvt_pk_bf16_f32 v108, v108, v109
  v_smfmac_f32_16x16x64_bf16 v[44:47], v[8:11], a[112:119], v112
  ds_write_b32 v5, v108 offset:0
  v_smfmac_f32_16x16x64_bf16 v[44:47], v[12:15], a[120:127], v112
  v_add_f32 v108, v40, v41
  v_smfmac_f32_16x16x64_bf16 v[44:47], v[16:19], a[128:135], v112
  v_add_f32 v109, v42, v43
  v_smfmac_f32_16x16x64_bf16 v[44:47], v[20:23], a[136:143], v112
  v_cvt_pk_bf16_f32 v108, v108, v109
  v_smfmac_f32_16x16x64_bf16 v[48:51], v[8:11], a[168:175], v112
  ds_write_b32 v5, v108 offset:512
  ds_read_b64_tr_b16 v[76:77], v6 offset:0
  v_smfmac_f32_16x16x64_bf16 v[48:51], v[12:15], a[176:183], v112
  v_add_f32 v108, v44, v45
  ds_read_b64_tr_b16 v[78:79], v6 offset:512
  v_smfmac_f32_16x16x64_bf16 v[48:51], v[16:19], a[184:191], v112
  v_add_f32 v109, v46, v47
  v_smfmac_f32_16x16x64_bf16 v[48:51], v[20:23], a[192:199], v112
  v_cvt_pk_bf16_f32 v108, v108, v109
  v_smfmac_f32_16x16x64_bf16 v[52:55], v[8:11], a[224:231], v112
  ds_write_b32 v5, v108 offset:1024
  v_smfmac_f32_16x16x64_bf16 v[52:55], v[12:15], a[232:239], v112
  v_add_f32 v108, v48, v49
  v_smfmac_f32_16x16x64_bf16 v[52:55], v[16:19], a[240:247], v112
  v_add_f32 v109, v50, v51
  v_smfmac_f32_16x16x64_bf16 v[52:55], v[20:23], a[248:255], v112
  v_cvt_pk_bf16_f32 v108, v108, v109
  s_waitcnt lgkmcnt(1)
  v_mfma_f32_16x16x32_bf16 v[64:67], v[88:91], v[76:79], 0
  v_mfma_f32_16x16x32_bf16 v[68:71], v[92:95], v[76:79], 0
  v_mfma_f32_16x16x32_bf16 v[72:75], v[96:99], v[76:79], 0
  ds_read2_b64 v[96:99], v7 offset0:128 offset1:160
  v_smfmac_f32_16x16x64_bf16 v[56:59], v[8:11], v[144:151], v112
  ds_write_b32 v5, v108 offset:1536
  ds_read_b64_tr_b16 v[80:81], v6 offset:1024
  v_smfmac_f32_16x16x64_bf16 v[56:59], v[12:15], v[152:159], v112
  v_add_f32 v108, v52, v53
  ds_read_b64_tr_b16 v[82:83], v6 offset:1536
  v_smfmac_f32_16x16x64_bf16 v[56:59], v[16:19], v[160:167], v112
  v_add_f32 v109, v54, v55
  v_smfmac_f32_16x16x64_bf16 v[56:59], v[20:23], v[168:175], v112
  v_cvt_pk_bf16_f32 v108, v108, v109
  v_smfmac_f32_16x16x64_bf16 v[60:63], v[8:11], v[200:207], v112
  ds_write_b32 v5, v108 offset:2048
  v_smfmac_f32_16x16x64_bf16 v[60:63], v[12:15], v[208:215], v112
  v_add_f32 v108, v56, v57
  v_smfmac_f32_16x16x64_bf16 v[60:63], v[16:19], v[216:223], v112
  v_add_f32 v109, v58, v59
  v_smfmac_f32_16x16x64_bf16 v[60:63], v[20:23], v[224:231], v112
  v_cvt_pk_bf16_f32 v108, v108, v109
  ds_write_b32 v5, v108 offset:2560
  s_waitcnt lgkmcnt(2)
  v_mfma_f32_16x16x32_bf16 v[64:67], v[24:27], v[80:83], v[64:67]
  ds_read_b64_tr_b16 v[76:77], v6 offset:2048
  ds_read_b64_tr_b16 v[78:79], v6 offset:2560
  v_mfma_f32_16x16x32_bf16 v[68:71], v[28:31], v[80:83], v[68:71]
  v_add_f32 v108, v60, v61
  v_add_f32 v109, v62, v63
  v_mfma_f32_16x16x32_bf16 v[72:75], v[116:119], v[80:83], v[72:75]
  v_cvt_pk_bf16_f32 v108, v108, v109
  ds_write_b32 v5, v108 offset:3072
  ds_read_b64_tr_b16 v[84:85], v6 offset:3072
  ds_read_b64 v[116:117], v7 offset:1536
  s_waitcnt lgkmcnt(3)
  v_mfma_f32_16x16x32_bf16 v[64:67], v[100:103], v[76:79], v[64:67]
  v_mfma_f32_16x16x32_bf16 v[68:71], v[104:107], v[76:79], v[68:71]
  v_mfma_f32_16x16x32_bf16 v[72:75], v[96:99], v[76:79], v[72:75]
  s_waitcnt lgkmcnt(0)
  v_mfma_f32_16x16x16_bf16 v[64:67], v[86:87], v[84:85], v[64:67]
  v_mfma_f32_16x16x16_bf16 v[68:71], v[110:111], v[84:85], v[68:71]
  v_mfma_f32_16x16x16_bf16 v[72:75], v[116:117], v[84:85], v[72:75]
  s_nop 3
  ds_write_b128 v115, v[64:67] offset:0
  v_cmp_u_f32 vcc, v64, v64
  ds_write_b128 v115, v[68:71] offset:64
  s_nop 0
  ds_write_b128 v115, v[72:75] offset:128
  s_cbranch_vccnz mk_c_fs2_redo2
mk_c_fs2_cont2:
  s_waitcnt lgkmcnt(0)
  s_barrier
  ds_read_b64 v[8:9], v113 offset:0
  ds_read_b64 v[10:11], v113 offset:3328
  ds_read_b64 v[12:13], v113 offset:6656
  ds_read_b64 v[14:15], v113 offset:9984
  s_mov_b32 s30, 0x42800000
  s_waitcnt lgkmcnt(2)
  v_pk_add_f32 v[8:9], v[8:9], v[10:11]
  s_waitcnt lgkmcnt(0)
  v_pk_add_f32 v[12:13], v[12:13], v[14:15]
  v_pk_add_f32 v[8:9], v[8:9], v[12:13]
  v_max_f32 v12, |v8|, |v9|
  v_exp_f32 v10, v8
  v_cmp_nge_f32 vcc, s30, v12
  v_exp_f32 v11, v9
  s_and_b64 vcc, vcc, s[42:43]
  s_cbranch_vccnz mk_c_fs2_smax
mk_c_fs2_smax_ret:
  v_add_f32 v12, v10, v11
  v_cndmask_b32 v12, 0, v12, s[42:43]
  s_nop 1
  v_add_f32_dpp v12, v12, v12 row_ror:8 row_mask:0xf bank_mask:0xf
  s_nop 1
  v_add_f32_dpp v12, v12, v12 row_ror:4 row_mask:0xf bank_mask:0xf
  s_nop 1
  v_add_f32_dpp v12, v12, v12 row_ror:2 row_mask:0xf bank_mask:0xf
  s_nop 1
  v_add_f32_dpp v12, v12, v12 row_ror:1 row_mask:0xf bank_mask:0xf
  v_mov_b32 v13, v12
  s_nop 1
  v_permlane16_swap_b32 v12, v13
  v_add_f32 v12, v12, v13
  v_rcp_f32 v12, v12
  s_nop 0
  v_mul_f32 v8, v10, v12
  v_mul_f32 v9, v11, v12
  v_cvt_pk_bf16_f32 v8, v8, v9
  s_mov_b64 exec, s[42:43]
  global_store_dword v114, v8, s[46:47]
  s_mov_b64 exec, -1
  global_load_dwordx4 v[88:91], v1, s[54:55] offset:0 sc1
  global_load_dwordx4 v[92:95], v3, s[54:55] offset:0 sc1
  s_mov_b32 m0, 44032
  s_nop 0
  global_load_lds_dwordx4 v1, s[54:55] offset:1024 sc1
  s_mov_b32 m0, 45056
  s_nop 0
  global_load_lds_dwordx4 v3, s[54:55] offset:1024 sc1
  global_load_dwordx4 v[100:103], v1, s[54:55] offset:2048 sc1
  global_load_dwordx4 v[104:107], v3, s[54:55] offset:2048 sc1
  global_load_dwordx2 v[86:87], v1, s[54:55] offset:3072 sc1
  global_load_dwordx2 v[110:111], v3, s[54:55] offset:3072 sc1
  s_add_u32 s54, s54, 32768
  s_addc_u32 s55, s55, 0
  v_mov_b32 v108, -1
  global_store_dword v114, v108, s[48:49]
  s_mov_b64 s[48:49], s[46:47]
  s_mov_b64 s[46:47], s[50:51]
  s_add_u32 s44, s46, 10240
  s_addc_u32 s45, s47, 0
  s_add_u32 s36, s36, 1
  s_add_u32 s30, s38, 15728640
  s_add_u32 s50, s4, s30
  s_addc_u32 s51, s5, 0
  s_add_u32 s38, s38, 147456
  s_cmp_eq_u32 s38, 589824
  s_cselect_b32 s38, 0, s38
  s_add_u32 s8, s8, 458752
  s_addc_u32 s9, s9, 0
  v_mov_b32 v36, 0
  v_mov_b32 v37, 0
  v_mov_b32 v38, 0
  v_mov_b32 v39, 0
  v_mov_b32 v40, 0
  v_mov_b32 v41, 0
  v_mov_b32 v42, 0
  v_mov_b32 v43, 0
  v_mov_b32 v44, 0
  v_mov_b32 v45, 0
  v_mov_b32 v46, 0
  v_mov_b32 v47, 0
  v_mov_b32 v48, 0
  v_mov_b32 v49, 0
  v_mov_b32 v50, 0
  v_mov_b32 v51, 0
  v_mov_b32 v52, 0
  v_mov_b32 v53, 0
  v_mov_b32 v54, 0
  v_mov_b32 v55, 0
  v_mov_b32 v56, 0
  v_mov_b32 v57, 0
  v_mov_b32 v58, 0
  v_mov_b32 v59, 0
  v_mov_b32 v60, 0
  v_mov_b32 v61, 0
  v_mov_b32 v62, 0
  v_mov_b32 v63, 0
  s_cmp_lt_u32 s36, 63
  s_cbranch_scc1 mk_c_fs2_loop
  s_branch mk_c_done
mk_c_fs2_entry:
  s_branch mk_c_fs2_mem
mk_c_fs2_smax:
  v_mov_b32 v24, 0xff800000
  v_max_f32 v12, v8, v9
  v_cndmask_b32 v12, v24, v12, s[42:43]
  s_nop 1
  v_max_f32_dpp v12, v12, v12 row_ror:8 row_mask:0xf bank_mask:0xf
  s_nop 1
  v_max_f32_dpp v12, v12, v12 row_ror:4 row_mask:0xf bank_mask:0xf
  s_nop 1
  v_max_f32_dpp v12, v12, v12 row_ror:2 row_mask:0xf bank_mask:0xf
  s_nop 1
  v_max_f32_dpp v12, v12, v12 row_ror:1 row_mask:0xf bank_mask:0xf
  v_mov_b32 v13, v12
  s_nop 1
  v_permlane16_swap_b32 v12, v13
  v_max_f32 v12, v12, v13
  v_sub_f32 v10, v8, v12
  v_sub_f32 v11, v9, v12
  v_exp_f32 v10, v10
  v_exp_f32 v11, v11
  s_branch mk_c_fs2_smax_ret
mk_c_fs2_redo2:
  s_nop 7
  s_sub_u32 s40, s40, 2000
  s_cbranch_scc0 mk_c_fs2_redo3
  s_mov_b32 s40, 0
  s_branch mk_c_fs2_cont2
mk_c_fs2_redo:
  s_nop 7
  s_sub_u32 s40, s40, 1
  s_cbranch_scc1 mk_c_fs2_giveup
mk_c_fs2_redo3:
  v_mov_b32 v36, 0
  v_mov_b32 v37, 0
  v_mov_b32 v38, 0
  v_mov_b32 v39, 0
  v_mov_b32 v40, 0
  v_mov_b32 v41, 0
  v_mov_b32 v42, 0
  v_mov_b32 v43, 0
  v_mov_b32 v44, 0
  v_mov_b32 v45, 0
  v_mov_b32 v46, 0
  v_mov_b32 v47, 0
  v_mov_b32 v48, 0
  v_mov_b32 v49, 0
  v_mov_b32 v50, 0
  v_mov_b32 v51, 0
  v_mov_b32 v52, 0
  v_mov_b32 v53, 0
  v_mov_b32 v54, 0
  v_mov_b32 v55, 0
  v_mov_b32 v56, 0
  v_mov_b32 v57, 0
  v_mov_b32 v58, 0
  v_mov_b32 v59, 0
  v_mov_b32 v60, 0
  v_mov_b32 v61, 0
  v_mov_b32 v62, 0
  v_mov_b32 v63, 0
  s_waitcnt lgkmcnt(0)
  s_branch mk_c_fs2_mem
mk_c_fs2_giveup:
  s_mov_b32 s40, 0
  s_branch mk_c_fs2_cont
mk_c_fs3_loop:
  s_barrier
mk_c_fs3_mem:
  global_load_dwordx4 v[32:35], v3, s[44:45] offset:2048 sc1
  s_nop 11
  global_load_dwordx4 v[8:11], v1, s[44:45] offset:0 sc1
  s_nop 11
  global_load_dwordx4 v[12:15], v1, s[44:45] offset:1024 sc1
  s_nop 11
  global_load_dwordx4 v[16:19], v1, s[44:45] offset:2048 sc1
  s_waitcnt vmcnt(3)
  v_smfmac_f32_16x16x64_bf16 v[36:39], v[32:35], a[48:55], v112
  ds_write_b128 v1, v[32:35] offset:10240
  v_smfmac_f32_16x16x64_bf16 v[40:43], v[32:35], a[104:111], v112
  global_load_dwordx4 v[20:23], v1, s[44:45] offset:3072 sc1
  v_smfmac_f32_16x16x64_bf16 v[44:47], v[32:35], a[160:167], v112
  v_max3_u32 v119, v32, v33, v34
  v_smfmac_f32_16x16x64_bf16 v[48:51], v[32:35], a[216:223], v112
  global_load_dwordx4 v[24:27], v3, s[44:45] offset:0 sc1
  v_smfmac_f32_16x16x64_bf16 v[52:55], v[32:35], v[136:143], v112
  v_max_u32 v119, v119, v35
  v_smfmac_f32_16x16x64_bf16 v[56:59], v[32:35], v[192:199], v112
  global_load_dwordx4 v[28:31], v3, s[44:45] offset:1024 sc1
  v_smfmac_f32_16x16x64_bf16 v[60:63], v[32:35], v[248:255], v112
  s_waitcnt vmcnt(5)
  v_smfmac_f32_16x16x64_bf16 v[36:39], v[8:11], a[0:7], v112
  v_smfmac_f32_16x16x64_bf16 v[40:43], v[8:11], a[56:63], v112
  v_smfmac_f32_16x16x64_bf16 v[44:47], v[8:11], a[112:119], v112
  v_max3_u32 v119, v119, v8, v9
  v_smfmac_f32_16x16x64_bf16 v[48:51], v[8:11], a[168:175], v112
  v_smfmac_f32_16x16x64_bf16 v[52:55], v[8:11], a[224:231], v112
  v_max3_u32 v119, v119, v10, v11
  v_smfmac_f32_16x16x64_bf16 v[56:59], v[8:11], v[144:151], v112
  v_smfmac_f32_16x16x64_bf16 v[60:63], v[8:11], v[200:207], v112
  s_waitcnt vmcnt(4)
  v_smfmac_f32_16x16x64_bf16 v[36:39], v[12:15], a[8:15], v112
  ds_read_b128 v[32:35], v1 offset:47104
  v_smfmac_f32_16x16x64_bf16 v[40:43], v[12:15], a[64:71], v112
  ds_read_b128 v[8:11], v1 offset:48128
  v_smfmac_f32_16x16x64_bf16 v[44:47], v[12:15], a[120:127], v112
  v_max3_u32 v119, v119, v12, v13
  v_smfmac_f32_16x16x64_bf16 v[48:51], v[12:15], a[176:183], v112
  v_max3_u32 v119, v119, v14, v15
  v_smfmac_f32_16x16x64_bf16 v[52:55], v[12:15], a[232:239], v112
  v_cmp_eq_u32 vcc, -1, v119
  v_smfmac_f32_16x16x64_bf16 v[56:59], v[12:15], v[152:159], v112
  v_smfmac_f32_16x16x64_bf16 v[60:63], v[12:15], v[208:215], v112
  s_cbranch_vccnz mk_c_fs3_redo
mk_c_fs3_cont:
  s_waitcnt vmcnt(3)
  v_smfmac_f32_16x16x64_bf16 v[36:39], v[16:19], a[16:23], v112
  s_waitcnt vmcnt(2)
  v_smfmac_f32_16x16x64_bf16 v[36:39], v[20:23], a[24:31], v112
  s_waitcnt vmcnt(1)
  v_smfmac_f32_16x16x64_bf16 v[36:39], v[24:27], a[32:39], v112
  s_waitcnt vmcnt(0)
  v_smfmac_f32_16x16x64_bf16 v[36:39], v[28:31], a[40:47], v112
  ds_write_b128 v1, v[28:31] offset:9216
  v_smfmac_f32_16x16x64_bf16 v[40:43], v[16:19], a[72:79], v112
  ds_read2_b64 v[96:99], v7 offset0:0 offset1:32
  ds_read2_b64 v[116:119], v7 offset0:64 offset1:96
  v_smfmac_f32_16x16x64_bf16 v[40:43], v[20:23], a[80:87], v112
  v_add_f32 v108, v36, v37
  v_smfmac_f32_16x16x64_bf16 v[40:43], v[24:27], a[88:95], v112
  v_add_f32 v109, v38, v39
  v_smfmac_f32_16x16x64_bf16 v[40:43], v[28:31], a[96:103], v112
  v_cvt_pk_bf16_f32 v108, v108, v109
  v_smfmac_f32_16x16x64_bf16 v[44:47], v[16:19], a[128:135], v112
  ds_write_b32 v5, v108 offset:0
  v_smfmac_f32_16x16x64_bf16 v[44:47], v[20:23], a[136:143], v112
  v_add_f32 v108, v40, v41
  v_smfmac_f32_16x16x64_bf16 v[44:47], v[24:27], a[144:151], v112
  v_add_f32 v109, v42, v43
  v_smfmac_f32_16x16x64_bf16 v[44:47], v[28:31], a[152:159], v112
  v_cvt_pk_bf16_f32 v108, v108, v109
  v_smfmac_f32_16x16x64_bf16 v[48:51], v[16:19], a[184:191], v112
  ds_write_b32 v5, v108 offset:512
  ds_read_b64_tr_b16 v[76:77], v6 offset:0
  v_smfmac_f32_16x16x64_bf16 v[48:51], v[20:23], a[192:199], v112
  v_add_f32 v108, v44, v45
  ds_read_b64_tr_b16 v[78:79], v6 offset:512
  v_smfmac_f32_16x16x64_bf16 v[48:51], v[24:27], a[200:207], v112
  v_add_f32 v109, v46, v47
  v_smfmac_f32_16x16x64_bf16 v[48:51], v[28:31], a[208:215], v112
  v_cvt_pk_bf16_f32 v108, v108, v109
  v_smfmac_f32_16x16x64_bf16 v[52:55], v[16:19], a[240:247], v112
  ds_write_b32 v5, v108 offset:1024
  v_smfmac_f32_16x16x64_bf16 v[52:55], v[20:23], a[248:255], v112
  v_add_f32 v108, v48, v49
  v_smfmac_f32_16x16x64_bf16 v[52:55], v[24:27], v[120:127], v112
  v_add_f32 v109, v50, v51
  v_smfmac_f32_16x16x64_bf16 v[52:55], v[28:31], v[128:135], v112
  v_cvt_pk_bf16_f32 v108, v108, v109
  s_waitcnt lgkmcnt(1)
  v_mfma_f32_16x16x32_bf16 v[64:67], v[88:91], v[76:79], 0
  v_mfma_f32_16x16x32_bf16 v[68:71], v[92:95], v[76:79], 0
  v_mfma_f32_16x16x32_bf16 v[72:75], v[96:99], v[76:79], 0
  ds_read2_b64 v[96:99], v7 offset0:128 offset1:160
  v_smfmac_f32_16x16x64_bf16 v[56:59], v[16:19], v[160:167], v112
  ds_write_b32 v5, v108 offset:1536
  ds_read_b64_tr_b16 v[80:81], v6 offset:1024
  v_smfmac_f32_16x16x64_bf16 v[56:59], v[20:23], v[168:175], v112
  v_add_f32 v108, v52, v53
  ds_read_b64_tr_b16 v[82:83], v6 offset:1536
  v_smfmac_f32_16x16x64_bf16 v[56:59], v[24:27], v[176:183], v112
  v_add_f32 v109, v54, v55
  v_smfmac_f32_16x16x64_bf16 v[56:59], v[28:31], v[184:191], v112
  v_cvt_pk_bf16_f32 v108, v108, v109
  v_smfmac_f32_16x16x64_bf16 v[60:63], v[16:19], v[216:223], v112
  ds_write_b32 v5, v108 offset:2048
  v_smfmac_f32_16x16x64_bf16 v[60:63], v[20:23], v[224:231], v112
  v_add_f32 v108, v56, v57
  v_smfmac_f32_16x16x64_bf16 v[60:63], v[24:27], v[232:239], v112
  v_add_f32 v109, v58, v59
  v_smfmac_f32_16x16x64_bf16 v[60:63], v[28:31], v[240:247], v112
  v_cvt_pk_bf16_f32 v108, v108, v109
  ds_write_b32 v5, v108 offset:2560
  s_waitcnt lgkmcnt(2)
  v_mfma_f32_16x16x32_bf16 v[64:67], v[32:35], v[80:83], v[64:67]
  ds_read_b64_tr_b16 v[76:77], v6 offset:2048
  ds_read_b64_tr_b16 v[78:79], v6 offset:2560
  v_mfma_f32_16x16x32_bf16 v[68:71], v[8:11], v[80:83], v[68:71]
  v_add_f32 v108, v60, v61
  v_add_f32 v109, v62, v63
  v_mfma_f32_16x16x32_bf16 v[72:75], v[116:119], v[80:83], v[72:75]
  v_cvt_pk_bf16_f32 v108, v108, v109
  ds_write_b32 v5, v108 offset:3072
  ds_read_b64_tr_b16 v[84:85], v6 offset:3072
  ds_read_b64 v[116:117], v7 offset:1536
  s_waitcnt lgkmcnt(3)
  v_mfma_f32_16x16x32_bf16 v[64:67], v[100:103], v[76:79], v[64:67]
  v_mfma_f32_16x16x32_bf16 v[68:71], v[104:107], v[76:79], v[68:71]
  v_mfma_f32_16x16x32_bf16 v[72:75], v[96:99], v[76:79], v[72:75]
  s_waitcnt lgkmcnt(0)
  v_mfma_f32_16x16x16_bf16 v[64:67], v[86:87], v[84:85], v[64:67]
  v_mfma_f32_16x16x16_bf16 v[68:71], v[110:111], v[84:85], v[68:71]
  v_mfma_f32_16x16x16_bf16 v[72:75], v[116:117], v[84:85], v[72:75]
  s_nop 3
  ds_write_b128 v115, v[64:67] offset:0
  v_cmp_u_f32 vcc, v64, v64
  ds_write_b128 v115, v[68:71] offset:64
  s_nop 0
  ds_write_b128 v115, v[72:75] offset:128
  s_cbranch_vccnz mk_c_fs3_redo2
mk_c_fs3_cont2:
  s_waitcnt lgkmcnt(0)
  s_barrier
  ds_read_b64 v[8:9], v113 offset:0
  ds_read_b64 v[10:11], v113 offset:3328
  ds_read_b64 v[12:13], v113 offset:6656
  ds_read_b64 v[14:15], v113 offset:9984
  s_mov_b32 s30, 0x42800000
  s_waitcnt lgkmcnt(2)
  v_pk_add_f32 v[8:9], v[8:9], v[10:11]
  s_waitcnt lgkmcnt(0)
  v_pk_add_f32 v[12:13], v[12:13], v[14:15]
  v_pk_add_f32 v[8:9], v[8:9], v[12:13]
  v_max_f32 v12, |v8|, |v9|
  v_exp_f32 v10, v8
  v_cmp_nge_f32 vcc, s30, v12
  v_exp_f32 v11, v9
  s_and_b64 vcc, vcc, s[42:43]
  s_cbranch_vccnz mk_c_fs3_smax
mk_c_fs3_smax_ret:
  v_add_f32 v12, v10, v11
  v_cndmask_b32 v12, 0, v12, s[42:43]
  s_nop 1
  v_add_f32_dpp v12, v12, v12 row_ror:8 row_mask:0xf bank_mask:0xf
  s_nop 1
  v_add_f32_dpp v12, v12, v12 row_ror:4 row_mask:0xf bank_mask:0xf
  s_nop 1
  v_add_f32_dpp v12, v12, v12 row_ror:2 row_mask:0xf bank_mask:0xf
  s_nop 1
  v_add_f32_dpp v12, v12, v12 row_ror:1 row_mask:0xf bank_mask:0xf
  v_mov_b32 v13, v12
  s_nop 1
  v_permlane16_swap_b32 v12, v13
  v_add_f32 v12, v12, v13
  v_rcp_f32 v12, v12
  s_nop 0
  v_mul_f32 v8, v10, v12
  v_mul_f32 v9, v11, v12
  v_cvt_pk_bf16_f32 v8, v8, v9
  s_mov_b64 exec, s[42:43]
  global_store_dword v114, v8, s[46:47]
  s_mov_b64 exec, -1
  global_load_dwordx4 v[88:91], v1, s[54:55] offset:0 sc1
  global_load_dwordx4 v[92:95], v3, s[54:55] offset:0 sc1
  s_mov_b32 m0, 46080
  s_nop 0
  global_load_lds_dwordx4 v1, s[54:55] offset:1024 sc1
  s_mov_b32 m0, 47104
  s_nop 0
  global_load_lds_dwordx4 v3, s[54:55] offset:1024 sc1
  global_load_dwordx4 v[100:103], v1, s[54:55] offset:2048 sc1
  global_load_dwordx4 v[104:107], v3, s[54:55] offset:2048 sc1
  global_load_dwordx2 v[86:87], v1, s[54:55] offset:3072 sc1
  global_load_dwordx2 v[110:111], v3, s[54:55] offset:3072 sc1
  s_add_u32 s54, s54, 32768
  s_addc_u32 s55, s55, 0
  v_mov_b32 v108, -1
  global_store_dword v114, v108, s[48:49]
  s_mov_b64 s[48:49], s[46:47]
  s_mov_b64 s[46:47], s[50:51]
  s_add_u32 s44, s46, 10240
  s_addc_u32 s45, s47, 0
  s_add_u32 s36, s36, 1
  s_add_u32 s30, s38, 15728640
  s_add_u32 s50, s4, s30
  s_addc_u32 s51, s5, 0
  s_add_u32 s38, s38, 147456
  s_cmp_eq_u32 s38, 589824
  s_cselect_b32 s38, 0, s38
  s_add_u32 s8, s8, 458752
  s_addc_u32 s9, s9, 0
  v_mov_b32 v36, 0
  v_mov_b32 v37, 0
  v_mov_b32 v38, 0
  v_mov_b32 v39, 0
  v_mov_b32 v40, 0
  v_mov_b32 v41, 0
  v_mov_b32 v42, 0
  v_mov_b32 v43, 0
  v_mov_b32 v44, 0
  v_mov_b32 v45, 0
  v_mov_b32 v46, 0
  v_mov_b32 v47, 0
  v_mov_b32 v48, 0
  v_mov_b32 v49, 0
  v_mov_b32 v50, 0
  v_mov_b32 v51, 0
  v_mov_b32 v52, 0
  v_mov_b32 v53, 0
  v_mov_b32 v54, 0
  v_mov_b32 v55, 0
  v_mov_b32 v56, 0
  v_mov_b32 v57, 0
  v_mov_b32 v58, 0
  v_mov_b32 v59, 0
  v_mov_b32 v60, 0
  v_mov_b32 v61, 0
  v_mov_b32 v62, 0
  v_mov_b32 v63, 0
  s_cmp_lt_u32 s36, 63
  s_cbranch_scc1 mk_c_fs3_loop
  s_branch mk_c_done
mk_c_fs3_entry:
  s_branch mk_c_fs3_mem
mk_c_fs3_smax:
  v_mov_b32 v24, 0xff800000
  v_max_f32 v12, v8, v9
  v_cndmask_b32 v12, v24, v12, s[42:43]
  s_nop 1
  v_max_f32_dpp v12, v12, v12 row_ror:8 row_mask:0xf bank_mask:0xf
  s_nop 1
  v_max_f32_dpp v12, v12, v12 row_ror:4 row_mask:0xf bank_mask:0xf
  s_nop 1
  v_max_f32_dpp v12, v12, v12 row_ror:2 row_mask:0xf bank_mask:0xf
  s_nop 1
  v_max_f32_dpp v12, v12, v12 row_ror:1 row_mask:0xf bank_mask:0xf
  v_mov_b32 v13, v12
  s_nop 1
  v_permlane16_swap_b32 v12, v13
  v_max_f32 v12, v12, v13
  v_sub_f32 v10, v8, v12
  v_sub_f32 v11, v9, v12
  v_exp_f32 v10, v10
  v_exp_f32 v11, v11
  s_branch mk_c_fs3_smax_ret
mk_c_fs3_redo2:
  s_nop 7
  s_sub_u32 s40, s40, 2000
  s_cbranch_scc0 mk_c_fs3_redo3
  s_mov_b32 s40, 0
  s_branch mk_c_fs3_cont2
mk_c_fs3_redo:
  s_nop 7
  s_sub_u32 s40, s40, 1
  s_cbranch_scc1 mk_c_fs3_giveup
mk_c_fs3_redo3:
  v_mov_b32 v36, 0
  v_mov_b32 v37, 0
  v_mov_b32 v38, 0
  v_mov_b32 v39, 0
  v_mov_b32 v40, 0
  v_mov_b32 v41, 0
  v_mov_b32 v42, 0
  v_mov_b32 v43, 0
  v_mov_b32 v44, 0
  v_mov_b32 v45, 0
  v_mov_b32 v46, 0
  v_mov_b32 v47, 0
  v_mov_b32 v48, 0
  v_mov_b32 v49, 0
  v_mov_b32 v50, 0
  v_mov_b32 v51, 0
  v_mov_b32 v52, 0
  v_mov_b32 v53, 0
  v_mov_b32 v54, 0
  v_mov_b32 v55, 0
  v_mov_b32 v56, 0
  v_mov_b32 v57, 0
  v_mov_b32 v58, 0
  v_mov_b32 v59, 0
  v_mov_b32 v60, 0
  v_mov_b32 v61, 0
  v_mov_b32 v62, 0
  v_mov_b32 v63, 0
  s_waitcnt lgkmcnt(0)
  s_branch mk_c_fs3_mem
mk_c_fs3_giveup:
  s_mov_b32 s40, 0
  s_branch mk_c_fs3_cont
mk_c_fv0_loop:
  s_barrier
mk_c_fv0_mem:
  global_load_dwordx4 v[8:11], v5, s[44:45] sc1
  s_nop 3
  global_load_dwordx4 v[12:15], v6, s[44:45] sc1
  s_nop 3
  global_load_dwordx4 v[16:19], v7, s[44:45] sc1
  s_barrier
  s_cmp_eq_u32 s36, 0
  s_cbranch_scc1 w0s_28
  s_add_u32 s30, s38, 15728640
  s_add_u32 s50, s4, s30
  s_addc_u32 s51, s5, 0
  s_add_u32 s38, s38, 147456
  s_cmp_eq_u32 s38, 589824
  s_cselect_b32 s38, 0, s38
  v_xor_b32 v100, 0x38000, v100
  v_mov_b32 v36, 0
  v_mov_b32 v37, 0
  v_mov_b32 v38, 0
  v_mov_b32 v39, 0
  v_mov_b32 v40, 0
  v_mov_b32 v41, 0
  v_mov_b32 v42, 0
  v_mov_b32 v43, 0
  v_mov_b32 v44, 0
  v_mov_b32 v45, 0
  v_mov_b32 v46, 0
  v_mov_b32 v47, 0
  v_mov_b32 v48, 0
  v_mov_b32 v49, 0
  v_mov_b32 v50, 0
  v_mov_b32 v51, 0
  v_mov_b32 v52, 0
  v_mov_b32 v53, 0
  v_mov_b32 v54, 0
  v_mov_b32 v55, 0
  v_mov_b32 v56, 0
  v_mov_b32 v57, 0
  v_mov_b32 v58, 0
  v_mov_b32 v59, 0
  v_mov_b32 v60, 0
  v_mov_b32 v61, 0
  v_mov_b32 v62, 0
  v_mov_b32 v63, 0
  v_mov_b32 v64, 0
  v_mov_b32 v65, 0
  v_mov_b32 v66, 0
  v_mov_b32 v67, 0
w0s_28:
  s_add_u32 m0, s35, 0
  s_nop 0
  global_load_lds_dwordx4 v1, s[56:57] offset:0 sc1
  s_add_u32 m0, s35, 0
  s_nop 0
  global_load_lds_dwordx4 v1, s[56:57] offset:1024 sc1
  s_add_u32 m0, s35, 0
  s_nop 0
  global_load_lds_dwordx4 v1, s[56:57] offset:2048 sc1
  s_add_u32 m0, s35, 0
  s_nop 0
  global_load_lds_dwordx4 v1, s[56:57] offset:3072 sc1
mk_c_fv0_got:
  s_waitcnt vmcnt(6)
  ds_write_b128 v1, v[8:11] offset:0
  v_smfmac_f32_16x16x64_bf16 v[36:39], v[8:11], a[0:7], v112
  s_waitcnt vmcnt(5)
  ds_write_b128 v1, v[12:15] offset:1024
  v_smfmac_f32_16x16x64_bf16 v[40:43], v[8:11], a[56:63], v112
  v_max3_u32 v119, v8, v9, v10
  v_smfmac_f32_16x16x64_bf16 v[44:47], v[8:11], a[112:119], v112
  v_max3_u32 v119, v119, v11, v12
  v_smfmac_f32_16x16x64_bf16 v[48:51], v[8:11], a[168:175], v112
  v_max3_u32 v119, v119, v13, v14
  v_smfmac_f32_16x16x64_bf16 v[52:55], v[8:11], a[224:231], v112
  v_max_u32 v119, v119, v15
  v_smfmac_f32_16x16x64_bf16 v[56:59], v[8:11], v[144:151], v112
  v_cmp_eq_u32 vcc, -1, v119
  v_smfmac_f32_16x16x64_bf16 v[60:63], v[8:11], v[200:207], v112
  s_cbranch_vccnz mk_c_fv0_redo
mk_c_fv0_cont:
  v_smfmac_f32_16x16x64_bf16 v[36:39], v[12:15], a[8:15], v112
  v_smfmac_f32_16x16x64_bf16 v[40:43], v[12:15], a[64:71], v112
  s_add_u32 m0, s35, 4096
  s_nop 0
  global_load_lds_dwordx4 v3, s[56:57] offset:0 sc1
  v_smfmac_f32_16x16x64_bf16 v[44:47], v[12:15], a[120:127], v112
  s_add_u32 m0, s35, 4096
  s_nop 0
  global_load_lds_dwordx4 v3, s[56:57] offset:1024 sc1
  v_smfmac_f32_16x16x64_bf16 v[48:51], v[12:15], a[176:183], v112
  s_add_u32 m0, s35, 4096
  s_nop 0
  global_load_lds_dwordx4 v3, s[56:57] offset:2048 sc1
  v_smfmac_f32_16x16x64_bf16 v[52:55], v[12:15], a[232:239], v112
  s_add_u32 m0, s35, 4096
  s_nop 0
  global_load_lds_dwordx4 v3, s[56:57] offset:3072 sc1
  s_waitcnt vmcnt(8)
  v_max3_u32 v119, v16, v17, v18
  v_smfmac_f32_16x16x64_bf16 v[56:59], v[12:15], v[152:159], v112
  global_store_dword v102, v104, s[10:11]
  s_mov_b64 exec, 15
  global_store_dword v0, v104, s[10:11]
  s_mov_b64 exec, -1
  v_max_u32 v119, v119, v19
  v_smfmac_f32_16x16x64_bf16 v[60:63], v[12:15], v[208:215], v112
  v_cmp_eq_u32 vcc, -1, v119
  s_waitcnt lgkmcnt(0)
  s_barrier
  s_nop 0
  s_cbranch_vccnz mk_c_fv0_fix2
mk_c_fv0_fix2r:
  ds_read_b128 v[20:23], v1 offset:3072
  ds_read_b128 v[24:27], v1 offset:4096
  ds_read_b128 v[28:31], v1 offset:5120
  ds_read_b128 v[32:35], v1 offset:6144
  ds_read_b128 v[68:71], v113 offset:0
  ds_read_b128 v[72:75], v113 offset:1024
  ds_read_b128 v[76:79], v113 offset:2048
  ds_read_b128 v[80:83], v113 offset:3072
  v_smfmac_f32_16x16x64_bf16 v[36:39], v[16:19], a[16:23], v112
  v_smfmac_f32_16x16x64_bf16 v[40:43], v[16:19], a[72:79], v112
  v_smfmac_f32_16x16x64_bf16 v[44:47], v[16:19], a[128:135], v112
  v_smfmac_f32_16x16x64_bf16 v[48:51], v[16:19], a[184:191], v112
  v_smfmac_f32_16x16x64_bf16 v[52:55], v[16:19], a[240:247], v112
  v_smfmac_f32_16x16x64_bf16 v[56:59], v[16:19], v[160:167], v112
  v_smfmac_f32_16x16x64_bf16 v[60:63], v[16:19], v[216:223], v112
  s_add_u32 s56, s56, 458752
  s_addc_u32 s57, s57, 0
  s_xor_b32 s35, s35, 0x38000
  s_waitcnt lgkmcnt(7)
  v_smfmac_f32_16x16x64_bf16 v[36:39], v[20:23], a[24:31], v112
  s_waitcnt lgkmcnt(6)
  v_smfmac_f32_16x16x64_bf16 v[36:39], v[24:27], a[32:39], v112
  s_waitcnt lgkmcnt(5)
  v_smfmac_f32_16x16x64_bf16 v[36:39], v[28:31], a[40:47], v112
  s_waitcnt lgkmcnt(4)
  v_smfmac_f32_16x16x64_bf16 v[36:39], v[32:35], a[48:55], v112
  s_waitcnt lgkmcnt(2)
  v_smfmac_f32_16x16x64_bf16 v[64:67], v[8:11], v[68:75], v112
  ds_read_b128 v[68:71], v113 offset:4096
  ds_read_b128 v[72:75], v113 offset:5120
  v_smfmac_f32_16x16x64_bf16 v[40:43], v[20:23], a[80:87], v112
  v_smfmac_f32_16x16x64_bf16 v[40:43], v[24:27], a[88:95], v112
  v_add_f32 v36, v36, v37
  v_smfmac_f32_16x16x64_bf16 v[40:43], v[28:31], a[96:103], v112
  v_add_f32 v38, v38, v39
  v_smfmac_f32_16x16x64_bf16 v[40:43], v[32:35], a[104:111], v112
  v_cvt_pk_bf16_f32 v96, v36, v38
  s_waitcnt lgkmcnt(2)
  v_smfmac_f32_16x16x64_bf16 v[64:67], v[12:15], v[76:83], v112
  ds_read_b128 v[76:79], v113 offset:6144
  ds_read_b128 v[80:83], v113 offset:7168
  ds_write_b32 v114, v96 offset:0
  v_smfmac_f32_16x16x64_bf16 v[44:47], v[20:23], a[136:143], v112
  v_smfmac_f32_16x16x64_bf16 v[44:47], v[24:27], a[144:151], v112
  v_add_f32 v40, v40, v41
  v_smfmac_f32_16x16x64_bf16 v[44:47], v[28:31], a[152:159], v112
  v_add_f32 v42, v42, v43
  v_smfmac_f32_16x16x64_bf16 v[44:47], v[32:35], a[160:167], v112
  v_cvt_pk_bf16_f32 v97, v40, v42
  s_waitcnt lgkmcnt(3)
  v_smfmac_f32_16x16x64_bf16 v[64:67], v[16:19], v[68:75], v112
  ds_read_b128 v[68:71], v113 offset:8192
  ds_read_b128 v[72:75], v113 offset:9216
  ds_write_b32 v114, v97 offset:4096
  v_smfmac_f32_16x16x64_bf16 v[48:51], v[20:23], a[192:199], v112
  v_smfmac_f32_16x16x64_bf16 v[48:51], v[24:27], a[200:207], v112
  v_add_f32 v44, v44, v45
  v_smfmac_f32_16x16x64_bf16 v[48:51], v[28:31], a[208:215], v112
  v_add_f32 v46, v46, v47
  v_smfmac_f32_16x16x64_bf16 v[48:51], v[32:35], a[216:223], v112
  v_cvt_pk_bf16_f32 v98, v44, v46
  s_waitcnt lgkmcnt(4)
  v_smfmac_f32_16x16x64_bf16 v[64:67], v[20:23], v[76:83], v112
  ds_read_b128 v[76:79], v113 offset:10240
  ds_read_b128 v[80:83], v113 offset:11264
  ds_write_b32 v114, v98 offset:4
  v_smfmac_f32_16x16x64_bf16 v[52:55], v[20:23], a[248:255], v112
  v_smfmac_f32_16x16x64_bf16 v[52:55], v[24:27], v[120:127], v112
  v_add_f32 v48, v48, v49
  v_smfmac_f32_16x16x64_bf16 v[52:55], v[28:31], v[128:135], v112
  v_add_f32 v50, v50, v51
  v_smfmac_f32_16x16x64_bf16 v[52:55], v[32:35], v[136:143], v112
  v_cvt_pk_bf16_f32 v99, v48, v50
  s_waitcnt lgkmcnt(4)
  v_smfmac_f32_16x16x64_bf16 v[64:67], v[24:27], v[68:75], v112
  ds_read_b128 v[68:71], v113 offset:12288
  ds_read_b128 v[72:75], v113 offset:13312
  ds_write_b32 v114, v99 offset:4100
  v_smfmac_f32_16x16x64_bf16 v[56:59], v[20:23], v[168:175], v112
  v_smfmac_f32_16x16x64_bf16 v[56:59], v[24:27], v[176:183], v112
  v_add_f32 v52, v52, v53
  v_smfmac_f32_16x16x64_bf16 v[56:59], v[28:31], v[184:191], v112
  v_add_f32 v54, v54, v55
  v_smfmac_f32_16x16x64_bf16 v[56:59], v[32:35], v[192:199], v112
  v_cvt_pk_bf16_f32 v96, v52, v54
  s_waitcnt lgkmcnt(4)
  v_smfmac_f32_16x16x64_bf16 v[64:67], v[28:31], v[76:83], v112
  ds_write_b32 v114, v96 offset:512
  v_smfmac_f32_16x16x64_bf16 v[60:63], v[20:23], v[224:231], v112
  v_smfmac_f32_16x16x64_bf16 v[60:63], v[24:27], v[232:239], v112
  v_add_f32 v56, v56, v57
  v_smfmac_f32_16x16x64_bf16 v[60:63], v[28:31], v[240:247], v112
  v_add_f32 v58, v58, v59
  v_smfmac_f32_16x16x64_bf16 v[60:63], v[32:35], v[248:255], v112
  v_cvt_pk_bf16_f32 v97, v56, v58
  s_waitcnt lgkmcnt(2)
  v_smfmac_f32_16x16x64_bf16 v[64:67], v[32:35], v[68:75], v112
  ds_write_b32 v114, v97 offset:4608
  s_nop 2
  v_add_f32 v60, v60, v61
  v_add_f32 v62, v62, v63
  v_cvt_pk_bf16_f32 v98, v60, v62
  ds_write_b32 v114, v98 offset:516
  v_add_f32 v64, v64, v65
  v_add_f32 v66, v66, v67
  v_cvt_pk_bf16_f32 v99, v64, v66
  ds_write_b32 v114, v99 offset:4612
  s_waitcnt lgkmcnt(0)
  s_barrier
  ds_read_b128 v[64:67], v100 offset:0
  ds_read_b128 v[68:71], v100 offset:1024
  ds_read_b128 v[72:75], v100 offset:2048
  ds_read_b128 v[76:79], v100 offset:3072
  ds_read_b128 v[80:83], v100 offset:4096
  ds_read_b128 v[84:87], v100 offset:5120
  ds_read_b128 v[88:91], v100 offset:6144
  ds_read_b128 v[92:95], v100 offset:7168
  ds_read_b128 v[48:51], v101 offset:0
  ds_read_b128 v[52:55], v101 offset:1024
  ds_read_b128 v[56:59], v101 offset:2048
  ds_read_b128 v[60:63], v101 offset:3072
  global_load_dword v108, v2, s[46:47] sc1
  s_nop 12
  global_load_dword v109, v2, s[46:47] sc1
  s_nop 12
  global_load_dword v110, v2, s[46:47] sc1
  s_nop 12
  global_load_dword v111, v2, s[46:47] sc1
  s_nop 12
  global_load_dword v116, v2, s[46:47] sc1
  s_nop 12
mk_c_fv0_fp_29:
  global_load_dword v117, v2, s[46:47] sc1
  s_waitcnt vmcnt(5)
  v_cmp_eq_u32 vcc, -1, v108
  s_cbranch_vccz mk_c_fv0_fd_30
  global_load_dword v108, v2, s[46:47] sc1
  s_waitcnt vmcnt(5)
  v_cmp_eq_u32 vcc, -1, v109
  s_cbranch_vccz mk_c_fv0_fd_30
  global_load_dword v109, v2, s[46:47] sc1
  s_waitcnt vmcnt(5)
  v_cmp_eq_u32 vcc, -1, v110
  s_cbranch_vccz mk_c_fv0_fd_30
  global_load_dword v110, v2, s[46:47] sc1
  s_waitcnt vmcnt(5)
  v_cmp_eq_u32 vcc, -1, v111
  s_cbranch_vccz mk_c_fv0_fd_30
  global_load_dword v111, v2, s[46:47] sc1
  s_waitcnt vmcnt(5)
  v_cmp_eq_u32 vcc, -1, v116
  s_cbranch_vccz mk_c_fv0_fd_30
  global_load_dword v116, v2, s[46:47] sc1
  s_waitcnt vmcnt(5)
  v_cmp_eq_u32 vcc, -1, v117
  s_cbranch_vccz mk_c_fv0_fd_30
  s_sub_u32 s40, s40, 1
  s_cbranch_scc0 mk_c_fv0_fp_29
  s_mov_b32 s40, 0
mk_c_fv0_fd_30:
  s_nop 3
mk_c_fv0_pld:
  global_load_dwordx4 v[40:43], v4, s[46:47] offset:0 sc1
  global_load_dwordx4 v[44:47], v4, s[46:47] offset:1024 sc1
  global_load_dwordx4 v[8:11], v1, s[46:47] offset:0 sc1
  global_load_dwordx4 v[12:15], v1, s[46:47] offset:1024 sc1
  global_load_dwordx4 v[16:19], v1, s[46:47] offset:2048 sc1
  global_load_dwordx4 v[20:23], v1, s[46:47] offset:3072 sc1
  global_load_dwordx4 v[24:27], v3, s[46:47] offset:0 sc1
  global_load_dwordx4 v[28:31], v3, s[46:47] offset:1024 sc1
  global_load_dwordx4 v[32:35], v3, s[46:47] offset:2048 sc1
  global_load_dwordx4 v[36:39], v3, s[46:47] offset:3072 sc1
  v_mov_b32 v96, 0
  v_mov_b32 v97, 0
  v_mov_b32 v98, 0
  v_mov_b32 v99, 0
  s_mov_b64 s[10:11], s[46:47]
  s_waitcnt lgkmcnt(0)
  s_waitcnt vmcnt(9)
  v_smfmac_f32_16x16x64_bf16 v[96:99], v[40:43], v[48:55], v112
  v_max3_u32 v119, v40, v41, v42
  s_waitcnt vmcnt(8)
  v_smfmac_f32_16x16x64_bf16 v[96:99], v[44:47], v[56:63], v112
  v_max3_u32 v119, v119, v43, v44
  v_max3_u32 v119, v119, v45, v46
  v_max_u32 v119, v119, v47
  v_cmp_eq_u32 vcc, -1, v119
  s_cbranch_vccnz mk_c_fv0_pre
mk_c_fv0_pgo:
  s_waitcnt vmcnt(7)
  v_smfmac_f32_16x16x64_bf16 v[96:99], v[8:11], v[64:71], v112
  ds_read_b128 v[64:67], v100 offset:8192
  ds_read_b128 v[68:71], v100 offset:9216
  s_waitcnt vmcnt(6)
  v_smfmac_f32_16x16x64_bf16 v[96:99], v[12:15], v[72:79], v112
  s_mov_b64 exec, 15
  global_store_dword v0, v112, s[50:51]
  s_mov_b64 exec, -1
  ds_read_b128 v[72:75], v100 offset:10240
  ds_read_b128 v[76:79], v100 offset:11264
  s_waitcnt vmcnt(6)
  v_smfmac_f32_16x16x64_bf16 v[96:99], v[16:19], v[80:87], v112
  ds_read_b128 v[80:83], v100 offset:12288
  ds_read_b128 v[84:87], v100 offset:13312
  s_waitcnt vmcnt(5)
  v_smfmac_f32_16x16x64_bf16 v[96:99], v[20:23], v[88:95], v112
  ds_read_b128 v[88:91], v100 offset:14336
  ds_read_b128 v[92:95], v100 offset:15360
  s_waitcnt vmcnt(4) lgkmcnt(6)
  v_smfmac_f32_16x16x64_bf16 v[96:99], v[24:27], v[64:71], v112
  s_waitcnt vmcnt(3) lgkmcnt(4)
  v_smfmac_f32_16x16x64_bf16 v[96:99], v[28:31], v[72:79], v112
  s_waitcnt vmcnt(2) lgkmcnt(2)
  v_smfmac_f32_16x16x64_bf16 v[96:99], v[32:35], v[80:87], v112
  s_waitcnt vmcnt(1) lgkmcnt(0)
  v_smfmac_f32_16x16x64_bf16 v[96:99], v[36:39], v[88:95], v112
  s_nop 7
  v_add_f32 v96, v96, v97
  v_add_f32 v98, v98, v99
  v_cmp_u_f32 vcc, v96, v98
  v_cvt_pk_bf16_f32 v96, v96, v98
  s_cbranch_vccnz mk_c_fv0_pnan
mk_c_fv0_pfin:
  s_nop 0
  v_mov_b32_dpp v97, v96 quad_perm:[1,0,3,2] row_mask:0xf bank_mask:0xf
  v_perm_b32 v96, v96, v97, v103
  global_store_dword v102, v96, s[50:51]
  s_cmp_lg_u32 s36, 62
  s_cbranch_scc1 mk_c_fv0_nopv
  s_add_u32 s30, s4, 17218560
  s_addc_u32 s31, s5, 0
  global_store_dword v102, v96, s[30:31] sc1
mk_c_fv0_nopv:
  s_mov_b64 s[48:49], s[46:47]
  s_mov_b64 s[46:47], s[50:51]
  s_add_u32 s44, s46, 10240
  s_addc_u32 s45, s47, 0
  s_add_u32 s36, s36, 1
  s_cmp_lt_u32 s36, 63
  s_cbranch_scc1 mk_c_fv0_loop
  s_branch mk_c_done
mk_c_fv0_entry:
  s_branch mk_c_fv0_mem
mk_c_fv0_fix2:
  ds_read_b128 v[16:19], v1 offset:2048
  s_waitcnt lgkmcnt(0)
  s_branch mk_c_fv0_fix2r
mk_c_fv0_redo:
  s_nop 7
  s_sub_u32 s40, s40, 1
  s_cbranch_scc1 mk_c_fv0_giveup
  s_waitcnt lgkmcnt(0)
  global_load_dwordx4 v[8:11], v5, s[44:45] sc1
  global_load_dwordx4 v[12:15], v6, s[44:45] sc1
  global_load_dwordx4 v[16:19], v7, s[44:45] sc1
  s_nop 7
  v_mov_b32 v36, 0
  v_mov_b32 v37, 0
  v_mov_b32 v38, 0
  v_mov_b32 v39, 0
  v_mov_b32 v40, 0
  v_mov_b32 v41, 0
  v_mov_b32 v42, 0
  v_mov_b32 v43, 0
  v_mov_b32 v44, 0
  v_mov_b32 v45, 0
  v_mov_b32 v46, 0
  v_mov_b32 v47, 0
  v_mov_b32 v48, 0
  v_mov_b32 v49, 0
  v_mov_b32 v50, 0
  v_mov_b32 v51, 0
  v_mov_b32 v52, 0
  v_mov_b32 v53, 0
  v_mov_b32 v54, 0
  v_mov_b32 v55, 0
  v_mov_b32 v56, 0
  v_mov_b32 v57, 0
  v_mov_b32 v58, 0
  v_mov_b32 v59, 0
  v_mov_b32 v60, 0
  v_mov_b32 v61, 0
  v_mov_b32 v62, 0
  v_mov_b32 v63, 0
  v_mov_b32 v64, 0
  v_mov_b32 v65, 0
  v_mov_b32 v66, 0
  v_mov_b32 v67, 0
  s_waitcnt vmcnt(0)
  s_branch mk_c_fv0_got
mk_c_fv0_giveup:
  s_mov_b32 s40, 0
  s_branch mk_c_fv0_cont
mk_c_fv0_pre:
  s_nop 7
  s_sub_u32 s40, s40, 1
  s_cbranch_scc0 mk_c_fv0_pld
  s_mov_b32 s40, 0
  s_branch mk_c_fv0_pgo
mk_c_fv0_pnan:
  v_max3_u32 v119, v8, v9, v10
  v_max3_u32 v119, v119, v11, v12
  v_max3_u32 v119, v119, v13, v14
  v_max3_u32 v119, v119, v15, v16
  v_max3_u32 v119, v119, v17, v18
  v_max3_u32 v119, v119, v19, v20
  v_max3_u32 v119, v119, v21, v22
  v_max3_u32 v119, v119, v23, v24
  v_max3_u32 v119, v119, v25, v26
  v_max3_u32 v119, v119, v27, v28
  v_max3_u32 v119, v119, v29, v30
  v_max3_u32 v119, v119, v31, v32
  v_max3_u32 v119, v119, v33, v34
  v_max3_u32 v119, v119, v35, v36
  v_max3_u32 v119, v119, v37, v38
  v_max3_u32 v119, v119, v39, v40
  v_max3_u32 v119, v119, v41, v42
  v_max3_u32 v119, v119, v43, v44
  v_max3_u32 v119, v119, v45, v46
  v_max_u32 v119, v119, v47
  v_cmp_eq_u32 vcc, -1, v119
  s_cbranch_vccz mk_c_fv0_pfin
  s_sub_u32 s40, s40, 1
  s_cbranch_scc1 mk_c_fv0_pgive
  ds_read_b128 v[64:67], v100 offset:0
  ds_read_b128 v[68:71], v100 offset:1024
  ds_read_b128 v[72:75], v100 offset:2048
  ds_read_b128 v[76:79], v100 offset:3072
  ds_read_b128 v[80:83], v100 offset:4096
  ds_read_b128 v[84:87], v100 offset:5120
  ds_read_b128 v[88:91], v100 offset:6144
  ds_read_b128 v[92:95], v100 offset:7168
  s_branch mk_c_fv0_pld
mk_c_fv0_pgive:
  s_mov_b32 s40, 0
  s_branch mk_c_fv0_pfin
mk_c_fv1_loop:
  s_barrier
mk_c_fv1_mem:
  global_load_dwordx4 v[16:19], v5, s[44:45] sc1
  s_nop 3
  global_load_dwordx4 v[20:23], v6, s[44:45] sc1
  s_nop 3
  global_load_dwordx4 v[24:27], v7, s[44:45] sc1
  s_barrier
  s_cmp_eq_u32 s36, 0
  s_cbranch_scc1 w0s_31
  s_add_u32 s30, s38, 15728640
  s_add_u32 s50, s4, s30
  s_addc_u32 s51, s5, 0
  s_add_u32 s38, s38, 147456
  s_cmp_eq_u32 s38, 589824
  s_cselect_b32 s38, 0, s38
  v_xor_b32 v100, 0x38000, v100
  v_mov_b32 v36, 0
  v_mov_b32 v37, 0
  v_mov_b32 v38, 0
  v_mov_b32 v39, 0
  v_mov_b32 v40, 0
  v_mov_b32 v41, 0
  v_mov_b32 v42, 0
  v_mov_b32 v43, 0
  v_mov_b32 v44, 0
  v_mov_b32 v45, 0
  v_mov_b32 v46, 0
  v_mov_b32 v47, 0
  v_mov_b32 v48, 0
  v_mov_b32 v49, 0
  v_mov_b32 v50, 0
  v_mov_b32 v51, 0
  v_mov_b32 v52, 0
  v_mov_b32 v53, 0
  v_mov_b32 v54, 0
  v_mov_b32 v55, 0
  v_mov_b32 v56, 0
  v_mov_b32 v57, 0
  v_mov_b32 v58, 0
  v_mov_b32 v59, 0
  v_mov_b32 v60, 0
  v_mov_b32 v61, 0
  v_mov_b32 v62, 0
  v_mov_b32 v63, 0
  v_mov_b32 v64, 0
  v_mov_b32 v65, 0
  v_mov_b32 v66, 0
  v_mov_b32 v67, 0
w0s_31:
  s_add_u32 m0, s35, 0
  s_nop 0
  global_load_lds_dwordx4 v1, s[56:57] offset:0 sc1
  s_add_u32 m0, s35, 0
  s_nop 0
  global_load_lds_dwordx4 v1, s[56:57] offset:1024 sc1
  s_add_u32 m0, s35, 0
  s_nop 0
  global_load_lds_dwordx4 v1, s[56:57] offset:2048 sc1
  s_add_u32 m0, s35, 0
  s_nop 0
  global_load_lds_dwordx4 v1, s[56:57] offset:3072 sc1
mk_c_fv1_got:
  s_waitcnt vmcnt(6)
  ds_write_b128 v1, v[16:19] offset:2048
  v_smfmac_f32_16x16x64_bf16 v[36:39], v[16:19], a[16:23], v112
  s_waitcnt vmcnt(5)
  ds_write_b128 v1, v[20:23] offset:3072
  v_smfmac_f32_16x16x64_bf16 v[40:43], v[16:19], a[72:79], v112
  v_max3_u32 v119, v16, v17, v18
  v_smfmac_f32_16x16x64_bf16 v[44:47], v[16:19], a[128:135], v112
  v_max3_u32 v119, v119, v19, v20
  v_smfmac_f32_16x16x64_bf16 v[48:51], v[16:19], a[184:191], v112
  v_max3_u32 v119, v119, v21, v22
  v_smfmac_f32_16x16x64_bf16 v[52:55], v[16:19], a[240:247], v112
  v_max_u32 v119, v119, v23
  v_smfmac_f32_16x16x64_bf16 v[56:59], v[16:19], v[160:167], v112
  v_cmp_eq_u32 vcc, -1, v119
  v_smfmac_f32_16x16x64_bf16 v[60:63], v[16:19], v[216:223], v112
  s_cbranch_vccnz mk_c_fv1_redo
mk_c_fv1_cont:
  v_smfmac_f32_16x16x64_bf16 v[36:39], v[20:23], a[24:31], v112
  v_smfmac_f32_16x16x64_bf16 v[40:43], v[20:23], a[80:87], v112
  s_add_u32 m0, s35, 4096
  s_nop 0
  global_load_lds_dwordx4 v3, s[56:57] offset:0 sc1
  v_smfmac_f32_16x16x64_bf16 v[44:47], v[20:23], a[136:143], v112
  s_add_u32 m0, s35, 4096
  s_nop 0
  global_load_lds_dwordx4 v3, s[56:57] offset:1024 sc1
  v_smfmac_f32_16x16x64_bf16 v[48:51], v[20:23], a[192:199], v112
  s_add_u32 m0, s35, 4096
  s_nop 0
  global_load_lds_dwordx4 v3, s[56:57] offset:2048 sc1
  v_smfmac_f32_16x16x64_bf16 v[52:55], v[20:23], a[248:255], v112
  s_add_u32 m0, s35, 4096
  s_nop 0
  global_load_lds_dwordx4 v3, s[56:57] offset:3072 sc1
  s_waitcnt vmcnt(8)
  v_max3_u32 v119, v24, v25, v26
  v_smfmac_f32_16x16x64_bf16 v[56:59], v[20:23], v[168:175], v112
  global_store_dword v102, v104, s[10:11]
  s_mov_b64 exec, 15
  global_store_dword v0, v104, s[10:11]
  s_mov_b64 exec, -1
  v_max_u32 v119, v119, v27
  v_smfmac_f32_16x16x64_bf16 v[60:63], v[20:23], v[224:231], v112
  v_cmp_eq_u32 vcc, -1, v119
  s_waitcnt lgkmcnt(0)
  s_barrier
  s_nop 0
  s_cbranch_vccnz mk_c_fv1_fix2
mk_c_fv1_fix2r:
  ds_read_b128 v[8:11], v1 offset:0
  ds_read_b128 v[12:15], v1 offset:1024
  ds_read_b128 v[28:31], v1 offset:5120
  ds_read_b128 v[32:35], v1 offset:6144
  ds_read_b128 v[68:71], v113 offset:4096
  ds_read_b128 v[72:75], v113 offset:5120
  ds_read_b128 v[76:79], v113 offset:6144
  ds_read_b128 v[80:83], v113 offset:7168
  v_smfmac_f32_16x16x64_bf16 v[36:39], v[24:27], a[32:39], v112
  v_smfmac_f32_16x16x64_bf16 v[40:43], v[24:27], a[88:95], v112
  v_smfmac_f32_16x16x64_bf16 v[44:47], v[24:27], a[144:151], v112
  v_smfmac_f32_16x16x64_bf16 v[48:51], v[24:27], a[200:207], v112
  v_smfmac_f32_16x16x64_bf16 v[52:55], v[24:27], v[120:127], v112
  v_smfmac_f32_16x16x64_bf16 v[56:59], v[24:27], v[176:183], v112
  v_smfmac_f32_16x16x64_bf16 v[60:63], v[24:27], v[232:239], v112
  s_add_u32 s56, s56, 458752
  s_addc_u32 s57, s57, 0
  s_xor_b32 s35, s35, 0x38000
  s_waitcnt lgkmcnt(7)
  v_smfmac_f32_16x16x64_bf16 v[36:39], v[8:11], a[0:7], v112
  s_waitcnt lgkmcnt(6)
  v_smfmac_f32_16x16x64_bf16 v[36:39], v[12:15], a[8:15], v112
  s_waitcnt lgkmcnt(5)
  v_smfmac_f32_16x16x64_bf16 v[36:39], v[28:31], a[40:47], v112
  s_waitcnt lgkmcnt(4)
  v_smfmac_f32_16x16x64_bf16 v[36:39], v[32:35], a[48:55], v112
  s_waitcnt lgkmcnt(2)
  v_smfmac_f32_16x16x64_bf16 v[64:67], v[16:19], v[68:75], v112
  ds_read_b128 v[68:71], v113 offset:8192
  ds_read_b128 v[72:75], v113 offset:9216
  v_smfmac_f32_16x16x64_bf16 v[40:43], v[8:11], a[56:63], v112
  v_smfmac_f32_16x16x64_bf16 v[40:43], v[12:15], a[64:71], v112
  v_add_f32 v36, v36, v37
  v_smfmac_f32_16x16x64_bf16 v[40:43], v[28:31], a[96:103], v112
  v_add_f32 v38, v38, v39
  v_smfmac_f32_16x16x64_bf16 v[40:43], v[32:35], a[104:111], v112
  v_cvt_pk_bf16_f32 v96, v36, v38
  s_waitcnt lgkmcnt(2)
  v_smfmac_f32_16x16x64_bf16 v[64:67], v[20:23], v[76:83], v112
  ds_read_b128 v[76:79], v113 offset:0
  ds_read_b128 v[80:83], v113 offset:1024
  ds_write_b32 v114, v96 offset:0
  v_smfmac_f32_16x16x64_bf16 v[44:47], v[8:11], a[112:119], v112
  v_smfmac_f32_16x16x64_bf16 v[44:47], v[12:15], a[120:127], v112
  v_add_f32 v40, v40, v41
  v_smfmac_f32_16x16x64_bf16 v[44:47], v[28:31], a[152:159], v112
  v_add_f32 v42, v42, v43
  v_smfmac_f32_16x16x64_bf16 v[44:47], v[32:35], a[160:167], v112
  v_cvt_pk_bf16_f32 v97, v40, v42
  s_waitcnt lgkmcnt(3)
  v_smfmac_f32_16x16x64_bf16 v[64:67], v[24:27], v[68:75], v112
  ds_read_b128 v[68:71], v113 offset:2048
  ds_read_b128 v[72:75], v113 offset:3072
  ds_write_b32 v114, v97 offset:4096
  v_smfmac_f32_16x16x64_bf16 v[48:51], v[8:11], a[168:175], v112
  v_smfmac_f32_16x16x64_bf16 v[48:51], v[12:15], a[176:183], v112
  v_add_f32 v44, v44, v45
  v_smfmac_f32_16x16x64_bf16 v[48:51], v[28:31], a[208:215], v112
  v_add_f32 v46, v46, v47
  v_smfmac_f32_16x16x64_bf16 v[48:51], v[32:35], a[216:223], v112
  v_cvt_pk_bf16_f32 v98, v44, v46
  s_waitcnt lgkmcnt(4)
  v_smfmac_f32_16x16x64_bf16 v[64:67], v[8:11], v[76:83], v112
  ds_read_b128 v[76:79], v113 offset:10240
  ds_read_b128 v[80:83], v113 offset:11264
  ds_write_b32 v114, v98 offset:4
  v_smfmac_f32_16x16x64_bf16 v[52:55], v[8:11], a[224:231], v112
  v_smfmac_f32_16x16x64_bf16 v[52:55], v[12:15], a[232:239], v112
  v_add_f32 v48, v48, v49
  v_smfmac_f32_16x16x64_bf16 v[52:55], v[28:31], v[128:135], v112
  v_add_f32 v50, v50, v51
  v_smfmac_f32_16x16x64_bf16 v[52:55], v[32:35], v[136:143], v112
  v_cvt_pk_bf16_f32 v99, v48, v50
  s_waitcnt lgkmcnt(4)
  v_smfmac_f32_16x16x64_bf16 v[64:67], v[12:15], v[68:75], v112
  ds_read_b128 v[68:71], v113 offset:12288
  ds_read_b128 v[72:75], v113 offset:13312
  ds_write_b32 v114, v99 offset:4100
  v_smfmac_f32_16x16x64_bf16 v[56:59], v[8:11], v[144:151], v112
  v_smfmac_f32_16x16x64_bf16 v[56:59], v[12:15], v[152:159], v112
  v_add_f32 v52, v52, v53
  v_smfmac_f32_16x16x64_bf16 v[56:59], v[28:31], v[184:191], v112
  v_add_f32 v54, v54, v55
  v_smfmac_f32_16x16x64_bf16 v[56:59], v[32:35], v[192:199], v112
  v_cvt_pk_bf16_f32 v96, v52, v54
  s_waitcnt lgkmcnt(4)
  v_smfmac_f32_16x16x64_bf16 v[64:67], v[28:31], v[76:83], v112
  ds_write_b32 v114, v96 offset:512
  v_smfmac_f32_16x16x64_bf16 v[60:63], v[8:11], v[200:207], v112
  v_smfmac_f32_16x16x64_bf16 v[60:63], v[12:15], v[208:215], v112
  v_add_f32 v56, v56, v57
  v_smfmac_f32_16x16x64_bf16 v[60:63], v[28:31], v[240:247], v112
  v_add_f32 v58, v58, v59
  v_smfmac_f32_16x16x64_bf16 v[60:63], v[32:35], v[248:255], v112
  v_cvt_pk_bf16_f32 v97, v56, v58
  s_waitcnt lgkmcnt(2)
  v_smfmac_f32_16x16x64_bf16 v[64:67], v[32:35], v[68:75], v112
  ds_write_b32 v114, v97 offset:4608
  s_nop 2
  v_add_f32 v60, v60, v61
  v_add_f32 v62, v62, v63
  v_cvt_pk_bf16_f32 v98, v60, v62
  ds_write_b32 v114, v98 offset:516
  v_add_f32 v64, v64, v65
  v_add_f32 v66, v66, v67
  v_cvt_pk_bf16_f32 v99, v64, v66
  ds_write_b32 v114, v99 offset:4612
  s_waitcnt lgkmcnt(0)
  s_barrier
  ds_read_b128 v[64:67], v100 offset:0
  ds_read_b128 v[68:71], v100 offset:1024
  ds_read_b128 v[72:75], v100 offset:2048
  ds_read_b128 v[76:79], v100 offset:3072
  ds_read_b128 v[80:83], v100 offset:4096
  ds_read_b128 v[84:87], v100 offset:5120
  ds_read_b128 v[88:91], v100 offset:6144
  ds_read_b128 v[92:95], v100 offset:7168
  ds_read_b128 v[48:51], v101 offset:0
  ds_read_b128 v[52:55], v101 offset:1024
  ds_read_b128 v[56:59], v101 offset:2048
  ds_read_b128 v[60:63], v101 offset:3072
  global_load_dword v108, v2, s[46:47] sc1
  s_nop 12
  global_load_dword v109, v2, s[46:47] sc1
  s_nop 12
  global_load_dword v110, v2, s[46:47] sc1
  s_nop 12
  global_load_dword v111, v2, s[46:47] sc1
  s_nop 12
  global_load_dword v116, v2, s[46:47] sc1
  s_nop 12
mk_c_fv1_fp_32:
  global_load_dword v117, v2, s[46:47] sc1
  s_waitcnt vmcnt(5)
  v_cmp_eq_u32 vcc, -1, v108
  s_cbranch_vccz mk_c_fv1_fd_33
  global_load_dword v108, v2, s[46:47] sc1
  s_waitcnt vmcnt(5)
  v_cmp_eq_u32 vcc, -1, v109
  s_cbranch_vccz mk_c_fv1_fd_33
  global_load_dword v109, v2, s[46:47] sc1
  s_waitcnt vmcnt(5)
  v_cmp_eq_u32 vcc, -1, v110
  s_cbranch_vccz mk_c_fv1_fd_33
  global_load_dword v110, v2, s[46:47] sc1
  s_waitcnt vmcnt(5)
  v_cmp_eq_u32 vcc, -1, v111
  s_cbranch_vccz mk_c_fv1_fd_33
  global_load_dword v111, v2, s[46:47] sc1
  s_waitcnt vmcnt(5)
  v_cmp_eq_u32 vcc, -1, v116
  s_cbranch_vccz mk_c_fv1_fd_33
  global_load_dword v116, v2, s[46:47] sc1
  s_waitcnt vmcnt(5)
  v_cmp_eq_u32 vcc, -1, v117
  s_cbranch_vccz mk_c_fv1_fd_33
  s_sub_u32 s40, s40, 1
  s_cbranch_scc0 mk_c_fv1_fp_32
  s_mov_b32 s40, 0
mk_c_fv1_fd_33:
  s_nop 3
mk_c_fv1_pld:
  global_load_dwordx4 v[40:43], v4, s[46:47] offset:0 sc1
  global_load_dwordx4 v[44:47], v4, s[46:47] offset:1024 sc1
  global_load_dwordx4 v[8:11], v1, s[46:47] offset:0 sc1
  global_load_dwordx4 v[12:15], v1, s[46:47] offset:1024 sc1
  global_load_dwordx4 v[16:19], v1, s[46:47] offset:2048 sc1
  global_load_dwordx4 v[20:23], v1, s[46:47] offset:3072 sc1
  global_load_dwordx4 v[24:27], v3, s[46:47] offset:0 sc1
  global_load_dwordx4 v[28:31], v3, s[46:47] offset:1024 sc1
  global_load_dwordx4 v[32:35], v3, s[46:47] offset:2048 sc1
  global_load_dwordx4 v[36:39], v3, s[46:47] offset:3072 sc1
  v_mov_b32 v96, 0
  v_mov_b32 v97, 0
  v_mov_b32 v98, 0
  v_mov_b32 v99, 0
  s_mov_b64 s[10:11], s[46:47]
  s_waitcnt lgkmcnt(0)
  s_waitcnt vmcnt(9)
  v_smfmac_f32_16x16x64_bf16 v[96:99], v[40:43], v[48:55], v112
  v_max3_u32 v119, v40, v41, v42
  s_waitcnt vmcnt(8)
  v_smfmac_f32_16x16x64_bf16 v[96:99], v[44:47], v[56:63], v112
  v_max3_u32 v119, v119, v43, v44
  v_max3_u32 v119, v119, v45, v46
  v_max_u32 v119, v119, v47
  v_cmp_eq_u32 vcc, -1, v119
  s_cbranch_vccnz mk_c_fv1_pre
mk_c_fv1_pgo:
  s_waitcnt vmcnt(7)
  v_smfmac_f32_16x16x64_bf16 v[96:99], v[8:11], v[64:71], v112
  ds_read_b128 v[64:67], v100 offset:8192
  ds_read_b128 v[68:71], v100 offset:9216
  s_waitcnt vmcnt(6)
  v_smfmac_f32_16x16x64_bf16 v[96:99], v[12:15], v[72:79], v112
  s_mov_b64 exec, 15
  global_store_dword v0, v112, s[50:51]
  s_mov_b64 exec, -1
  ds_read_b128 v[72:75], v100 offset:10240
  ds_read_b128 v[76:79], v100 offset:11264
  s_waitcnt vmcnt(6)
  v_smfmac_f32_16x16x64_bf16 v[96:99], v[16:19], v[80:87], v112
  ds_read_b128 v[80:83], v100 offset:12288
  ds_read_b128 v[84:87], v100 offset:13312
  s_waitcnt vmcnt(5)
  v_smfmac_f32_16x16x64_bf16 v[96:99], v[20:23], v[88:95], v112
  ds_read_b128 v[88:91], v100 offset:14336
  ds_read_b128 v[92:95], v100 offset:15360
  s_waitcnt vmcnt(4) lgkmcnt(6)
  v_smfmac_f32_16x16x64_bf16 v[96:99], v[24:27], v[64:71], v112
  s_waitcnt vmcnt(3) lgkmcnt(4)
  v_smfmac_f32_16x16x64_bf16 v[96:99], v[28:31], v[72:79], v112
  s_waitcnt vmcnt(2) lgkmcnt(2)
  v_smfmac_f32_16x16x64_bf16 v[96:99], v[32:35], v[80:87], v112
  s_waitcnt vmcnt(1) lgkmcnt(0)
  v_smfmac_f32_16x16x64_bf16 v[96:99], v[36:39], v[88:95], v112
  s_nop 7
  v_add_f32 v96, v96, v97
  v_add_f32 v98, v98, v99
  v_cmp_u_f32 vcc, v96, v98
  v_cvt_pk_bf16_f32 v96, v96, v98
  s_cbranch_vccnz mk_c_fv1_pnan
mk_c_fv1_pfin:
  s_nop 0
  v_mov_b32_dpp v97, v96 quad_perm:[1,0,3,2] row_mask:0xf bank_mask:0xf
  v_perm_b32 v96, v96, v97, v103
  global_store_dword v102, v96, s[50:51]
  s_cmp_lg_u32 s36, 62
  s_cbranch_scc1 mk_c_fv1_nopv
  s_add_u32 s30, s4, 17218560
  s_addc_u32 s31, s5, 0
  global_store_dword v102, v96, s[30:31] sc1
mk_c_fv1_nopv:
  s_mov_b64 s[48:49], s[46:47]
  s_mov_b64 s[46:47], s[50:51]
  s_add_u32 s44, s46, 10240
  s_addc_u32 s45, s47, 0
  s_add_u32 s36, s36, 1
  s_cmp_lt_u32 s36, 63
  s_cbranch_scc1 mk_c_fv1_loop
  s_branch mk_c_done
mk_c_fv1_entry:
  s_branch mk_c_fv1_mem
mk_c_fv1_fix2:
  ds_read_b128 v[24:27], v1 offset:4096
  s_waitcnt lgkmcnt(0)
  s_branch mk_c_fv1_fix2r
mk_c_fv1_redo:
  s_nop 7
  s_sub_u32 s40, s40, 1
  s_cbranch_scc1 mk_c_fv1_giveup
  s_waitcnt lgkmcnt(0)
  global_load_dwordx4 v[16:19], v5, s[44:45] sc1
  global_load_dwordx4 v[20:23], v6, s[44:45] sc1
  global_load_dwordx4 v[24:27], v7, s[44:45] sc1
  s_nop 7
  v_mov_b32 v36, 0
  v_mov_b32 v37, 0
  v_mov_b32 v38, 0
  v_mov_b32 v39, 0
  v_mov_b32 v40, 0
  v_mov_b32 v41, 0
  v_mov_b32 v42, 0
  v_mov_b32 v43, 0
  v_mov_b32 v44, 0
  v_mov_b32 v45, 0
  v_mov_b32 v46, 0
  v_mov_b32 v47, 0
  v_mov_b32 v48, 0
  v_mov_b32 v49, 0
  v_mov_b32 v50, 0
  v_mov_b32 v51, 0
  v_mov_b32 v52, 0
  v_mov_b32 v53, 0
  v_mov_b32 v54, 0
  v_mov_b32 v55, 0
  v_mov_b32 v56, 0
  v_mov_b32 v57, 0
  v_mov_b32 v58, 0
  v_mov_b32 v59, 0
  v_mov_b32 v60, 0
  v_mov_b32 v61, 0
  v_mov_b32 v62, 0
  v_mov_b32 v63, 0
  v_mov_b32 v64, 0
  v_mov_b32 v65, 0
  v_mov_b32 v66, 0
  v_mov_b32 v67, 0
  s_waitcnt vmcnt(0)
  s_branch mk_c_fv1_got
mk_c_fv1_giveup:
  s_mov_b32 s40, 0
  s_branch mk_c_fv1_cont
mk_c_fv1_pre:
  s_nop 7
  s_sub_u32 s40, s40, 1
  s_cbranch_scc0 mk_c_fv1_pld
  s_mov_b32 s40, 0
  s_branch mk_c_fv1_pgo
mk_c_fv1_pnan:
  v_max3_u32 v119, v8, v9, v10
  v_max3_u32 v119, v119, v11, v12
  v_max3_u32 v119, v119, v13, v14
  v_max3_u32 v119, v119, v15, v16
  v_max3_u32 v119, v119, v17, v18
  v_max3_u32 v119, v119, v19, v20
  v_max3_u32 v119, v119, v21, v22
  v_max3_u32 v119, v119, v23, v24
  v_max3_u32 v119, v119, v25, v26
  v_max3_u32 v119, v119, v27, v28
  v_max3_u32 v119, v119, v29, v30
  v_max3_u32 v119, v119, v31, v32
  v_max3_u32 v119, v119, v33, v34
  v_max3_u32 v119, v119, v35, v36
  v_max3_u32 v119, v119, v37, v38
  v_max3_u32 v119, v119, v39, v40
  v_max3_u32 v119, v119, v41, v42
  v_max3_u32 v119, v119, v43, v44
  v_max3_u32 v119, v119, v45, v46
  v_max_u32 v119, v119, v47
  v_cmp_eq_u32 vcc, -1, v119
  s_cbranch_vccz mk_c_fv1_pfin
  s_sub_u32 s40, s40, 1
  s_cbranch_scc1 mk_c_fv1_pgive
  ds_read_b128 v[64:67], v100 offset:0
  ds_read_b128 v[68:71], v100 offset:1024
  ds_read_b128 v[72:75], v100 offset:2048
  ds_read_b128 v[76:79], v100 offset:3072
  ds_read_b128 v[80:83], v100 offset:4096
  ds_read_b128 v[84:87], v100 offset:5120
  ds_read_b128 v[88:91], v100 offset:6144
  ds_read_b128 v[92:95], v100 offset:7168
  s_branch mk_c_fv1_pld
mk_c_fv1_pgive:
  s_mov_b32 s40, 0
  s_branch mk_c_fv1_pfin
mk_c_fv2_loop:
  global_load_dword v96, v2, s[46:47] sc1
  s_nop 11
  global_load_dword v97, v2, s[46:47] sc1
  s_nop 11
  global_load_dword v98, v2, s[46:47] sc1
  s_nop 11
  global_load_dword v99, v2, s[46:47] sc1
  s_nop 11
mk_c_fv2_fp_34:
  global_load_dword v117, v2, s[46:47] sc1
  s_waitcnt vmcnt(4)
  v_cmp_eq_u32 vcc, -1, v96
  s_cbranch_vccz mk_c_fv2_fd_35
  global_load_dword v96, v2, s[46:47] sc1
  s_waitcnt vmcnt(4)
  v_cmp_eq_u32 vcc, -1, v97
  s_cbranch_vccz mk_c_fv2_fd_35
  global_load_dword v97, v2, s[46:47] sc1
  s_waitcnt vmcnt(4)
  v_cmp_eq_u32 vcc, -1, v98
  s_cbranch_vccz mk_c_fv2_fd_35
  global_load_dword v98, v2, s[46:47] sc1
  s_waitcnt vmcnt(4)
  v_cmp_eq_u32 vcc, -1, v99
  s_cbranch_vccz mk_c_fv2_fd_35
  global_load_dword v99, v2, s[46:47] sc1
  s_waitcnt vmcnt(4)
  v_cmp_eq_u32 vcc, -1, v117
  s_cbranch_vccz mk_c_fv2_fd_35
  s_sub_u32 s40, s40, 1
  s_cbranch_scc0 mk_c_fv2_fp_34
  s_mov_b32 s40, 0
mk_c_fv2_fd_35:
  s_barrier
mk_c_fv2_mem:
  global_load_dwordx4 v[24:27], v5, s[44:45] sc1
  s_nop 3
  global_load_dwordx4 v[28:31], v6, s[44:45] sc1
  s_nop 3
  global_load_dwordx4 v[32:35], v7, s[44:45] sc1
  s_barrier
  s_add_u32 m0, s35, 0
  s_nop 0
  global_load_lds_dwordx4 v1, s[56:57] offset:0 sc1
  s_add_u32 m0, s35, 0
  s_nop 0
  global_load_lds_dwordx4 v1, s[56:57] offset:1024 sc1
  s_add_u32 m0, s35, 0
  s_nop 0
  global_load_lds_dwordx4 v1, s[56:57] offset:2048 sc1
  s_add_u32 m0, s35, 0
  s_nop 0
  global_load_lds_dwordx4 v1, s[56:57] offset:3072 sc1
mk_c_fv2_got:
  s_waitcnt vmcnt(6)
  ds_write_b128 v1, v[24:27] offset:4096
  v_smfmac_f32_16x16x64_bf16 v[36:39], v[24:27], a[32:39], v112
  s_waitcnt vmcnt(5)
  ds_write_b128 v1, v[28:31] offset:5120
  v_smfmac_f32_16x16x64_bf16 v[40:43], v[24:27], a[88:95], v112
  v_max3_u32 v119, v24, v25, v26
  v_smfmac_f32_16x16x64_bf16 v[44:47], v[24:27], a[144:151], v112
  v_max3_u32 v119, v119, v27, v28
  v_smfmac_f32_16x16x64_bf16 v[48:51], v[24:27], a[200:207], v112
  v_max3_u32 v119, v119, v29, v30
  v_smfmac_f32_16x16x64_bf16 v[52:55], v[24:27], v[120:127], v112
  v_max_u32 v119, v119, v31
  v_smfmac_f32_16x16x64_bf16 v[56:59], v[24:27], v[176:183], v112
  v_cmp_eq_u32 vcc, -1, v119
  v_smfmac_f32_16x16x64_bf16 v[60:63], v[24:27], v[232:239], v112
  s_cbranch_vccnz mk_c_fv2_redo
mk_c_fv2_cont:
  v_smfmac_f32_16x16x64_bf16 v[36:39], v[28:31], a[40:47], v112
  v_smfmac_f32_16x16x64_bf16 v[40:43], v[28:31], a[96:103], v112
  s_add_u32 m0, s35, 4096
  s_nop 0
  global_load_lds_dwordx4 v3, s[56:57] offset:0 sc1
  v_smfmac_f32_16x16x64_bf16 v[44:47], v[28:31], a[152:159], v112
  s_add_u32 m0, s35, 4096
  s_nop 0
  global_load_lds_dwordx4 v3, s[56:57] offset:1024 sc1
  v_smfmac_f32_16x16x64_bf16 v[48:51], v[28:31], a[208:215], v112
  s_add_u32 m0, s35, 4096
  s_nop 0
  global_load_lds_dwordx4 v3, s[56:57] offset:2048 sc1
  v_smfmac_f32_16x16x64_bf16 v[52:55], v[28:31], v[128:135], v112
  s_add_u32 m0, s35, 4096
  s_nop 0
  global_load_lds_dwordx4 v3, s[56:57] offset:3072 sc1
  s_waitcnt vmcnt(8)
  v_max3_u32 v119, v32, v33, v34
  v_smfmac_f32_16x16x64_bf16 v[56:59], v[28:31], v[184:191], v112
  v_max_u32 v119, v119, v35
  v_smfmac_f32_16x16x64_bf16 v[60:63], v[28:31], v[240:247], v112
  v_cmp_eq_u32 vcc, -1, v119
  s_waitcnt lgkmcnt(0)
  s_barrier
  s_nop 0
  s_cbranch_vccnz mk_c_fv2_fix2
mk_c_fv2_fix2r:
  ds_read_b128 v[8:11], v1 offset:0
  ds_read_b128 v[12:15], v1 offset:1024
  ds_read_b128 v[16:19], v1 offset:2048
  ds_read_b128 v[20:23], v1 offset:3072
  ds_read_b128 v[68:71], v113 offset:8192
  ds_read_b128 v[72:75], v113 offset:9216
  ds_read_b128 v[76:79], v113 offset:10240
  ds_read_b128 v[80:83], v113 offset:11264
  v_smfmac_f32_16x16x64_bf16 v[36:39], v[32:35], a[48:55], v112
  v_smfmac_f32_16x16x64_bf16 v[40:43], v[32:35], a[104:111], v112
  v_smfmac_f32_16x16x64_bf16 v[44:47], v[32:35], a[160:167], v112
  v_smfmac_f32_16x16x64_bf16 v[48:51], v[32:35], a[216:223], v112
  v_smfmac_f32_16x16x64_bf16 v[52:55], v[32:35], v[136:143], v112
  v_smfmac_f32_16x16x64_bf16 v[56:59], v[32:35], v[192:199], v112
  v_smfmac_f32_16x16x64_bf16 v[60:63], v[32:35], v[248:255], v112
  s_add_u32 s56, s56, 458752
  s_addc_u32 s57, s57, 0
  s_xor_b32 s35, s35, 0x38000
  s_waitcnt lgkmcnt(7)
  v_smfmac_f32_16x16x64_bf16 v[36:39], v[8:11], a[0:7], v112
  s_waitcnt lgkmcnt(6)
  v_smfmac_f32_16x16x64_bf16 v[36:39], v[12:15], a[8:15], v112
  s_waitcnt lgkmcnt(5)
  v_smfmac_f32_16x16x64_bf16 v[36:39], v[16:19], a[16:23], v112
  s_waitcnt lgkmcnt(4)
  v_smfmac_f32_16x16x64_bf16 v[36:39], v[20:23], a[24:31], v112
  s_waitcnt lgkmcnt(2)
  v_smfmac_f32_16x16x64_bf16 v[64:67], v[24:27], v[68:75], v112
  ds_read_b128 v[68:71], v113 offset:12288
  ds_read_b128 v[72:75], v113 offset:13312
  v_smfmac_f32_16x16x64_bf16 v[40:43], v[8:11], a[56:63], v112
  v_smfmac_f32_16x16x64_bf16 v[40:43], v[12:15], a[64:71], v112
  v_add_f32 v36, v36, v37
  v_smfmac_f32_16x16x64_bf16 v[40:43], v[16:19], a[72:79], v112
  v_add_f32 v38, v38, v39
  v_smfmac_f32_16x16x64_bf16 v[40:43], v[20:23], a[80:87], v112
  v_cvt_pk_bf16_f32 v96, v36, v38
  s_waitcnt lgkmcnt(2)
  v_smfmac_f32_16x16x64_bf16 v[64:67], v[28:31], v[76:83], v112
  ds_read_b128 v[76:79], v113 offset:0
  ds_read_b128 v[80:83], v113 offset:1024
  ds_write_b32 v114, v96 offset:0
  v_smfmac_f32_16x16x64_bf16 v[44:47], v[8:11], a[112:119], v112
  v_smfmac_f32_16x16x64_bf16 v[44:47], v[12:15], a[120:127], v112
  v_add_f32 v40, v40, v41
  v_smfmac_f32_16x16x64_bf16 v[44:47], v[16:19], a[128:135], v112
  v_add_f32 v42, v42, v43
  v_smfmac_f32_16x16x64_bf16 v[44:47], v[20:23], a[136:143], v112
  v_cvt_pk_bf16_f32 v97, v40, v42
  s_waitcnt lgkmcnt(3)
  v_smfmac_f32_16x16x64_bf16 v[64:67], v[32:35], v[68:75], v112
  ds_read_b128 v[68:71], v113 offset:2048
  ds_read_b128 v[72:75], v113 offset:3072
  ds_write_b32 v114, v97 offset:4096
  v_smfmac_f32_16x16x64_bf16 v[48:51], v[8:11], a[168:175], v112
  v_smfmac_f32_16x16x64_bf16 v[48:51], v[12:15], a[176:183], v112
  v_add_f32 v44, v44, v45
  v_smfmac_f32_16x16x64_bf16 v[48:51], v[16:19], a[184:191], v112
  v_add_f32 v46, v46, v47
  v_smfmac_f32_16x16x64_bf16 v[48:51], v[20:23], a[192:199], v112
  v_cvt_pk_bf16_f32 v98, v44, v46
  s_waitcnt lgkmcnt(4)
  v_smfmac_f32_16x16x64_bf16 v[64:67], v[8:11], v[76:83], v112
  ds_read_b128 v[76:79], v113 offset:4096
  ds_read_b128 v[80:83], v113 offset:5120
  ds_write_b32 v114, v98 offset:4
  v_smfmac_f32_16x16x64_bf16 v[52:55], v[8:11], a[224:231], v112
  v_smfmac_f32_16x16x64_bf16 v[52:55], v[12:15], a[232:239], v112
  v_add_f32 v48, v48, v49
  v_smfmac_f32_16x16x64_bf16 v[52:55], v[16:19], a[240:247], v112
  v_add_f32 v50, v50, v51
  v_smfmac_f32_16x16x64_bf16 v[52:55], v[20:23], a[248:255], v112
  v_cvt_pk_bf16_f32 v99, v48, v50
  s_waitcnt lgkmcnt(4)
  v_smfmac_f32_16x16x64_bf16 v[64:67], v[12:15], v[68:75], v112
  ds_read_b128 v[68:71], v113 offset:6144
  ds_read_b128 v[72:75], v113 offset:7168
  ds_write_b32 v114, v99 offset:4100
  v_smfmac_f32_16x16x64_bf16 v[56:59], v[8:11], v[144:151], v112
  v_smfmac_f32_16x16x64_bf16 v[56:59], v[12:15], v[152:159], v112
  v_add_f32 v52, v52, v53
  v_smfmac_f32_16x16x64_bf16 v[56:59], v[16:19], v[160:167], v112
  v_add_f32 v54, v54, v55
  v_smfmac_f32_16x16x64_bf16 v[56:59], v[20:23], v[168:175], v112
  v_cvt_pk_bf16_f32 v96, v52, v54
  s_waitcnt lgkmcnt(4)
  v_smfmac_f32_16x16x64_bf16 v[64:67], v[16:19], v[76:83], v112
  ds_write_b32 v114, v96 offset:512
  v_smfmac_f32_16x16x64_bf16 v[60:63], v[8:11], v[200:207], v112
  v_smfmac_f32_16x16x64_bf16 v[60:63], v[12:15], v[208:215], v112
  v_add_f32 v56, v56, v57
  v_smfmac_f32_16x16x64_bf16 v[60:63], v[16:19], v[216:223], v112
  v_add_f32 v58, v58, v59
  v_smfmac_f32_16x16x64_bf16 v[60:63], v[20:23], v[224:231], v112
  v_cvt_pk_bf16_f32 v97, v56, v58
  s_waitcnt lgkmcnt(2)
  v_smfmac_f32_16x16x64_bf16 v[64:67], v[20:23], v[68:75], v112
  ds_write_b32 v114, v97 offset:4608
  s_nop 2
  v_add_f32 v60, v60, v61
  v_add_f32 v62, v62, v63
  v_cvt_pk_bf16_f32 v98, v60, v62
  ds_write_b32 v114, v98 offset:516
  v_add_f32 v64, v64, v65
  v_add_f32 v66, v66, v67
  v_cvt_pk_bf16_f32 v99, v64, v66
  ds_write_b32 v114, v99 offset:4612
  s_waitcnt lgkmcnt(0)
  s_barrier
  s_mov_b64 s[48:49], s[46:47]
  s_mov_b64 s[46:47], s[50:51]
  s_add_u32 s44, s46, 10240
  s_addc_u32 s45, s47, 0
  s_add_u32 s36, s36, 1
  s_add_u32 s30, s38, 15728640
  s_add_u32 s50, s4, s30
  s_addc_u32 s51, s5, 0
  s_add_u32 s38, s38, 147456
  s_cmp_eq_u32 s38, 589824
  s_cselect_b32 s38, 0, s38
  v_mov_b32 v36, 0
  v_mov_b32 v37, 0
  v_mov_b32 v38, 0
  v_mov_b32 v39, 0
  v_mov_b32 v40, 0
  v_mov_b32 v41, 0
  v_mov_b32 v42, 0
  v_mov_b32 v43, 0
  v_mov_b32 v44, 0
  v_mov_b32 v45, 0
  v_mov_b32 v46, 0
  v_mov_b32 v47, 0
  v_mov_b32 v48, 0
  v_mov_b32 v49, 0
  v_mov_b32 v50, 0
  v_mov_b32 v51, 0
  v_mov_b32 v52, 0
  v_mov_b32 v53, 0
  v_mov_b32 v54, 0
  v_mov_b32 v55, 0
  v_mov_b32 v56, 0
  v_mov_b32 v57, 0
  v_mov_b32 v58, 0
  v_mov_b32 v59, 0
  v_mov_b32 v60, 0
  v_mov_b32 v61, 0
  v_mov_b32 v62, 0
  v_mov_b32 v63, 0
  v_mov_b32 v64, 0
  v_mov_b32 v65, 0
  v_mov_b32 v66, 0
  v_mov_b32 v67, 0
  s_cmp_lt_u32 s36, 63
  s_cbranch_scc1 mk_c_fv2_loop
  s_branch mk_c_done
mk_c_fv2_entry:
  s_branch mk_c_fv2_mem
mk_c_fv2_fix2:
  ds_read_b128 v[32:35], v1 offset:6144
  s_waitcnt lgkmcnt(0)
  s_branch mk_c_fv2_fix2r
mk_c_fv2_redo:
  s_nop 7
  s_sub_u32 s40, s40, 1
  s_cbranch_scc1 mk_c_fv2_giveup
  s_waitcnt lgkmcnt(0)
  global_load_dwordx4 v[24:27], v5, s[44:45] sc1
  global_load_dwordx4 v[28:31], v6, s[44:45] sc1
  global_load_dwordx4 v[32:35], v7, s[44:45] sc1
  s_nop 7
  v_mov_b32 v36, 0
  v_mov_b32 v37, 0
  v_mov_b32 v38, 0
  v_mov_b32 v39, 0
  v_mov_b32 v40, 0
  v_mov_b32 v41, 0
  v_mov_b32 v42, 0
  v_mov_b32 v43, 0
  v_mov_b32 v44, 0
  v_mov_b32 v45, 0
  v_mov_b32 v46, 0
  v_mov_b32 v47, 0
  v_mov_b32 v48, 0
  v_mov_b32 v49, 0
  v_mov_b32 v50, 0
  v_mov_b32 v51, 0
  v_mov_b32 v52, 0
  v_mov_b32 v53, 0
  v_mov_b32 v54, 0
  v_mov_b32 v55, 0
  v_mov_b32 v56, 0
  v_mov_b32 v57, 0
  v_mov_b32 v58, 0
  v_mov_b32 v59, 0
  v_mov_b32 v60, 0
  v_mov_b32 v61, 0
  v_mov_b32 v62, 0
  v_mov_b32 v63, 0
  v_mov_b32 v64, 0
  v_mov_b32 v65, 0
  v_mov_b32 v66, 0
  v_mov_b32 v67, 0
  s_waitcnt vmcnt(0)
  s_branch mk_c_fv2_got
mk_c_fv2_giveup:
  s_mov_b32 s40, 0
  s_branch mk_c_fv2_cont
mk_c_fv3_loop:
  s_barrier
mk_c_fv3_mem:
  global_load_dwordx4 v[32:35], v5, s[44:45] sc1
  s_nop 3
  global_load_dwordx4 v[8:11], v6, s[44:45] sc1
  s_nop 3
  global_load_dwordx4 v[12:15], v7, s[44:45] sc1
  s_barrier
  s_add_u32 m0, s35, 0
  s_nop 0
  global_load_lds_dwordx4 v1, s[56:57] offset:0 sc1
  s_add_u32 m0, s35, 0
  s_nop 0
  global_load_lds_dwordx4 v1, s[56:57] offset:1024 sc1
  s_add_u32 m0, s35, 0
  s_nop 0
  global_load_lds_dwordx4 v1, s[56:57] offset:2048 sc1
  s_add_u32 m0, s35, 0
  s_nop 0
  global_load_lds_dwordx4 v1, s[56:57] offset:3072 sc1
mk_c_fv3_got:
  s_waitcnt vmcnt(6)
  ds_write_b128 v1, v[32:35] offset:6144
  v_smfmac_f32_16x16x64_bf16 v[36:39], v[32:35], a[48:55], v112
  s_waitcnt vmcnt(5)
  v_smfmac_f32_16x16x64_bf16 v[40:43], v[32:35], a[104:111], v112
  v_max3_u32 v119, v32, v33, v34
  v_smfmac_f32_16x16x64_bf16 v[44:47], v[32:35], a[160:167], v112
  v_max3_u32 v119, v119, v35, v8
  v_smfmac_f32_16x16x64_bf16 v[48:51], v[32:35], a[216:223], v112
  v_max3_u32 v119, v119, v9, v10
  v_smfmac_f32_16x16x64_bf16 v[52:55], v[32:35], v[136:143], v112
  v_max_u32 v119, v119, v11
  v_smfmac_f32_16x16x64_bf16 v[56:59], v[32:35], v[192:199], v112
  v_cmp_eq_u32 vcc, -1, v119
  v_smfmac_f32_16x16x64_bf16 v[60:63], v[32:35], v[248:255], v112
  s_cbranch_vccnz mk_c_fv3_redo
mk_c_fv3_cont:
  v_smfmac_f32_16x16x64_bf16 v[36:39], v[8:11], a[0:7], v112
  v_smfmac_f32_16x16x64_bf16 v[40:43], v[8:11], a[56:63], v112
  s_add_u32 m0, s35, 4096
  s_nop 0
  global_load_lds_dwordx4 v3, s[56:57] offset:0 sc1
  v_smfmac_f32_16x16x64_bf16 v[44:47], v[8:11], a[112:119], v112
  s_add_u32 m0, s35, 4096
  s_nop 0
  global_load_lds_dwordx4 v3, s[56:57] offset:1024 sc1
  v_smfmac_f32_16x16x64_bf16 v[48:51], v[8:11], a[168:175], v112
  s_add_u32 m0, s35, 4096
  s_nop 0
  global_load_lds_dwordx4 v3, s[56:57] offset:2048 sc1
  v_smfmac_f32_16x16x64_bf16 v[52:55], v[8:11], a[224:231], v112
  s_add_u32 m0, s35, 4096
  s_nop 0
  global_load_lds_dwordx4 v3, s[56:57] offset:3072 sc1
  s_waitcnt vmcnt(8)
  v_max3_u32 v119, v12, v13, v14
  v_smfmac_f32_16x16x64_bf16 v[56:59], v[8:11], v[144:151], v112
  v_max_u32 v119, v119, v15
  v_smfmac_f32_16x16x64_bf16 v[60:63], v[8:11], v[200:207], v112
  v_cmp_eq_u32 vcc, -1, v119
  s_waitcnt lgkmcnt(0)
  s_barrier
  s_nop 0
  s_cbranch_vccnz mk_c_fv3_fix2
mk_c_fv3_fix2r:
  ds_read_b128 v[16:19], v1 offset:2048
  ds_read_b128 v[20:23], v1 offset:3072
  ds_read_b128 v[24:27], v1 offset:4096
  ds_read_b128 v[28:31], v1 offset:5120
  ds_read_b128 v[68:71], v113 offset:12288
  ds_read_b128 v[72:75], v113 offset:13312
  ds_read_b128 v[76:79], v113 offset:0
  ds_read_b128 v[80:83], v113 offset:1024
  v_smfmac_f32_16x16x64_bf16 v[36:39], v[12:15], a[8:15], v112
  global_load_dword v116, v105, s[12:13] sc1
  v_smfmac_f32_16x16x64_bf16 v[40:43], v[12:15], a[64:71], v112
  v_smfmac_f32_16x16x64_bf16 v[44:47], v[12:15], a[120:127], v112
  v_smfmac_f32_16x16x64_bf16 v[48:51], v[12:15], a[176:183], v112
  v_smfmac_f32_16x16x64_bf16 v[52:55], v[12:15], a[232:239], v112
  v_smfmac_f32_16x16x64_bf16 v[56:59], v[12:15], v[152:159], v112
  v_smfmac_f32_16x16x64_bf16 v[60:63], v[12:15], v[208:215], v112
  s_add_u32 s56, s56, 458752
  s_addc_u32 s57, s57, 0
  s_xor_b32 s35, s35, 0x38000
  s_waitcnt lgkmcnt(7)
  v_smfmac_f32_16x16x64_bf16 v[36:39], v[16:19], a[16:23], v112
  s_waitcnt lgkmcnt(6)
  v_smfmac_f32_16x16x64_bf16 v[36:39], v[20:23], a[24:31], v112
  s_waitcnt lgkmcnt(5)
  v_smfmac_f32_16x16x64_bf16 v[36:39], v[24:27], a[32:39], v112
  s_waitcnt lgkmcnt(4)
  v_smfmac_f32_16x16x64_bf16 v[36:39], v[28:31], a[40:47], v112
  s_waitcnt lgkmcnt(2)
  v_smfmac_f32_16x16x64_bf16 v[64:67], v[32:35], v[68:75], v112
  ds_read_b128 v[68:71], v113 offset:2048
  ds_read_b128 v[72:75], v113 offset:3072
  v_smfmac_f32_16x16x64_bf16 v[40:43], v[16:19], a[72:79], v112
  v_smfmac_f32_16x16x64_bf16 v[40:43], v[20:23], a[80:87], v112
  v_add_f32 v36, v36, v37
  v_smfmac_f32_16x16x64_bf16 v[40:43], v[24:27], a[88:95], v112
  v_add_f32 v38, v38, v39
  v_smfmac_f32_16x16x64_bf16 v[40:43], v[28:31], a[96:103], v112
  v_cvt_pk_bf16_f32 v96, v36, v38
  s_waitcnt lgkmcnt(2)
  v_smfmac_f32_16x16x64_bf16 v[64:67], v[8:11], v[76:83], v112
  ds_read_b128 v[76:79], v113 offset:4096
  ds_read_b128 v[80:83], v113 offset:5120
  ds_write_b32 v114, v96 offset:0
  v_smfmac_f32_16x16x64_bf16 v[44:47], v[16:19], a[128:135], v112
  v_smfmac_f32_16x16x64_bf16 v[44:47], v[20:23], a[136:143], v112
  v_add_f32 v40, v40, v41
  v_smfmac_f32_16x16x64_bf16 v[44:47], v[24:27], a[144:151], v112
  v_add_f32 v42, v42, v43
  v_smfmac_f32_16x16x64_bf16 v[44:47], v[28:31], a[152:159], v112
  v_cvt_pk_bf16_f32 v97, v40, v42
  s_waitcnt lgkmcnt(3)
  v_smfmac_f32_16x16x64_bf16 v[64:67], v[12:15], v[68:75], v112
  ds_read_b128 v[68:71], v113 offset:6144
  ds_read_b128 v[72:75], v113 offset:7168
  ds_write_b32 v114, v97 offset:4096
  v_smfmac_f32_16x16x64_bf16 v[48:51], v[16:19], a[184:191], v112
  v_smfmac_f32_16x16x64_bf16 v[48:51], v[20:23], a[192:199], v112
  v_add_f32 v44, v44, v45
  v_smfmac_f32_16x16x64_bf16 v[48:51], v[24:27], a[200:207], v112
  v_add_f32 v46, v46, v47
  v_smfmac_f32_16x16x64_bf16 v[48:51], v[28:31], a[208:215], v112
  v_cvt_pk_bf16_f32 v98, v44, v46
  s_waitcnt lgkmcnt(4)
  v_smfmac_f32_16x16x64_bf16 v[64:67], v[16:19], v[76:83], v112
  ds_read_b128 v[76:79], v113 offset:8192
  ds_read_b128 v[80:83], v113 offset:9216
  ds_write_b32 v114, v98 offset:4
  v_smfmac_f32_16x16x64_bf16 v[52:55], v[16:19], a[240:247], v112
  v_smfmac_f32_16x16x64_bf16 v[52:55], v[20:23], a[248:255], v112
  v_add_f32 v48, v48, v49
  v_smfmac_f32_16x16x64_bf16 v[52:55], v[24:27], v[120:127], v112
  v_add_f32 v50, v50, v51
  v_smfmac_f32_16x16x64_bf16 v[52:55], v[28:31], v[128:135], v112
  v_cvt_pk_bf16_f32 v99, v48, v50
  s_waitcnt lgkmcnt(4)
  v_smfmac_f32_16x16x64_bf16 v[64:67], v[20:23], v[68:75], v112
  ds_read_b128 v[68:71], v113 offset:10240
  ds_read_b128 v[72:75], v113 offset:11264
  ds_write_b32 v114, v99 offset:4100
  v_smfmac_f32_16x16x64_bf16 v[56:59], v[16:19], v[160:167], v112
  v_smfmac_f32_16x16x64_bf16 v[56:59], v[20:23], v[168:175], v112
  v_add_f32 v52, v52, v53
  v_smfmac_f32_16x16x64_bf16 v[56:59], v[24:27], v[176:183], v112
  v_add_f32 v54, v54, v55
  v_smfmac_f32_16x16x64_bf16 v[56:59], v[28:31], v[184:191], v112
  v_cvt_pk_bf16_f32 v96, v52, v54
  s_waitcnt lgkmcnt(4)
  v_smfmac_f32_16x16x64_bf16 v[64:67], v[24:27], v[76:83], v112
  ds_write_b32 v114, v96 offset:512
  v_smfmac_f32_16x16x64_bf16 v[60:63], v[16:19], v[216:223], v112
  v_smfmac_f32_16x16x64_bf16 v[60:63], v[20:23], v[224:231], v112
  v_add_f32 v56, v56, v57
  v_smfmac_f32_16x16x64_bf16 v[60:63], v[24:27], v[232:239], v112
  v_add_f32 v58, v58, v59
  v_smfmac_f32_16x16x64_bf16 v[60:63], v[28:31], v[240:247], v112
  v_cvt_pk_bf16_f32 v97, v56, v58
  s_waitcnt lgkmcnt(2)
  v_smfmac_f32_16x16x64_bf16 v[64:67], v[28:31], v[68:75], v112
  ds_write_b32 v114, v97 offset:4608
  s_nop 2
  v_add_f32 v60, v60, v61
  v_add_f32 v62, v62, v63
  v_cvt_pk_bf16_f32 v98, v60, v62
  ds_write_b32 v114, v98 offset:516
  v_add_f32 v64, v64, v65
  v_add_f32 v66, v66, v67
  v_cvt_pk_bf16_f32 v99, v64, v66
  ds_write_b32 v114, v99 offset:4612
  s_waitcnt lgkmcnt(0)
  s_barrier
  s_waitcnt vmcnt(0)
  v_cmp_ne_u32 vcc, v115, v116
  s_cbranch_vccnz mk_c_fv3_uwait
mk_c_fv3_uok:
  s_mov_b64 s[48:49], s[46:47]
  s_mov_b64 s[46:47], s[50:51]
  s_add_u32 s44, s46, 10240
  s_addc_u32 s45, s47, 0
  s_add_u32 s36, s36, 1
  s_add_u32 s30, s38, 15728640
  s_add_u32 s50, s4, s30
  s_addc_u32 s51, s5, 0
  s_add_u32 s38, s38, 147456
  s_cmp_eq_u32 s38, 589824
  s_cselect_b32 s38, 0, s38
  s_add_u32 s12, s12, 448
  s_addc_u32 s13, s13, 0
  v_mov_b32 v36, 0
  v_mov_b32 v37, 0
  v_mov_b32 v38, 0
  v_mov_b32 v39, 0
  v_mov_b32 v40, 0
  v_mov_b32 v41, 0
  v_mov_b32 v42, 0
  v_mov_b32 v43, 0
  v_mov_b32 v44, 0
  v_mov_b32 v45, 0
  v_mov_b32 v46, 0
  v_mov_b32 v47, 0
  v_mov_b32 v48, 0
  v_mov_b32 v49, 0
  v_mov_b32 v50, 0
  v_mov_b32 v51, 0
  v_mov_b32 v52, 0
  v_mov_b32 v53, 0
  v_mov_b32 v54, 0
  v_mov_b32 v55, 0
  v_mov_b32 v56, 0
  v_mov_b32 v57, 0
  v_mov_b32 v58, 0
  v_mov_b32 v59, 0
  v_mov_b32 v60, 0
  v_mov_b32 v61, 0
  v_mov_b32 v62, 0
  v_mov_b32 v63, 0
  v_mov_b32 v64, 0
  v_mov_b32 v65, 0
  v_mov_b32 v66, 0
  v_mov_b32 v67, 0
  s_cmp_lt_u32 s36, 63
  s_cbranch_scc1 mk_c_fv3_loop
  s_branch mk_c_done
mk_c_fv3_entry:
  s_branch mk_c_fv3_mem
mk_c_fv3_uwait:
  s_cmp_ge_u32 s36, 61
  s_cbranch_scc1 mk_c_fv3_uok
  global_load_dword v116, v105, s[12:13] sc1
  s_waitcnt vmcnt(0)
  v_cmp_ne_u32 vcc, v115, v116
  s_cbranch_vccz mk_c_fv3_uok
  s_sleep 4
  s_sub_u32 s40, s40, 1
  s_cbranch_scc0 mk_c_fv3_uwait
  s_mov_b32 s40, 0
  s_branch mk_c_fv3_uok
mk_c_fv3_fix2:
  ds_read_b128 v[12:15], v1 offset:1024
  s_waitcnt lgkmcnt(0)
  s_branch mk_c_fv3_fix2r
mk_c_fv3_redo:
  s_nop 7
  s_sub_u32 s40, s40, 1
  s_cbranch_scc1 mk_c_fv3_giveup
  s_waitcnt lgkmcnt(0)
  global_load_dwordx4 v[32:35], v5, s[44:45] sc1
  global_load_dwordx4 v[8:11], v6, s[44:45] sc1
  global_load_dwordx4 v[12:15], v7, s[44:45] sc1
  s_nop 7
  v_mov_b32 v36, 0
  v_mov_b32 v37, 0
  v_mov_b32 v38, 0
  v_mov_b32 v39, 0
  v_mov_b32 v40, 0
  v_mov_b32 v41, 0
  v_mov_b32 v42, 0
  v_mov_b32 v43, 0
  v_mov_b32 v44, 0
  v_mov_b32 v45, 0
  v_mov_b32 v46, 0
  v_mov_b32 v47, 0
  v_mov_b32 v48, 0
  v_mov_b32 v49, 0
  v_mov_b32 v50, 0
  v_mov_b32 v51, 0
  v_mov_b32 v52, 0
  v_mov_b32 v53, 0
  v_mov_b32 v54, 0
  v_mov_b32 v55, 0
  v_mov_b32 v56, 0
  v_mov_b32 v57, 0
  v_mov_b32 v58, 0
  v_mov_b32 v59, 0
  v_mov_b32 v60, 0
  v_mov_b32 v61, 0
  v_mov_b32 v62, 0
  v_mov_b32 v63, 0
  v_mov_b32 v64, 0
  v_mov_b32 v65, 0
  v_mov_b32 v66, 0
  v_mov_b32 v67, 0
  s_waitcnt vmcnt(0)
  s_branch mk_c_fv3_got
mk_c_fv3_giveup:
  s_mov_b32 s40, 0
  s_branch mk_c_fv3_cont
mk_c_ss0_loop:
  s_barrier
mk_c_ss0_mem:
  global_load_dwordx4 v[8:11], v1, s[44:45] offset:0 sc1
  s_nop 11
  global_load_dwordx4 v[12:15], v1, s[44:45] offset:1024 sc1
  s_nop 11
  global_load_dwordx4 v[16:19], v1, s[44:45] offset:2048 sc1
  s_nop 11
  global_load_dwordx4 v[20:23], v1, s[44:45] offset:3072 sc1
  s_waitcnt vmcnt(3)
  v_smfmac_f32_16x16x64_bf16 v[36:39], v[8:11], a[0:7], v112
  ds_write_b128 v1, v[8:11] offset:0
  v_smfmac_f32_16x16x64_bf16 v[40:43], v[8:11], a[56:63], v112
  global_load_dwordx4 v[24:27], v3, s[44:45] offset:0 sc1
  v_smfmac_f32_16x16x64_bf16 v[44:47], v[8:11], a[112:119], v112
  v_max3_u32 v119, v8, v9, v10
  v_smfmac_f32_16x16x64_bf16 v[48:51], v[8:11], a[168:175], v112
  global_load_dwordx4 v[28:31], v3, s[44:45] offset:1024 sc1
  v_smfmac_f32_16x16x64_bf16 v[52:55], v[8:11], a[224:231], v112
  v_max_u32 v119, v119, v11
  v_smfmac_f32_16x16x64_bf16 v[56:59], v[8:11], v[144:151], v112
  global_load_dwordx4 v[32:35], v3, s[44:45] offset:2048 sc1
  v_smfmac_f32_16x16x64_bf16 v[60:63], v[8:11], v[200:207], v112
  s_waitcnt vmcnt(5)
  v_smfmac_f32_16x16x64_bf16 v[36:39], v[12:15], a[8:15], v112
  ds_write_b128 v1, v[12:15] offset:1024
  v_smfmac_f32_16x16x64_bf16 v[40:43], v[12:15], a[64:71], v112
  v_smfmac_f32_16x16x64_bf16 v[44:47], v[12:15], a[120:127], v112
  v_max3_u32 v119, v119, v12, v13
  v_smfmac_f32_16x16x64_bf16 v[48:51], v[12:15], a[176:183], v112
  v_smfmac_f32_16x16x64_bf16 v[52:55], v[12:15], a[232:239], v112
  v_max3_u32 v119, v119, v14, v15
  v_smfmac_f32_16x16x64_bf16 v[56:59], v[12:15], v[152:159], v112
  v_smfmac_f32_16x16x64_bf16 v[60:63], v[12:15], v[208:215], v112
  s_waitcnt vmcnt(4)
  v_smfmac_f32_16x16x64_bf16 v[36:39], v[16:19], a[16:23], v112
  ds_read_b128 v[8:11], v1 offset:40960
  v_smfmac_f32_16x16x64_bf16 v[40:43], v[16:19], a[72:79], v112
  ds_read_b128 v[12:15], v1 offset:41984
  v_smfmac_f32_16x16x64_bf16 v[44:47], v[16:19], a[128:135], v112
  v_max3_u32 v119, v119, v16, v17
  v_smfmac_f32_16x16x64_bf16 v[48:51], v[16:19], a[184:191], v112
  v_max3_u32 v119, v119, v18, v19
  v_smfmac_f32_16x16x64_bf16 v[52:55], v[16:19], a[240:247], v112
  v_cmp_eq_u32 vcc, -1, v119
  v_smfmac_f32_16x16x64_bf16 v[56:59], v[16:19], v[160:167], v112
  v_smfmac_f32_16x16x64_bf16 v[60:63], v[16:19], v[216:223], v112
  s_cbranch_vccnz mk_c_ss0_redo
mk_c_ss0_cont:
  s_waitcnt vmcnt(3)
  v_smfmac_f32_16x16x64_bf16 v[36:39], v[20:23], a[24:31], v112
  s_waitcnt vmcnt(2)
  v_smfmac_f32_16x16x64_bf16 v[36:39], v[24:27], a[32:39], v112
  s_waitcnt vmcnt(1)
  v_smfmac_f32_16x16x64_bf16 v[36:39], v[28:31], a[40:47], v112
  s_waitcnt vmcnt(0)
  v_smfmac_f32_16x16x64_bf16 v[36:39], v[32:35], a[48:55], v112
  v_smfmac_f32_16x16x64_bf16 v[40:43], v[20:23], a[80:87], v112
  ds_read2_b64 v[96:99], v7 offset0:0 offset1:32
  ds_read2_b64 v[116:119], v7 offset0:64 offset1:96
  v_smfmac_f32_16x16x64_bf16 v[40:43], v[24:27], a[88:95], v112
  v_add_f32 v108, v36, v37
  v_smfmac_f32_16x16x64_bf16 v[40:43], v[28:31], a[96:103], v112
  v_add_f32 v109, v38, v39
  v_smfmac_f32_16x16x64_bf16 v[40:43], v[32:35], a[104:111], v112
  v_cvt_pk_bf16_f32 v108, v108, v109
  v_smfmac_f32_16x16x64_bf16 v[44:47], v[20:23], a[136:143], v112
  ds_write_b32 v5, v108 offset:0
  v_smfmac_f32_16x16x64_bf16 v[44:47], v[24:27], a[144:151], v112
  v_add_f32 v108, v40, v41
  v_smfmac_f32_16x16x64_bf16 v[44:47], v[28:31], a[152:159], v112
  v_add_f32 v109, v42, v43
  v_smfmac_f32_16x16x64_bf16 v[44:47], v[32:35], a[160:167], v112
  v_cvt_pk_bf16_f32 v108, v108, v109
  v_smfmac_f32_16x16x64_bf16 v[48:51], v[20:23], a[192:199], v112
  ds_write_b32 v5, v108 offset:512
  ds_read_b64_tr_b16 v[76:77], v6 offset:0
  v_smfmac_f32_16x16x64_bf16 v[48:51], v[24:27], a[200:207], v112
  v_add_f32 v108, v44, v45
  ds_read_b64_tr_b16 v[78:79], v6 offset:512
  v_smfmac_f32_16x16x64_bf16 v[48:51], v[28:31], a[208:215], v112
  v_add_f32 v109, v46, v47
  v_smfmac_f32_16x16x64_bf16 v[48:51], v[32:35], a[216:223], v112
  v_cvt_pk_bf16_f32 v108, v108, v109
  v_smfmac_f32_16x16x64_bf16 v[52:55], v[20:23], a[248:255], v112
  ds_write_b32 v5, v108 offset:1024
  v_smfmac_f32_16x16x64_bf16 v[52:55], v[24:27], v[120:127], v112
  v_add_f32 v108, v48, v49
  v_smfmac_f32_16x16x64_bf16 v[52:55], v[28:31], v[128:135], v112
  v_add_f32 v109, v50, v51
  v_smfmac_f32_16x16x64_bf16 v[52:55], v[32:35], v[136:143], v112
  v_cvt_pk_bf16_f32 v108, v108, v109
  s_waitcnt lgkmcnt(1)
  v_mfma_f32_16x16x32_bf16 v[64:67], v[88:91], v[76:79], 0
  v_mfma_f32_16x16x32_bf16 v[68:71], v[92:95], v[76:79], 0
  v_mfma_f32_16x16x32_bf16 v[72:75], v[96:99], v[76:79], 0
  ds_read2_b64 v[96:99], v7 offset0:128 offset1:160
  v_smfmac_f32_16x16x64_bf16 v[56:59], v[20:23], v[168:175], v112
  ds_write_b32 v5, v108 offset:1536
  ds_read_b64_tr_b16 v[80:81], v6 offset:1024
  v_smfmac_f32_16x16x64_bf16 v[56:59], v[24:27], v[176:183], v112
  v_add_f32 v108, v52, v53
  ds_read_b64_tr_b16 v[82:83], v6 offset:1536
  v_smfmac_f32_16x16x64_bf16 v[56:59], v[28:31], v[184:191], v112
  v_add_f32 v109, v54, v55
  v_smfmac_f32_16x16x64_bf16 v[56:59], v[32:35], v[192:199], v112
  v_cvt_pk_bf16_f32 v108, v108, v109
  v_smfmac_f32_16x16x64_bf16 v[60:63], v[20:23], v[224:231], v112
  ds_write_b32 v5, v108 offset:2048
  v_smfmac_f32_16x16x64_bf16 v[60:63], v[24:27], v[232:239], v112
  v_add_f32 v108, v56, v57
  v_smfmac_f32_16x16x64_bf16 v[60:63], v[28:31], v[240:247], v112
  v_add_f32 v109, v58, v59
  v_smfmac_f32_16x16x64_bf16 v[60:63], v[32:35], v[248:255], v112
  v_cvt_pk_bf16_f32 v108, v108, v109
  ds_write_b32 v5, v108 offset:2560
  s_waitcnt lgkmcnt(2)
  v_mfma_f32_16x16x32_bf16 v[64:67], v[8:11], v[80:83], v[64:67]
  ds_read_b64_tr_b16 v[76:77], v6 offset:2048
  ds_read_b64_tr_b16 v[78:79], v6 offset:2560
  v_mfma_f32_16x16x32_bf16 v[68:71], v[12:15], v[80:83], v[68:71]
  v_add_f32 v108, v60, v61
  v_add_f32 v109, v62, v63
  v_mfma_f32_16x16x32_bf16 v[72:75], v[116:119], v[80:83], v[72:75]
  v_cvt_pk_bf16_f32 v108, v108, v109
  ds_write_b32 v5, v108 offset:3072
  ds_read_b64_tr_b16 v[84:85], v6 offset:3072
  ds_read_b64 v[116:117], v7 offset:1536
  s_waitcnt lgkmcnt(3)
  v_mfma_f32_16x16x32_bf16 v[64:67], v[100:103], v[76:79], v[64:67]
  v_mfma_f32_16x16x32_bf16 v[68:71], v[104:107], v[76:79], v[68:71]
  v_mfma_f32_16x16x32_bf16 v[72:75], v[96:99], v[76:79], v[72:75]
  s_waitcnt lgkmcnt(0)
  v_mfma_f32_16x16x16_bf16 v[64:67], v[86:87], v[84:85], v[64:67]
  v_mfma_f32_16x16x16_bf16 v[68:71], v[110:111], v[84:85], v[68:71]
  v_mfma_f32_16x16x16_bf16 v[72:75], v[116:117], v[84:85], v[72:75]
  s_nop 3
  ds_write_b128 v115, v[64:67] offset:0
  v_cmp_u_f32 vcc, v64, v64
  ds_write_b128 v115, v[68:71] offset:64
  s_nop 0
  ds_write_b128 v115, v[72:75] offset:128
  s_cbranch_vccnz mk_c_ss0_redo2
mk_c_ss0_cont2:
  s_waitcnt lgkmcnt(0)
  s_barrier
  ds_read_b64 v[8:9], v113 offset:0
  ds_read_b64 v[10:11], v113 offset:3328
  ds_read_b64 v[12:13], v113 offset:6656
  ds_read_b64 v[14:15], v113 offset:9984
  s_mov_b32 s30, 0x42800000
  s_waitcnt lgkmcnt(2)
  v_pk_add_f32 v[8:9], v[8:9], v[10:11]
  s_waitcnt lgkmcnt(0)
  v_pk_add_f32 v[12:13], v[12:13], v[14:15]
  v_pk_add_f32 v[8:9], v[8:9], v[12:13]
  v_max_f32 v12, |v8|, |v9|
  v_exp_f32 v10, v8
  v_cmp_nge_f32 vcc, s30, v12
  v_exp_f32 v11, v9
  s_and_b64 vcc, vcc, s[42:43]
  s_cbranch_vccnz mk_c_ss0_smax
mk_c_ss0_smax_ret:
  v_add_f32 v12, v10, v11
  v_cndmask_b32 v12, 0, v12, s[42:43]
  s_nop 1
  v_add_f32_dpp v12, v12, v12 row_ror:8 row_mask:0xf bank_mask:0xf
  s_nop 1
  v_add_f32_dpp v12, v12, v12 row_ror:4 row_mask:0xf bank_mask:0xf
  s_nop 1
  v_add_f32_dpp v12, v12, v12 row_ror:2 row_mask:0xf bank_mask:0xf
  s_nop 1
  v_add_f32_dpp v12, v12, v12 row_ror:1 row_mask:0xf bank_mask:0xf
  v_mov_b32 v13, v12
  s_mov_b64 exec, 15
  global_store_dword v0, v112, s[46:47] sc1
  s_mov_b64 exec, -1
  v_permlane16_swap_b32 v12, v13
  v_add_f32 v12, v12, v13
  v_rcp_f32 v12, v12
  s_nop 0
  v_mul_f32 v8, v10, v12
  v_mul_f32 v9, v11, v12
  v_cvt_pk_bf16_f32 v8, v8, v9
  s_mov_b64 exec, s[42:43]
  global_store_dword v114, v8, s[46:47] sc1
  s_mov_b64 exec, -1
  global_load_dwordx4 v[88:91], v1, s[54:55] offset:0 sc1
  global_load_dwordx4 v[92:95], v3, s[54:55] offset:0 sc1
  s_mov_b32 m0, 39936
  s_nop 0
  global_load_lds_dwordx4 v1, s[54:55] offset:1024 sc1
  s_mov_b32 m0, 40960
  s_nop 0
  global_load_lds_dwordx4 v3, s[54:55] offset:1024 sc1
  global_load_dwordx4 v[100:103], v1, s[54:55] offset:2048 sc1
  global_load_dwordx4 v[104:107], v3, s[54:55] offset:2048 sc1
  global_load_dwordx2 v[86:87], v1, s[54:55] offset:3072 sc1
  global_load_dwordx2 v[110:111], v3, s[54:55] offset:3072 sc1
  s_add_u32 s54, s54, 32768
  s_addc_u32 s55, s55, 0
  v_mov_b32 v108, -1
  global_store_dword v114, v108, s[48:49] sc1
  s_mov_b64 exec, 15
  global_store_dword v0, v108, s[48:49] sc1
  s_mov_b64 exec, -1
  s_mov_b64 s[48:49], s[46:47]
  s_mov_b64 s[46:47], s[50:51]
  s_add_u32 s44, s46, 10240
  s_addc_u32 s45, s47, 0
  s_add_u32 s36, s36, 1
  s_add_u32 s30, s38, 15728640
  s_add_u32 s50, s4, s30
  s_addc_u32 s51, s5, 0
  s_add_u32 s38, s38, 147456
  s_cmp_eq_u32 s38, 589824
  s_cselect_b32 s38, 0, s38
  s_add_u32 s8, s8, 458752
  s_addc_u32 s9, s9, 0
  v_mov_b32 v36, 0
  v_mov_b32 v37, 0
  v_mov_b32 v38, 0
  v_mov_b32 v39, 0
  v_mov_b32 v40, 0
  v_mov_b32 v41, 0
  v_mov_b32 v42, 0
  v_mov_b32 v43, 0
  v_mov_b32 v44, 0
  v_mov_b32 v45, 0
  v_mov_b32 v46, 0
  v_mov_b32 v47, 0
  v_mov_b32 v48, 0
  v_mov_b32 v49, 0
  v_mov_b32 v50, 0
  v_mov_b32 v51, 0
  v_mov_b32 v52, 0
  v_mov_b32 v53, 0
  v_mov_b32 v54, 0
  v_mov_b32 v55, 0
  v_mov_b32 v56, 0
  v_mov_b32 v57, 0
  v_mov_b32 v58, 0
  v_mov_b32 v59, 0
  v_mov_b32 v60, 0
  v_mov_b32 v61, 0
  v_mov_b32 v62, 0
  v_mov_b32 v63, 0
  s_cmp_lt_u32 s36, 63
  s_cbranch_scc1 mk_c_ss0_loop
  s_branch mk_c_done
mk_c_ss0_entry:
  s_branch mk_c_ss0_mem
mk_c_ss0_smax:
  v_mov_b32 v24, 0xff800000
  v_max_f32 v12, v8, v9
  v_cndmask_b32 v12, v24, v12, s[42:43]
  s_nop 1
  v_max_f32_dpp v12, v12, v12 row_ror:8 row_mask:0xf bank_mask:0xf
  s_nop 1
  v_max_f32_dpp v12, v12, v12 row_ror:4 row_mask:0xf bank_mask:0xf
  s_nop 1
  v_max_f32_dpp v12, v12, v12 row_ror:2 row_mask:0xf bank_mask:0xf
  s_nop 1
  v_max_f32_dpp v12, v12, v12 row_ror:1 row_mask:0xf bank_mask:0xf
  v_mov_b32 v13, v12
  s_nop 1
  v_permlane16_swap_b32 v12, v13
  v_max_f32 v12, v12, v13
  v_sub_f32 v10, v8, v12
  v_sub_f32 v11, v9, v12
  v_exp_f32 v10, v10
  v_exp_f32 v11, v11
  s_branch mk_c_ss0_smax_ret
mk_c_ss0_redo2:
  s_nop 7
  s_sub_u32 s40, s40, 2000
  s_cbranch_scc0 mk_c_ss0_redo3
  s_mov_b32 s40, 0
  s_branch mk_c_ss0_cont2
mk_c_ss0_redo:
  s_nop 7
  s_sub_u32 s40, s40, 1
  s_cbranch_scc1 mk_c_ss0_giveup
mk_c_ss0_redo3:
  v_mov_b32 v36, 0
  v_mov_b32 v37, 0
  v_mov_b32 v38, 0
  v_mov_b32 v39, 0
  v_mov_b32 v40, 0
  v_mov_b32 v41, 0
  v_mov_b32 v42, 0
  v_mov_b32 v43, 0
  v_mov_b32 v44, 0
  v_mov_b32 v45, 0
  v_mov_b32 v46, 0
  v_mov_b32 v47, 0
  v_mov_b32 v48, 0
  v_mov_b32 v49, 0
  v_mov_b32 v50, 0
  v_mov_b32 v51, 0
  v_mov_b32 v52, 0
  v_mov_b32 v53, 0
  v_mov_b32 v54, 0
  v_mov_b32 v55, 0
  v_mov_b32 v56, 0
  v_mov_b32 v57, 0
  v_mov_b32 v58, 0
  v_mov_b32 v59, 0
  v_mov_b32 v60, 0
  v_mov_b32 v61, 0
  v_mov_b32 v62, 0
  v_mov_b32 v63, 0
  s_waitcnt lgkmcnt(0)
  s_branch mk_c_ss0_mem
mk_c_ss0_giveup:
  s_mov_b32 s40, 0
  s_branch mk_c_ss0_cont
mk_c_ss1_loop:
  global_load_dword v96, v2, s[46:47] sc1
  s_nop 11
  global_load_dword v97, v2, s[46:47] sc1
  s_nop 11
  global_load_dword v98, v2, s[46:47] sc1
  s_nop 11
  global_load_dword v99, v2, s[46:47] sc1
  s_nop 11
mk_c_ss1_fp_36:
  global_load_dword v117, v2, s[46:47] sc1
  s_waitcnt vmcnt(4)
  v_cmp_eq_u32 vcc, -1, v96
  s_cbranch_vccz mk_c_ss1_fd_37
  global_load_dword v96, v2, s[46:47] sc1
  s_waitcnt vmcnt(4)
  v_cmp_eq_u32 vcc, -1, v97
  s_cbranch_vccz mk_c_ss1_fd_37
  global_load_dword v97, v2, s[46:47] sc1
  s_waitcnt vmcnt(4)
  v_cmp_eq_u32 vcc, -1, v98
  s_cbranch_vccz mk_c_ss1_fd_37
  global_load_dword v98, v2, s[46:47] sc1
  s_waitcnt vmcnt(4)
  v_cmp_eq_u32 vcc, -1, v99
  s_cbranch_vccz mk_c_ss1_fd_37
  global_load_dword v99, v2, s[46:47] sc1
  s_waitcnt vmcnt(4)
  v_cmp_eq_u32 vcc, -1, v117
  s_cbranch_vccz mk_c_ss1_fd_37
  s_sub_u32 s40, s40, 1
  s_cbranch_scc0 mk_c_ss1_fp_36
  s_mov_b32 s40, 0
mk_c_ss1_fd_37:
  s_barrier
mk_c_ss1_mem:
  global_load_dwordx4 v[16:19], v1, s[44:45] offset:2048 sc1
  s_nop 11
  global_load_dwordx4 v[20:23], v1, s[44:45] offset:3072 sc1
  s_nop 11
  global_load_dwordx4 v[24:27], v3, s[44:45] offset:0 sc1
  s_nop 11
  global_load_dwordx4 v[28:31], v3, s[44:45] offset:1024 sc1
  s_waitcnt vmcnt(3)
  v_smfmac_f32_16x16x64_bf16 v[36:39], v[16:19], a[16:23], v112
  ds_write_b128 v1, v[16:19] offset:4096
  v_smfmac_f32_16x16x64_bf16 v[40:43], v[16:19], a[72:79], v112
  global_load_dwordx4 v[32:35], v3, s[44:45] offset:2048 sc1
  v_smfmac_f32_16x16x64_bf16 v[44:47], v[16:19], a[128:135], v112
  v_max3_u32 v119, v16, v17, v18
  v_smfmac_f32_16x16x64_bf16 v[48:51], v[16:19], a[184:191], v112
  global_load_dwordx4 v[8:11], v1, s[44:45] offset:0 sc1
  v_smfmac_f32_16x16x64_bf16 v[52:55], v[16:19], a[240:247], v112
  v_max_u32 v119, v119, v19
  v_smfmac_f32_16x16x64_bf16 v[56:59], v[16:19], v[160:167], v112
  global_load_dwordx4 v[12:15], v1, s[44:45] offset:1024 sc1
  v_smfmac_f32_16x16x64_bf16 v[60:63], v[16:19], v[216:223], v112
  s_waitcnt vmcnt(5)
  v_smfmac_f32_16x16x64_bf16 v[36:39], v[20:23], a[24:31], v112
  ds_write_b128 v1, v[20:23] offset:5120
  v_smfmac_f32_16x16x64_bf16 v[40:43], v[20:23], a[80:87], v112
  v_smfmac_f32_16x16x64_bf16 v[44:47], v[20:23], a[136:143], v112
  v_max3_u32 v119, v119, v20, v21
  v_smfmac_f32_16x16x64_bf16 v[48:51], v[20:23], a[192:199], v112
  v_smfmac_f32_16x16x64_bf16 v[52:55], v[20:23], a[248:255], v112
  v_max3_u32 v119, v119, v22, v23
  v_smfmac_f32_16x16x64_bf16 v[56:59], v[20:23], v[168:175], v112
  v_smfmac_f32_16x16x64_bf16 v[60:63], v[20:23], v[224:231], v112
  s_waitcnt vmcnt(4)
  v_smfmac_f32_16x16x64_bf16 v[36:39], v[24:27], a[32:39], v112
  ds_read_b128 v[16:19], v1 offset:43008
  v_smfmac_f32_16x16x64_bf16 v[40:43], v[24:27], a[88:95], v112
  ds_read_b128 v[20:23], v1 offset:44032
  v_smfmac_f32_16x16x64_bf16 v[44:47], v[24:27], a[144:151], v112
  v_max3_u32 v119, v119, v24, v25
  v_smfmac_f32_16x16x64_bf16 v[48:51], v[24:27], a[200:207], v112
  v_max3_u32 v119, v119, v26, v27
  v_smfmac_f32_16x16x64_bf16 v[52:55], v[24:27], v[120:127], v112
  v_cmp_eq_u32 vcc, -1, v119
  v_smfmac_f32_16x16x64_bf16 v[56:59], v[24:27], v[176:183], v112
  v_smfmac_f32_16x16x64_bf16 v[60:63], v[24:27], v[232:239], v112
  s_cbranch_vccnz mk_c_ss1_redo
mk_c_ss1_cont:
  s_waitcnt vmcnt(3)
  v_smfmac_f32_16x16x64_bf16 v[36:39], v[28:31], a[40:47], v112
  s_waitcnt vmcnt(2)
  v_smfmac_f32_16x16x64_bf16 v[36:39], v[32:35], a[48:55], v112
  s_waitcnt vmcnt(1)
  v_smfmac_f32_16x16x64_bf16 v[36:39], v[8:11], a[0:7], v112
  s_waitcnt vmcnt(0)
  v_smfmac_f32_16x16x64_bf16 v[36:39], v[12:15], a[8:15], v112
  ds_write_b128 v1, v[12:15] offset:3072
  v_smfmac_f32_16x16x64_bf16 v[40:43], v[28:31], a[96:103], v112
  ds_read2_b64 v[96:99], v7 offset0:0 offset1:32
  ds_read2_b64 v[116:119], v7 offset0:64 offset1:96
  v_smfmac_f32_16x16x64_bf16 v[40:43], v[32:35], a[104:111], v112
  v_add_f32 v108, v36, v37
  v_smfmac_f32_16x16x64_bf16 v[40:43], v[8:11], a[56:63], v112
  v_add_f32 v109, v38, v39
  v_smfmac_f32_16x16x64_bf16 v[40:43], v[12:15], a[64:71], v112
  v_cvt_pk_bf16_f32 v108, v108, v109
  v_smfmac_f32_16x16x64_bf16 v[44:47], v[28:31], a[152:159], v112
  ds_write_b32 v5, v108 offset:0
  v_smfmac_f32_16x16x64_bf16 v[44:47], v[32:35], a[160:167], v112
  v_add_f32 v108, v40, v41
  v_smfmac_f32_16x16x64_bf16 v[44:47], v[8:11], a[112:119], v112
  v_add_f32 v109, v42, v43
  v_smfmac_f32_16x16x64_bf16 v[44:47], v[12:15], a[120:127], v112
  v_cvt_pk_bf16_f32 v108, v108, v109
  v_smfmac_f32_16x16x64_bf16 v[48:51], v[28:31], a[208:215], v112
  ds_write_b32 v5, v108 offset:512
  ds_read_b64_tr_b16 v[76:77], v6 offset:0
  v_smfmac_f32_16x16x64_bf16 v[48:51], v[32:35], a[216:223], v112
  v_add_f32 v108, v44, v45
  ds_read_b64_tr_b16 v[78:79], v6 offset:512
  v_smfmac_f32_16x16x64_bf16 v[48:51], v[8:11], a[168:175], v112
  v_add_f32 v109, v46, v47
  v_smfmac_f32_16x16x64_bf16 v[48:51], v[12:15], a[176:183], v112
  v_cvt_pk_bf16_f32 v108, v108, v109
  v_smfmac_f32_16x16x64_bf16 v[52:55], v[28:31], v[128:135], v112
  ds_write_b32 v5, v108 offset:1024
  v_smfmac_f32_16x16x64_bf16 v[52:55], v[32:35], v[136:143], v112
  v_add_f32 v108, v48, v49
  v_smfmac_f32_16x16x64_bf16 v[52:55], v[8:11], a[224:231], v112
  v_add_f32 v109, v50, v51
  v_smfmac_f32_16x16x64_bf16 v[52:55], v[12:15], a[232:239], v112
  v_cvt_pk_bf16_f32 v108, v108, v109
  s_waitcnt lgkmcnt(1)
  v_mfma_f32_16x16x32_bf16 v[64:67], v[88:91], v[76:79], 0
  v_mfma_f32_16x16x32_bf16 v[68:71], v[92:95], v[76:79], 0
  v_mfma_f32_16x16x32_bf16 v[72:75], v[96:99], v[76:79], 0
  ds_read2_b64 v[96:99], v7 offset0:128 offset1:160
  v_smfmac_f32_16x16x64_bf16 v[56:59], v[28:31], v[184:191], v112
  ds_write_b32 v5, v108 offset:1536
  ds_read_b64_tr_b16 v[80:81], v6 offset:1024
  v_smfmac_f32_16x16x64_bf16 v[56:59], v[32:35], v[192:199], v112
  v_add_f32 v108, v52, v53
  ds_read_b64_tr_b16 v[82:83], v6 offset:1536
  v_smfmac_f32_16x16x64_bf16 v[56:59], v[8:11], v[144:151], v112
  v_add_f32 v109, v54, v55
  v_smfmac_f32_16x16x64_bf16 v[56:59], v[12:15], v[152:159], v112
  v_cvt_pk_bf16_f32 v108, v108, v109
  v_smfmac_f32_16x16x64_bf16 v[60:63], v[28:31], v[240:247], v112
  ds_write_b32 v5, v108 offset:2048
  v_smfmac_f32_16x16x64_bf16 v[60:63], v[32:35], v[248:255], v112
  v_add_f32 v108, v56, v57
  v_smfmac_f32_16x16x64_bf16 v[60:63], v[8:11], v[200:207], v112
  v_add_f32 v109, v58, v59
  v_smfmac_f32_16x16x64_bf16 v[60:63], v[12:15], v[208:215], v112
  v_cvt_pk_bf16_f32 v108, v108, v109
  ds_write_b32 v5, v108 offset:2560
  s_waitcnt lgkmcnt(2)
  v_mfma_f32_16x16x32_bf16 v[64:67], v[16:19], v[80:83], v[64:67]
  ds_read_b64_tr_b16 v[76:77], v6 offset:2048
  ds_read_b64_tr_b16 v[78:79], v6 offset:2560
  v_mfma_f32_16x16x32_bf16 v[68:71], v[20:23], v[80:83], v[68:71]
  v_add_f32 v108, v60, v61
  v_add_f32 v109, v62, v63
  v_mfma_f32_16x16x32_bf16 v[72:75], v[116:119], v[80:83], v[72:75]
  v_cvt_pk_bf16_f32 v108, v108, v109
  ds_write_b32 v5, v108 offset:3072
  ds_read_b64_tr_b16 v[84:85], v6 offset:3072
  ds_read_b64 v[116:117], v7 offset:1536
  s_waitcnt lgkmcnt(3)
  v_mfma_f32_16x16x32_bf16 v[64:67], v[100:103], v[76:79], v[64:67]
  v_mfma_f32_16x16x32_bf16 v[68:71], v[104:107], v[76:79], v[68:71]
  v_mfma_f32_16x16x32_bf16 v[72:75], v[96:99], v[76:79], v[72:75]
  s_waitcnt lgkmcnt(0)
  v_mfma_f32_16x16x16_bf16 v[64:67], v[86:87], v[84:85], v[64:67]
  v_mfma_f32_16x16x16_bf16 v[68:71], v[110:111], v[84:85], v[68:71]
  v_mfma_f32_16x16x16_bf16 v[72:75], v[116:117], v[84:85], v[72:75]
  s_nop 3
  ds_write_b128 v115, v[64:67] offset:0
  v_cmp_u_f32 vcc, v64, v64
  ds_write_b128 v115, v[68:71] offset:64
  s_nop 0
  ds_write_b128 v115, v[72:75] offset:128
  s_cbranch_vccnz mk_c_ss1_redo2
mk_c_ss1_cont2:
  s_waitcnt lgkmcnt(0)
  s_barrier
  ds_read_b64 v[8:9], v113 offset:0
  ds_read_b64 v[10:11], v113 offset:3328
  ds_read_b64 v[12:13], v113 offset:6656
  ds_read_b64 v[14:15], v113 offset:9984
  s_mov_b32 s30, 0x42800000
  s_waitcnt lgkmcnt(2)
  v_pk_add_f32 v[8:9], v[8:9], v[10:11]
  s_waitcnt lgkmcnt(0)
  v_pk_add_f32 v[12:13], v[12:13], v[14:15]
  v_pk_add_f32 v[8:9], v[8:9], v[12:13]
  v_max_f32 v12, |v8|, |v9|
  v_exp_f32 v10, v8
  v_cmp_nge_f32 vcc, s30, v12
  v_exp_f32 v11, v9
  s_and_b64 vcc, vcc, s[42:43]
  s_cbranch_vccnz mk_c_ss1_smax
mk_c_ss1_smax_ret:
  v_add_f32 v12, v10, v11
  v_cndmask_b32 v12, 0, v12, s[42:43]
  s_nop 1
  v_add_f32_dpp v12, v12, v12 row_ror:8 row_mask:0xf bank_mask:0xf
  s_nop 1
  v_add_f32_dpp v12, v12, v12 row_ror:4 row_mask:0xf bank_mask:0xf
  s_nop 1
  v_add_f32_dpp v12, v12, v12 row_ror:2 row_mask:0xf bank_mask:0xf
  s_nop 1
  v_add_f32_dpp v12, v12, v12 row_ror:1 row_mask:0xf bank_mask:0xf
  v_mov_b32 v13, v12
  s_nop 1
  v_permlane16_swap_b32 v12, v13
  v_add_f32 v12, v12, v13
  v_rcp_f32 v12, v12
  s_nop 0
  v_mul_f32 v8, v10, v12
  v_mul_f32 v9, v11, v12
  v_cvt_pk_bf16_f32 v8, v8, v9
  s_mov_b64 exec, s[42:43]
  global_store_dword v114, v8, s[46:47] sc1
  s_mov_b64 exec, -1
  global_load_dwordx4 v[88:91], v1, s[54:55] offset:0 sc1
  global_load_dwordx4 v[92:95], v3, s[54:55] offset:0 sc1
  s_mov_b32 m0, 41984
  s_nop 0
  global_load_lds_dwordx4 v1, s[54:55] offset:1024 sc1
  s_mov_b32 m0, 43008
  s_nop 0
  global_load_lds_dwordx4 v3, s[54:55] offset:1024 sc1
  global_load_dwordx4 v[100:103], v1, s[54:55] offset:2048 sc1
  global_load_dwordx4 v[104:107], v3, s[54:55] offset:2048 sc1
  global_load_dwordx2 v[86:87], v1, s[54:55] offset:3072 sc1
  global_load_dwordx2 v[110:111], v3, s[54:55] offset:3072 sc1
  s_add_u32 s54, s54, 32768
  s_addc_u32 s55, s55, 0
  v_mov_b32 v108, -1
  global_store_dword v114, v108, s[48:49] sc1
  s_mov_b64 s[48:49], s[46:47]
  s_mov_b64 s[46:47], s[50:51]
  s_add_u32 s44, s46, 10240
  s_addc_u32 s45, s47, 0
  s_add_u32 s36, s36, 1
  s_add_u32 s30, s38, 15728640
  s_add_u32 s50, s4, s30
  s_addc_u32 s51, s5, 0
  s_add_u32 s38, s38, 147456
  s_cmp_eq_u32 s38, 589824
  s_cselect_b32 s38, 0, s38
  s_add_u32 s8, s8, 458752
  s_addc_u32 s9, s9, 0
  v_mov_b32 v36, 0
  v_mov_b32 v37, 0
  v_mov_b32 v38, 0
  v_mov_b32 v39, 0
  v_mov_b32 v40, 0
  v_mov_b32 v41, 0
  v_mov_b32 v42, 0
  v_mov_b32 v43, 0
  v_mov_b32 v44, 0
  v_mov_b32 v45, 0
  v_mov_b32 v46, 0
  v_mov_b32 v47, 0
  v_mov_b32 v48, 0
  v_mov_b32 v49, 0
  v_mov_b32 v50, 0
  v_mov_b32 v51, 0
  v_mov_b32 v52, 0
  v_mov_b32 v53, 0
  v_mov_b32 v54, 0
  v_mov_b32 v55, 0
  v_mov_b32 v56, 0
  v_mov_b32 v57, 0
  v_mov_b32 v58, 0
  v_mov_b32 v59, 0
  v_mov_b32 v60, 0
  v_mov_b32 v61, 0
  v_mov_b32 v62, 0
  v_mov_b32 v63, 0
  s_cmp_lt_u32 s36, 63
  s_cbranch_scc1 mk_c_ss1_loop
  s_branch mk_c_done
mk_c_ss1_entry:
  s_branch mk_c_ss1_mem
mk_c_ss1_smax:
  v_mov_b32 v24, 0xff800000
  v_max_f32 v12, v8, v9
  v_cndmask_b32 v12, v24, v12, s[42:43]
  s_nop 1
  v_max_f32_dpp v12, v12, v12 row_ror:8 row_mask:0xf bank_mask:0xf
  s_nop 1
  v_max_f32_dpp v12, v12, v12 row_ror:4 row_mask:0xf bank_mask:0xf
  s_nop 1
  v_max_f32_dpp v12, v12, v12 row_ror:2 row_mask:0xf bank_mask:0xf
  s_nop 1
  v_max_f32_dpp v12, v12, v12 row_ror:1 row_mask:0xf bank_mask:0xf
  v_mov_b32 v13, v12
  s_nop 1
  v_permlane16_swap_b32 v12, v13
  v_max_f32 v12, v12, v13
  v_sub_f32 v10, v8, v12
  v_sub_f32 v11, v9, v12
  v_exp_f32 v10, v10
  v_exp_f32 v11, v11
  s_branch mk_c_ss1_smax_ret
mk_c_ss1_redo2:
  s_nop 7
  s_sub_u32 s40, s40, 2000
  s_cbranch_scc0 mk_c_ss1_redo3
  s_mov_b32 s40, 0
  s_branch mk_c_ss1_cont2
mk_c_ss1_redo:
  s_nop 7
  s_sub_u32 s40, s40, 1
  s_cbranch_scc1 mk_c_ss1_giveup
mk_c_ss1_redo3:
  v_mov_b32 v36, 0
  v_mov_b32 v37, 0
  v_mov_b32 v38, 0
  v_mov_b32 v39, 0
  v_mov_b32 v40, 0
  v_mov_b32 v41, 0
  v_mov_b32 v42, 0
  v_mov_b32 v43, 0
  v_mov_b32 v44, 0
  v_mov_b32 v45, 0
  v_mov_b32 v46, 0
  v_mov_b32 v47, 0
  v_mov_b32 v48, 0
  v_mov_b32 v49, 0
  v_mov_b32 v50, 0
  v_mov_b32 v51, 0
  v_mov_b32 v52, 0
  v_mov_b32 v53, 0
  v_mov_b32 v54, 0
  v_mov_b32 v55, 0
  v_mov_b32 v56, 0
  v_mov_b32 v57, 0
  v_mov_b32 v58, 0
  v_mov_b32 v59, 0
  v_mov_b32 v60, 0
  v_mov_b32 v61, 0
  v_mov_b32 v62, 0
  v_mov_b32 v63, 0
  s_waitcnt lgkmcnt(0)
  s_branch mk_c_ss1_mem
mk_c_ss1_giveup:
  s_mov_b32 s40, 0
  s_branch mk_c_ss1_cont
mk_c_ss2_loop:
  s_barrier
mk_c_ss2_mem:
  global_load_dwordx4 v[24:27], v3, s[44:45] offset:0 sc1
  s_nop 11
  global_load_dwordx4 v[28:31], v3, s[44:45] offset:1024 sc1
  s_nop 11
  global_load_dwordx4 v[32:35], v3, s[44:45] offset:2048 sc1
  s_nop 11
  global_load_dwordx4 v[8:11], v1, s[44:45] offset:0 sc1
  s_waitcnt vmcnt(3)
  v_smfmac_f32_16x16x64_bf16 v[36:39], v[24:27], a[32:39], v112
  ds_write_b128 v1, v[24:27] offset:7168
  v_smfmac_f32_16x16x64_bf16 v[40:43], v[24:27], a[88:95], v112
  global_load_dwordx4 v[12:15], v1, s[44:45] offset:1024 sc1
  v_smfmac_f32_16x16x64_bf16 v[44:47], v[24:27], a[144:151], v112
  v_max3_u32 v119, v24, v25, v26
  v_smfmac_f32_16x16x64_bf16 v[48:51], v[24:27], a[200:207], v112
  global_load_dwordx4 v[16:19], v1, s[44:45] offset:2048 sc1
  v_smfmac_f32_16x16x64_bf16 v[52:55], v[24:27], v[120:127], v112
  v_max_u32 v119, v119, v27
  v_smfmac_f32_16x16x64_bf16 v[56:59], v[24:27], v[176:183], v112
  global_load_dwordx4 v[20:23], v1, s[44:45] offset:3072 sc1
  v_smfmac_f32_16x16x64_bf16 v[60:63], v[24:27], v[232:239], v112
  s_waitcnt vmcnt(5)
  v_smfmac_f32_16x16x64_bf16 v[36:39], v[28:31], a[40:47], v112
  ds_write_b128 v1, v[28:31] offset:8192
  v_smfmac_f32_16x16x64_bf16 v[40:43], v[28:31], a[96:103], v112
  v_smfmac_f32_16x16x64_bf16 v[44:47], v[28:31], a[152:159], v112
  v_max3_u32 v119, v119, v28, v29
  v_smfmac_f32_16x16x64_bf16 v[48:51], v[28:31], a[208:215], v112
  v_smfmac_f32_16x16x64_bf16 v[52:55], v[28:31], v[128:135], v112
  v_max3_u32 v119, v119, v30, v31
  v_smfmac_f32_16x16x64_bf16 v[56:59], v[28:31], v[184:191], v112
  v_smfmac_f32_16x16x64_bf16 v[60:63], v[28:31], v[240:247], v112
  s_waitcnt vmcnt(4)
  v_smfmac_f32_16x16x64_bf16 v[36:39], v[32:35], a[48:55], v112
  ds_read_b128 v[24:27], v1 offset:45056
  v_smfmac_f32_16x16x64_bf16 v[40:43], v[32:35], a[104:111], v112
  ds_read_b128 v[28:31], v1 offset:46080
  v_smfmac_f32_16x16x64_bf16 v[44:47], v[32:35], a[160:167], v112
  v_max3_u32 v119, v119, v32, v33
  v_smfmac_f32_16x16x64_bf16 v[48:51], v[32:35], a[216:223], v112
  v_max3_u32 v119, v119, v34, v35
  v_smfmac_f32_16x16x64_bf16 v[52:55], v[32:35], v[136:143], v112
  v_cmp_eq_u32 vcc, -1, v119
  v_smfmac_f32_16x16x64_bf16 v[56:59], v[32:35], v[192:199], v112
  v_smfmac_f32_16x16x64_bf16 v[60:63], v[32:35], v[248:255], v112
  s_cbranch_vccnz mk_c_ss2_redo
mk_c_ss2_cont:
  s_waitcnt vmcnt(3)
  v_smfmac_f32_16x16x64_bf16 v[36:39], v[8:11], a[0:7], v112
  s_waitcnt vmcnt(2)
  v_smfmac_f32_16x16x64_bf16 v[36:39], v[12:15], a[8:15], v112
  s_waitcnt vmcnt(1)
  v_smfmac_f32_16x16x64_bf16 v[36:39], v[16:19], a[16:23], v112
  s_waitcnt vmcnt(0)
  v_smfmac_f32_16x16x64_bf16 v[36:39], v[20:23], a[24:31], v112
  ds_write_b128 v1, v[20:23] offset:6144
  v_smfmac_f32_16x16x64_bf16 v[40:43], v[8:11], a[56:63], v112
  ds_read2_b64 v[96:99], v7 offset0:0 offset1:32
  ds_read2_b64 v[116:119], v7 offset0:64 offset1:96
  v_smfmac_f32_16x16x64_bf16 v[40:43], v[12:15], a[64:71], v112
  v_add_f32 v108, v36, v37
  v_smfmac_f32_16x16x64_bf16 v[40:43], v[16:19], a[72:79], v112
  v_add_f32 v109, v38, v39
  v_smfmac_f32_16x16x64_bf16 v[40:43], v[20:23], a[80:87], v112
  v_cvt_pk_bf16_f32 v108, v108, v109
  v_smfmac_f32_16x16x64_bf16 v[44:47], v[8:11], a[112:119], v112
  ds_write_b32 v5, v108 offset:0
  v_smfmac_f32_16x16x64_bf16 v[44:47], v[12:15], a[120:127], v112
  v_add_f32 v108, v40, v41
  v_smfmac_f32_16x16x64_bf16 v[44:47], v[16:19], a[128:135], v112
  v_add_f32 v109, v42, v43
  v_smfmac_f32_16x16x64_bf16 v[44:47], v[20:23], a[136:143], v112
  v_cvt_pk_bf16_f32 v108, v108, v109
  v_smfmac_f32_16x16x64_bf16 v[48:51], v[8:11], a[168:175], v112
  ds_write_b32 v5, v108 offset:512
  ds_read_b64_tr_b16 v[76:77], v6 offset:0
  v_smfmac_f32_16x16x64_bf16 v[48:51], v[12:15], a[176:183], v112
  v_add_f32 v108, v44, v45
  ds_read_b64_tr_b16 v[78:79], v6 offset:512
  v_smfmac_f32_16x16x64_bf16 v[48:51], v[16:19], a[184:191], v112
  v_add_f32 v109, v46, v47
  v_smfmac_f32_16x16x64_bf16 v[48:51], v[20:23], a[192:199], v112
  v_cvt_pk_bf16_f32 v108, v108, v109
  v_smfmac_f32_16x16x64_bf16 v[52:55], v[8:11], a[224:231], v112
  ds_write_b32 v5, v108 offset:1024
  v_smfmac_f32_16x16x64_bf16 v[52:55], v[12:15], a[232:239], v112
  v_add_f32 v108, v48, v49
  v_smfmac_f32_16x16x64_bf16 v[52:55], v[16:19], a[240:247], v112
  v_add_f32 v109, v50, v51
  v_smfmac_f32_16x16x64_bf16 v[52:55], v[20:23], a[248:255], v112
  v_cvt_pk_bf16_f32 v108, v108, v109
  s_waitcnt lgkmcnt(1)
  v_mfma_f32_16x16x32_bf16 v[64:67], v[88:91], v[76:79], 0
  v_mfma_f32_16x16x32_bf16 v[68:71], v[92:95], v[76:79], 0
  v_mfma_f32_16x16x32_bf16 v[72:75], v[96:99], v[76:79], 0
  ds_read2_b64 v[96:99], v7 offset0:128 offset1:160
  v_smfmac_f32_16x16x64_bf16 v[56:59], v[8:11], v[144:151], v112
  ds_write_b32 v5, v108 offset:1536
  ds_read_b64_tr_b16 v[80:81], v6 offset:1024
  v_smfmac_f32_16x16x64_bf16 v[56:59], v[12:15], v[152:159], v112
  v_add_f32 v108, v52, v53
  ds_read_b64_tr_b16 v[82:83], v6 offset:1536
  v_smfmac_f32_16x16x64_bf16 v[56:59], v[16:19], v[160:167], v112
  v_add_f32 v109, v54, v55
  v_smfmac_f32_16x16x64_bf16 v[56:59], v[20:23], v[168:175], v112
  v_cvt_pk_bf16_f32 v108, v108, v109
  v_smfmac_f32_16x16x64_bf16 v[60:63], v[8:11], v[200:207], v112
  ds_write_b32 v5, v108 offset:2048
  v_smfmac_f32_16x16x64_bf16 v[60:63], v[12:15], v[208:215], v112
  v_add_f32 v108, v56, v57
  v_smfmac_f32_16x16x64_bf16 v[60:63], v[16:19], v[216:223], v112
  v_add_f32 v109, v58, v59
  v_smfmac_f32_16x16x64_bf16 v[60:63], v[20:23], v[224:231], v112
  v_cvt_pk_bf16_f32 v108, v108, v109
  ds_write_b32 v5, v108 offset:2560
  s_waitcnt lgkmcnt(2)
  v_mfma_f32_16x16x32_bf16 v[64:67], v[24:27], v[80:83], v[64:67]
  ds_read_b64_tr_b16 v[76:77], v6 offset:2048
  ds_read_b64_tr_b16 v[78:79], v6 offset:2560
  v_mfma_f32_16x16x32_bf16 v[68:71], v[28:31], v[80:83], v[68:71]
  v_add_f32 v108, v60, v61
  v_add_f32 v109, v62, v63
  v_mfma_f32_16x16x32_bf16 v[72:75], v[116:119], v[80:83], v[72:75]
  v_cvt_pk_bf16_f32 v108, v108, v109
  ds_write_b32 v5, v108 offset:3072
  ds_read_b64_tr_b16 v[84:85], v6 offset:3072
  ds_read_b64 v[116:117], v7 offset:1536
  s_waitcnt lgkmcnt(3)
  v_mfma_f32_16x16x32_bf16 v[64:67], v[100:103], v[76:79], v[64:67]
  v_mfma_f32_16x16x32_bf16 v[68:71], v[104:107], v[76:79], v[68:71]
  v_mfma_f32_16x16x32_bf16 v[72:75], v[96:99], v[76:79], v[72:75]
  s_waitcnt lgkmcnt(0)
  v_mfma_f32_16x16x16_bf16 v[64:67], v[86:87], v[84:85], v[64:67]
  v_mfma_f32_16x16x16_bf16 v[68:71], v[110:111], v[84:85], v[68:71]
  v_mfma_f32_16x16x16_bf16 v[72:75], v[116:117], v[84:85], v[72:75]
  s_nop 3
  ds_write_b128 v115, v[64:67] offset:0
  v_cmp_u_f32 vcc, v64, v64
  ds_write_b128 v115, v[68:71] offset:64
  s_nop 0
  ds_write_b128 v115, v[72:75] offset:128
  s_cbranch_vccnz mk_c_ss2_redo2
mk_c_ss2_cont2:
  s_waitcnt lgkmcnt(0)
  s_barrier
  ds_read_b64 v[8:9], v113 offset:0
  ds_read_b64 v[10:11], v113 offset:3328
  ds_read_b64 v[12:13], v113 offset:6656
  ds_read_b64 v[14:15], v113 offset:9984
  s_mov_b32 s30, 0x42800000
  s_waitcnt lgkmcnt(2)
  v_pk_add_f32 v[8:9], v[8:9], v[10:11]
  s_waitcnt lgkmcnt(0)
  v_pk_add_f32 v[12:13], v[12:13], v[14:15]
  v_pk_add_f32 v[8:9], v[8:9], v[12:13]
  v_max_f32 v12, |v8|, |v9|
  v_exp_f32 v10, v8
  v_cmp_nge_f32 vcc, s30, v12
  v_exp_f32 v11, v9
  s_and_b64 vcc, vcc, s[42:43]
  s_cbranch_vccnz mk_c_ss2_smax
mk_c_ss2_smax_ret:
  v_add_f32 v12, v10, v11
  v_cndmask_b32 v12, 0, v12, s[42:43]
  s_nop 1
  v_add_f32_dpp v12, v12, v12 row_ror:8 row_mask:0xf bank_mask:0xf
  s_nop 1
  v_add_f32_dpp v12, v12, v12 row_ror:4 row_mask:0xf bank_mask:0xf
  s_nop 1
  v_add_f32_dpp v12, v12, v12 row_ror:2 row_mask:0xf bank_mask:0xf
  s_nop 1
  v_add_f32_dpp v12, v12, v12 row_ror:1 row_mask:0xf bank_mask:0xf
  v_mov_b32 v13, v12
  s_nop 1
  v_permlane16_swap_b32 v12, v13
  v_add_f32 v12, v12, v13
  v_rcp_f32 v12, v12
  s_nop 0
  v_mul_f32 v8, v10, v12
  v_mul_f32 v9, v11, v12
  v_cvt_pk_bf16_f32 v8, v8, v9
  s_mov_b64 exec, s[42:43]
  global_store_dword v114, v8, s[46:47] sc1
  s_mov_b64 exec, -1
  global_load_dwordx4 v[88:91], v1, s[54:55] offset:0 sc1
  global_load_dwordx4 v[92:95], v3, s[54:55] offset:0 sc1
  s_mov_b32 m0, 44032
  s_nop 0
  global_load_lds_dwordx4 v1, s[54:55] offset:1024 sc1
  s_mov_b32 m0, 45056
  s_nop 0
  global_load_lds_dwordx4 v3, s[54:55] offset:1024 sc1
  global_load_dwordx4 v[100:103], v1, s[54:55] offset:2048 sc1
  global_load_dwordx4 v[104:107], v3, s[54:55] offset:2048 sc1
  global_load_dwordx2 v[86:87], v1, s[54:55] offset:3072 sc1
  global_load_dwordx2 v[110:111], v3, s[54:55] offset:3072 sc1
  s_add_u32 s54, s54, 32768
  s_addc_u32 s55, s55, 0
  v_mov_b32 v108, -1
  global_store_dword v114, v108, s[48:49] sc1
  s_mov_b64 s[48:49], s[46:47]
  s_mov_b64 s[46:47], s[50:51]
  s_add_u32 s44, s46, 10240
  s_addc_u32 s45, s47, 0
  s_add_u32 s36, s36, 1
  s_add_u32 s30, s38, 15728640
  s_add_u32 s50, s4, s30
  s_addc_u32 s51, s5, 0
  s_add_u32 s38, s38, 147456
  s_cmp_eq_u32 s38, 589824
  s_cselect_b32 s38, 0, s38
  s_add_u32 s8, s8, 458752
  s_addc_u32 s9, s9, 0
  v_mov_b32 v36, 0
  v_mov_b32 v37, 0
  v_mov_b32 v38, 0
  v_mov_b32 v39, 0
  v_mov_b32 v40, 0
  v_mov_b32 v41, 0
  v_mov_b32 v42, 0
  v_mov_b32 v43, 0
  v_mov_b32 v44, 0
  v_mov_b32 v45, 0
  v_mov_b32 v46, 0
  v_mov_b32 v47, 0
  v_mov_b32 v48, 0
  v_mov_b32 v49, 0
  v_mov_b32 v50, 0
  v_mov_b32 v51, 0
  v_mov_b32 v52, 0
  v_mov_b32 v53, 0
  v_mov_b32 v54, 0
  v_mov_b32 v55, 0
  v_mov_b32 v56, 0
  v_mov_b32 v57, 0
  v_mov_b32 v58, 0
  v_mov_b32 v59, 0
  v_mov_b32 v60, 0
  v_mov_b32 v61, 0
  v_mov_b32 v62, 0
  v_mov_b32 v63, 0
  s_cmp_lt_u32 s36, 63
  s_cbranch_scc1 mk_c_ss2_loop
  s_branch mk_c_done
mk_c_ss2_entry:
  s_branch mk_c_ss2_mem
mk_c_ss2_smax:
  v_mov_b32 v24, 0xff800000
  v_max_f32 v12, v8, v9
  v_cndmask_b32 v12, v24, v12, s[42:43]
  s_nop 1
  v_max_f32_dpp v12, v12, v12 row_ror:8 row_mask:0xf bank_mask:0xf
  s_nop 1
  v_max_f32_dpp v12, v12, v12 row_ror:4 row_mask:0xf bank_mask:0xf
  s_nop 1
  v_max_f32_dpp v12, v12, v12 row_ror:2 row_mask:0xf bank_mask:0xf
  s_nop 1
  v_max_f32_dpp v12, v12, v12 row_ror:1 row_mask:0xf bank_mask:0xf
  v_mov_b32 v13, v12
  s_nop 1
  v_permlane16_swap_b32 v12, v13
  v_max_f32 v12, v12, v13
  v_sub_f32 v10, v8, v12
  v_sub_f32 v11, v9, v12
  v_exp_f32 v10, v10
  v_exp_f32 v11, v11
  s_branch mk_c_ss2_smax_ret
mk_c_ss2_redo2:
  s_nop 7
  s_sub_u32 s40, s40, 2000
  s_cbranch_scc0 mk_c_ss2_redo3
  s_mov_b32 s40, 0
  s_branch mk_c_ss2_cont2
mk_c_ss2_redo:
  s_nop 7
  s_sub_u32 s40, s40, 1
  s_cbranch_scc1 mk_c_ss2_giveup
mk_c_ss2_redo3:
  v_mov_b32 v36, 0
  v_mov_b32 v37, 0
  v_mov_b32 v38, 0
  v_mov_b32 v39, 0
  v_mov_b32 v40, 0
  v_mov_b32 v41, 0
  v_mov_b32 v42, 0
  v_mov_b32 v43, 0
  v_mov_b32 v44, 0
  v_mov_b32 v45, 0
  v_mov_b32 v46, 0
  v_mov_b32 v47, 0
  v_mov_b32 v48, 0
  v_mov_b32 v49, 0
  v_mov_b32 v50, 0
  v_mov_b32 v51, 0
  v_mov_b32 v52, 0
  v_mov_b32 v53, 0
  v_mov_b32 v54, 0
  v_mov_b32 v55, 0
  v_mov_b32 v56, 0
  v_mov_b32 v57, 0
  v_mov_b32 v58, 0
  v_mov_b32 v59, 0
  v_mov_b32 v60, 0
  v_mov_b32 v61, 0
  v_mov_b32 v62, 0
  v_mov_b32 v63, 0
  s_waitcnt lgkmcnt(0)
  s_branch mk_c_ss2_mem
mk_c_ss2_giveup:
  s_mov_b32 s40, 0
  s_branch mk_c_ss2_cont
mk_c_ss3_loop:
  s_barrier
mk_c_ss3_mem:
  global_load_dwordx4 v[32:35], v3, s[44:45] offset:2048 sc1
  s_nop 11
  global_load_dwordx4 v[8:11], v1, s[44:45] offset:0 sc1
  s_nop 11
  global_load_dwordx4 v[12:15], v1, s[44:45] offset:1024 sc1
  s_nop 11
  global_load_dwordx4 v[16:19], v1, s[44:45] offset:2048 sc1
  s_waitcnt vmcnt(3)
  v_smfmac_f32_16x16x64_bf16 v[36:39], v[32:35], a[48:55], v112
  ds_write_b128 v1, v[32:35] offset:10240
  v_smfmac_f32_16x16x64_bf16 v[40:43], v[32:35], a[104:111], v112
  global_load_dwordx4 v[20:23], v1, s[44:45] offset:3072 sc1
  v_smfmac_f32_16x16x64_bf16 v[44:47], v[32:35], a[160:167], v112
  v_max3_u32 v119, v32, v33, v34
  v_smfmac_f32_16x16x64_bf16 v[48:51], v[32:35], a[216:223], v112
  global_load_dwordx4 v[24:27], v3, s[44:45] offset:0 sc1
  v_smfmac_f32_16x16x64_bf16 v[52:55], v[32:35], v[136:143], v112
  v_max_u32 v119, v119, v35
  v_smfmac_f32_16x16x64_bf16 v[56:59], v[32:35], v[192:199], v112
  global_load_dwordx4 v[28:31], v3, s[44:45] offset:1024 sc1
  v_smfmac_f32_16x16x64_bf16 v[60:63], v[32:35], v[248:255], v112
  s_waitcnt vmcnt(5)
  v_smfmac_f32_16x16x64_bf16 v[36:39], v[8:11], a[0:7], v112
  v_smfmac_f32_16x16x64_bf16 v[40:43], v[8:11], a[56:63], v112
  v_smfmac_f32_16x16x64_bf16 v[44:47], v[8:11], a[112:119], v112
  v_max3_u32 v119, v119, v8, v9
  v_smfmac_f32_16x16x64_bf16 v[48:51], v[8:11], a[168:175], v112
  v_smfmac_f32_16x16x64_bf16 v[52:55], v[8:11], a[224:231], v112
  v_max3_u32 v119, v119, v10, v11
  v_smfmac_f32_16x16x64_bf16 v[56:59], v[8:11], v[144:151], v112
  v_smfmac_f32_16x16x64_bf16 v[60:63], v[8:11], v[200:207], v112
  s_waitcnt vmcnt(4)
  v_smfmac_f32_16x16x64_bf16 v[36:39], v[12:15], a[8:15], v112
  ds_read_b128 v[32:35], v1 offset:47104
  v_smfmac_f32_16x16x64_bf16 v[40:43], v[12:15], a[64:71], v112
  ds_read_b128 v[8:11], v1 offset:48128
  v_smfmac_f32_16x16x64_bf16 v[44:47], v[12:15], a[120:127], v112
  v_max3_u32 v119, v119, v12, v13
  v_smfmac_f32_16x16x64_bf16 v[48:51], v[12:15], a[176:183], v112
  v_max3_u32 v119, v119, v14, v15
  v_smfmac_f32_16x16x64_bf16 v[52:55], v[12:15], a[232:239], v112
  v_cmp_eq_u32 vcc, -1, v119
  v_smfmac_f32_16x16x64_bf16 v[56:59], v[12:15], v[152:159], v112
  v_smfmac_f32_16x16x64_bf16 v[60:63], v[12:15], v[208:215], v112
  s_cbranch_vccnz mk_c_ss3_redo
mk_c_ss3_cont:
  s_waitcnt vmcnt(3)
  v_smfmac_f32_16x16x64_bf16 v[36:39], v[16:19], a[16:23], v112
  s_waitcnt vmcnt(2)
  v_smfmac_f32_16x16x64_bf16 v[36:39], v[20:23], a[24:31], v112
  s_waitcnt vmcnt(1)
  v_smfmac_f32_16x16x64_bf16 v[36:39], v[24:27], a[32:39], v112
  s_waitcnt vmcnt(0)
  v_smfmac_f32_16x16x64_bf16 v[36:39], v[28:31], a[40:47], v112
  ds_write_b128 v1, v[28:31] offset:9216
  v_smfmac_f32_16x16x64_bf16 v[40:43], v[16:19], a[72:79], v112
  ds_read2_b64 v[96:99], v7 offset0:0 offset1:32
  ds_read2_b64 v[116:119], v7 offset0:64 offset1:96
  v_smfmac_f32_16x16x64_bf16 v[40:43], v[20:23], a[80:87], v112
  v_add_f32 v108, v36, v37
  v_smfmac_f32_16x16x64_bf16 v[40:43], v[24:27], a[88:95], v112
  v_add_f32 v109, v38, v39
  v_smfmac_f32_16x16x64_bf16 v[40:43], v[28:31], a[96:103], v112
  v_cvt_pk_bf16_f32 v108, v108, v109
  v_smfmac_f32_16x16x64_bf16 v[44:47], v[16:19], a[128:135], v112
  ds_write_b32 v5, v108 offset:0
  v_smfmac_f32_16x16x64_bf16 v[44:47], v[20:23], a[136:143], v112
  v_add_f32 v108, v40, v41
  v_smfmac_f32_16x16x64_bf16 v[44:47], v[24:27], a[144:151], v112
  v_add_f32 v109, v42, v43
  v_smfmac_f32_16x16x64_bf16 v[44:47], v[28:31], a[152:159], v112
  v_cvt_pk_bf16_f32 v108, v108, v109
  v_smfmac_f32_16x16x64_bf16 v[48:51], v[16:19], a[184:191], v112
  ds_write_b32 v5, v108 offset:512
  ds_read_b64_tr_b16 v[76:77], v6 offset:0
  v_smfmac_f32_16x16x64_bf16 v[48:51], v[20:23], a[192:199], v112
  v_add_f32 v108, v44, v45
  ds_read_b64_tr_b16 v[78:79], v6 offset:512
  v_smfmac_f32_16x16x64_bf16 v[48:51], v[24:27], a[200:207], v112
  v_add_f32 v109, v46, v47
  v_smfmac_f32_16x16x64_bf16 v[48:51], v[28:31], a[208:215], v112
  v_cvt_pk_bf16_f32 v108, v108, v109
  v_smfmac_f32_16x16x64_bf16 v[52:55], v[16:19], a[240:247], v112
  ds_write_b32 v5, v108 offset:1024
  v_smfmac_f32_16x16x64_bf16 v[52:55], v[20:23], a[248:255], v112
  v_add_f32 v108, v48, v49
  v_smfmac_f32_16x16x64_bf16 v[52:55], v[24:27], v[120:127], v112
  v_add_f32 v109, v50, v51
  v_smfmac_f32_16x16x64_bf16 v[52:55], v[28:31], v[128:135], v112
  v_cvt_pk_bf16_f32 v108, v108, v109
  s_waitcnt lgkmcnt(1)
  v_mfma_f32_16x16x32_bf16 v[64:67], v[88:91], v[76:79], 0
  v_mfma_f32_16x16x32_bf16 v[68:71], v[92:95], v[76:79], 0
  v_mfma_f32_16x16x32_bf16 v[72:75], v[96:99], v[76:79], 0
  ds_read2_b64 v[96:99], v7 offset0:128 offset1:160
  v_smfmac_f32_16x16x64_bf16 v[56:59], v[16:19], v[160:167], v112
  ds_write_b32 v5, v108 offset:1536
  ds_read_b64_tr_b16 v[80:81], v6 offset:1024
  v_smfmac_f32_16x16x64_bf16 v[56:59], v[20:23], v[168:175], v112
  v_add_f32 v108, v52, v53
  ds_read_b64_tr_b16 v[82:83], v6 offset:1536
  v_smfmac_f32_16x16x64_bf16 v[56:59], v[24:27], v[176:183], v112
  v_add_f32 v109, v54, v55
  v_smfmac_f32_16x16x64_bf16 v[56:59], v[28:31], v[184:191], v112
  v_cvt_pk_bf16_f32 v108, v108, v109
  v_smfmac_f32_16x16x64_bf16 v[60:63], v[16:19], v[216:223], v112
  ds_write_b32 v5, v108 offset:2048
  v_smfmac_f32_16x16x64_bf16 v[60:63], v[20:23], v[224:231], v112
  v_add_f32 v108, v56, v57
  v_smfmac_f32_16x16x64_bf16 v[60:63], v[24:27], v[232:239], v112
  v_add_f32 v109, v58, v59
  v_smfmac_f32_16x16x64_bf16 v[60:63], v[28:31], v[240:247], v112
  v_cvt_pk_bf16_f32 v108, v108, v109
  ds_write_b32 v5, v108 offset:2560
  s_waitcnt lgkmcnt(2)
  v_mfma_f32_16x16x32_bf16 v[64:67], v[32:35], v[80:83], v[64:67]
  ds_read_b64_tr_b16 v[76:77], v6 offset:2048
  ds_read_b64_tr_b16 v[78:79], v6 offset:2560
  v_mfma_f32_16x16x32_bf16 v[68:71], v[8:11], v[80:83], v[68:71]
  v_add_f32 v108, v60, v61
  v_add_f32 v109, v62, v63
  v_mfma_f32_16x16x32_bf16 v[72:75], v[116:119], v[80:83], v[72:75]
  v_cvt_pk_bf16_f32 v108, v108, v109
  ds_write_b32 v5, v108 offset:3072
  ds_read_b64_tr_b16 v[84:85], v6 offset:3072
  ds_read_b64 v[116:117], v7 offset:1536
  s_waitcnt lgkmcnt(3)
  v_mfma_f32_16x16x32_bf16 v[64:67], v[100:103], v[76:79], v[64:67]
  v_mfma_f32_16x16x32_bf16 v[68:71], v[104:107], v[76:79], v[68:71]
  v_mfma_f32_16x16x32_bf16 v[72:75], v[96:99], v[76:79], v[72:75]
  s_waitcnt lgkmcnt(0)
  v_mfma_f32_16x16x16_bf16 v[64:67], v[86:87], v[84:85], v[64:67]
  v_mfma_f32_16x16x16_bf16 v[68:71], v[110:111], v[84:85], v[68:71]
  v_mfma_f32_16x16x16_bf16 v[72:75], v[116:117], v[84:85], v[72:75]
  s_nop 3
  ds_write_b128 v115, v[64:67] offset:0
  v_cmp_u_f32 vcc, v64, v64
  ds_write_b128 v115, v[68:71] offset:64
  s_nop 0
  ds_write_b128 v115, v[72:75] offset:128
  s_cbranch_vccnz mk_c_ss3_redo2
mk_c_ss3_cont2:
  s_waitcnt lgkmcnt(0)
  s_barrier
  ds_read_b64 v[8:9], v113 offset:0
  ds_read_b64 v[10:11], v113 offset:3328
  ds_read_b64 v[12:13], v113 offset:6656
  ds_read_b64 v[14:15], v113 offset:9984
  s_mov_b32 s30, 0x42800000
  s_waitcnt lgkmcnt(2)
  v_pk_add_f32 v[8:9], v[8:9], v[10:11]
  s_waitcnt lgkmcnt(0)
  v_pk_add_f32 v[12:13], v[12:13], v[14:15]
  v_pk_add_f32 v[8:9], v[8:9], v[12:13]
  v_max_f32 v12, |v8|, |v9|
  v_exp_f32 v10, v8
  v_cmp_nge_f32 vcc, s30, v12
  v_exp_f32 v11, v9
  s_and_b64 vcc, vcc, s[42:43]
  s_cbranch_vccnz mk_c_ss3_smax
mk_c_ss3_smax_ret:
  v_add_f32 v12, v10, v11
  v_cndmask_b32 v12, 0, v12, s[42:43]
  s_nop 1
  v_add_f32_dpp v12, v12, v12 row_ror:8 row_mask:0xf bank_mask:0xf
  s_nop 1
  v_add_f32_dpp v12, v12, v12 row_ror:4 row_mask:0xf bank_mask:0xf
  s_nop 1
  v_add_f32_dpp v12, v12, v12 row_ror:2 row_mask:0xf bank_mask:0xf
  s_nop 1
  v_add_f32_dpp v12, v12, v12 row_ror:1 row_mask:0xf bank_mask:0xf
  v_mov_b32 v13, v12
  s_nop 1
  v_permlane16_swap_b32 v12, v13
  v_add_f32 v12, v12, v13
  v_rcp_f32 v12, v12
  s_nop 0
  v_mul_f32 v8, v10, v12
  v_mul_f32 v9, v11, v12
  v_cvt_pk_bf16_f32 v8, v8, v9
  s_mov_b64 exec, s[42:43]
  global_store_dword v114, v8, s[46:47] sc1
  s_mov_b64 exec, -1
  global_load_dwordx4 v[88:91], v1, s[54:55] offset:0 sc1
  global_load_dwordx4 v[92:95], v3, s[54:55] offset:0 sc1
  s_mov_b32 m0, 46080
  s_nop 0
  global_load_lds_dwordx4 v1, s[54:55] offset:1024 sc1
  s_mov_b32 m0, 47104
  s_nop 0
  global_load_lds_dwordx4 v3, s[54:55] offset:1024 sc1
  global_load_dwordx4 v[100:103], v1, s[54:55] offset:2048 sc1
  global_load_dwordx4 v[104:107], v3, s[54:55] offset:2048 sc1
  global_load_dwordx2 v[86:87], v1, s[54:55] offset:3072 sc1
  global_load_dwordx2 v[110:111], v3, s[54:55] offset:3072 sc1
  s_add_u32 s54, s54, 32768
  s_addc_u32 s55, s55, 0
  v_mov_b32 v108, -1
  global_store_dword v114, v108, s[48:49] sc1
  s_mov_b64 s[48:49], s[46:47]
  s_mov_b64 s[46:47], s[50:51]
  s_add_u32 s44, s46, 10240
  s_addc_u32 s45, s47, 0
  s_add_u32 s36, s36, 1
  s_add_u32 s30, s38, 15728640
  s_add_u32 s50, s4, s30
  s_addc_u32 s51, s5, 0
  s_add_u32 s38, s38, 147456
  s_cmp_eq_u32 s38, 589824
  s_cselect_b32 s38, 0, s38
  s_add_u32 s8, s8, 458752
  s_addc_u32 s9, s9, 0
  v_mov_b32 v36, 0
  v_mov_b32 v37, 0
  v_mov_b32 v38, 0
  v_mov_b32 v39, 0
  v_mov_b32 v40, 0
  v_mov_b32 v41, 0
  v_mov_b32 v42, 0
  v_mov_b32 v43, 0
  v_mov_b32 v44, 0
  v_mov_b32 v45, 0
  v_mov_b32 v46, 0
  v_mov_b32 v47, 0
  v_mov_b32 v48, 0
  v_mov_b32 v49, 0
  v_mov_b32 v50, 0
  v_mov_b32 v51, 0
  v_mov_b32 v52, 0
  v_mov_b32 v53, 0
  v_mov_b32 v54, 0
  v_mov_b32 v55, 0
  v_mov_b32 v56, 0
  v_mov_b32 v57, 0
  v_mov_b32 v58, 0
  v_mov_b32 v59, 0
  v_mov_b32 v60, 0
  v_mov_b32 v61, 0
  v_mov_b32 v62, 0
  v_mov_b32 v63, 0
  s_cmp_lt_u32 s36, 63
  s_cbranch_scc1 mk_c_ss3_loop
  s_branch mk_c_done
mk_c_ss3_entry:
  s_branch mk_c_ss3_mem
mk_c_ss3_smax:
  v_mov_b32 v24, 0xff800000
  v_max_f32 v12, v8, v9
  v_cndmask_b32 v12, v24, v12, s[42:43]
  s_nop 1
  v_max_f32_dpp v12, v12, v12 row_ror:8 row_mask:0xf bank_mask:0xf
  s_nop 1
  v_max_f32_dpp v12, v12, v12 row_ror:4 row_mask:0xf bank_mask:0xf
  s_nop 1
  v_max_f32_dpp v12, v12, v12 row_ror:2 row_mask:0xf bank_mask:0xf
  s_nop 1
  v_max_f32_dpp v12, v12, v12 row_ror:1 row_mask:0xf bank_mask:0xf
  v_mov_b32 v13, v12
  s_nop 1
  v_permlane16_swap_b32 v12, v13
  v_max_f32 v12, v12, v13
  v_sub_f32 v10, v8, v12
  v_sub_f32 v11, v9, v12
  v_exp_f32 v10, v10
  v_exp_f32 v11, v11
  s_branch mk_c_ss3_smax_ret
mk_c_ss3_redo2:
  s_nop 7
  s_sub_u32 s40, s40, 2000
  s_cbranch_scc0 mk_c_ss3_redo3
  s_mov_b32 s40, 0
  s_branch mk_c_ss3_cont2
mk_c_ss3_redo:
  s_nop 7
  s_sub_u32 s40, s40, 1
  s_cbranch_scc1 mk_c_ss3_giveup
mk_c_ss3_redo3:
  v_mov_b32 v36, 0
  v_mov_b32 v37, 0
  v_mov_b32 v38, 0
  v_mov_b32 v39, 0
  v_mov_b32 v40, 0
  v_mov_b32 v41, 0
  v_mov_b32 v42, 0
  v_mov_b32 v43, 0
  v_mov_b32 v44, 0
  v_mov_b32 v45, 0
  v_mov_b32 v46, 0
  v_mov_b32 v47, 0
  v_mov_b32 v48, 0
  v_mov_b32 v49, 0
  v_mov_b32 v50, 0
  v_mov_b32 v51, 0
  v_mov_b32 v52, 0
  v_mov_b32 v53, 0
  v_mov_b32 v54, 0
  v_mov_b32 v55, 0
  v_mov_b32 v56, 0
  v_mov_b32 v57, 0
  v_mov_b32 v58, 0
  v_mov_b32 v59, 0
  v_mov_b32 v60, 0
  v_mov_b32 v61, 0
  v_mov_b32 v62, 0
  v_mov_b32 v63, 0
  s_waitcnt lgkmcnt(0)
  s_branch mk_c_ss3_mem
mk_c_ss3_giveup:
  s_mov_b32 s40, 0
  s_branch mk_c_ss3_cont
mk_c_sv0_loop:
  s_barrier
mk_c_sv0_mem:
  global_load_dwordx4 v[8:11], v5, s[44:45] sc1
  s_nop 3
  global_load_dwordx4 v[12:15], v6, s[44:45] sc1
  s_nop 3
  global_load_dwordx4 v[16:19], v7, s[44:45] sc1
  s_barrier
  s_cmp_eq_u32 s36, 0
  s_cbranch_scc1 w0s_38
  s_add_u32 s30, s38, 15728640
  s_add_u32 s50, s4, s30
  s_addc_u32 s51, s5, 0
  s_add_u32 s38, s38, 147456
  s_cmp_eq_u32 s38, 589824
  s_cselect_b32 s38, 0, s38
  v_xor_b32 v100, 0x38000, v100
  v_mov_b32 v36, 0
  v_mov_b32 v37, 0
  v_mov_b32 v38, 0
  v_mov_b32 v39, 0
  v_mov_b32 v40, 0
  v_mov_b32 v41, 0
  v_mov_b32 v42, 0
  v_mov_b32 v43, 0
  v_mov_b32 v44, 0
  v_mov_b32 v45, 0
  v_mov_b32 v46, 0
  v_mov_b32 v47, 0
  v_mov_b32 v48, 0
  v_mov_b32 v49, 0
  v_mov_b32 v50, 0
  v_mov_b32 v51, 0
  v_mov_b32 v52, 0
  v_mov_b32 v53, 0
  v_mov_b32 v54, 0
  v_mov_b32 v55, 0
  v_mov_b32 v56, 0
  v_mov_b32 v57, 0
  v_mov_b32 v58, 0
  v_mov_b32 v59, 0
  v_mov_b32 v60, 0
  v_mov_b32 v61, 0
  v_mov_b32 v62, 0
  v_mov_b32 v63, 0
  v_mov_b32 v64, 0
  v_mov_b32 v65, 0
  v_mov_b32 v66, 0
  v_mov_b32 v67, 0
w0s_38:
  s_add_u32 m0, s35, 0
  s_nop 0
  global_load_lds_dwordx4 v1, s[56:57] offset:0 sc1
  s_add_u32 m0, s35, 0
  s_nop 0
  global_load_lds_dwordx4 v1, s[56:57] offset:1024 sc1
  s_add_u32 m0, s35, 0
  s_nop 0
  global_load_lds_dwordx4 v1, s[56:57] offset:2048 sc1
  s_add_u32 m0, s35, 0
  s_nop 0
  global_load_lds_dwordx4 v1, s[56:57] offset:3072 sc1
mk_c_sv0_got:
  s_waitcnt vmcnt(6)
  ds_write_b128 v1, v[8:11] offset:0
  v_smfmac_f32_16x16x64_bf16 v[36:39], v[8:11], a[0:7], v112
  s_waitcnt vmcnt(5)
  ds_write_b128 v1, v[12:15] offset:1024
  v_smfmac_f32_16x16x64_bf16 v[40:43], v[8:11], a[56:63], v112
  v_max3_u32 v119, v8, v9, v10
  v_smfmac_f32_16x16x64_bf16 v[44:47], v[8:11], a[112:119], v112
  v_max3_u32 v119, v119, v11, v12
  v_smfmac_f32_16x16x64_bf16 v[48:51], v[8:11], a[168:175], v112
  v_max3_u32 v119, v119, v13, v14
  v_smfmac_f32_16x16x64_bf16 v[52:55], v[8:11], a[224:231], v112
  v_max_u32 v119, v119, v15
  v_smfmac_f32_16x16x64_bf16 v[56:59], v[8:11], v[144:151], v112
  v_cmp_eq_u32 vcc, -1, v119
  v_smfmac_f32_16x16x64_bf16 v[60:63], v[8:11], v[200:207], v112
  s_cbranch_vccnz mk_c_sv0_redo
mk_c_sv0_cont:
  v_smfmac_f32_16x16x64_bf16 v[36:39], v[12:15], a[8:15], v112
  v_smfmac_f32_16x16x64_bf16 v[40:43], v[12:15], a[64:71], v112
  s_add_u32 m0, s35, 4096
  s_nop 0
  global_load_lds_dwordx4 v3, s[56:57] offset:0 sc1
  v_smfmac_f32_16x16x64_bf16 v[44:47], v[12:15], a[120:127], v112
  s_add_u32 m0, s35, 4096
  s_nop 0
  global_load_lds_dwordx4 v3, s[56:57] offset:1024 sc1
  v_smfmac_f32_16x16x64_bf16 v[48:51], v[12:15], a[176:183], v112
  s_add_u32 m0, s35, 4096
  s_nop 0
  global_load_lds_dwordx4 v3, s[56:57] offset:2048 sc1
  v_smfmac_f32_16x16x64_bf16 v[52:55], v[12:15], a[232:239], v112
  s_add_u32 m0, s35, 4096
  s_nop 0
  global_load_lds_dwordx4 v3, s[56:57] offset:3072 sc1
  s_waitcnt vmcnt(8)
  v_max3_u32 v119, v16, v17, v18
  v_smfmac_f32_16x16x64_bf16 v[56:59], v[12:15], v[152:159], v112
  global_store_dword v102, v104, s[10:11] sc1
  s_mov_b64 exec, 15
  global_store_dword v0, v104, s[10:11] sc1
  s_mov_b64 exec, -1
  v_max_u32 v119, v119, v19
  v_smfmac_f32_16x16x64_bf16 v[60:63], v[12:15], v[208:215], v112
  v_cmp_eq_u32 vcc, -1, v119
  s_waitcnt lgkmcnt(0)
  s_barrier
  s_nop 0
  s_cbranch_vccnz mk_c_sv0_fix2
mk_c_sv0_fix2r:
  ds_read_b128 v[20:23], v1 offset:3072
  ds_read_b128 v[24:27], v1 offset:4096
  ds_read_b128 v[28:31], v1 offset:5120
  ds_read_b128 v[32:35], v1 offset:6144
  ds_read_b128 v[68:71], v113 offset:0
  ds_read_b128 v[72:75], v113 offset:1024
  ds_read_b128 v[76:79], v113 offset:2048
  ds_read_b128 v[80:83], v113 offset:3072
  v_smfmac_f32_16x16x64_bf16 v[36:39], v[16:19], a[16:23], v112
  v_smfmac_f32_16x16x64_bf16 v[40:43], v[16:19], a[72:79], v112
  v_smfmac_f32_16x16x64_bf16 v[44:47], v[16:19], a[128:135], v112
  v_smfmac_f32_16x16x64_bf16 v[48:51], v[16:19], a[184:191], v112
  v_smfmac_f32_16x16x64_bf16 v[52:55], v[16:19], a[240:247], v112
  v_smfmac_f32_16x16x64_bf16 v[56:59], v[16:19], v[160:167], v112
  v_smfmac_f32_16x16x64_bf16 v[60:63], v[16:19], v[216:223], v112
  s_add_u32 s56, s56, 458752
  s_addc_u32 s57, s57, 0
  s_xor_b32 s35, s35, 0x38000
  s_waitcnt lgkmcnt(7)
  v_smfmac_f32_16x16x64_bf16 v[36:39], v[20:23], a[24:31], v112
  s_waitcnt lgkmcnt(6)
  v_smfmac_f32_16x16x64_bf16 v[36:39], v[24:27], a[32:39], v112
  s_waitcnt lgkmcnt(5)
  v_smfmac_f32_16x16x64_bf16 v[36:39], v[28:31], a[40:47], v112
  s_waitcnt lgkmcnt(4)
  v_smfmac_f32_16x16x64_bf16 v[36:39], v[32:35], a[48:55], v112
  s_waitcnt lgkmcnt(2)
  v_smfmac_f32_16x16x64_bf16 v[64:67], v[8:11], v[68:75], v112
  ds_read_b128 v[68:71], v113 offset:4096
  ds_read_b128 v[72:75], v113 offset:5120
  v_smfmac_f32_16x16x64_bf16 v[40:43], v[20:23], a[80:87], v112
  v_smfmac_f32_16x16x64_bf16 v[40:43], v[24:27], a[88:95], v112
  v_add_f32 v36, v36, v37
  v_smfmac_f32_16x16x64_bf16 v[40:43], v[28:31], a[96:103], v112
  v_add_f32 v38, v38, v39
  v_smfmac_f32_16x16x64_bf16 v[40:43], v[32:35], a[104:111], v112
  v_cvt_pk_bf16_f32 v96, v36, v38
  s_waitcnt lgkmcnt(2)
  v_smfmac_f32_16x16x64_bf16 v[64:67], v[12:15], v[76:83], v112
  ds_read_b128 v[76:79], v113 offset:6144
  ds_read_b128 v[80:83], v113 offset:7168
  ds_write_b32 v114, v96 offset:0
  v_smfmac_f32_16x16x64_bf16 v[44:47], v[20:23], a[136:143], v112
  v_smfmac_f32_16x16x64_bf16 v[44:47], v[24:27], a[144:151], v112
  v_add_f32 v40, v40, v41
  v_smfmac_f32_16x16x64_bf16 v[44:47], v[28:31], a[152:159], v112
  v_add_f32 v42, v42, v43
  v_smfmac_f32_16x16x64_bf16 v[44:47], v[32:35], a[160:167], v112
  v_cvt_pk_bf16_f32 v97, v40, v42
  s_waitcnt lgkmcnt(3)
  v_smfmac_f32_16x16x64_bf16 v[64:67], v[16:19], v[68:75], v112
  ds_read_b128 v[68:71], v113 offset:8192
  ds_read_b128 v[72:75], v113 offset:9216
  ds_write_b32 v114, v97 offset:4096
  v_smfmac_f32_16x16x64_bf16 v[48:51], v[20:23], a[192:199], v112
  v_smfmac_f32_16x16x64_bf16 v[48:51], v[24:27], a[200:207], v112
  v_add_f32 v44, v44, v45
  v_smfmac_f32_16x16x64_bf16 v[48:51], v[28:31], a[208:215], v112
  v_add_f32 v46, v46, v47
  v_smfmac_f32_16x16x64_bf16 v[48:51], v[32:35], a[216:223], v112
  v_cvt_pk_bf16_f32 v98, v44, v46
  s_waitcnt lgkmcnt(4)
  v_smfmac_f32_16x16x64_bf16 v[64:67], v[20:23], v[76:83], v112
  ds_read_b128 v[76:79], v113 offset:10240
  ds_read_b128 v[80:83], v113 offset:11264
  ds_write_b32 v114, v98 offset:4
  v_smfmac_f32_16x16x64_bf16 v[52:55], v[20:23], a[248:255], v112
  v_smfmac_f32_16x16x64_bf16 v[52:55], v[24:27], v[120:127], v112
  v_add_f32 v48, v48, v49
  v_smfmac_f32_16x16x64_bf16 v[52:55], v[28:31], v[128:135], v112
  v_add_f32 v50, v50, v51
  v_smfmac_f32_16x16x64_bf16 v[52:55], v[32:35], v[136:143], v112
  v_cvt_pk_bf16_f32 v99, v48, v50
  s_waitcnt lgkmcnt(4)
  v_smfmac_f32_16x16x64_bf16 v[64:67], v[24:27], v[68:75], v112
  ds_read_b128 v[68:71], v113 offset:12288
  ds_read_b128 v[72:75], v113 offset:13312
  ds_write_b32 v114, v99 offset:4100
  v_smfmac_f32_16x16x64_bf16 v[56:59], v[20:23], v[168:175], v112
  v_smfmac_f32_16x16x64_bf16 v[56:59], v[24:27], v[176:183], v112
  v_add_f32 v52, v52, v53
  v_smfmac_f32_16x16x64_bf16 v[56:59], v[28:31], v[184:191], v112
  v_add_f32 v54, v54, v55
  v_smfmac_f32_16x16x64_bf16 v[56:59], v[32:35], v[192:199], v112
  v_cvt_pk_bf16_f32 v96, v52, v54
  s_waitcnt lgkmcnt(4)
  v_smfmac_f32_16x16x64_bf16 v[64:67], v[28:31], v[76:83], v112
  ds_write_b32 v114, v96 offset:512
  v_smfmac_f32_16x16x64_bf16 v[60:63], v[20:23], v[224:231], v112
  v_smfmac_f32_16x16x64_bf16 v[60:63], v[24:27], v[232:239], v112
  v_add_f32 v56, v56, v57
  v_smfmac_f32_16x16x64_bf16 v[60:63], v[28:31], v[240:247], v112
  v_add_f32 v58, v58, v59
  v_smfmac_f32_16x16x64_bf16 v[60:63], v[32:35], v[248:255], v112
  v_cvt_pk_bf16_f32 v97, v56, v58
  s_waitcnt lgkmcnt(2)
  v_smfmac_f32_16x16x64_bf16 v[64:67], v[32:35], v[68:75], v112
  ds_write_b32 v114, v97 offset:4608
  s_nop 2
  v_add_f32 v60, v60, v61
  v_add_f32 v62, v62, v63
  v_cvt_pk_bf16_f32 v98, v60, v62
  ds_write_b32 v114, v98 offset:516
  v_add_f32 v64, v64, v65
  v_add_f32 v66, v66, v67
  v_cvt_pk_bf16_f32 v99, v64, v66
  ds_write_b32 v114, v99 offset:4612
  s_waitcnt lgkmcnt(0)
  s_barrier
  ds_read_b128 v[64:67], v100 offset:0
  ds_read_b128 v[68:71], v100 offset:1024
  ds_read_b128 v[72:75], v100 offset:2048
  ds_read_b128 v[76:79], v100 offset:3072
  ds_read_b128 v[80:83], v100 offset:4096
  ds_read_b128 v[84:87], v100 offset:5120
  ds_read_b128 v[88:91], v100 offset:6144
  ds_read_b128 v[92:95], v100 offset:7168
  ds_read_b128 v[48:51], v101 offset:0
  ds_read_b128 v[52:55], v101 offset:1024
  ds_read_b128 v[56:59], v101 offset:2048
  ds_read_b128 v[60:63], v101 offset:3072
  global_load_dword v108, v2, s[46:47] sc1
  s_nop 12
  global_load_dword v109, v2, s[46:47] sc1
  s_nop 12
  global_load_dword v110, v2, s[46:47] sc1
  s_nop 12
  global_load_dword v111, v2, s[46:47] sc1
  s_nop 12
  global_load_dword v116, v2, s[46:47] sc1
  s_nop 12
mk_c_sv0_fp_39:
  global_load_dword v117, v2, s[46:47] sc1
  s_waitcnt vmcnt(5)
  v_cmp_eq_u32 vcc, -1, v108
  s_cbranch_vccz mk_c_sv0_fd_40
  global_load_dword v108, v2, s[46:47] sc1
  s_waitcnt vmcnt(5)
  v_cmp_eq_u32 vcc, -1, v109
  s_cbranch_vccz mk_c_sv0_fd_40
  global_load_dword v109, v2, s[46:47] sc1
  s_waitcnt vmcnt(5)
  v_cmp_eq_u32 vcc, -1, v110
  s_cbranch_vccz mk_c_sv0_fd_40
  global_load_dword v110, v2, s[46:47] sc1
  s_waitcnt vmcnt(5)
  v_cmp_eq_u32 vcc, -1, v111
  s_cbranch_vccz mk_c_sv0_fd_40
  global_load_dword v111, v2, s[46:47] sc1
  s_waitcnt vmcnt(5)
  v_cmp_eq_u32 vcc, -1, v116
  s_cbranch_vccz mk_c_sv0_fd_40
  global_load_dword v116, v2, s[46:47] sc1
  s_waitcnt vmcnt(5)
  v_cmp_eq_u32 vcc, -1, v117
  s_cbranch_vccz mk_c_sv0_fd_40
  s_sub_u32 s40, s40, 1
  s_cbranch_scc0 mk_c_sv0_fp_39
  s_mov_b32 s40, 0
mk_c_sv0_fd_40:
  s_nop 3
mk_c_sv0_pld:
  global_load_dwordx4 v[40:43], v4, s[46:47] offset:0 sc1
  global_load_dwordx4 v[44:47], v4, s[46:47] offset:1024 sc1
  global_load_dwordx4 v[8:11], v1, s[46:47] offset:0 sc1
  global_load_dwordx4 v[12:15], v1, s[46:47] offset:1024 sc1
  global_load_dwordx4 v[16:19], v1, s[46:47] offset:2048 sc1
  global_load_dwordx4 v[20:23], v1, s[46:47] offset:3072 sc1
  global_load_dwordx4 v[24:27], v3, s[46:47] offset:0 sc1
  global_load_dwordx4 v[28:31], v3, s[46:47] offset:1024 sc1
  global_load_dwordx4 v[32:35], v3, s[46:47] offset:2048 sc1
  global_load_dwordx4 v[36:39], v3, s[46:47] offset:3072 sc1
  v_mov_b32 v96, 0
  v_mov_b32 v97, 0
  v_mov_b32 v98, 0
  v_mov_b32 v99, 0
  s_mov_b64 s[10:11], s[46:47]
  s_waitcnt lgkmcnt(0)
  s_waitcnt vmcnt(9)
  v_smfmac_f32_16x16x64_bf16 v[96:99], v[40:43], v[48:55], v112
  v_max3_u32 v119, v40, v41, v42
  s_waitcnt vmcnt(8)
  v_smfmac_f32_16x16x64_bf16 v[96:99], v[44:47], v[56:63], v112
  v_max3_u32 v119, v119, v43, v44
  v_max3_u32 v119, v119, v45, v46
  v_max_u32 v119, v119, v47
  v_cmp_eq_u32 vcc, -1, v119
  s_cbranch_vccnz mk_c_sv0_pre
mk_c_sv0_pgo:
  s_waitcnt vmcnt(7)
  v_smfmac_f32_16x16x64_bf16 v[96:99], v[8:11], v[64:71], v112
  ds_read_b128 v[64:67], v100 offset:8192
  ds_read_b128 v[68:71], v100 offset:9216
  s_waitcnt vmcnt(6)
  v_smfmac_f32_16x16x64_bf16 v[96:99], v[12:15], v[72:79], v112
  s_mov_b64 exec, 15
  global_store_dword v0, v112, s[50:51] sc1
  s_mov_b64 exec, -1
  ds_read_b128 v[72:75], v100 offset:10240
  ds_read_b128 v[76:79], v100 offset:11264
  s_waitcnt vmcnt(6)
  v_smfmac_f32_16x16x64_bf16 v[96:99], v[16:19], v[80:87], v112
  ds_read_b128 v[80:83], v100 offset:12288
  ds_read_b128 v[84:87], v100 offset:13312
  s_waitcnt vmcnt(5)
  v_smfmac_f32_16x16x64_bf16 v[96:99], v[20:23], v[88:95], v112
  ds_read_b128 v[88:91], v100 offset:14336
  ds_read_b128 v[92:95], v100 offset:15360
  s_waitcnt vmcnt(4) lgkmcnt(6)
  v_smfmac_f32_16x16x64_bf16 v[96:99], v[24:27], v[64:71], v112
  s_waitcnt vmcnt(3) lgkmcnt(4)
  v_smfmac_f32_16x16x64_bf16 v[96:99], v[28:31], v[72:79], v112
  s_waitcnt vmcnt(2) lgkmcnt(2)
  v_smfmac_f32_16x16x64_bf16 v[96:99], v[32:35], v[80:87], v112
  s_waitcnt vmcnt(1) lgkmcnt(0)
  v_smfmac_f32_16x16x64_bf16 v[96:99], v[36:39], v[88:95], v112
  s_nop 7
  v_add_f32 v96, v96, v97
  v_add_f32 v98, v98, v99
  v_cmp_u_f32 vcc, v96, v98
  v_cvt_pk_bf16_f32 v96, v96, v98
  s_cbranch_vccnz mk_c_sv0_pnan
mk_c_sv0_pfin:
  s_nop 0
  v_mov_b32_dpp v97, v96 quad_perm:[1,0,3,2] row_mask:0xf bank_mask:0xf
  v_perm_b32 v96, v96, v97, v103
  global_store_dword v102, v96, s[50:51] sc1
  s_cmp_lg_u32 s36, 62
  s_cbranch_scc1 mk_c_sv0_nopv
  s_add_u32 s30, s4, 17218560
  s_addc_u32 s31, s5, 0
  global_store_dword v102, v96, s[30:31] sc1
mk_c_sv0_nopv:
  s_mov_b64 s[48:49], s[46:47]
  s_mov_b64 s[46:47], s[50:51]
  s_add_u32 s44, s46, 10240
  s_addc_u32 s45, s47, 0
  s_add_u32 s36, s36, 1
  s_cmp_lt_u32 s36, 63
  s_cbranch_scc1 mk_c_sv0_loop
  s_branch mk_c_done
mk_c_sv0_entry:
  s_branch mk_c_sv0_mem
mk_c_sv0_fix2:
  ds_read_b128 v[16:19], v1 offset:2048
  s_waitcnt lgkmcnt(0)
  s_branch mk_c_sv0_fix2r
mk_c_sv0_redo:
  s_nop 7
  s_sub_u32 s40, s40, 1
  s_cbranch_scc1 mk_c_sv0_giveup
  s_waitcnt lgkmcnt(0)
  global_load_dwordx4 v[8:11], v5, s[44:45] sc1
  global_load_dwordx4 v[12:15], v6, s[44:45] sc1
  global_load_dwordx4 v[16:19], v7, s[44:45] sc1
  s_nop 7
  v_mov_b32 v36, 0
  v_mov_b32 v37, 0
  v_mov_b32 v38, 0
  v_mov_b32 v39, 0
  v_mov_b32 v40, 0
  v_mov_b32 v41, 0
  v_mov_b32 v42, 0
  v_mov_b32 v43, 0
  v_mov_b32 v44, 0
  v_mov_b32 v45, 0
  v_mov_b32 v46, 0
  v_mov_b32 v47, 0
  v_mov_b32 v48, 0
  v_mov_b32 v49, 0
  v_mov_b32 v50, 0
  v_mov_b32 v51, 0
  v_mov_b32 v52, 0
  v_mov_b32 v53, 0
  v_mov_b32 v54, 0
  v_mov_b32 v55, 0
  v_mov_b32 v56, 0
  v_mov_b32 v57, 0
  v_mov_b32 v58, 0
  v_mov_b32 v59, 0
  v_mov_b32 v60, 0
  v_mov_b32 v61, 0
  v_mov_b32 v62, 0
  v_mov_b32 v63, 0
  v_mov_b32 v64, 0
  v_mov_b32 v65, 0
  v_mov_b32 v66, 0
  v_mov_b32 v67, 0
  s_waitcnt vmcnt(0)
  s_branch mk_c_sv0_got
mk_c_sv0_giveup:
  s_mov_b32 s40, 0
  s_branch mk_c_sv0_cont
mk_c_sv0_pre:
  s_nop 7
  s_sub_u32 s40, s40, 1
  s_cbranch_scc0 mk_c_sv0_pld
  s_mov_b32 s40, 0
  s_branch mk_c_sv0_pgo
mk_c_sv0_pnan:
  v_max3_u32 v119, v8, v9, v10
  v_max3_u32 v119, v119, v11, v12
  v_max3_u32 v119, v119, v13, v14
  v_max3_u32 v119, v119, v15, v16
  v_max3_u32 v119, v119, v17, v18
  v_max3_u32 v119, v119, v19, v20
  v_max3_u32 v119, v119, v21, v22
  v_max3_u32 v119, v119, v23, v24
  v_max3_u32 v119, v119, v25, v26
  v_max3_u32 v119, v119, v27, v28
  v_max3_u32 v119, v119, v29, v30
  v_max3_u32 v119, v119, v31, v32
  v_max3_u32 v119, v119, v33, v34
  v_max3_u32 v119, v119, v35, v36
  v_max3_u32 v119, v119, v37, v38
  v_max3_u32 v119, v119, v39, v40
  v_max3_u32 v119, v119, v41, v42
  v_max3_u32 v119, v119, v43, v44
  v_max3_u32 v119, v119, v45, v46
  v_max_u32 v119, v119, v47
  v_cmp_eq_u32 vcc, -1, v119
  s_cbranch_vccz mk_c_sv0_pfin
  s_sub_u32 s40, s40, 1
  s_cbranch_scc1 mk_c_sv0_pgive
  ds_read_b128 v[64:67], v100 offset:0
  ds_read_b128 v[68:71], v100 offset:1024
  ds_read_b128 v[72:75], v100 offset:2048
  ds_read_b128 v[76:79], v100 offset:3072
  ds_read_b128 v[80:83], v100 offset:4096
  ds_read_b128 v[84:87], v100 offset:5120
  ds_read_b128 v[88:91], v100 offset:6144
  ds_read_b128 v[92:95], v100 offset:7168
  s_branch mk_c_sv0_pld
mk_c_sv0_pgive:
  s_mov_b32 s40, 0
  s_branch mk_c_sv0_pfin
mk_c_sv1_loop:
  s_barrier
mk_c_sv1_mem:
  global_load_dwordx4 v[16:19], v5, s[44:45] sc1
  s_nop 3
  global_load_dwordx4 v[20:23], v6, s[44:45] sc1
  s_nop 3
  global_load_dwordx4 v[24:27], v7, s[44:45] sc1
  s_barrier
  s_cmp_eq_u32 s36, 0
  s_cbranch_scc1 w0s_41
  s_add_u32 s30, s38, 15728640
  s_add_u32 s50, s4, s30
  s_addc_u32 s51, s5, 0
  s_add_u32 s38, s38, 147456
  s_cmp_eq_u32 s38, 589824
  s_cselect_b32 s38, 0, s38
  v_xor_b32 v100, 0x38000, v100
  v_mov_b32 v36, 0
  v_mov_b32 v37, 0
  v_mov_b32 v38, 0
  v_mov_b32 v39, 0
  v_mov_b32 v40, 0
  v_mov_b32 v41, 0
  v_mov_b32 v42, 0
  v_mov_b32 v43, 0
  v_mov_b32 v44, 0
  v_mov_b32 v45, 0
  v_mov_b32 v46, 0
  v_mov_b32 v47, 0
  v_mov_b32 v48, 0
  v_mov_b32 v49, 0
  v_mov_b32 v50, 0
  v_mov_b32 v51, 0
  v_mov_b32 v52, 0
  v_mov_b32 v53, 0
  v_mov_b32 v54, 0
  v_mov_b32 v55, 0
  v_mov_b32 v56, 0
  v_mov_b32 v57, 0
  v_mov_b32 v58, 0
  v_mov_b32 v59, 0
  v_mov_b32 v60, 0
  v_mov_b32 v61, 0
  v_mov_b32 v62, 0
  v_mov_b32 v63, 0
  v_mov_b32 v64, 0
  v_mov_b32 v65, 0
  v_mov_b32 v66, 0
  v_mov_b32 v67, 0
w0s_41:
  s_add_u32 m0, s35, 0
  s_nop 0
  global_load_lds_dwordx4 v1, s[56:57] offset:0 sc1
  s_add_u32 m0, s35, 0
  s_nop 0
  global_load_lds_dwordx4 v1, s[56:57] offset:1024 sc1
  s_add_u32 m0, s35, 0
  s_nop 0
  global_load_lds_dwordx4 v1, s[56:57] offset:2048 sc1
  s_add_u32 m0, s35, 0
  s_nop 0
  global_load_lds_dwordx4 v1, s[56:57] offset:3072 sc1
mk_c_sv1_got:
  s_waitcnt vmcnt(6)
  ds_write_b128 v1, v[16:19] offset:2048
  v_smfmac_f32_16x16x64_bf16 v[36:39], v[16:19], a[16:23], v112
  s_waitcnt vmcnt(5)
  ds_write_b128 v1, v[20:23] offset:3072
  v_smfmac_f32_16x16x64_bf16 v[40:43], v[16:19], a[72:79], v112
  v_max3_u32 v119, v16, v17, v18
  v_smfmac_f32_16x16x64_bf16 v[44:47], v[16:19], a[128:135], v112
  v_max3_u32 v119, v119, v19, v20
  v_smfmac_f32_16x16x64_bf16 v[48:51], v[16:19], a[184:191], v112
  v_max3_u32 v119, v119, v21, v22
  v_smfmac_f32_16x16x64_bf16 v[52:55], v[16:19], a[240:247], v112
  v_max_u32 v119, v119, v23
  v_smfmac_f32_16x16x64_bf16 v[56:59], v[16:19], v[160:167], v112
  v_cmp_eq_u32 vcc, -1, v119
  v_smfmac_f32_16x16x64_bf16 v[60:63], v[16:19], v[216:223], v112
  s_cbranch_vccnz mk_c_sv1_redo
mk_c_sv1_cont:
  v_smfmac_f32_16x16x64_bf16 v[36:39], v[20:23], a[24:31], v112
  v_smfmac_f32_16x16x64_bf16 v[40:43], v[20:23], a[80:87], v112
  s_add_u32 m0, s35, 4096
  s_nop 0
  global_load_lds_dwordx4 v3, s[56:57] offset:0 sc1
  v_smfmac_f32_16x16x64_bf16 v[44:47], v[20:23], a[136:143], v112
  s_add_u32 m0, s35, 4096
  s_nop 0
  global_load_lds_dwordx4 v3, s[56:57] offset:1024 sc1
  v_smfmac_f32_16x16x64_bf16 v[48:51], v[20:23], a[192:199], v112
  s_add_u32 m0, s35, 4096
  s_nop 0
  global_load_lds_dwordx4 v3, s[56:57] offset:2048 sc1
  v_smfmac_f32_16x16x64_bf16 v[52:55], v[20:23], a[248:255], v112
  s_add_u32 m0, s35, 4096
  s_nop 0
  global_load_lds_dwordx4 v3, s[56:57] offset:3072 sc1
  s_waitcnt vmcnt(8)
  v_max3_u32 v119, v24, v25, v26
  v_smfmac_f32_16x16x64_bf16 v[56:59], v[20:23], v[168:175], v112
  global_store_dword v102, v104, s[10:11] sc1
  s_mov_b64 exec, 15
  global_store_dword v0, v104, s[10:11] sc1
  s_mov_b64 exec, -1
  v_max_u32 v119, v119, v27
  v_smfmac_f32_16x16x64_bf16 v[60:63], v[20:23], v[224:231], v112
  v_cmp_eq_u32 vcc, -1, v119
  s_waitcnt lgkmcnt(0)
  s_barrier
  s_nop 0
  s_cbranch_vccnz mk_c_sv1_fix2
mk_c_sv1_fix2r:
  ds_read_b128 v[8:11], v1 offset:0
  ds_read_b128 v[12:15], v1 offset:1024
  ds_read_b128 v[28:31], v1 offset:5120
  ds_read_b128 v[32:35], v1 offset:6144
  ds_read_b128 v[68:71], v113 offset:4096
  ds_read_b128 v[72:75], v113 offset:5120
  ds_read_b128 v[76:79], v113 offset:6144
  ds_read_b128 v[80:83], v113 offset:7168
  v_smfmac_f32_16x16x64_bf16 v[36:39], v[24:27], a[32:39], v112
  v_smfmac_f32_16x16x64_bf16 v[40:43], v[24:27], a[88:95], v112
  v_smfmac_f32_16x16x64_bf16 v[44:47], v[24:27], a[144:151], v112
  v_smfmac_f32_16x16x64_bf16 v[48:51], v[24:27], a[200:207], v112
  v_smfmac_f32_16x16x64_bf16 v[52:55], v[24:27], v[120:127], v112
  v_smfmac_f32_16x16x64_bf16 v[56:59], v[24:27], v[176:183], v112
  v_smfmac_f32_16x16x64_bf16 v[60:63], v[24:27], v[232:239], v112
  s_add_u32 s56, s56, 458752
  s_addc_u32 s57, s57, 0
  s_xor_b32 s35, s35, 0x38000
  s_waitcnt lgkmcnt(7)
  v_smfmac_f32_16x16x64_bf16 v[36:39], v[8:11], a[0:7], v112
  s_waitcnt lgkmcnt(6)
  v_smfmac_f32_16x16x64_bf16 v[36:39], v[12:15], a[8:15], v112
  s_waitcnt lgkmcnt(5)
  v_smfmac_f32_16x16x64_bf16 v[36:39], v[28:31], a[40:47], v112
  s_waitcnt lgkmcnt(4)
  v_smfmac_f32_16x16x64_bf16 v[36:39], v[32:35], a[48:55], v112
  s_waitcnt lgkmcnt(2)
  v_smfmac_f32_16x16x64_bf16 v[64:67], v[16:19], v[68:75], v112
  ds_read_b128 v[68:71], v113 offset:8192
  ds_read_b128 v[72:75], v113 offset:9216
  v_smfmac_f32_16x16x64_bf16 v[40:43], v[8:11], a[56:63], v112
  v_smfmac_f32_16x16x64_bf16 v[40:43], v[12:15], a[64:71], v112
  v_add_f32 v36, v36, v37
  v_smfmac_f32_16x16x64_bf16 v[40:43], v[28:31], a[96:103], v112
  v_add_f32 v38, v38, v39
  v_smfmac_f32_16x16x64_bf16 v[40:43], v[32:35], a[104:111], v112
  v_cvt_pk_bf16_f32 v96, v36, v38
  s_waitcnt lgkmcnt(2)
  v_smfmac_f32_16x16x64_bf16 v[64:67], v[20:23], v[76:83], v112
  ds_read_b128 v[76:79], v113 offset:0
  ds_read_b128 v[80:83], v113 offset:1024
  ds_write_b32 v114, v96 offset:0
  v_smfmac_f32_16x16x64_bf16 v[44:47], v[8:11], a[112:119], v112
  v_smfmac_f32_16x16x64_bf16 v[44:47], v[12:15], a[120:127], v112
  v_add_f32 v40, v40, v41
  v_smfmac_f32_16x16x64_bf16 v[44:47], v[28:31], a[152:159], v112
  v_add_f32 v42, v42, v43
  v_smfmac_f32_16x16x64_bf16 v[44:47], v[32:35], a[160:167], v112
  v_cvt_pk_bf16_f32 v97, v40, v42
  s_waitcnt lgkmcnt(3)
  v_smfmac_f32_16x16x64_bf16 v[64:67], v[24:27], v[68:75], v112
  ds_read_b128 v[68:71], v113 offset:2048
  ds_read_b128 v[72:75], v113 offset:3072
  ds_write_b32 v114, v97 offset:4096
  v_smfmac_f32_16x16x64_bf16 v[48:51], v[8:11], a[168:175], v112
  v_smfmac_f32_16x16x64_bf16 v[48:51], v[12:15], a[176:183], v112
  v_add_f32 v44, v44, v45
  v_smfmac_f32_16x16x64_bf16 v[48:51], v[28:31], a[208:215], v112
  v_add_f32 v46, v46, v47
  v_smfmac_f32_16x16x64_bf16 v[48:51], v[32:35], a[216:223], v112
  v_cvt_pk_bf16_f32 v98, v44, v46
  s_waitcnt lgkmcnt(4)
  v_smfmac_f32_16x16x64_bf16 v[64:67], v[8:11], v[76:83], v112
  ds_read_b128 v[76:79], v113 offset:10240
  ds_read_b128 v[80:83], v113 offset:11264
  ds_write_b32 v114, v98 offset:4
  v_smfmac_f32_16x16x64_bf16 v[52:55], v[8:11], a[224:231], v112
  v_smfmac_f32_16x16x64_bf16 v[52:55], v[12:15], a[232:239], v112
  v_add_f32 v48, v48, v49
  v_smfmac_f32_16x16x64_bf16 v[52:55], v[28:31], v[128:135], v112
  v_add_f32 v50, v50, v51
  v_smfmac_f32_16x16x64_bf16 v[52:55], v[32:35], v[136:143], v112
  v_cvt_pk_bf16_f32 v99, v48, v50
  s_waitcnt lgkmcnt(4)
  v_smfmac_f32_16x16x64_bf16 v[64:67], v[12:15], v[68:75], v112
  ds_read_b128 v[68:71], v113 offset:12288
  ds_read_b128 v[72:75], v113 offset:13312
  ds_write_b32 v114, v99 offset:4100
  v_smfmac_f32_16x16x64_bf16 v[56:59], v[8:11], v[144:151], v112
  v_smfmac_f32_16x16x64_bf16 v[56:59], v[12:15], v[152:159], v112
  v_add_f32 v52, v52, v53
  v_smfmac_f32_16x16x64_bf16 v[56:59], v[28:31], v[184:191], v112
  v_add_f32 v54, v54, v55
  v_smfmac_f32_16x16x64_bf16 v[56:59], v[32:35], v[192:199], v112
  v_cvt_pk_bf16_f32 v96, v52, v54
  s_waitcnt lgkmcnt(4)
  v_smfmac_f32_16x16x64_bf16 v[64:67], v[28:31], v[76:83], v112
  ds_write_b32 v114, v96 offset:512
  v_smfmac_f32_16x16x64_bf16 v[60:63], v[8:11], v[200:207], v112
  v_smfmac_f32_16x16x64_bf16 v[60:63], v[12:15], v[208:215], v112
  v_add_f32 v56, v56, v57
  v_smfmac_f32_16x16x64_bf16 v[60:63], v[28:31], v[240:247], v112
  v_add_f32 v58, v58, v59
  v_smfmac_f32_16x16x64_bf16 v[60:63], v[32:35], v[248:255], v112
  v_cvt_pk_bf16_f32 v97, v56, v58
  s_waitcnt lgkmcnt(2)
  v_smfmac_f32_16x16x64_bf16 v[64:67], v[32:35], v[68:75], v112
  ds_write_b32 v114, v97 offset:4608
  s_nop 2
  v_add_f32 v60, v60, v61
  v_add_f32 v62, v62, v63
  v_cvt_pk_bf16_f32 v98, v60, v62
  ds_write_b32 v114, v98 offset:516
  v_add_f32 v64, v64, v65
  v_add_f32 v66, v66, v67
  v_cvt_pk_bf16_f32 v99, v64, v66
  ds_write_b32 v114, v99 offset:4612
  s_waitcnt lgkmcnt(0)
  s_barrier
  ds_read_b128 v[64:67], v100 offset:0
  ds_read_b128 v[68:71], v100 offset:1024
  ds_read_b128 v[72:75], v100 offset:2048
  ds_read_b128 v[76:79], v100 offset:3072
  ds_read_b128 v[80:83], v100 offset:4096
  ds_read_b128 v[84:87], v100 offset:5120
  ds_read_b128 v[88:91], v100 offset:6144
  ds_read_b128 v[92:95], v100 offset:7168
  ds_read_b128 v[48:51], v101 offset:0
  ds_read_b128 v[52:55], v101 offset:1024
  ds_read_b128 v[56:59], v101 offset:2048
  ds_read_b128 v[60:63], v101 offset:3072
  global_load_dword v108, v2, s[46:47] sc1
  s_nop 12
  global_load_dword v109, v2, s[46:47] sc1
  s_nop 12
  global_load_dword v110, v2, s[46:47] sc1
  s_nop 12
  global_load_dword v111, v2, s[46:47] sc1
  s_nop 12
  global_load_dword v116, v2, s[46:47] sc1
  s_nop 12
mk_c_sv1_fp_42:
  global_load_dword v117, v2, s[46:47] sc1
  s_waitcnt vmcnt(5)
  v_cmp_eq_u32 vcc, -1, v108
  s_cbranch_vccz mk_c_sv1_fd_43
  global_load_dword v108, v2, s[46:47] sc1
  s_waitcnt vmcnt(5)
  v_cmp_eq_u32 vcc, -1, v109
  s_cbranch_vccz mk_c_sv1_fd_43
  global_load_dword v109, v2, s[46:47] sc1
  s_waitcnt vmcnt(5)
  v_cmp_eq_u32 vcc, -1, v110
  s_cbranch_vccz mk_c_sv1_fd_43
  global_load_dword v110, v2, s[46:47] sc1
  s_waitcnt vmcnt(5)
  v_cmp_eq_u32 vcc, -1, v111
  s_cbranch_vccz mk_c_sv1_fd_43
  global_load_dword v111, v2, s[46:47] sc1
  s_waitcnt vmcnt(5)
  v_cmp_eq_u32 vcc, -1, v116
  s_cbranch_vccz mk_c_sv1_fd_43
  global_load_dword v116, v2, s[46:47] sc1
  s_waitcnt vmcnt(5)
  v_cmp_eq_u32 vcc, -1, v117
  s_cbranch_vccz mk_c_sv1_fd_43
  s_sub_u32 s40, s40, 1
  s_cbranch_scc0 mk_c_sv1_fp_42
  s_mov_b32 s40, 0
mk_c_sv1_fd_43:
  s_nop 3
mk_c_sv1_pld:
  global_load_dwordx4 v[40:43], v4, s[46:47] offset:0 sc1
  global_load_dwordx4 v[44:47], v4, s[46:47] offset:1024 sc1
  global_load_dwordx4 v[8:11], v1, s[46:47] offset:0 sc1
  global_load_dwordx4 v[12:15], v1, s[46:47] offset:1024 sc1
  global_load_dwordx4 v[16:19], v1, s[46:47] offset:2048 sc1
  global_load_dwordx4 v[20:23], v1, s[46:47] offset:3072 sc1
  global_load_dwordx4 v[24:27], v3, s[46:47] offset:0 sc1
  global_load_dwordx4 v[28:31], v3, s[46:47] offset:1024 sc1
  global_load_dwordx4 v[32:35], v3, s[46:47] offset:2048 sc1
  global_load_dwordx4 v[36:39], v3, s[46:47] offset:3072 sc1
  v_mov_b32 v96, 0
  v_mov_b32 v97, 0
  v_mov_b32 v98, 0
  v_mov_b32 v99, 0
  s_mov_b64 s[10:11], s[46:47]
  s_waitcnt lgkmcnt(0)
  s_waitcnt vmcnt(9)
  v_smfmac_f32_16x16x64_bf16 v[96:99], v[40:43], v[48:55], v112
  v_max3_u32 v119, v40, v41, v42
  s_waitcnt vmcnt(8)
  v_smfmac_f32_16x16x64_bf16 v[96:99], v[44:47], v[56:63], v112
  v_max3_u32 v119, v119, v43, v44
  v_max3_u32 v119, v119, v45, v46
  v_max_u32 v119, v119, v47
  v_cmp_eq_u32 vcc, -1, v119
  s_cbranch_vccnz mk_c_sv1_pre
mk_c_sv1_pgo:
  s_waitcnt vmcnt(7)
  v_smfmac_f32_16x16x64_bf16 v[96:99], v[8:11], v[64:71], v112
  ds_read_b128 v[64:67], v100 offset:8192
  ds_read_b128 v[68:71], v100 offset:9216
  s_waitcnt vmcnt(6)
  v_smfmac_f32_16x16x64_bf16 v[96:99], v[12:15], v[72:79], v112
  s_mov_b64 exec, 15
  global_store_dword v0, v112, s[50:51] sc1
  s_mov_b64 exec, -1
  ds_read_b128 v[72:75], v100 offset:10240
  ds_read_b128 v[76:79], v100 offset:11264
  s_waitcnt vmcnt(6)
  v_smfmac_f32_16x16x64_bf16 v[96:99], v[16:19], v[80:87], v112
  ds_read_b128 v[80:83], v100 offset:12288
  ds_read_b128 v[84:87], v100 offset:13312
  s_waitcnt vmcnt(5)
  v_smfmac_f32_16x16x64_bf16 v[96:99], v[20:23], v[88:95], v112
  ds_read_b128 v[88:91], v100 offset:14336
  ds_read_b128 v[92:95], v100 offset:15360
  s_waitcnt vmcnt(4) lgkmcnt(6)
  v_smfmac_f32_16x16x64_bf16 v[96:99], v[24:27], v[64:71], v112
  s_waitcnt vmcnt(3) lgkmcnt(4)
  v_smfmac_f32_16x16x64_bf16 v[96:99], v[28:31], v[72:79], v112
  s_waitcnt vmcnt(2) lgkmcnt(2)
  v_smfmac_f32_16x16x64_bf16 v[96:99], v[32:35], v[80:87], v112
  s_waitcnt vmcnt(1) lgkmcnt(0)
  v_smfmac_f32_16x16x64_bf16 v[96:99], v[36:39], v[88:95], v112
  s_nop 7
  v_add_f32 v96, v96, v97
  v_add_f32 v98, v98, v99
  v_cmp_u_f32 vcc, v96, v98
  v_cvt_pk_bf16_f32 v96, v96, v98
  s_cbranch_vccnz mk_c_sv1_pnan
mk_c_sv1_pfin:
  s_nop 0
  v_mov_b32_dpp v97, v96 quad_perm:[1,0,3,2] row_mask:0xf bank_mask:0xf
  v_perm_b32 v96, v96, v97, v103
  global_store_dword v102, v96, s[50:51] sc1
  s_cmp_lg_u32 s36, 62
  s_cbranch_scc1 mk_c_sv1_nopv
  s_add_u32 s30, s4, 17218560
  s_addc_u32 s31, s5, 0
  global_store_dword v102, v96, s[30:31] sc1
mk_c_sv1_nopv:
  s_mov_b64 s[48:49], s[46:47]
  s_mov_b64 s[46:47], s[50:51]
  s_add_u32 s44, s46, 10240
  s_addc_u32 s45, s47, 0
  s_add_u32 s36, s36, 1
  s_cmp_lt_u32 s36, 63
  s_cbranch_scc1 mk_c_sv1_loop
  s_branch mk_c_done
mk_c_sv1_entry:
  s_branch mk_c_sv1_mem
mk_c_sv1_fix2:
  ds_read_b128 v[24:27], v1 offset:4096
  s_waitcnt lgkmcnt(0)
  s_branch mk_c_sv1_fix2r
mk_c_sv1_redo:
  s_nop 7
  s_sub_u32 s40, s40, 1
  s_cbranch_scc1 mk_c_sv1_giveup
  s_waitcnt lgkmcnt(0)
  global_load_dwordx4 v[16:19], v5, s[44:45] sc1
  global_load_dwordx4 v[20:23], v6, s[44:45] sc1
  global_load_dwordx4 v[24:27], v7, s[44:45] sc1
  s_nop 7
  v_mov_b32 v36, 0
  v_mov_b32 v37, 0
  v_mov_b32 v38, 0
  v_mov_b32 v39, 0
  v_mov_b32 v40, 0
  v_mov_b32 v41, 0
  v_mov_b32 v42, 0
  v_mov_b32 v43, 0
  v_mov_b32 v44, 0
  v_mov_b32 v45, 0
  v_mov_b32 v46, 0
  v_mov_b32 v47, 0
  v_mov_b32 v48, 0
  v_mov_b32 v49, 0
  v_mov_b32 v50, 0
  v_mov_b32 v51, 0
  v_mov_b32 v52, 0
  v_mov_b32 v53, 0
  v_mov_b32 v54, 0
  v_mov_b32 v55, 0
  v_mov_b32 v56, 0
  v_mov_b32 v57, 0
  v_mov_b32 v58, 0
  v_mov_b32 v59, 0
  v_mov_b32 v60, 0
  v_mov_b32 v61, 0
  v_mov_b32 v62, 0
  v_mov_b32 v63, 0
  v_mov_b32 v64, 0
  v_mov_b32 v65, 0
  v_mov_b32 v66, 0
  v_mov_b32 v67, 0
  s_waitcnt vmcnt(0)
  s_branch mk_c_sv1_got
mk_c_sv1_giveup:
  s_mov_b32 s40, 0
  s_branch mk_c_sv1_cont
mk_c_sv1_pre:
  s_nop 7
  s_sub_u32 s40, s40, 1
  s_cbranch_scc0 mk_c_sv1_pld
  s_mov_b32 s40, 0
  s_branch mk_c_sv1_pgo
mk_c_sv1_pnan:
  v_max3_u32 v119, v8, v9, v10
  v_max3_u32 v119, v119, v11, v12
  v_max3_u32 v119, v119, v13, v14
  v_max3_u32 v119, v119, v15, v16
  v_max3_u32 v119, v119, v17, v18
  v_max3_u32 v119, v119, v19, v20
  v_max3_u32 v119, v119, v21, v22
  v_max3_u32 v119, v119, v23, v24
  v_max3_u32 v119, v119, v25, v26
  v_max3_u32 v119, v119, v27, v28
  v_max3_u32 v119, v119, v29, v30
  v_max3_u32 v119, v119, v31, v32
  v_max3_u32 v119, v119, v33, v34
  v_max3_u32 v119, v119, v35, v36
  v_max3_u32 v119, v119, v37, v38
  v_max3_u32 v119, v119, v39, v40
  v_max3_u32 v119, v119, v41, v42
  v_max3_u32 v119, v119, v43, v44
  v_max3_u32 v119, v119, v45, v46
  v_max_u32 v119, v119, v47
  v_cmp_eq_u32 vcc, -1, v119
  s_cbranch_vccz mk_c_sv1_pfin
  s_sub_u32 s40, s40, 1
  s_cbranch_scc1 mk_c_sv1_pgive
  ds_read_b128 v[64:67], v100 offset:0
  ds_read_b128 v[68:71], v100 offset:1024
  ds_read_b128 v[72:75], v100 offset:2048
  ds_read_b128 v[76:79], v100 offset:3072
  ds_read_b128 v[80:83], v100 offset:4096
  ds_read_b128 v[84:87], v100 offset:5120
  ds_read_b128 v[88:91], v100 offset:6144
  ds_read_b128 v[92:95], v100 offset:7168
  s_branch mk_c_sv1_pld
mk_c_sv1_pgive:
  s_mov_b32 s40, 0
  s_branch mk_c_sv1_pfin
mk_c_sv2_loop:
  global_load_dword v96, v2, s[46:47] sc1
  s_nop 11
  global_load_dword v97, v2, s[46:47] sc1
  s_nop 11
  global_load_dword v98, v2, s[46:47] sc1
  s_nop 11
  global_load_dword v99, v2, s[46:47] sc1
  s_nop 11
mk_c_sv2_fp_44:
  global_load_dword v117, v2, s[46:47] sc1
  s_waitcnt vmcnt(4)
  v_cmp_eq_u32 vcc, -1, v96
  s_cbranch_vccz mk_c_sv2_fd_45
  global_load_dword v96, v2, s[46:47] sc1
  s_waitcnt vmcnt(4)
  v_cmp_eq_u32 vcc, -1, v97
  s_cbranch_vccz mk_c_sv2_fd_45
  global_load_dword v97, v2, s[46:47] sc1
  s_waitcnt vmcnt(4)
  v_cmp_eq_u32 vcc, -1, v98
  s_cbranch_vccz mk_c_sv2_fd_45
  global_load_dword v98, v2, s[46:47] sc1
  s_waitcnt vmcnt(4)
  v_cmp_eq_u32 vcc, -1, v99
  s_cbranch_vccz mk_c_sv2_fd_45
  global_load_dword v99, v2, s[46:47] sc1
  s_waitcnt vmcnt(4)
  v_cmp_eq_u32 vcc, -1, v117
  s_cbranch_vccz mk_c_sv2_fd_45
  s_sub_u32 s40, s40, 1
  s_cbranch_scc0 mk_c_sv2_fp_44
  s_mov_b32 s40, 0
mk_c_sv2_fd_45:
  s_barrier
mk_c_sv2_mem:
  global_load_dwordx4 v[24:27], v5, s[44:45] sc1
  s_nop 3
  global_load_dwordx4 v[28:31], v6, s[44:45] sc1
  s_nop 3
  global_load_dwordx4 v[32:35], v7, s[44:45] sc1
  s_barrier
  s_add_u32 m0, s35, 0
  s_nop 0
  global_load_lds_dwordx4 v1, s[56:57] offset:0 sc1
  s_add_u32 m0, s35, 0
  s_nop 0
  global_load_lds_dwordx4 v1, s[56:57] offset:1024 sc1
  s_add_u32 m0, s35, 0
  s_nop 0
  global_load_lds_dwordx4 v1, s[56:57] offset:2048 sc1
  s_add_u32 m0, s35, 0
  s_nop 0
  global_load_lds_dwordx4 v1, s[56:57] offset:3072 sc1
mk_c_sv2_got:
  s_waitcnt vmcnt(6)
  ds_write_b128 v1, v[24:27] offset:4096
  v_smfmac_f32_16x16x64_bf16 v[36:39], v[24:27], a[32:39], v112
  s_waitcnt vmcnt(5)
  ds_write_b128 v1, v[28:31] offset:5120
  v_smfmac_f32_16x16x64_bf16 v[40:43], v[24:27], a[88:95], v112
  v_max3_u32 v119, v24, v25, v26
  v_smfmac_f32_16x16x64_bf16 v[44:47], v[24:27], a[144:151], v112
  v_max3_u32 v119, v119, v27, v28
  v_smfmac_f32_16x16x64_bf16 v[48:51], v[24:27], a[200:207], v112
  v_max3_u32 v119, v119, v29, v30
  v_smfmac_f32_16x16x64_bf16 v[52:55], v[24:27], v[120:127], v112
  v_max_u32 v119, v119, v31
  v_smfmac_f32_16x16x64_bf16 v[56:59], v[24:27], v[176:183], v112
  v_cmp_eq_u32 vcc, -1, v119
  v_smfmac_f32_16x16x64_bf16 v[60:63], v[24:27], v[232:239], v112
  s_cbranch_vccnz mk_c_sv2_redo
mk_c_sv2_cont:
  v_smfmac_f32_16x16x64_bf16 v[36:39], v[28:31], a[40:47], v112
  v_smfmac_f32_16x16x64_bf16 v[40:43], v[28:31], a[96:103], v112
  s_add_u32 m0, s35, 4096
  s_nop 0
  global_load_lds_dwordx4 v3, s[56:57] offset:0 sc1
  v_smfmac_f32_16x16x64_bf16 v[44:47], v[28:31], a[152:159], v112
  s_add_u32 m0, s35, 4096
  s_nop 0
  global_load_lds_dwordx4 v3, s[56:57] offset:1024 sc1
  v_smfmac_f32_16x16x64_bf16 v[48:51], v[28:31], a[208:215], v112
  s_add_u32 m0, s35, 4096
  s_nop 0
  global_load_lds_dwordx4 v3, s[56:57] offset:2048 sc1
  v_smfmac_f32_16x16x64_bf16 v[52:55], v[28:31], v[128:135], v112
  s_add_u32 m0, s35, 4096
  s_nop 0
  global_load_lds_dwordx4 v3, s[56:57] offset:3072 sc1
  s_waitcnt vmcnt(8)
  v_max3_u32 v119, v32, v33, v34
  v_smfmac_f32_16x16x64_bf16 v[56:59], v[28:31], v[184:191], v112
  v_max_u32 v119, v119, v35
  v_smfmac_f32_16x16x64_bf16 v[60:63], v[28:31], v[240:247], v112
  v_cmp_eq_u32 vcc, -1, v119
  s_waitcnt lgkmcnt(0)
  s_barrier
  s_nop 0
  s_cbranch_vccnz mk_c_sv2_fix2
mk_c_sv2_fix2r:
  ds_read_b128 v[8:11], v1 offset:0
  ds_read_b128 v[12:15], v1 offset:1024
  ds_read_b128 v[16:19], v1 offset:2048
  ds_read_b128 v[20:23], v1 offset:3072
  ds_read_b128 v[68:71], v113 offset:8192
  ds_read_b128 v[72:75], v113 offset:9216
  ds_read_b128 v[76:79], v113 offset:10240
  ds_read_b128 v[80:83], v113 offset:11264
  v_smfmac_f32_16x16x64_bf16 v[36:39], v[32:35], a[48:55], v112
  v_smfmac_f32_16x16x64_bf16 v[40:43], v[32:35], a[104:111], v112
  v_smfmac_f32_16x16x64_bf16 v[44:47], v[32:35], a[160:167], v112
  v_smfmac_f32_16x16x64_bf16 v[48:51], v[32:35], a[216:223], v112
  v_smfmac_f32_16x16x64_bf16 v[52:55], v[32:35], v[136:143], v112
  v_smfmac_f32_16x16x64_bf16 v[56:59], v[32:35], v[192:199], v112
  v_smfmac_f32_16x16x64_bf16 v[60:63], v[32:35], v[248:255], v112
  s_add_u32 s56, s56, 458752
  s_addc_u32 s57, s57, 0
  s_xor_b32 s35, s35, 0x38000
  s_waitcnt lgkmcnt(7)
  v_smfmac_f32_16x16x64_bf16 v[36:39], v[8:11], a[0:7], v112
  s_waitcnt lgkmcnt(6)
  v_smfmac_f32_16x16x64_bf16 v[36:39], v[12:15], a[8:15], v112
  s_waitcnt lgkmcnt(5)
  v_smfmac_f32_16x16x64_bf16 v[36:39], v[16:19], a[16:23], v112
  s_waitcnt lgkmcnt(4)
  v_smfmac_f32_16x16x64_bf16 v[36:39], v[20:23], a[24:31], v112
  s_waitcnt lgkmcnt(2)
  v_smfmac_f32_16x16x64_bf16 v[64:67], v[24:27], v[68:75], v112
  ds_read_b128 v[68:71], v113 offset:12288
  ds_read_b128 v[72:75], v113 offset:13312
  v_smfmac_f32_16x16x64_bf16 v[40:43], v[8:11], a[56:63], v112
  v_smfmac_f32_16x16x64_bf16 v[40:43], v[12:15], a[64:71], v112
  v_add_f32 v36, v36, v37
  v_smfmac_f32_16x16x64_bf16 v[40:43], v[16:19], a[72:79], v112
  v_add_f32 v38, v38, v39
  v_smfmac_f32_16x16x64_bf16 v[40:43], v[20:23], a[80:87], v112
  v_cvt_pk_bf16_f32 v96, v36, v38
  s_waitcnt lgkmcnt(2)
  v_smfmac_f32_16x16x64_bf16 v[64:67], v[28:31], v[76:83], v112
  ds_read_b128 v[76:79], v113 offset:0
  ds_read_b128 v[80:83], v113 offset:1024
  ds_write_b32 v114, v96 offset:0
  v_smfmac_f32_16x16x64_bf16 v[44:47], v[8:11], a[112:119], v112
  v_smfmac_f32_16x16x64_bf16 v[44:47], v[12:15], a[120:127], v112
  v_add_f32 v40, v40, v41
  v_smfmac_f32_16x16x64_bf16 v[44:47], v[16:19], a[128:135], v112
  v_add_f32 v42, v42, v43
  v_smfmac_f32_16x16x64_bf16 v[44:47], v[20:23], a[136:143], v112
  v_cvt_pk_bf16_f32 v97, v40, v42
  s_waitcnt lgkmcnt(3)
  v_smfmac_f32_16x16x64_bf16 v[64:67], v[32:35], v[68:75], v112
  ds_read_b128 v[68:71], v113 offset:2048
  ds_read_b128 v[72:75], v113 offset:3072
  ds_write_b32 v114, v97 offset:4096
  v_smfmac_f32_16x16x64_bf16 v[48:51], v[8:11], a[168:175], v112
  v_smfmac_f32_16x16x64_bf16 v[48:51], v[12:15], a[176:183], v112
  v_add_f32 v44, v44, v45
  v_smfmac_f32_16x16x64_bf16 v[48:51], v[16:19], a[184:191], v112
  v_add_f32 v46, v46, v47
  v_smfmac_f32_16x16x64_bf16 v[48:51], v[20:23], a[192:199], v112
  v_cvt_pk_bf16_f32 v98, v44, v46
  s_waitcnt lgkmcnt(4)
  v_smfmac_f32_16x16x64_bf16 v[64:67], v[8:11], v[76:83], v112
  ds_read_b128 v[76:79], v113 offset:4096
  ds_read_b128 v[80:83], v113 offset:5120
  ds_write_b32 v114, v98 offset:4
  v_smfmac_f32_16x16x64_bf16 v[52:55], v[8:11], a[224:231], v112
  v_smfmac_f32_16x16x64_bf16 v[52:55], v[12:15], a[232:239], v112
  v_add_f32 v48, v48, v49
  v_smfmac_f32_16x16x64_bf16 v[52:55], v[16:19], a[240:247], v112
  v_add_f32 v50, v50, v51
  v_smfmac_f32_16x16x64_bf16 v[52:55], v[20:23], a[248:255], v112
  v_cvt_pk_bf16_f32 v99, v48, v50
  s_waitcnt lgkmcnt(4)
  v_smfmac_f32_16x16x64_bf16 v[64:67], v[12:15], v[68:75], v112
  ds_read_b128 v[68:71], v113 offset:6144
  ds_read_b128 v[72:75], v113 offset:7168
  ds_write_b32 v114, v99 offset:4100
  v_smfmac_f32_16x16x64_bf16 v[56:59], v[8:11], v[144:151], v112
  v_smfmac_f32_16x16x64_bf16 v[56:59], v[12:15], v[152:159], v112
  v_add_f32 v52, v52, v53
  v_smfmac_f32_16x16x64_bf16 v[56:59], v[16:19], v[160:167], v112
  v_add_f32 v54, v54, v55
  v_smfmac_f32_16x16x64_bf16 v[56:59], v[20:23], v[168:175], v112
  v_cvt_pk_bf16_f32 v96, v52, v54
  s_waitcnt lgkmcnt(4)
  v_smfmac_f32_16x16x64_bf16 v[64:67], v[16:19], v[76:83], v112
  ds_write_b32 v114, v96 offset:512
  v_smfmac_f32_16x16x64_bf16 v[60:63], v[8:11], v[200:207], v112
  v_smfmac_f32_16x16x64_bf16 v[60:63], v[12:15], v[208:215], v112
  v_add_f32 v56, v56, v57
  v_smfmac_f32_16x16x64_bf16 v[60:63], v[16:19], v[216:223], v112
  v_add_f32 v58, v58, v59
  v_smfmac_f32_16x16x64_bf16 v[60:63], v[20:23], v[224:231], v112
  v_cvt_pk_bf16_f32 v97, v56, v58
  s_waitcnt lgkmcnt(2)
  v_smfmac_f32_16x16x64_bf16 v[64:67], v[20:23], v[68:75], v112
  ds_write_b32 v114, v97 offset:4608
  s_nop 2
  v_add_f32 v60, v60, v61
  v_add_f32 v62, v62, v63
  v_cvt_pk_bf16_f32 v98, v60, v62
  ds_write_b32 v114, v98 offset:516
  v_add_f32 v64, v64, v65
  v_add_f32 v66, v66, v67
  v_cvt_pk_bf16_f32 v99, v64, v66
  ds_write_b32 v114, v99 offset:4612
  s_waitcnt lgkmcnt(0)
  s_barrier
  s_mov_b64 s[48:49], s[46:47]
  s_mov_b64 s[46:47], s[50:51]
  s_add_u32 s44, s46, 10240
  s_addc_u32 s45, s47, 0
  s_add_u32 s36, s36, 1
  s_add_u32 s30, s38, 15728640
  s_add_u32 s50, s4, s30
  s_addc_u32 s51, s5, 0
  s_add_u32 s38, s38, 147456
  s_cmp_eq_u32 s38, 589824
  s_cselect_b32 s38, 0, s38
  v_mov_b32 v36, 0
  v_mov_b32 v37, 0
  v_mov_b32 v38, 0
  v_mov_b32 v39, 0
  v_mov_b32 v40, 0
  v_mov_b32 v41, 0
  v_mov_b32 v42, 0
  v_mov_b32 v43, 0
  v_mov_b32 v44, 0
  v_mov_b32 v45, 0
  v_mov_b32 v46, 0
  v_mov_b32 v47, 0
  v_mov_b32 v48, 0
  v_mov_b32 v49, 0
  v_mov_b32 v50, 0
  v_mov_b32 v51, 0
  v_mov_b32 v52, 0
  v_mov_b32 v53, 0
  v_mov_b32 v54, 0
  v_mov_b32 v55, 0
  v_mov_b32 v56, 0
  v_mov_b32 v57, 0
  v_mov_b32 v58, 0
  v_mov_b32 v59, 0
  v_mov_b32 v60, 0
  v_mov_b32 v61, 0
  v_mov_b32 v62, 0
  v_mov_b32 v63, 0
  v_mov_b32 v64, 0
  v_mov_b32 v65, 0
  v_mov_b32 v66, 0
  v_mov_b32 v67, 0
  s_cmp_lt_u32 s36, 63
  s_cbranch_scc1 mk_c_sv2_loop
  s_branch mk_c_done
mk_c_sv2_entry:
  s_branch mk_c_sv2_mem
mk_c_sv2_fix2:
  ds_read_b128 v[32:35], v1 offset:6144
  s_waitcnt lgkmcnt(0)
  s_branch mk_c_sv2_fix2r
mk_c_sv2_redo:
  s_nop 7
  s_sub_u32 s40, s40, 1
  s_cbranch_scc1 mk_c_sv2_giveup
  s_waitcnt lgkmcnt(0)
  global_load_dwordx4 v[24:27], v5, s[44:45] sc1
  global_load_dwordx4 v[28:31], v6, s[44:45] sc1
  global_load_dwordx4 v[32:35], v7, s[44:45] sc1
  s_nop 7
  v_mov_b32 v36, 0
  v_mov_b32 v37, 0
  v_mov_b32 v38, 0
  v_mov_b32 v39, 0
  v_mov_b32 v40, 0
  v_mov_b32 v41, 0
  v_mov_b32 v42, 0
  v_mov_b32 v43, 0
  v_mov_b32 v44, 0
  v_mov_b32 v45, 0
  v_mov_b32 v46, 0
  v_mov_b32 v47, 0
  v_mov_b32 v48, 0
  v_mov_b32 v49, 0
  v_mov_b32 v50, 0
  v_mov_b32 v51, 0
  v_mov_b32 v52, 0
  v_mov_b32 v53, 0
  v_mov_b32 v54, 0
  v_mov_b32 v55, 0
  v_mov_b32 v56, 0
  v_mov_b32 v57, 0
  v_mov_b32 v58, 0
  v_mov_b32 v59, 0
  v_mov_b32 v60, 0
  v_mov_b32 v61, 0
  v_mov_b32 v62, 0
  v_mov_b32 v63, 0
  v_mov_b32 v64, 0
  v_mov_b32 v65, 0
  v_mov_b32 v66, 0
  v_mov_b32 v67, 0
  s_waitcnt vmcnt(0)
  s_branch mk_c_sv2_got
mk_c_sv2_giveup:
  s_mov_b32 s40, 0
  s_branch mk_c_sv2_cont
mk_c_sv3_loop:
  s_barrier
mk_c_sv3_mem:
  global_load_dwordx4 v[32:35], v5, s[44:45] sc1
  s_nop 3
  global_load_dwordx4 v[8:11], v6, s[44:45] sc1
  s_nop 3
  global_load_dwordx4 v[12:15], v7, s[44:45] sc1
  s_barrier
  s_add_u32 m0, s35, 0
  s_nop 0
  global_load_lds_dwordx4 v1, s[56:57] offset:0 sc1
  s_add_u32 m0, s35, 0
  s_nop 0
  global_load_lds_dwordx4 v1, s[56:57] offset:1024 sc1
  s_add_u32 m0, s35, 0
  s_nop 0
  global_load_lds_dwordx4 v1, s[56:57] offset:2048 sc1
  s_add_u32 m0, s35, 0
  s_nop 0
  global_load_lds_dwordx4 v1, s[56:57] offset:3072 sc1
mk_c_sv3_got:
  s_waitcnt vmcnt(6)
  ds_write_b128 v1, v[32:35] offset:6144
  v_smfmac_f32_16x16x64_bf16 v[36:39], v[32:35], a[48:55], v112
  s_waitcnt vmcnt(5)
  v_smfmac_f32_16x16x64_bf16 v[40:43], v[32:35], a[104:111], v112
  v_max3_u32 v119, v32, v33, v34
  v_smfmac_f32_16x16x64_bf16 v[44:47], v[32:35], a[160:167], v112
  v_max3_u32 v119, v119, v35, v8
  v_smfmac_f32_16x16x64_bf16 v[48:51], v[32:35], a[216:223], v112
  v_max3_u32 v119, v119, v9, v10
  v_smfmac_f32_16x16x64_bf16 v[52:55], v[32:35], v[136:143], v112
  v_max_u32 v119, v119, v11
  v_smfmac_f32_16x16x64_bf16 v[56:59], v[32:35], v[192:199], v112
  v_cmp_eq_u32 vcc, -1, v119
  v_smfmac_f32_16x16x64_bf16 v[60:63], v[32:35], v[248:255], v112
  s_cbranch_vccnz mk_c_sv3_redo
mk_c_sv3_cont:
  v_smfmac_f32_16x16x64_bf16 v[36:39], v[8:11], a[0:7], v112
  v_smfmac_f32_16x16x64_bf16 v[40:43], v[8:11], a[56:63], v112
  s_add_u32 m0, s35, 4096
  s_nop 0
  global_load_lds_dwordx4 v3, s[56:57] offset:0 sc1
  v_smfmac_f32_16x16x64_bf16 v[44:47], v[8:11], a[112:119], v112
  s_add_u32 m0, s35, 4096
  s_nop 0
  global_load_lds_dwordx4 v3, s[56:57] offset:1024 sc1
  v_smfmac_f32_16x16x64_bf16 v[48:51], v[8:11], a[168:175], v112
  s_add_u32 m0, s35, 4096
  s_nop 0
  global_load_lds_dwordx4 v3, s[56:57] offset:2048 sc1
  v_smfmac_f32_16x16x64_bf16 v[52:55], v[8:11], a[224:231], v112
  s_add_u32 m0, s35, 4096
  s_nop 0
  global_load_lds_dwordx4 v3, s[56:57] offset:3072 sc1
  s_waitcnt vmcnt(8)
  v_max3_u32 v119, v12, v13, v14
  v_smfmac_f32_16x16x64_bf16 v[56:59], v[8:11], v[144:151], v112
  v_max_u32 v119, v119, v15
  v_smfmac_f32_16x16x64_bf16 v[60:63], v[8:11], v[200:207], v112
  v_cmp_eq_u32 vcc, -1, v119
  s_waitcnt lgkmcnt(0)
  s_barrier
  s_nop 0
  s_cbranch_vccnz mk_c_sv3_fix2
mk_c_sv3_fix2r:
  ds_read_b128 v[16:19], v1 offset:2048
  ds_read_b128 v[20:23], v1 offset:3072
  ds_read_b128 v[24:27], v1 offset:4096
  ds_read_b128 v[28:31], v1 offset:5120
  ds_read_b128 v[68:71], v113 offset:12288
  ds_read_b128 v[72:75], v113 offset:13312
  ds_read_b128 v[76:79], v113 offset:0
  ds_read_b128 v[80:83], v113 offset:1024
  v_smfmac_f32_16x16x64_bf16 v[36:39], v[12:15], a[8:15], v112
  global_load_dword v116, v105, s[12:13] sc1
  v_smfmac_f32_16x16x64_bf16 v[40:43], v[12:15], a[64:71], v112
  v_smfmac_f32_16x16x64_bf16 v[44:47], v[12:15], a[120:127], v112
  v_smfmac_f32_16x16x64_bf16 v[48:51], v[12:15], a[176:183], v112
  v_smfmac_f32_16x16x64_bf16 v[52:55], v[12:15], a[232:239], v112
  v_smfmac_f32_16x16x64_bf16 v[56:59], v[12:15], v[152:159], v112
  v_smfmac_f32_16x16x64_bf16 v[60:63], v[12:15], v[208:215], v112
  s_add_u32 s56, s56, 458752
  s_addc_u32 s57, s57, 0
  s_xor_b32 s35, s35, 0x38000
  s_waitcnt lgkmcnt(7)
  v_smfmac_f32_16x16x64_bf16 v[36:39], v[16:19], a[16:23], v112
  s_waitcnt lgkmcnt(6)
  v_smfmac_f32_16x16x64_bf16 v[36:39], v[20:23], a[24:31], v112
  s_waitcnt lgkmcnt(5)
  v_smfmac_f32_16x16x64_bf16 v[36:39], v[24:27], a[32:39], v112
  s_waitcnt lgkmcnt(4)
  v_smfmac_f32_16x16x64_bf16 v[36:39], v[28:31], a[40:47], v112
  s_waitcnt lgkmcnt(2)
  v_smfmac_f32_16x16x64_bf16 v[64:67], v[32:35], v[68:75], v112
  ds_read_b128 v[68:71], v113 offset:2048
  ds_read_b128 v[72:75], v113 offset:3072
  v_smfmac_f32_16x16x64_bf16 v[40:43], v[16:19], a[72:79], v112
  v_smfmac_f32_16x16x64_bf16 v[40:43], v[20:23], a[80:87], v112
  v_add_f32 v36, v36, v37
  v_smfmac_f32_16x16x64_bf16 v[40:43], v[24:27], a[88:95], v112
  v_add_f32 v38, v38, v39
  v_smfmac_f32_16x16x64_bf16 v[40:43], v[28:31], a[96:103], v112
  v_cvt_pk_bf16_f32 v96, v36, v38
  s_waitcnt lgkmcnt(2)
  v_smfmac_f32_16x16x64_bf16 v[64:67], v[8:11], v[76:83], v112
  ds_read_b128 v[76:79], v113 offset:4096
  ds_read_b128 v[80:83], v113 offset:5120
  ds_write_b32 v114, v96 offset:0
  v_smfmac_f32_16x16x64_bf16 v[44:47], v[16:19], a[128:135], v112
  v_smfmac_f32_16x16x64_bf16 v[44:47], v[20:23], a[136:143], v112
  v_add_f32 v40, v40, v41
  v_smfmac_f32_16x16x64_bf16 v[44:47], v[24:27], a[144:151], v112
  v_add_f32 v42, v42, v43
  v_smfmac_f32_16x16x64_bf16 v[44:47], v[28:31], a[152:159], v112
  v_cvt_pk_bf16_f32 v97, v40, v42
  s_waitcnt lgkmcnt(3)
  v_smfmac_f32_16x16x64_bf16 v[64:67], v[12:15], v[68:75], v112
  ds_read_b128 v[68:71], v113 offset:6144
  ds_read_b128 v[72:75], v113 offset:7168
  ds_write_b32 v114, v97 offset:4096
  v_smfmac_f32_16x16x64_bf16 v[48:51], v[16:19], a[184:191], v112
  v_smfmac_f32_16x16x64_bf16 v[48:51], v[20:23], a[192:199], v112
  v_add_f32 v44, v44, v45
  v_smfmac_f32_16x16x64_bf16 v[48:51], v[24:27], a[200:207], v112
  v_add_f32 v46, v46, v47
  v_smfmac_f32_16x16x64_bf16 v[48:51], v[28:31], a[208:215], v112
  v_cvt_pk_bf16_f32 v98, v44, v46
  s_waitcnt lgkmcnt(4)
  v_smfmac_f32_16x16x64_bf16 v[64:67], v[16:19], v[76:83], v112
  ds_read_b128 v[76:79], v113 offset:8192
  ds_read_b128 v[80:83], v113 offset:9216
  ds_write_b32 v114, v98 offset:4
  v_smfmac_f32_16x16x64_bf16 v[52:55], v[16:19], a[240:247], v112
  v_smfmac_f32_16x16x64_bf16 v[52:55], v[20:23], a[248:255], v112
  v_add_f32 v48, v48, v49
  v_smfmac_f32_16x16x64_bf16 v[52:55], v[24:27], v[120:127], v112
  v_add_f32 v50, v50, v51
  v_smfmac_f32_16x16x64_bf16 v[52:55], v[28:31], v[128:135], v112
  v_cvt_pk_bf16_f32 v99, v48, v50
  s_waitcnt lgkmcnt(4)
  v_smfmac_f32_16x16x64_bf16 v[64:67], v[20:23], v[68:75], v112
  ds_read_b128 v[68:71], v113 offset:10240
  ds_read_b128 v[72:75], v113 offset:11264
  ds_write_b32 v114, v99 offset:4100
  v_smfmac_f32_16x16x64_bf16 v[56:59], v[16:19], v[160:167], v112
  v_smfmac_f32_16x16x64_bf16 v[56:59], v[20:23], v[168:175], v112
  v_add_f32 v52, v52, v53
  v_smfmac_f32_16x16x64_bf16 v[56:59], v[24:27], v[176:183], v112
  v_add_f32 v54, v54, v55
  v_smfmac_f32_16x16x64_bf16 v[56:59], v[28:31], v[184:191], v112
  v_cvt_pk_bf16_f32 v96, v52, v54
  s_waitcnt lgkmcnt(4)
  v_smfmac_f32_16x16x64_bf16 v[64:67], v[24:27], v[76:83], v112
  ds_write_b32 v114, v96 offset:512
  v_smfmac_f32_16x16x64_bf16 v[60:63], v[16:19], v[216:223], v112
  v_smfmac_f32_16x16x64_bf16 v[60:63], v[20:23], v[224:231], v112
  v_add_f32 v56, v56, v57
  v_smfmac_f32_16x16x64_bf16 v[60:63], v[24:27], v[232:239], v112
  v_add_f32 v58, v58, v59
  v_smfmac_f32_16x16x64_bf16 v[60:63], v[28:31], v[240:247], v112
  v_cvt_pk_bf16_f32 v97, v56, v58
  s_waitcnt lgkmcnt(2)
  v_smfmac_f32_16x16x64_bf16 v[64:67], v[28:31], v[68:75], v112
  ds_write_b32 v114, v97 offset:4608
  s_nop 2
  v_add_f32 v60, v60, v61
  v_add_f32 v62, v62, v63
  v_cvt_pk_bf16_f32 v98, v60, v62
  ds_write_b32 v114, v98 offset:516
  v_add_f32 v64, v64, v65
  v_add_f32 v66, v66, v67
  v_cvt_pk_bf16_f32 v99, v64, v66
  ds_write_b32 v114, v99 offset:4612
  s_waitcnt lgkmcnt(0)
  s_barrier
  s_waitcnt vmcnt(0)
  v_cmp_ne_u32 vcc, v115, v116
  s_cbranch_vccnz mk_c_sv3_uwait
mk_c_sv3_uok:
  s_mov_b64 s[48:49], s[46:47]
  s_mov_b64 s[46:47], s[50:51]
  s_add_u32 s44, s46, 10240
  s_addc_u32 s45, s47, 0
  s_add_u32 s36, s36, 1
  s_add_u32 s30, s38, 15728640
  s_add_u32 s50, s4, s30
  s_addc_u32 s51, s5, 0
  s_add_u32 s38, s38, 147456
  s_cmp_eq_u32 s38, 589824
  s_cselect_b32 s38, 0, s38
  s_add_u32 s12, s12, 448
  s_addc_u32 s13, s13, 0
  v_mov_b32 v36, 0
  v_mov_b32 v37, 0
  v_mov_b32 v38, 0
  v_mov_b32 v39, 0
  v_mov_b32 v40, 0
  v_mov_b32 v41, 0
  v_mov_b32 v42, 0
  v_mov_b32 v43, 0
  v_mov_b32 v44, 0
  v_mov_b32 v45, 0
  v_mov_b32 v46, 0
  v_mov_b32 v47, 0
  v_mov_b32 v48, 0
  v_mov_b32 v49, 0
  v_mov_b32 v50, 0
  v_mov_b32 v51, 0
  v_mov_b32 v52, 0
  v_mov_b32 v53, 0
  v_mov_b32 v54, 0
  v_mov_b32 v55, 0
  v_mov_b32 v56, 0
  v_mov_b32 v57, 0
  v_mov_b32 v58, 0
  v_mov_b32 v59, 0
  v_mov_b32 v60, 0
  v_mov_b32 v61, 0
  v_mov_b32 v62, 0
  v_mov_b32 v63, 0
  v_mov_b32 v64, 0
  v_mov_b32 v65, 0
  v_mov_b32 v66, 0
  v_mov_b32 v67, 0
  s_cmp_lt_u32 s36, 63
  s_cbranch_scc1 mk_c_sv3_loop
  s_branch mk_c_done
mk_c_sv3_entry:
  s_branch mk_c_sv3_mem
mk_c_sv3_uwait:
  s_cmp_ge_u32 s36, 61
  s_cbranch_scc1 mk_c_sv3_uok
  global_load_dword v116, v105, s[12:13] sc1
  s_waitcnt vmcnt(0)
  v_cmp_ne_u32 vcc, v115, v116
  s_cbranch_vccz mk_c_sv3_uok
  s_sleep 4
  s_sub_u32 s40, s40, 1
  s_cbranch_scc0 mk_c_sv3_uwait
  s_mov_b32 s40, 0
  s_branch mk_c_sv3_uok
mk_c_sv3_fix2:
  ds_read_b128 v[12:15], v1 offset:1024
  s_waitcnt lgkmcnt(0)
  s_branch mk_c_sv3_fix2r
mk_c_sv3_redo:
  s_nop 7
  s_sub_u32 s40, s40, 1
  s_cbranch_scc1 mk_c_sv3_giveup
  s_waitcnt lgkmcnt(0)
  global_load_dwordx4 v[32:35], v5, s[44:45] sc1
  global_load_dwordx4 v[8:11], v6, s[44:45] sc1
  global_load_dwordx4 v[12:15], v7, s[44:45] sc1
  s_nop 7
  v_mov_b32 v36, 0
  v_mov_b32 v37, 0
  v_mov_b32 v38, 0
  v_mov_b32 v39, 0
  v_mov_b32 v40, 0
  v_mov_b32 v41, 0
  v_mov_b32 v42, 0
  v_mov_b32 v43, 0
  v_mov_b32 v44, 0
  v_mov_b32 v45, 0
  v_mov_b32 v46, 0
  v_mov_b32 v47, 0
  v_mov_b32 v48, 0
  v_mov_b32 v49, 0
  v_mov_b32 v50, 0
  v_mov_b32 v51, 0
  v_mov_b32 v52, 0
  v_mov_b32 v53, 0
  v_mov_b32 v54, 0
  v_mov_b32 v55, 0
  v_mov_b32 v56, 0
  v_mov_b32 v57, 0
  v_mov_b32 v58, 0
  v_mov_b32 v59, 0
  v_mov_b32 v60, 0
  v_mov_b32 v61, 0
  v_mov_b32 v62, 0
  v_mov_b32 v63, 0
  v_mov_b32 v64, 0
  v_mov_b32 v65, 0
  v_mov_b32 v66, 0
  v_mov_b32 v67, 0
  s_waitcnt vmcnt(0)
  s_branch mk_c_sv3_got
mk_c_sv3_giveup:
  s_mov_b32 s40, 0
  s_branch mk_c_sv3_cont
  s_branch mk_c_done
mk_c_spare:
  s_cmp_lg_u32 s24, 30
  s_cbranch_scc1 mk_c_done
  s_cmp_ge_u32 s22, 2
  s_cbranch_scc1 mk_c_done
  v_lshlrev_b32 v16, 2, v0
  v_add_u32 v16, 14946304, v16
mk_c_wf_46:
  global_load_dword v17, v16, s[4:5] offset:0 sc1
  global_load_dword v18, v16, s[4:5] offset:256 sc1
  global_load_dword v19, v16, s[4:5] offset:512 sc1
  global_load_dword v20, v16, s[4:5] offset:768 sc1
  s_waitcnt vmcnt(0)
  v_xor_b32 v17, s20, v17
  v_xor_b32 v18, s20, v18
  v_or_b32 v17, v17, v18
  v_xor_b32 v19, s20, v19
  v_or_b32 v17, v17, v19
  v_xor_b32 v20, s20, v20
  v_or_b32 v17, v17, v20
  v_cmp_ne_u32 vcc, 0, v17
  s_cbranch_vccz mk_c_wd_47
  s_sleep 8
  s_sub_u32 s40, s40, 1
  s_cbranch_scc0 mk_c_wf_46
  s_mov_b32 s40, 0
mk_c_wd_47:
  v_add_u32 v3, 4096, v1
  v_lshlrev_b32 v5, 4, v1
  v_add_u32 v9, 7232, v5
  v_add_u32 v5, 14995456, v5
  s_add_u32 s30, s20, s22
  v_mov_b32 v6, s30
  v_add_u32 v6, -1, v6
  v_lshlrev_b32 v7, 3, v1
  v_mov_b32 v10, -1
  s_mov_b32 s36, s22
  s_mul_i32 s38, s22, 147456
  s_mul_i32 s30, s22, 7168
  s_add_u32 s30, s30, 16784384
  s_add_u32 s58, s4, s30
  s_addc_u32 s59, s5, 0
  s_mul_i32 s30, s22, 49152
  s_add_u32 s30, s30, 29360128
  s_add_u32 s54, s4, s30
  s_addc_u32 s55, s5, 0
  global_load_dword v8, v7, s[54:55]
  s_add_u32 s54, s54, 8192
  s_addc_u32 s55, s55, 0
  global_load_dword v8, v7, s[54:55]
  s_add_u32 s54, s54, 8192
  s_addc_u32 s55, s55, 0
  global_load_dword v8, v7, s[54:55]
  s_add_u32 s54, s54, 8192
  s_addc_u32 s55, s55, 0
  global_load_dword v8, v7, s[54:55]
  s_add_u32 s54, s54, 8192
  s_addc_u32 s55, s55, 0
  global_load_dword v8, v7, s[54:55]
  s_add_u32 s54, s54, 8192
  s_addc_u32 s55, s55, 0
  global_load_dword v8, v7, s[54:55]
  s_add_u32 s54, s54, 8192
  s_addc_u32 s55, s55, 0
  s_lshl_b32 s30, s22, 15
  s_add_u32 s30, s30, 29458432
  s_add_u32 s54, s4, s30
  s_addc_u32 s55, s5, 0
  s_add_u32 s44, s4, 15738880
  s_addc_u32 s45, s5, 0
  s_add_u32 s46, s4, 15746048
  s_addc_u32 s47, s5, 0
  s_cmp_lg_u32 s22, 0
  s_cbranch_scc1 mk_c_spl
  s_mov_b64 exec, 15
  s_cmp_lt_u32 s21, 32
  s_cbranch_scc1 fs_48
  global_store_dword v9, v1, s[44:45]
  s_branch fs_49
fs_48:
  global_store_dword v9, v1, s[44:45] sc1
fs_49:
  s_mov_b64 exec, -1
  v_mov_b32 v2, 0
mk_c_sp0:
  global_load_dword v8, v2, s[46:47] sc1
  s_waitcnt vmcnt(0)
  v_cmp_eq_u32 vcc, -1, v8
  s_cbranch_vccz mk_c_sp1
  s_sleep 8
  s_sub_u32 s40, s40, 1
  s_cbranch_scc0 mk_c_sp0
  s_mov_b32 s40, 0
mk_c_sp1:
  v_add_u32 v8, 2, v6
  s_mov_b64 exec, 0xffff
  global_store_dword v5, v8, s[4:5] sc1
  s_mov_b64 exec, -1
mk_c_spl:
  s_add_u32 s30, s38, 15738880
  s_add_u32 s48, s4, s30
  s_addc_u32 s49, s5, 0
  s_add_u32 s38, s38, 147456
  s_cmp_eq_u32 s38, 589824
  s_cselect_b32 s38, 0, s38
  s_add_u32 s30, s38, 15738880
  s_add_u32 s44, s4, s30
  s_addc_u32 s45, s5, 0
  s_add_u32 s38, s38, 147456
  s_cmp_eq_u32 s38, 589824
  s_cselect_b32 s38, 0, s38
mk_c_spp:
  global_load_dwordx4 v[16:19], v1, s[44:45] offset:0 sc1
  global_load_dwordx4 v[20:23], v1, s[44:45] offset:1024 sc1
  global_load_dwordx4 v[24:27], v1, s[44:45] offset:2048 sc1
  global_load_dwordx4 v[28:31], v1, s[44:45] offset:3072 sc1
  global_load_dwordx4 v[32:35], v3, s[44:45] offset:0 sc1
  global_load_dwordx4 v[36:39], v3, s[44:45] offset:1024 sc1
  global_load_dwordx4 v[40:43], v3, s[44:45] offset:2048 sc1
  s_waitcnt vmcnt(0)
  v_max3_u32 v8, v16, v17, v18
  v_max3_u32 v8, v8, v19, v20
  v_max3_u32 v8, v8, v21, v22
  v_max3_u32 v8, v8, v23, v24
  v_max3_u32 v8, v8, v25, v26
  v_max3_u32 v8, v8, v27, v28
  v_max3_u32 v8, v8, v29, v30
  v_max3_u32 v8, v8, v31, v32
  v_max3_u32 v8, v8, v33, v34
  v_max3_u32 v8, v8, v35, v36
  v_max3_u32 v8, v8, v37, v38
  v_max3_u32 v8, v8, v39, v40
  v_max3_u32 v8, v8, v41, v42
  v_max_u32 v8, v8, v43
  v_cmp_eq_u32 vcc, -1, v8
  s_cbranch_vccz mk_c_spk
  s_sleep 4
  s_sub_u32 s40, s40, 1
  s_cbranch_scc0 mk_c_spp
  s_mov_b32 s40, 0
mk_c_spk:
  s_mov_b64 exec, 15
  s_cmp_lt_u32 s21, 32
  s_cbranch_scc1 fs_50
  global_store_dword v9, v1, s[44:45]
  s_branch fs_51
fs_50:
  global_store_dword v9, v1, s[44:45] sc1
fs_51:
  s_mov_b64 exec, -1
  s_mov_b64 exec, 15
  s_cmp_lt_u32 s21, 32
  s_cbranch_scc1 fs_52
  global_store_dword v9, v10, s[48:49]
  s_branch fs_53
fs_52:
  global_store_dword v9, v10, s[48:49] sc1
fs_53:
  s_mov_b64 exec, -1
  global_store_dwordx4 v1, v[16:19], s[58:59] offset:0 sc1
  global_store_dwordx4 v1, v[20:23], s[58:59] offset:1024 sc1
  global_store_dwordx4 v1, v[24:27], s[58:59] offset:2048 sc1
  global_store_dwordx4 v1, v[28:31], s[58:59] offset:3072 sc1
  global_store_dwordx4 v3, v[32:35], s[58:59] offset:0 sc1
  global_store_dwordx4 v3, v[36:39], s[58:59] offset:1024 sc1
  global_store_dwordx4 v3, v[40:43], s[58:59] offset:2048 sc1
  v_add_u32 v6, 2, v6
  v_add_u32 v8, 1, v6
  s_mov_b64 exec, 0xffff
  global_store_dword v5, v8, s[4:5] sc1
  s_mov_b64 exec, -1
  global_load_dword v8, v7, s[54:55]
  s_add_u32 s54, s54, 8192
  s_addc_u32 s55, s55, 0
  global_load_dword v8, v7, s[54:55]
  s_add_u32 s54, s54, 8192
  s_addc_u32 s55, s55, 0
  global_load_dword v8, v7, s[54:55]
  s_add_u32 s54, s54, 8192
  s_addc_u32 s55, s55, 0
  global_load_dword v8, v7, s[54:55]
  s_add_u32 s54, s54, 8192
  s_addc_u32 s55, s55, 0
  s_add_u32 s54, s54, 32768
  s_addc_u32 s55, s55, 0
  s_add_u32 s58, s58, 14336
  s_addc_u32 s59, s59, 0
  s_add_u32 s36, s36, 2
  s_cmp_lt_u32 s36, 63
  s_cbranch_scc1 mk_c_spl
mk_c_done:
  s_branch mk_fin
mk_helper:
  s_sub_u32 s24, s24, 32
  v_mov_b32 v250, v0
  s_mov_b32 s38, s24
  s_and_b32 s21, s24, 31
  s_mul_i32 s21, s21, 7
  s_lshr_b32 s25, s24, 5
  s_add_u32 s21, s21, s25
  s_mov_b32 s24, s21
  s_sub_u32 s25, s24, 140
  s_cmp_ge_u32 s25, 64
  s_cbranch_scc1 mk_nopf
  s_cmp_ge_u32 s22, 3
  s_cbranch_scc1 mk_nopf
  s_mul_i32 s25, s25, 2560
  s_add_u32 s25, s25, 17301504
  v_min_u32 v1, 159, v0
  v_lshlrev_b32 v1, 4, v1
  v_add_u32 v1, s25, v1
  v_mov_b32 v4, -1
  v_mov_b32 v5, -1
  v_mov_b32 v6, -1
  v_mov_b32 v7, -1
  global_store_dwordx4 v1, v[4:7], s[4:5] sc1
  v_add_u32 v1, 163840, v1
  global_store_dwordx4 v1, v[4:7], s[4:5] sc1
  v_add_u32 v1, 163840, v1
  global_store_dwordx4 v1, v[4:7], s[4:5] sc1
  v_add_u32 v1, 163840, v1
  global_store_dwordx4 v1, v[4:7], s[4:5] sc1
  v_add_u32 v1, 163840, v1
  global_store_dwordx4 v1, v[4:7], s[4:5] sc1
  v_add_u32 v1, 163840, v1
  global_store_dwordx4 v1, v[4:7], s[4:5] sc1
  v_add_u32 v1, 163840, v1
  global_store_dwordx4 v1, v[4:7], s[4:5] sc1
  v_add_u32 v1, 163840, v1
  global_store_dwordx4 v1, v[4:7], s[4:5] sc1
  v_add_u32 v1, 163840, v1
  global_store_dwordx4 v1, v[4:7], s[4:5] sc1
  v_add_u32 v1, 163840, v1
  global_store_dwordx4 v1, v[4:7], s[4:5] sc1
  v_add_u32 v1, 163840, v1
  global_store_dwordx4 v1, v[4:7], s[4:5] sc1
  v_add_u32 v1, 163840, v1
  global_store_dwordx4 v1, v[4:7], s[4:5] sc1
  v_add_u32 v1, 163840, v1
  global_store_dwordx4 v1, v[4:7], s[4:5] sc1
  v_add_u32 v1, 163840, v1
  global_store_dwordx4 v1, v[4:7], s[4:5] sc1
  v_add_u32 v1, 163840, v1
  global_store_dwordx4 v1, v[4:7], s[4:5] sc1
  v_add_u32 v1, 163840, v1
  global_store_dwordx4 v1, v[4:7], s[4:5] sc1
  v_add_u32 v1, 163840, v1
mk_nopf:
  s_sub_u32 s25, s24, 112
  s_cmp_ge_u32 s25, 28
  s_cbranch_scc1 mk_nopm
  s_lshl_b32 s25, s25, 12
  s_add_u32 s25, s25, 70270976
  v_lshlrev_b32 v1, 4, v0
  v_add_u32 v1, s25, v1
  v_mov_b32 v4, -1
  v_mov_b32 v5, -1
  v_mov_b32 v6, -1
  v_mov_b32 v7, -1
  global_store_dwordx4 v1, v[4:7], s[4:5] sc1
  s_nop 1
mk_nopm:
  s_lshr_b32 s25, s38, 3
  s_mul_i32 s26, s25, 9363
  s_lshr_b32 s26, s26, 16
  s_mul_i32 s27, s26, 7
  s_sub_u32 s27, s25, s27
  s_lshl_b32 s26, s26, 3
  s_and_b32 s25, s38, 7
  s_add_u32 s26, s26, s25
  s_mul_i32 s39, s26, 7
  s_add_u32 s39, s39, s27
  s_load_dwordx4 s[8:11], s[0:1], 16
  s_load_dwordx4 s[12:15], s[0:1], 32
  s_mul_i32 s25, s39, 9363
  s_lshr_b32 s25, s25, 16
  s_mul_i32 s26, s25, 7
  s_sub_u32 s26, s39, s26
  s_lshr_b32 s23, s25, 4
  s_and_b32 s25, s25, 15
  v_and_b32 v3, 63, v0
  v_and_b32 v8, 15, v3
  v_lshrrev_b32 v9, 4, v3
  s_waitcnt lgkmcnt(0)
  s_cmp_eq_u32 s23, 1
  s_cselect_b32 s28, s12, s8
  s_cselect_b32 s29, s13, s9
  s_cselect_b32 s30, 6422528, 0
  s_cselect_b32 s31, 1.0, 0x3db8aa3b
  s_cbranch_scc1 mk_stV
  v_lshrrev_b32 v14, 5, v0
  v_and_b32 v15, 31, v0
  s_lshl_b32 s34, s26, 6
  v_add_u32 v1, s34, v14
  v_lshlrev_b32 v1, 13, v1
  s_lshl_b32 s33, s25, 9
  v_lshl_add_u32 v1, v15, 4, v1
  v_add_u32 v1, s33, v1
  global_load_dwordx4 v[208:211], v1, s[10:11]
  v_add_u32 v1, 0x10000, v1
  global_load_dwordx4 v[212:215], v1, s[10:11]
  v_add_u32 v1, 0x10000, v1
  global_load_dwordx4 v[216:219], v1, s[10:11]
  v_add_u32 v1, 0x10000, v1
  global_load_dwordx4 v[220:223], v1, s[10:11]
  v_add_u32 v1, 0x10000, v1
  global_load_dwordx4 v[224:227], v1, s[10:11]
  v_add_u32 v1, 0x10000, v1
  global_load_dwordx4 v[228:231], v1, s[10:11]
  v_add_u32 v1, 0x10000, v1
  global_load_dwordx4 v[232:235], v1, s[10:11]
  v_add_u32 v1, 0x10000, v1
  global_load_dwordx4 v[236:239], v1, s[10:11]
  v_mul_u32_u24 v2, 528, v14
  v_lshl_add_u32 v2, v15, 4, v2
  s_mov_b32 s35, 4224
  s_branch mk_stD
mk_stV:
  v_lshrrev_b32 v14, 3, v0
  v_and_b32 v15, 7, v0
  v_mul_u32_u24 v1, 896, v14
  v_lshl_add_u32 v1, v15, 4, v1
  s_mul_i32 s33, s25, 229376
  s_lshl_b32 s34, s26, 7
  s_add_u32 s33, s33, s34
  v_add_u32 v1, s33, v1
  global_load_dwordx4 v[208:211], v1, s[14:15]
  v_add_u32 v1, 28672, v1
  global_load_dwordx4 v[212:215], v1, s[14:15]
  v_add_u32 v1, 28672, v1
  global_load_dwordx4 v[216:219], v1, s[14:15]
  v_add_u32 v1, 28672, v1
  global_load_dwordx4 v[220:223], v1, s[14:15]
  v_add_u32 v1, 28672, v1
  global_load_dwordx4 v[224:227], v1, s[14:15]
  v_add_u32 v1, 28672, v1
  global_load_dwordx4 v[228:231], v1, s[14:15]
  v_add_u32 v1, 28672, v1
  global_load_dwordx4 v[232:235], v1, s[14:15]
  v_add_u32 v1, 28672, v1
  global_load_dwordx4 v[236:239], v1, s[14:15]
  v_mul_u32_u24 v2, 144, v14
  v_lshl_add_u32 v2, v15, 4, v2
  s_mov_b32 s35, 4608
mk_stD:
  s_add_u32 s36, s22, s26
  s_cmp_ge_u32 s36, 7
  s_cselect_b32 s32, 7, 0
  s_sub_u32 s36, s36, s32
  s_add_u32 s37, s36, 4
  s_cmp_ge_u32 s37, 7
  s_cselect_b32 s32, 7, 0
  s_sub_u32 s37, s37, s32
  v_lshlrev_b32 v10, 13, v9
  v_lshl_add_u32 v10, v8, 4, v10
  s_lshl_b32 s33, s25, 9
  v_add_u32 v10, s33, v10
  s_lshl_b32 s32, s36, 19
  s_add_u32 s16, s28, s32
  s_addc_u32 s17, s29, 0
  s_lshl_b32 s32, s37, 19
  s_add_u32 s18, s28, s32
  s_addc_u32 s19, s29, 0
  s_cmp_eq_u32 s22, 3
  s_cbranch_scc1 mk_skA
  s_add_u32 s32, s22, 0
  s_and_b32 s32, s32, 3
  s_lshl_b32 s32, s32, 17
  v_add_u32 v11, s32, v10
  global_load_dwordx4 v[16:19], v11, s[16:17] offset:0
  global_load_dwordx4 v[80:83], v11, s[16:17] offset:256
  v_add_u32 v11, 0x8000, v11
  global_load_dwordx4 v[20:23], v11, s[16:17] offset:0
  global_load_dwordx4 v[84:87], v11, s[16:17] offset:256
  v_add_u32 v11, 0x8000, v11
  global_load_dwordx4 v[24:27], v11, s[16:17] offset:0
  global_load_dwordx4 v[88:91], v11, s[16:17] offset:256
  v_add_u32 v11, 0x8000, v11
  global_load_dwordx4 v[28:31], v11, s[16:17] offset:0
  global_load_dwordx4 v[92:95], v11, s[16:17] offset:256
  s_add_u32 s32, s22, 1
  s_and_b32 s32, s32, 3
  s_lshl_b32 s32, s32, 17
  v_add_u32 v11, s32, v10
  global_load_dwordx4 v[32:35], v11, s[16:17] offset:0
  global_load_dwordx4 v[96:99], v11, s[16:17] offset:256
  v_add_u32 v11, 0x8000, v11
  global_load_dwordx4 v[36:39], v11, s[16:17] offset:0
  global_load_dwordx4 v[100:103], v11, s[16:17] offset:256
  v_add_u32 v11, 0x8000, v11
  global_load_dwordx4 v[40:43], v11, s[16:17] offset:0
  global_load_dwordx4 v[104:107], v11, s[16:17] offset:256
  v_add_u32 v11, 0x8000, v11
  global_load_dwordx4 v[44:47], v11, s[16:17] offset:0
  global_load_dwordx4 v[108:111], v11, s[16:17] offset:256
  s_add_u32 s32, s22, 2
  s_and_b32 s32, s32, 3
  s_lshl_b32 s32, s32, 17
  v_add_u32 v11, s32, v10
  global_load_dwordx4 v[48:51], v11, s[16:17] offset:0
  global_load_dwordx4 v[112:115], v11, s[16:17] offset:256
  v_add_u32 v11, 0x8000, v11
  global_load_dwordx4 v[52:55], v11, s[16:17] offset:0
  global_load_dwordx4 v[116:119], v11, s[16:17] offset:256
  v_add_u32 v11, 0x8000, v11
  global_load_dwordx4 v[56:59], v11, s[16:17] offset:0
  global_load_dwordx4 v[120:123], v11, s[16:17] offset:256
  v_add_u32 v11, 0x8000, v11
  global_load_dwordx4 v[60:63], v11, s[16:17] offset:0
  global_load_dwordx4 v[124:127], v11, s[16:17] offset:256
  s_add_u32 s32, s22, 3
  s_and_b32 s32, s32, 3
  s_lshl_b32 s32, s32, 17
  v_add_u32 v11, s32, v10
  global_load_dwordx4 v[64:67], v11, s[16:17] offset:0
  global_load_dwordx4 v[128:131], v11, s[16:17] offset:256
  v_add_u32 v11, 0x8000, v11
  global_load_dwordx4 v[68:71], v11, s[16:17] offset:0
  global_load_dwordx4 v[132:135], v11, s[16:17] offset:256
  v_add_u32 v11, 0x8000, v11
  global_load_dwordx4 v[72:75], v11, s[16:17] offset:0
  global_load_dwordx4 v[136:139], v11, s[16:17] offset:256
  v_add_u32 v11, 0x8000, v11
  global_load_dwordx4 v[76:79], v11, s[16:17] offset:0
  global_load_dwordx4 v[140:143], v11, s[16:17] offset:256
  s_branch mk_skAd
mk_skA:
  s_waitcnt vmcnt(0)
mk_skAd:
  s_waitcnt vmcnt(39)
  ds_write_b128 v2, v[208:211]
  v_add_u32 v2, s35, v2
  s_waitcnt vmcnt(38)
  ds_write_b128 v2, v[212:215]
  v_add_u32 v2, s35, v2
  s_waitcnt vmcnt(37)
  ds_write_b128 v2, v[216:219]
  v_add_u32 v2, s35, v2
  s_waitcnt vmcnt(36)
  ds_write_b128 v2, v[220:223]
  v_add_u32 v2, s35, v2
  s_waitcnt vmcnt(35)
  ds_write_b128 v2, v[224:227]
  v_add_u32 v2, s35, v2
  s_waitcnt vmcnt(34)
  ds_write_b128 v2, v[228:231]
  v_add_u32 v2, s35, v2
  s_waitcnt vmcnt(33)
  ds_write_b128 v2, v[232:235]
  v_add_u32 v2, s35, v2
  s_waitcnt vmcnt(32)
  ds_write_b128 v2, v[236:239]
  s_mul_i32 s32, s22, 17408
  s_add_u32 s32, s32, 40960
  v_mul_u32_u24 v12, 272, v9
  v_lshl_add_u32 v12, v8, 4, v12
  v_add_u32 v12, s32, v12
  v_lshrrev_b32 v13, 3, v8
  v_lshlrev_b32 v13, 4, v13
  v_bfe_u32 v11, v8, 2, 1
  v_lshl_add_u32 v13, v11, 2, v13
  v_and_b32 v11, 3, v8
  v_add_u32 v13, v13, v11
  v_mul_u32_u24 v13, 272, v13
  v_lshl_add_u32 v13, v9, 4, v13
  v_add_u32 v13, s32, v13
  s_waitcnt lgkmcnt(0)
  s_barrier
  s_mov_b32 s40, 1000000
  v_mov_b32 v5, 0
mk_gt_54:
  global_load_dword v6, v5, s[6:7] offset:8 sc1
  s_waitcnt vmcnt(0)
  v_readfirstlane_b32 s20, v6
  s_nop 0
  s_cmp_lg_u32 s20, 0
  s_cbranch_scc1 mk_gd_55
  s_sleep 2
  s_sub_u32 s40, s40, 1
  s_cbranch_scc0 mk_gt_54
  s_mov_b32 s40, 0
mk_gd_55:
  s_lshl_b32 s38, s39, 2
  s_add_u32 s38, s38, s22
  s_lshl_b32 s38, s38, 2
  s_add_u32 s38, s38, 15069184
  s_cmp_lg_u32 s22, 3
  s_cbranch_scc1 mk_nx
  s_waitcnt vmcnt(0)
  v_mov_b32 v5, s38
  v_mov_b32 v6, s20
  s_mov_b64 exec, 1
  global_store_dword v5, v6, s[4:5] sc1
  s_mov_b64 exec, -1
  s_cmp_ge_u32 s21, 128
  s_cbranch_scc1 mk_nx2
  v_mov_b32 v251, v10
  v_mov_b32 v252, v12
  v_mov_b32 v253, v13
  s_mov_b64 s[44:45], s[16:17]
  s_mov_b64 s[46:47], s[18:19]
  s_mov_b32 s48, s25
  s_mov_b32 s49, s26
  s_mov_b32 s34, 93184
  s_load_dwordx2 s[16:17], s[0:1], 0
  s_load_dwordx2 s[18:19], s[0:1], 64
  s_load_dwordx2 s[12:13], s[0:1], 96
  v_lshlrev_b32 v1, 4, v3
  s_mul_i32 s25, s21, 14336
  v_add_u32 v2, s25, v1
  v_add_u32 v4, 8192, v2
  v_min_u32 v5, 880, v1
  s_waitcnt lgkmcnt(0)
  global_load_dwordx4 v[16:19], v2, s[16:17] offset:0
  global_load_dwordx4 v[20:23], v2, s[16:17] offset:1024
  global_load_dwordx4 v[24:27], v2, s[16:17] offset:2048
  global_load_dwordx4 v[28:31], v2, s[16:17] offset:3072
  v_add_u32 v6, 4096, v4
  global_load_dwordx4 v[32:35], v4, s[16:17] offset:-4096
  global_load_dwordx4 v[36:39], v4, s[16:17] offset:-3072
  global_load_dwordx4 v[40:43], v4, s[16:17] offset:-2048
  global_load_dwordx4 v[44:47], v4, s[16:17] offset:-1024
  global_load_dwordx4 v[48:51], v4, s[16:17] offset:0
  global_load_dwordx4 v[52:55], v4, s[16:17] offset:1024
  global_load_dwordx4 v[56:59], v4, s[16:17] offset:2048
  global_load_dwordx4 v[60:63], v4, s[16:17] offset:3072
  global_load_dwordx4 v[64:67], v6, s[16:17] offset:0
  global_load_dwordx4 v[68:71], v6, s[16:17] offset:1024
  global_load_dwordx4 v[72:75], v5, s[18:19]
  global_load_dwordx4 v[76:79], v5, s[12:13]
  v_add_u32 v10, 0, v3
  v_mul_u32_u24 v11, 1171, v10
  v_lshrrev_b32 v11, 16, v11
  v_add_lshl_u32 v10, v10, v11, 4
  v_add_u32 v10, s34, v10
  s_waitcnt vmcnt(15)
  ds_write_b128 v10, v[16:19]
  v_add_u32 v10, 64, v3
  v_mul_u32_u24 v11, 1171, v10
  v_lshrrev_b32 v11, 16, v11
  v_add_lshl_u32 v10, v10, v11, 4
  v_add_u32 v10, s34, v10
  s_waitcnt vmcnt(14)
  ds_write_b128 v10, v[20:23]
  v_add_u32 v10, 128, v3
  v_mul_u32_u24 v11, 1171, v10
  v_lshrrev_b32 v11, 16, v11
  v_add_lshl_u32 v10, v10, v11, 4
  v_add_u32 v10, s34, v10
  s_waitcnt vmcnt(13)
  ds_write_b128 v10, v[24:27]
  v_add_u32 v10, 192, v3
  v_mul_u32_u24 v11, 1171, v10
  v_lshrrev_b32 v11, 16, v11
  v_add_lshl_u32 v10, v10, v11, 4
  v_add_u32 v10, s34, v10
  s_waitcnt vmcnt(12)
  ds_write_b128 v10, v[28:31]
  v_add_u32 v10, 256, v3
  v_mul_u32_u24 v11, 1171, v10
  v_lshrrev_b32 v11, 16, v11
  v_add_lshl_u32 v10, v10, v11, 4
  v_add_u32 v10, s34, v10
  s_waitcnt vmcnt(11)
  ds_write_b128 v10, v[32:35]
  v_add_u32 v10, 320, v3
  v_mul_u32_u24 v11, 1171, v10
  v_lshrrev_b32 v11, 16, v11
  v_add_lshl_u32 v10, v10, v11, 4
  v_add_u32 v10, s34, v10
  s_waitcnt vmcnt(10)
  ds_write_b128 v10, v[36:39]
  v_add_u32 v10, 384, v3
  v_mul_u32_u24 v11, 1171, v10
  v_lshrrev_b32 v11, 16, v11
  v_add_lshl_u32 v10, v10, v11, 4
  v_add_u32 v10, s34, v10
  s_waitcnt vmcnt(9)
  ds_write_b128 v10, v[40:43]
  v_add_u32 v10, 448, v3
  v_mul_u32_u24 v11, 1171, v10
  v_lshrrev_b32 v11, 16, v11
  v_add_lshl_u32 v10, v10, v11, 4
  v_add_u32 v10, s34, v10
  s_waitcnt vmcnt(8)
  ds_write_b128 v10, v[44:47]
  v_add_u32 v10, 512, v3
  v_mul_u32_u24 v11, 1171, v10
  v_lshrrev_b32 v11, 16, v11
  v_add_lshl_u32 v10, v10, v11, 4
  v_add_u32 v10, s34, v10
  s_waitcnt vmcnt(7)
  ds_write_b128 v10, v[48:51]
  v_add_u32 v10, 576, v3
  v_mul_u32_u24 v11, 1171, v10
  v_lshrrev_b32 v11, 16, v11
  v_add_lshl_u32 v10, v10, v11, 4
  v_add_u32 v10, s34, v10
  s_waitcnt vmcnt(6)
  ds_write_b128 v10, v[52:55]
  v_add_u32 v10, 640, v3
  v_mul_u32_u24 v11, 1171, v10
  v_lshrrev_b32 v11, 16, v11
  v_add_lshl_u32 v10, v10, v11, 4
  v_add_u32 v10, s34, v10
  s_waitcnt vmcnt(5)
  ds_write_b128 v10, v[56:59]
  v_add_u32 v10, 704, v3
  v_mul_u32_u24 v11, 1171, v10
  v_lshrrev_b32 v11, 16, v11
  v_add_lshl_u32 v10, v10, v11, 4
  v_add_u32 v10, s34, v10
  s_waitcnt vmcnt(4)
  ds_write_b128 v10, v[60:63]
  v_add_u32 v10, 768, v3
  v_mul_u32_u24 v11, 1171, v10
  v_lshrrev_b32 v11, 16, v11
  v_add_lshl_u32 v10, v10, v11, 4
  v_add_u32 v10, s34, v10
  s_waitcnt vmcnt(3)
  ds_write_b128 v10, v[64:67]
  v_add_u32 v10, 832, v3
  v_mul_u32_u24 v11, 1171, v10
  v_lshrrev_b32 v11, 16, v11
  v_add_lshl_u32 v10, v10, v11, 4
  v_add_u32 v10, s34, v10
  s_waitcnt vmcnt(2)
  ds_write_b128 v10, v[68:71]
  v_add_u32 v10, s34, v5
  s_waitcnt vmcnt(0)
  ds_write_b128 v10, v[72:75] offset:14592
  ds_write_b128 v10, v[76:79] offset:15504
  v_lshrrev_b32 v11, 1, v9
  v_lshlrev_b32 v11, 5, v11
  v_and_b32 v12, 1, v9
  v_lshl_add_u32 v11, v12, 3, v11
  v_add_u32 v11, s34, v11
  v_mul_u32_u24 v12, 912, v8
  v_add_u32 v13, v12, v11
  v_lshl_add_u32 v12, v9, 3, v12
  v_add_u32 v12, s34, v12
  s_add_u32 s25, s25, 12845056
  v_add_u32 v2, s25, v1
  s_lshr_b32 s26, s21, 1
  s_lshl_b32 s26, s26, 15
  s_and_b32 s27, s21, 1
  s_lshl_b32 s27, s27, 12
  s_add_u32 s26, s26, s27
  s_add_u32 s26, s26, 29360128
  v_add_u32 v4, s26, v1
  s_waitcnt lgkmcnt(0)
  ds_read2_b64 v[80:83], v12 offset0:0 offset1:4
  ds_read2_b64 v[84:87], v12 offset0:8 offset1:12
  ds_read2_b64 v[88:91], v12 offset0:16 offset1:20
  ds_read_b64 v[92:93], v12 offset:192
  v_mov_b32 v94, 0
  v_mov_b32 v95, 0
  ds_read2_b64 v[96:99], v12 offset0:28 offset1:32
  ds_read2_b64 v[100:103], v12 offset0:36 offset1:40
  ds_read2_b64 v[104:107], v12 offset0:44 offset1:48
  ds_read_b64 v[108:109], v12 offset:416
  v_mov_b32 v110, 0
  v_mov_b32 v111, 0
  ds_read2_b64 v[112:115], v12 offset0:56 offset1:60
  ds_read2_b64 v[116:119], v12 offset0:64 offset1:68
  ds_read2_b64 v[120:123], v12 offset0:72 offset1:76
  ds_read_b64 v[124:125], v12 offset:640
  v_mov_b32 v126, 0
  v_mov_b32 v127, 0
  ds_read2_b64 v[128:131], v12 offset0:84 offset1:88
  ds_read2_b64 v[132:135], v12 offset0:92 offset1:96
  ds_read2_b64 v[136:139], v12 offset0:100 offset1:104
  ds_read_b64 v[140:141], v12 offset:864
  v_mov_b32 v142, 0
  v_mov_b32 v143, 0
  s_waitcnt lgkmcnt(0)
  global_store_dwordx4 v4, v[80:83], s[4:5] offset:0 sc1
  global_store_dwordx4 v4, v[84:87], s[4:5] offset:1024 sc1
  global_store_dwordx4 v4, v[88:91], s[4:5] offset:2048 sc1
  global_store_dwordx4 v4, v[92:95], s[4:5] offset:3072 sc1
  v_add_u32 v4, 8192, v4
  global_store_dwordx4 v4, v[96:99], s[4:5] offset:0 sc1
  global_store_dwordx4 v4, v[100:103], s[4:5] offset:1024 sc1
  global_store_dwordx4 v4, v[104:107], s[4:5] offset:2048 sc1
  global_store_dwordx4 v4, v[108:111], s[4:5] offset:3072 sc1
  v_add_u32 v4, 8192, v4
  global_store_dwordx4 v4, v[112:115], s[4:5] offset:0 sc1
  global_store_dwordx4 v4, v[116:119], s[4:5] offset:1024 sc1
  global_store_dwordx4 v4, v[120:123], s[4:5] offset:2048 sc1
  global_store_dwordx4 v4, v[124:127], s[4:5] offset:3072 sc1
  v_add_u32 v4, 8192, v4
  global_store_dwordx4 v4, v[128:131], s[4:5] offset:0 sc1
  global_store_dwordx4 v4, v[132:135], s[4:5] offset:1024 sc1
  global_store_dwordx4 v4, v[136:139], s[4:5] offset:2048 sc1
  global_store_dwordx4 v4, v[140:143], s[4:5] offset:3072 sc1
  v_mov_b32 v14, 0
  v_mov_b32 v15, 0
  v_add_u32 v10, 14592, v11
  s_mov_b32 s27, 0
mk_xb:
  ds_read2_b64 v[16:19], v13 offset0:0 offset1:2
  ds_read2_b64 v[144:147], v10 offset0:0 offset1:2
  ds_read2_b64 v[148:151], v10 offset0:114 offset1:116
  v_add_u32 v13, 64, v13
  v_add_u32 v10, 64, v10
  s_waitcnt lgkmcnt(2)
  v_lshlrev_b32 v152, 16, v16
  v_and_b32 v153, 0xffff0000, v16
  v_lshlrev_b32 v154, 16, v17
  v_and_b32 v155, 0xffff0000, v17
  v_lshlrev_b32 v156, 16, v18
  v_and_b32 v157, 0xffff0000, v18
  v_lshlrev_b32 v158, 16, v19
  v_and_b32 v159, 0xffff0000, v19
  v_swap_b32 v17, v18
  global_store_dwordx4 v2, v[16:19], s[4:5] sc1
  v_add_u32 v2, 1024, v2
  s_waitcnt lgkmcnt(0)
  v_lshlrev_b32 v160, 16, v144
  v_and_b32 v161, 0xffff0000, v144
  v_fmac_f32 v14, v152, v160
  v_fmac_f32 v14, v153, v161
  v_lshlrev_b32 v160, 16, v148
  v_and_b32 v161, 0xffff0000, v148
  v_mul_f32 v160, v152, v160
  v_mul_f32 v161, v153, v161
  v_cvt_pk_bf16_f32 v160, v160, v161
  v_and_b32 v161, 0xffff0000, v160
  v_lshlrev_b32 v160, 16, v160
  v_add_f32 v15, v15, v160
  v_add_f32 v15, v15, v161
  v_lshlrev_b32 v160, 16, v145
  v_and_b32 v161, 0xffff0000, v145
  v_fmac_f32 v14, v154, v160
  v_fmac_f32 v14, v155, v161
  v_lshlrev_b32 v160, 16, v149
  v_and_b32 v161, 0xffff0000, v149
  v_mul_f32 v160, v154, v160
  v_mul_f32 v161, v155, v161
  v_cvt_pk_bf16_f32 v160, v160, v161
  v_and_b32 v161, 0xffff0000, v160
  v_lshlrev_b32 v160, 16, v160
  v_add_f32 v15, v15, v160
  v_add_f32 v15, v15, v161
  v_lshlrev_b32 v160, 16, v146
  v_and_b32 v161, 0xffff0000, v146
  v_fmac_f32 v14, v156, v160
  v_fmac_f32 v14, v157, v161
  v_lshlrev_b32 v160, 16, v150
  v_and_b32 v161, 0xffff0000, v150
  v_mul_f32 v160, v156, v160
  v_mul_f32 v161, v157, v161
  v_cvt_pk_bf16_f32 v160, v160, v161
  v_and_b32 v161, 0xffff0000, v160
  v_lshlrev_b32 v160, 16, v160
  v_add_f32 v15, v15, v160
  v_add_f32 v15, v15, v161
  v_lshlrev_b32 v160, 16, v147
  v_and_b32 v161, 0xffff0000, v147
  v_fmac_f32 v14, v158, v160
  v_fmac_f32 v14, v159, v161
  v_lshlrev_b32 v160, 16, v151
  v_and_b32 v161, 0xffff0000, v151
  v_mul_f32 v160, v158, v160
  v_mul_f32 v161, v159, v161
  v_cvt_pk_bf16_f32 v160, v160, v161
  v_and_b32 v161, 0xffff0000, v160
  v_lshlrev_b32 v160, 16, v160
  v_add_f32 v15, v15, v160
  v_add_f32 v15, v15, v161
  s_add_u32 s27, s27, 1
  s_cmp_lt_u32 s27, 14
  s_cbranch_scc1 mk_xb
  v_mov_b32 v160, v14
  v_mov_b32 v161, v15
  s_nop 0
  v_permlane16_swap_b32 v14, v160
  v_permlane16_swap_b32 v15, v161
  v_add_f32 v14, v14, v160
  v_add_f32 v15, v15, v161
  v_mov_b32 v160, v14
  v_mov_b32 v161, v15
  s_nop 0
  v_permlane32_swap_b32 v14, v160
  v_permlane32_swap_b32 v15, v161
  v_add_f32 v14, v14, v160
  v_add_f32 v15, v15, v161
  v_cvt_pk_bf16_f32 v98, v14, v15
  v_lshlrev_b32 v99, 16, v98
  v_ashrrev_i32 v100, 31, v99
  v_or_b32 v100, 0x80000000, v100
  v_xor_b32 v99, v99, v100
  v_and_b32 v99, 0xffff0000, v99
  s_lshl_b32 s26, s21, 4
  v_add_u32 v102, s26, v8
  v_sub_u32 v103, 2047, v102
  v_or_b32 v99, v103, v99
  v_and_b32 v100, 0xffff0000, v98
  v_mul_f32 v100, 0xbfb8aa3b, v100
  v_exp_f32 v100, v100
  s_nop 0
  v_add_f32 v100, 1.0, v100
  v_rcp_f32 v100, v100
  s_nop 0
  v_cvt_pk_bf16_f32 v100, v100, v100
  v_and_b32 v100, 0xffff0000, v100
  v_sub_f32 v101, 1.0, v100
  v_cvt_pk_bf16_f32 v101, v101, v101
  v_and_b32 v101, 0xffff0000, v101
  v_lshlrev_b32 v103, 3, v102
  v_add_u32 v103, 14688256, v103
  v_lshlrev_b32 v102, 2, v102
  v_add_u32 v102, 14680064, v102
  s_mov_b64 exec, 0xffff
  global_store_dword v102, v99, s[4:5] sc1
  global_store_dwordx2 v103, v[100:101], s[4:5] sc1
  s_mov_b64 exec, -1
  s_lshl_b32 s26, s21, 2
  s_add_u32 s26, s26, 14946304
  s_waitcnt vmcnt(0)
  v_mov_b32 v1, s26
  v_mov_b32 v2, s20
  s_mov_b64 exec, 1
  global_store_dword v1, v2, s[4:5] sc1
  s_mov_b64 exec, -1
  v_mov_b32 v10, v251
  v_mov_b32 v12, v252
  v_mov_b32 v13, v253
  s_mov_b64 s[16:17], s[44:45]
  s_mov_b64 s[18:19], s[46:47]
  s_mov_b32 s25, s48
  s_mov_b32 s26, s49
mk_nx2:
  s_add_u32 s32, s22, 0
  s_and_b32 s32, s32, 3
  s_lshl_b32 s32, s32, 17
  v_add_u32 v11, s32, v10
  global_load_dwordx4 v[16:19], v11, s[16:17] offset:0
  global_load_dwordx4 v[80:83], v11, s[16:17] offset:256
  v_add_u32 v11, 0x8000, v11
  global_load_dwordx4 v[20:23], v11, s[16:17] offset:0
  global_load_dwordx4 v[84:87], v11, s[16:17] offset:256
  v_add_u32 v11, 0x8000, v11
  global_load_dwordx4 v[24:27], v11, s[16:17] offset:0
  global_load_dwordx4 v[88:91], v11, s[16:17] offset:256
  v_add_u32 v11, 0x8000, v11
  global_load_dwordx4 v[28:31], v11, s[16:17] offset:0
  global_load_dwordx4 v[92:95], v11, s[16:17] offset:256
  s_add_u32 s32, s22, 1
  s_and_b32 s32, s32, 3
  s_lshl_b32 s32, s32, 17
  v_add_u32 v11, s32, v10
  global_load_dwordx4 v[32:35], v11, s[16:17] offset:0
  global_load_dwordx4 v[96:99], v11, s[16:17] offset:256
  v_add_u32 v11, 0x8000, v11
  global_load_dwordx4 v[36:39], v11, s[16:17] offset:0
  global_load_dwordx4 v[100:103], v11, s[16:17] offset:256
  v_add_u32 v11, 0x8000, v11
  global_load_dwordx4 v[40:43], v11, s[16:17] offset:0
  global_load_dwordx4 v[104:107], v11, s[16:17] offset:256
  v_add_u32 v11, 0x8000, v11
  global_load_dwordx4 v[44:47], v11, s[16:17] offset:0
  global_load_dwordx4 v[108:111], v11, s[16:17] offset:256
  s_add_u32 s32, s22, 2
  s_and_b32 s32, s32, 3
  s_lshl_b32 s32, s32, 17
  v_add_u32 v11, s32, v10
  global_load_dwordx4 v[48:51], v11, s[16:17] offset:0
  global_load_dwordx4 v[112:115], v11, s[16:17] offset:256
  v_add_u32 v11, 0x8000, v11
  global_load_dwordx4 v[52:55], v11, s[16:17] offset:0
  global_load_dwordx4 v[116:119], v11, s[16:17] offset:256
  v_add_u32 v11, 0x8000, v11
  global_load_dwordx4 v[56:59], v11, s[16:17] offset:0
  global_load_dwordx4 v[120:123], v11, s[16:17] offset:256
  v_add_u32 v11, 0x8000, v11
  global_load_dwordx4 v[60:63], v11, s[16:17] offset:0
  global_load_dwordx4 v[124:127], v11, s[16:17] offset:256
  s_add_u32 s32, s22, 3
  s_and_b32 s32, s32, 3
  s_lshl_b32 s32, s32, 17
  v_add_u32 v11, s32, v10
  global_load_dwordx4 v[64:67], v11, s[16:17] offset:0
  global_load_dwordx4 v[128:131], v11, s[16:17] offset:256
  v_add_u32 v11, 0x8000, v11
  global_load_dwordx4 v[68:71], v11, s[16:17] offset:0
  global_load_dwordx4 v[132:135], v11, s[16:17] offset:256
  v_add_u32 v11, 0x8000, v11
  global_load_dwordx4 v[72:75], v11, s[16:17] offset:0
  global_load_dwordx4 v[136:139], v11, s[16:17] offset:256
  v_add_u32 v11, 0x8000, v11
  global_load_dwordx4 v[76:79], v11, s[16:17] offset:0
  global_load_dwordx4 v[140:143], v11, s[16:17] offset:256
mk_nx:
  s_mul_i32 s33, s25, 28
  s_lshl_b32 s34, s26, 2
  s_add_u32 s33, s33, s34
  s_mul_i32 s33, s33, 14
  s_lshl_b32 s33, s33, 10
  s_add_u32 s33, s33, s30
  v_lshlrev_b32 v1, 4, v3
  v_add_u32 v1, s33, v1
  s_lshl_b32 s34, s37, 11
  v_add_u32 v15, s34, v1
  s_lshl_b32 s34, s36, 11
  v_add_u32 v1, s34, v1
  s_mov_b32 s42, s31
  s_mov_b32 s43, s31
  s_cmp_eq_u32 s23, 1
  s_cbranch_scc1 mk_bV
  v_mul_u32_u24 v2, 528, v8
  v_lshl_add_u32 v2, v9, 4, v2
  ds_read_b128 a[128:131], v2 offset:0
  ds_read_b128 a[132:135], v2 offset:8448
  ds_read_b128 a[136:139], v2 offset:16896
  ds_read_b128 a[140:143], v2 offset:25344
  ds_read_b128 a[144:147], v2 offset:64
  ds_read_b128 a[148:151], v2 offset:8512
  ds_read_b128 a[152:155], v2 offset:16960
  ds_read_b128 a[156:159], v2 offset:25408
  ds_read_b128 a[160:163], v2 offset:128
  ds_read_b128 a[164:167], v2 offset:8576
  ds_read_b128 a[168:171], v2 offset:17024
  ds_read_b128 a[172:175], v2 offset:25472
  ds_read_b128 a[176:179], v2 offset:192
  ds_read_b128 a[180:183], v2 offset:8640
  ds_read_b128 a[184:187], v2 offset:17088
  ds_read_b128 a[188:191], v2 offset:25536
  ds_read_b128 a[192:195], v2 offset:256
  ds_read_b128 a[196:199], v2 offset:8704
  ds_read_b128 a[200:203], v2 offset:17152
  ds_read_b128 a[204:207], v2 offset:25600
  ds_read_b128 a[208:211], v2 offset:320
  ds_read_b128 a[212:215], v2 offset:8768
  ds_read_b128 a[216:219], v2 offset:17216
  ds_read_b128 a[220:223], v2 offset:25664
  ds_read_b128 a[224:227], v2 offset:384
  ds_read_b128 a[228:231], v2 offset:8832
  ds_read_b128 a[232:235], v2 offset:17280
  ds_read_b128 a[236:239], v2 offset:25728
  ds_read_b128 a[240:243], v2 offset:448
  ds_read_b128 a[244:247], v2 offset:8896
  ds_read_b128 a[248:251], v2 offset:17344
  ds_read_b128 a[252:255], v2 offset:25792
  s_branch mk_bD
mk_bV:
  v_lshrrev_b32 v2, 2, v8
  v_lshl_add_u32 v2, v9, 3, v2
  v_mul_u32_u24 v2, 144, v2
  v_and_b32 v14, 3, v8
  v_lshl_add_u32 v2, v14, 3, v2
  ds_read_b64_tr_b16 a[128:129], v2 offset:0
  ds_read_b64_tr_b16 a[130:131], v2 offset:576
  ds_read_b64_tr_b16 a[132:133], v2 offset:32
  ds_read_b64_tr_b16 a[134:135], v2 offset:608
  ds_read_b64_tr_b16 a[136:137], v2 offset:64
  ds_read_b64_tr_b16 a[138:139], v2 offset:640
  ds_read_b64_tr_b16 a[140:141], v2 offset:96
  ds_read_b64_tr_b16 a[142:143], v2 offset:672
  ds_read_b64_tr_b16 a[144:145], v2 offset:4608
  ds_read_b64_tr_b16 a[146:147], v2 offset:5184
  ds_read_b64_tr_b16 a[148:149], v2 offset:4640
  ds_read_b64_tr_b16 a[150:151], v2 offset:5216
  ds_read_b64_tr_b16 a[152:153], v2 offset:4672
  ds_read_b64_tr_b16 a[154:155], v2 offset:5248
  ds_read_b64_tr_b16 a[156:157], v2 offset:4704
  ds_read_b64_tr_b16 a[158:159], v2 offset:5280
  ds_read_b64_tr_b16 a[160:161], v2 offset:9216
  ds_read_b64_tr_b16 a[162:163], v2 offset:9792
  ds_read_b64_tr_b16 a[164:165], v2 offset:9248
  ds_read_b64_tr_b16 a[166:167], v2 offset:9824
  ds_read_b64_tr_b16 a[168:169], v2 offset:9280
  ds_read_b64_tr_b16 a[170:171], v2 offset:9856
  ds_read_b64_tr_b16 a[172:173], v2 offset:9312
  ds_read_b64_tr_b16 a[174:175], v2 offset:9888
  ds_read_b64_tr_b16 a[176:177], v2 offset:13824
  ds_read_b64_tr_b16 a[178:179], v2 offset:14400
  ds_read_b64_tr_b16 a[180:181], v2 offset:13856
  ds_read_b64_tr_b16 a[182:183], v2 offset:14432
  ds_read_b64_tr_b16 a[184:185], v2 offset:13888
  ds_read_b64_tr_b16 a[186:187], v2 offset:14464
  ds_read_b64_tr_b16 a[188:189], v2 offset:13920
  ds_read_b64_tr_b16 a[190:191], v2 offset:14496
  ds_read_b64_tr_b16 a[192:193], v2 offset:18432
  ds_read_b64_tr_b16 a[194:195], v2 offset:19008
  ds_read_b64_tr_b16 a[196:197], v2 offset:18464
  ds_read_b64_tr_b16 a[198:199], v2 offset:19040
  ds_read_b64_tr_b16 a[200:201], v2 offset:18496
  ds_read_b64_tr_b16 a[202:203], v2 offset:19072
  ds_read_b64_tr_b16 a[204:205], v2 offset:18528
  ds_read_b64_tr_b16 a[206:207], v2 offset:19104
  ds_read_b64_tr_b16 a[208:209], v2 offset:23040
  ds_read_b64_tr_b16 a[210:211], v2 offset:23616
  ds_read_b64_tr_b16 a[212:213], v2 offset:23072
  ds_read_b64_tr_b16 a[214:215], v2 offset:23648
  ds_read_b64_tr_b16 a[216:217], v2 offset:23104
  ds_read_b64_tr_b16 a[218:219], v2 offset:23680
  ds_read_b64_tr_b16 a[220:221], v2 offset:23136
  ds_read_b64_tr_b16 a[222:223], v2 offset:23712
  ds_read_b64_tr_b16 a[224:225], v2 offset:27648
  ds_read_b64_tr_b16 a[226:227], v2 offset:28224
  ds_read_b64_tr_b16 a[228:229], v2 offset:27680
  ds_read_b64_tr_b16 a[230:231], v2 offset:28256
  ds_read_b64_tr_b16 a[232:233], v2 offset:27712
  ds_read_b64_tr_b16 a[234:235], v2 offset:28288
  ds_read_b64_tr_b16 a[236:237], v2 offset:27744
  ds_read_b64_tr_b16 a[238:239], v2 offset:28320
  ds_read_b64_tr_b16 a[240:241], v2 offset:32256
  ds_read_b64_tr_b16 a[242:243], v2 offset:32832
  ds_read_b64_tr_b16 a[244:245], v2 offset:32288
  ds_read_b64_tr_b16 a[246:247], v2 offset:32864
  ds_read_b64_tr_b16 a[248:249], v2 offset:32320
  ds_read_b64_tr_b16 a[250:251], v2 offset:32896
  ds_read_b64_tr_b16 a[252:253], v2 offset:32352
  ds_read_b64_tr_b16 a[254:255], v2 offset:32928
mk_bD:
  s_add_u32 s32, s22, 0
  s_and_b32 s32, s32, 3
  s_lshl_b32 s33, s32, 17
  v_add_u32 v208, s33, v10
  s_mul_i32 s32, s32, 4352
  v_add_u32 v212, s32, v12
  s_add_u32 s32, s22, 1
  s_and_b32 s32, s32, 3
  s_lshl_b32 s33, s32, 17
  v_add_u32 v209, s33, v10
  s_mul_i32 s32, s32, 4352
  v_add_u32 v213, s32, v12
  s_add_u32 s32, s22, 2
  s_and_b32 s32, s32, 3
  s_lshl_b32 s33, s32, 17
  v_add_u32 v210, s33, v10
  s_mul_i32 s32, s32, 4352
  v_add_u32 v214, s32, v12
  s_add_u32 s32, s22, 3
  s_and_b32 s32, s32, 3
  s_lshl_b32 s33, s32, 17
  v_add_u32 v211, s33, v10
  s_mul_i32 s32, s32, 4352
  v_add_u32 v215, s32, v12
  s_mov_b32 s41, 0
  s_waitcnt vmcnt(0)
mk_ul:
  s_cmp_eq_u32 s41, 0
  s_cbranch_scc0 mk_w10
  ds_write_b128 v212, v[16:19] offset:0
  ds_write_b128 v212, v[20:23] offset:1088
  ds_write_b128 v212, v[24:27] offset:2176
  ds_write_b128 v212, v[28:31] offset:3264
  ds_write_b128 v213, v[32:35] offset:0
  ds_write_b128 v213, v[36:39] offset:1088
  ds_write_b128 v213, v[40:43] offset:2176
  ds_write_b128 v213, v[44:47] offset:3264
  ds_write_b128 v214, v[48:51] offset:0
  ds_write_b128 v214, v[52:55] offset:1088
  ds_write_b128 v214, v[56:59] offset:2176
  ds_write_b128 v214, v[60:63] offset:3264
  ds_write_b128 v215, v[64:67] offset:0
  ds_write_b128 v215, v[68:71] offset:1088
  ds_write_b128 v215, v[72:75] offset:2176
  ds_write_b128 v215, v[76:79] offset:3264
  s_branch mk_wd0
mk_w10:
  ds_write_b128 v212, a[0:3] offset:0
  ds_write_b128 v212, a[4:7] offset:1088
  ds_write_b128 v212, a[8:11] offset:2176
  ds_write_b128 v212, a[12:15] offset:3264
  ds_write_b128 v213, a[16:19] offset:0
  ds_write_b128 v213, a[20:23] offset:1088
  ds_write_b128 v213, a[24:27] offset:2176
  ds_write_b128 v213, a[28:31] offset:3264
  ds_write_b128 v214, a[32:35] offset:0
  ds_write_b128 v214, a[36:39] offset:1088
  ds_write_b128 v214, a[40:43] offset:2176
  ds_write_b128 v214, a[44:47] offset:3264
  ds_write_b128 v215, a[48:51] offset:0
  ds_write_b128 v215, a[52:55] offset:1088
  ds_write_b128 v215, a[56:59] offset:2176
  ds_write_b128 v215, a[60:63] offset:3264
mk_wd0:
  s_waitcnt lgkmcnt(0)
  ds_read_b128 v[216:219], v13 offset:0
  ds_read_b128 v[220:223], v13 offset:2176
  ds_read_b128 v[224:227], v13 offset:8704
  ds_read_b128 v[228:231], v13 offset:10880
  ds_read_b128 v[232:235], v13 offset:64
  ds_read_b128 v[236:239], v13 offset:2240
  ds_read_b128 v[240:243], v13 offset:8768
  ds_read_b128 v[244:247], v13 offset:10944
  s_waitcnt lgkmcnt(4)
  v_mfma_f32_16x16x32_bf16 v[144:147], v[216:219], a[128:131], 0
  v_mfma_f32_16x16x32_bf16 v[148:151], v[216:219], a[132:135], 0
  v_mfma_f32_16x16x32_bf16 v[152:155], v[216:219], a[136:139], 0
  v_mfma_f32_16x16x32_bf16 v[156:159], v[216:219], a[140:143], 0
  v_mfma_f32_16x16x32_bf16 v[160:163], v[220:223], a[128:131], 0
  v_mfma_f32_16x16x32_bf16 v[164:167], v[220:223], a[132:135], 0
  v_mfma_f32_16x16x32_bf16 v[168:171], v[220:223], a[136:139], 0
  v_mfma_f32_16x16x32_bf16 v[172:175], v[220:223], a[140:143], 0
  v_mfma_f32_16x16x32_bf16 v[176:179], v[224:227], a[128:131], 0
  v_mfma_f32_16x16x32_bf16 v[180:183], v[224:227], a[132:135], 0
  v_mfma_f32_16x16x32_bf16 v[184:187], v[224:227], a[136:139], 0
  v_mfma_f32_16x16x32_bf16 v[188:191], v[224:227], a[140:143], 0
  v_mfma_f32_16x16x32_bf16 v[192:195], v[228:231], a[128:131], 0
  v_mfma_f32_16x16x32_bf16 v[196:199], v[228:231], a[132:135], 0
  v_mfma_f32_16x16x32_bf16 v[200:203], v[228:231], a[136:139], 0
  v_mfma_f32_16x16x32_bf16 v[204:207], v[228:231], a[140:143], 0
  ds_read_b128 v[216:219], v13 offset:128
  ds_read_b128 v[220:223], v13 offset:2304
  ds_read_b128 v[224:227], v13 offset:8832
  ds_read_b128 v[228:231], v13 offset:11008
  s_waitcnt lgkmcnt(4)
  v_mfma_f32_16x16x32_bf16 v[144:147], v[232:235], a[144:147], v[144:147]
  v_mfma_f32_16x16x32_bf16 v[148:151], v[232:235], a[148:151], v[148:151]
  v_mfma_f32_16x16x32_bf16 v[152:155], v[232:235], a[152:155], v[152:155]
  v_mfma_f32_16x16x32_bf16 v[156:159], v[232:235], a[156:159], v[156:159]
  v_mfma_f32_16x16x32_bf16 v[160:163], v[236:239], a[144:147], v[160:163]
  v_mfma_f32_16x16x32_bf16 v[164:167], v[236:239], a[148:151], v[164:167]
  v_mfma_f32_16x16x32_bf16 v[168:171], v[236:239], a[152:155], v[168:171]
  v_mfma_f32_16x16x32_bf16 v[172:175], v[236:239], a[156:159], v[172:175]
  v_mfma_f32_16x16x32_bf16 v[176:179], v[240:243], a[144:147], v[176:179]
  v_mfma_f32_16x16x32_bf16 v[180:183], v[240:243], a[148:151], v[180:183]
  v_mfma_f32_16x16x32_bf16 v[184:187], v[240:243], a[152:155], v[184:187]
  v_mfma_f32_16x16x32_bf16 v[188:191], v[240:243], a[156:159], v[188:191]
  v_mfma_f32_16x16x32_bf16 v[192:195], v[244:247], a[144:147], v[192:195]
  v_mfma_f32_16x16x32_bf16 v[196:199], v[244:247], a[148:151], v[196:199]
  v_mfma_f32_16x16x32_bf16 v[200:203], v[244:247], a[152:155], v[200:203]
  v_mfma_f32_16x16x32_bf16 v[204:207], v[244:247], a[156:159], v[204:207]
  ds_read_b128 v[232:235], v13 offset:192
  ds_read_b128 v[236:239], v13 offset:2368
  ds_read_b128 v[240:243], v13 offset:8896
  ds_read_b128 v[244:247], v13 offset:11072
  s_waitcnt lgkmcnt(4)
  v_mfma_f32_16x16x32_bf16 v[144:147], v[216:219], a[160:163], v[144:147]
  v_mfma_f32_16x16x32_bf16 v[148:151], v[216:219], a[164:167], v[148:151]
  v_mfma_f32_16x16x32_bf16 v[152:155], v[216:219], a[168:171], v[152:155]
  v_mfma_f32_16x16x32_bf16 v[156:159], v[216:219], a[172:175], v[156:159]
  v_mfma_f32_16x16x32_bf16 v[160:163], v[220:223], a[160:163], v[160:163]
  v_mfma_f32_16x16x32_bf16 v[164:167], v[220:223], a[164:167], v[164:167]
  v_mfma_f32_16x16x32_bf16 v[168:171], v[220:223], a[168:171], v[168:171]
  v_mfma_f32_16x16x32_bf16 v[172:175], v[220:223], a[172:175], v[172:175]
  v_mfma_f32_16x16x32_bf16 v[176:179], v[224:227], a[160:163], v[176:179]
  v_mfma_f32_16x16x32_bf16 v[180:183], v[224:227], a[164:167], v[180:183]
  v_mfma_f32_16x16x32_bf16 v[184:187], v[224:227], a[168:171], v[184:187]
  v_mfma_f32_16x16x32_bf16 v[188:191], v[224:227], a[172:175], v[188:191]
  v_mfma_f32_16x16x32_bf16 v[192:195], v[228:231], a[160:163], v[192:195]
  v_mfma_f32_16x16x32_bf16 v[196:199], v[228:231], a[164:167], v[196:199]
  v_mfma_f32_16x16x32_bf16 v[200:203], v[228:231], a[168:171], v[200:203]
  v_mfma_f32_16x16x32_bf16 v[204:207], v[228:231], a[172:175], v[204:207]
  s_waitcnt lgkmcnt(0)
  v_mfma_f32_16x16x32_bf16 v[144:147], v[232:235], a[176:179], v[144:147]
  v_mfma_f32_16x16x32_bf16 v[148:151], v[232:235], a[180:183], v[148:151]
  v_mfma_f32_16x16x32_bf16 v[152:155], v[232:235], a[184:187], v[152:155]
  v_mfma_f32_16x16x32_bf16 v[156:159], v[232:235], a[188:191], v[156:159]
  v_mfma_f32_16x16x32_bf16 v[160:163], v[236:239], a[176:179], v[160:163]
  v_mfma_f32_16x16x32_bf16 v[164:167], v[236:239], a[180:183], v[164:167]
  v_mfma_f32_16x16x32_bf16 v[168:171], v[236:239], a[184:187], v[168:171]
  v_mfma_f32_16x16x32_bf16 v[172:175], v[236:239], a[188:191], v[172:175]
  v_mfma_f32_16x16x32_bf16 v[176:179], v[240:243], a[176:179], v[176:179]
  v_mfma_f32_16x16x32_bf16 v[180:183], v[240:243], a[180:183], v[180:183]
  v_mfma_f32_16x16x32_bf16 v[184:187], v[240:243], a[184:187], v[184:187]
  v_mfma_f32_16x16x32_bf16 v[188:191], v[240:243], a[188:191], v[188:191]
  v_mfma_f32_16x16x32_bf16 v[192:195], v[244:247], a[176:179], v[192:195]
  v_mfma_f32_16x16x32_bf16 v[196:199], v[244:247], a[180:183], v[196:199]
  v_mfma_f32_16x16x32_bf16 v[200:203], v[244:247], a[184:187], v[200:203]
  v_mfma_f32_16x16x32_bf16 v[204:207], v[244:247], a[188:191], v[204:207]
  s_cmp_eq_u32 s41, 0
  s_cbranch_scc0 mk_w11
  ds_write_b128 v212, v[80:83] offset:0
  ds_write_b128 v212, v[84:87] offset:1088
  ds_write_b128 v212, v[88:91] offset:2176
  ds_write_b128 v212, v[92:95] offset:3264
  ds_write_b128 v213, v[96:99] offset:0
  ds_write_b128 v213, v[100:103] offset:1088
  ds_write_b128 v213, v[104:107] offset:2176
  ds_write_b128 v213, v[108:111] offset:3264
  ds_write_b128 v214, v[112:115] offset:0
  ds_write_b128 v214, v[116:119] offset:1088
  ds_write_b128 v214, v[120:123] offset:2176
  ds_write_b128 v214, v[124:127] offset:3264
  ds_write_b128 v215, v[128:131] offset:0
  ds_write_b128 v215, v[132:135] offset:1088
  ds_write_b128 v215, v[136:139] offset:2176
  ds_write_b128 v215, v[140:143] offset:3264
  s_branch mk_wd1
mk_w11:
  ds_write_b128 v212, a[64:67] offset:0
  ds_write_b128 v212, a[68:71] offset:1088
  ds_write_b128 v212, a[72:75] offset:2176
  ds_write_b128 v212, a[76:79] offset:3264
  ds_write_b128 v213, a[80:83] offset:0
  ds_write_b128 v213, a[84:87] offset:1088
  ds_write_b128 v213, a[88:91] offset:2176
  ds_write_b128 v213, a[92:95] offset:3264
  ds_write_b128 v214, a[96:99] offset:0
  ds_write_b128 v214, a[100:103] offset:1088
  ds_write_b128 v214, a[104:107] offset:2176
  ds_write_b128 v214, a[108:111] offset:3264
  ds_write_b128 v215, a[112:115] offset:0
  ds_write_b128 v215, a[116:119] offset:1088
  ds_write_b128 v215, a[120:123] offset:2176
  ds_write_b128 v215, a[124:127] offset:3264
mk_wd1:
  s_waitcnt lgkmcnt(0)
  ds_read_b128 v[216:219], v13 offset:0
  ds_read_b128 v[220:223], v13 offset:2176
  ds_read_b128 v[224:227], v13 offset:8704
  ds_read_b128 v[228:231], v13 offset:10880
  ds_read_b128 v[232:235], v13 offset:64
  ds_read_b128 v[236:239], v13 offset:2240
  ds_read_b128 v[240:243], v13 offset:8768
  ds_read_b128 v[244:247], v13 offset:10944
  s_waitcnt lgkmcnt(4)
  v_mfma_f32_16x16x32_bf16 v[144:147], v[216:219], a[192:195], v[144:147]
  v_mfma_f32_16x16x32_bf16 v[148:151], v[216:219], a[196:199], v[148:151]
  v_mfma_f32_16x16x32_bf16 v[152:155], v[216:219], a[200:203], v[152:155]
  v_mfma_f32_16x16x32_bf16 v[156:159], v[216:219], a[204:207], v[156:159]
  v_mfma_f32_16x16x32_bf16 v[160:163], v[220:223], a[192:195], v[160:163]
  v_mfma_f32_16x16x32_bf16 v[164:167], v[220:223], a[196:199], v[164:167]
  v_mfma_f32_16x16x32_bf16 v[168:171], v[220:223], a[200:203], v[168:171]
  v_mfma_f32_16x16x32_bf16 v[172:175], v[220:223], a[204:207], v[172:175]
  v_mfma_f32_16x16x32_bf16 v[176:179], v[224:227], a[192:195], v[176:179]
  v_mfma_f32_16x16x32_bf16 v[180:183], v[224:227], a[196:199], v[180:183]
  v_mfma_f32_16x16x32_bf16 v[184:187], v[224:227], a[200:203], v[184:187]
  v_mfma_f32_16x16x32_bf16 v[188:191], v[224:227], a[204:207], v[188:191]
  v_mfma_f32_16x16x32_bf16 v[192:195], v[228:231], a[192:195], v[192:195]
  v_mfma_f32_16x16x32_bf16 v[196:199], v[228:231], a[196:199], v[196:199]
  v_mfma_f32_16x16x32_bf16 v[200:203], v[228:231], a[200:203], v[200:203]
  v_mfma_f32_16x16x32_bf16 v[204:207], v[228:231], a[204:207], v[204:207]
  ds_read_b128 v[216:219], v13 offset:128
  ds_read_b128 v[220:223], v13 offset:2304
  ds_read_b128 v[224:227], v13 offset:8832
  ds_read_b128 v[228:231], v13 offset:11008
  s_waitcnt lgkmcnt(4)
  v_mfma_f32_16x16x32_bf16 v[144:147], v[232:235], a[208:211], v[144:147]
  v_mfma_f32_16x16x32_bf16 v[148:151], v[232:235], a[212:215], v[148:151]
  v_mfma_f32_16x16x32_bf16 v[152:155], v[232:235], a[216:219], v[152:155]
  v_mfma_f32_16x16x32_bf16 v[156:159], v[232:235], a[220:223], v[156:159]
  v_mfma_f32_16x16x32_bf16 v[160:163], v[236:239], a[208:211], v[160:163]
  v_mfma_f32_16x16x32_bf16 v[164:167], v[236:239], a[212:215], v[164:167]
  v_mfma_f32_16x16x32_bf16 v[168:171], v[236:239], a[216:219], v[168:171]
  v_mfma_f32_16x16x32_bf16 v[172:175], v[236:239], a[220:223], v[172:175]
  v_mfma_f32_16x16x32_bf16 v[176:179], v[240:243], a[208:211], v[176:179]
  v_mfma_f32_16x16x32_bf16 v[180:183], v[240:243], a[212:215], v[180:183]
  v_mfma_f32_16x16x32_bf16 v[184:187], v[240:243], a[216:219], v[184:187]
  v_mfma_f32_16x16x32_bf16 v[188:191], v[240:243], a[220:223], v[188:191]
  v_mfma_f32_16x16x32_bf16 v[192:195], v[244:247], a[208:211], v[192:195]
  v_mfma_f32_16x16x32_bf16 v[196:199], v[244:247], a[212:215], v[196:199]
  v_mfma_f32_16x16x32_bf16 v[200:203], v[244:247], a[216:219], v[200:203]
  v_mfma_f32_16x16x32_bf16 v[204:207], v[244:247], a[220:223], v[204:207]
  ds_read_b128 v[232:235], v13 offset:192
  ds_read_b128 v[236:239], v13 offset:2368
  ds_read_b128 v[240:243], v13 offset:8896
  ds_read_b128 v[244:247], v13 offset:11072
  s_waitcnt lgkmcnt(4)
  v_mfma_f32_16x16x32_bf16 v[144:147], v[216:219], a[224:227], v[144:147]
  v_mfma_f32_16x16x32_bf16 v[148:151], v[216:219], a[228:231], v[148:151]
  v_mfma_f32_16x16x32_bf16 v[152:155], v[216:219], a[232:235], v[152:155]
  v_mfma_f32_16x16x32_bf16 v[156:159], v[216:219], a[236:239], v[156:159]
  v_mfma_f32_16x16x32_bf16 v[160:163], v[220:223], a[224:227], v[160:163]
  v_mfma_f32_16x16x32_bf16 v[164:167], v[220:223], a[228:231], v[164:167]
  v_mfma_f32_16x16x32_bf16 v[168:171], v[220:223], a[232:235], v[168:171]
  v_mfma_f32_16x16x32_bf16 v[172:175], v[220:223], a[236:239], v[172:175]
  v_mfma_f32_16x16x32_bf16 v[176:179], v[224:227], a[224:227], v[176:179]
  v_mfma_f32_16x16x32_bf16 v[180:183], v[224:227], a[228:231], v[180:183]
  v_mfma_f32_16x16x32_bf16 v[184:187], v[224:227], a[232:235], v[184:187]
  v_mfma_f32_16x16x32_bf16 v[188:191], v[224:227], a[236:239], v[188:191]
  v_mfma_f32_16x16x32_bf16 v[192:195], v[228:231], a[224:227], v[192:195]
  v_mfma_f32_16x16x32_bf16 v[196:199], v[228:231], a[228:231], v[196:199]
  v_mfma_f32_16x16x32_bf16 v[200:203], v[228:231], a[232:235], v[200:203]
  v_mfma_f32_16x16x32_bf16 v[204:207], v[228:231], a[236:239], v[204:207]
  s_waitcnt lgkmcnt(0)
  v_mfma_f32_16x16x32_bf16 v[144:147], v[232:235], a[240:243], v[144:147]
  v_mfma_f32_16x16x32_bf16 v[148:151], v[232:235], a[244:247], v[148:151]
  v_mfma_f32_16x16x32_bf16 v[152:155], v[232:235], a[248:251], v[152:155]
  v_mfma_f32_16x16x32_bf16 v[156:159], v[232:235], a[252:255], v[156:159]
  v_mfma_f32_16x16x32_bf16 v[160:163], v[236:239], a[240:243], v[160:163]
  v_mfma_f32_16x16x32_bf16 v[164:167], v[236:239], a[244:247], v[164:167]
  v_mfma_f32_16x16x32_bf16 v[168:171], v[236:239], a[248:251], v[168:171]
  v_mfma_f32_16x16x32_bf16 v[172:175], v[236:239], a[252:255], v[172:175]
  v_mfma_f32_16x16x32_bf16 v[176:179], v[240:243], a[240:243], v[176:179]
  v_mfma_f32_16x16x32_bf16 v[180:183], v[240:243], a[244:247], v[180:183]
  v_mfma_f32_16x16x32_bf16 v[184:187], v[240:243], a[248:251], v[184:187]
  v_mfma_f32_16x16x32_bf16 v[188:191], v[240:243], a[252:255], v[188:191]
  v_mfma_f32_16x16x32_bf16 v[192:195], v[244:247], a[240:243], v[192:195]
  v_mfma_f32_16x16x32_bf16 v[196:199], v[244:247], a[244:247], v[196:199]
  v_mfma_f32_16x16x32_bf16 v[200:203], v[244:247], a[248:251], v[200:203]
  v_mfma_f32_16x16x32_bf16 v[204:207], v[244:247], a[252:255], v[204:207]
  v_mov_b32 v4, v1
  v_pk_mul_f32 v[144:145], v[144:145], s[42:43]
  v_pk_mul_f32 v[160:161], v[160:161], s[42:43]
  v_pk_mul_f32 v[146:147], v[146:147], s[42:43]
  v_pk_mul_f32 v[162:163], v[162:163], s[42:43]
  v_cvt_pk_bf16_f32 v216, v144, v145
  v_cvt_pk_bf16_f32 v217, v160, v161
  v_cvt_pk_bf16_f32 v218, v146, v147
  v_cvt_pk_bf16_f32 v219, v162, v163
  global_store_dwordx4 v4, v[216:219], s[4:5] offset:0 sc1
  v_pk_mul_f32 v[176:177], v[176:177], s[42:43]
  v_pk_mul_f32 v[192:193], v[192:193], s[42:43]
  v_pk_mul_f32 v[178:179], v[178:179], s[42:43]
  v_pk_mul_f32 v[194:195], v[194:195], s[42:43]
  v_cvt_pk_bf16_f32 v220, v176, v177
  v_cvt_pk_bf16_f32 v221, v192, v193
  v_cvt_pk_bf16_f32 v222, v178, v179
  v_cvt_pk_bf16_f32 v223, v194, v195
  global_store_dwordx4 v4, v[220:223], s[4:5] offset:1024 sc1
  v_add_u32 v4, 14336, v4
  v_pk_mul_f32 v[148:149], v[148:149], s[42:43]
  v_pk_mul_f32 v[164:165], v[164:165], s[42:43]
  v_pk_mul_f32 v[150:151], v[150:151], s[42:43]
  v_pk_mul_f32 v[166:167], v[166:167], s[42:43]
  v_cvt_pk_bf16_f32 v224, v148, v149
  v_cvt_pk_bf16_f32 v225, v164, v165
  v_cvt_pk_bf16_f32 v226, v150, v151
  v_cvt_pk_bf16_f32 v227, v166, v167
  global_store_dwordx4 v4, v[224:227], s[4:5] offset:0 sc1
  v_pk_mul_f32 v[180:181], v[180:181], s[42:43]
  v_pk_mul_f32 v[196:197], v[196:197], s[42:43]
  v_pk_mul_f32 v[182:183], v[182:183], s[42:43]
  v_pk_mul_f32 v[198:199], v[198:199], s[42:43]
  v_cvt_pk_bf16_f32 v228, v180, v181
  v_cvt_pk_bf16_f32 v229, v196, v197
  v_cvt_pk_bf16_f32 v230, v182, v183
  v_cvt_pk_bf16_f32 v231, v198, v199
  global_store_dwordx4 v4, v[228:231], s[4:5] offset:1024 sc1
  v_add_u32 v4, 14336, v4
  v_pk_mul_f32 v[152:153], v[152:153], s[42:43]
  v_pk_mul_f32 v[168:169], v[168:169], s[42:43]
  v_pk_mul_f32 v[154:155], v[154:155], s[42:43]
  v_pk_mul_f32 v[170:171], v[170:171], s[42:43]
  v_cvt_pk_bf16_f32 v232, v152, v153
  v_cvt_pk_bf16_f32 v233, v168, v169
  v_cvt_pk_bf16_f32 v234, v154, v155
  v_cvt_pk_bf16_f32 v235, v170, v171
  global_store_dwordx4 v4, v[232:235], s[4:5] offset:0 sc1
  v_pk_mul_f32 v[184:185], v[184:185], s[42:43]
  v_pk_mul_f32 v[200:201], v[200:201], s[42:43]
  v_pk_mul_f32 v[186:187], v[186:187], s[42:43]
  v_pk_mul_f32 v[202:203], v[202:203], s[42:43]
  v_cvt_pk_bf16_f32 v236, v184, v185
  v_cvt_pk_bf16_f32 v237, v200, v201
  v_cvt_pk_bf16_f32 v238, v186, v187
  v_cvt_pk_bf16_f32 v239, v202, v203
  global_store_dwordx4 v4, v[236:239], s[4:5] offset:1024 sc1
  v_add_u32 v4, 14336, v4
  v_pk_mul_f32 v[156:157], v[156:157], s[42:43]
  v_pk_mul_f32 v[172:173], v[172:173], s[42:43]
  v_pk_mul_f32 v[158:159], v[158:159], s[42:43]
  v_pk_mul_f32 v[174:175], v[174:175], s[42:43]
  v_cvt_pk_bf16_f32 v240, v156, v157
  v_cvt_pk_bf16_f32 v241, v172, v173
  v_cvt_pk_bf16_f32 v242, v158, v159
  v_cvt_pk_bf16_f32 v243, v174, v175
  global_store_dwordx4 v4, v[240:243], s[4:5] offset:0 sc1
  v_pk_mul_f32 v[188:189], v[188:189], s[42:43]
  v_pk_mul_f32 v[204:205], v[204:205], s[42:43]
  v_pk_mul_f32 v[190:191], v[190:191], s[42:43]
  v_pk_mul_f32 v[206:207], v[206:207], s[42:43]
  v_cvt_pk_bf16_f32 v244, v188, v189
  v_cvt_pk_bf16_f32 v245, v204, v205
  v_cvt_pk_bf16_f32 v246, v190, v191
  v_cvt_pk_bf16_f32 v247, v206, v207
  global_store_dwordx4 v4, v[244:247], s[4:5] offset:1024 sc1
  v_mov_b32 v1, v15
  s_cmp_eq_u32 s22, 3
  s_cbranch_scc1 mk_jd
  s_cmp_eq_u32 s41, 1
  s_cbranch_scc1 mk_jd
  s_mov_b32 s41, 1
  global_load_dwordx4 a[0:3], v208, s[18:19] offset:0
  global_load_dwordx4 a[64:67], v208, s[18:19] offset:256
  v_add_u32 v208, 0x8000, v208
  global_load_dwordx4 a[4:7], v208, s[18:19] offset:0
  global_load_dwordx4 a[68:71], v208, s[18:19] offset:256
  v_add_u32 v208, 0x8000, v208
  global_load_dwordx4 a[8:11], v208, s[18:19] offset:0
  global_load_dwordx4 a[72:75], v208, s[18:19] offset:256
  v_add_u32 v208, 0x8000, v208
  global_load_dwordx4 a[12:15], v208, s[18:19] offset:0
  global_load_dwordx4 a[76:79], v208, s[18:19] offset:256
  v_add_u32 v208, 0x8000, v208
  global_load_dwordx4 a[16:19], v209, s[18:19] offset:0
  global_load_dwordx4 a[80:83], v209, s[18:19] offset:256
  v_add_u32 v209, 0x8000, v209
  global_load_dwordx4 a[20:23], v209, s[18:19] offset:0
  global_load_dwordx4 a[84:87], v209, s[18:19] offset:256
  v_add_u32 v209, 0x8000, v209
  global_load_dwordx4 a[24:27], v209, s[18:19] offset:0
  global_load_dwordx4 a[88:91], v209, s[18:19] offset:256
  v_add_u32 v209, 0x8000, v209
  global_load_dwordx4 a[28:31], v209, s[18:19] offset:0
  global_load_dwordx4 a[92:95], v209, s[18:19] offset:256
  v_add_u32 v209, 0x8000, v209
  global_load_dwordx4 a[32:35], v210, s[18:19] offset:0
  global_load_dwordx4 a[96:99], v210, s[18:19] offset:256
  v_add_u32 v210, 0x8000, v210
  global_load_dwordx4 a[36:39], v210, s[18:19] offset:0
  global_load_dwordx4 a[100:103], v210, s[18:19] offset:256
  v_add_u32 v210, 0x8000, v210
  global_load_dwordx4 a[40:43], v210, s[18:19] offset:0
  global_load_dwordx4 a[104:107], v210, s[18:19] offset:256
  v_add_u32 v210, 0x8000, v210
  global_load_dwordx4 a[44:47], v210, s[18:19] offset:0
  global_load_dwordx4 a[108:111], v210, s[18:19] offset:256
  v_add_u32 v210, 0x8000, v210
  global_load_dwordx4 a[48:51], v211, s[18:19] offset:0
  global_load_dwordx4 a[112:115], v211, s[18:19] offset:256
  v_add_u32 v211, 0x8000, v211
  global_load_dwordx4 a[52:55], v211, s[18:19] offset:0
  global_load_dwordx4 a[116:119], v211, s[18:19] offset:256
  v_add_u32 v211, 0x8000, v211
  global_load_dwordx4 a[56:59], v211, s[18:19] offset:0
  global_load_dwordx4 a[120:123], v211, s[18:19] offset:256
  v_add_u32 v211, 0x8000, v211
  global_load_dwordx4 a[60:63], v211, s[18:19] offset:0
  global_load_dwordx4 a[124:127], v211, s[18:19] offset:256
  v_add_u32 v211, 0x8000, v211
  s_waitcnt vmcnt(32)
  v_mov_b32 v5, s38
  v_mov_b32 v6, s20
  s_mov_b64 exec, 1
  global_store_dword v5, v6, s[4:5] sc1
  s_mov_b64 exec, -1
  s_waitcnt vmcnt(1)
  s_branch mk_ul
mk_jd:
  s_lshl_b32 s33, s39, 2
  s_add_u32 s33, s33, s22
  s_lshl_b32 s33, s33, 2
  s_add_u32 s33, s33, 14942208
  s_waitcnt vmcnt(0)
  v_mov_b32 v1, s33
  v_mov_b32 v2, s20
  s_mov_b64 exec, 1
  global_store_dword v1, v2, s[4:5] sc1
  s_mov_b64 exec, -1
  s_barrier
  v_mov_b32 v0, v250
  s_mov_b32 s24, s21
  s_cmp_lt_u32 s24, 112
  s_cbranch_scc1 mk_hu
  s_cmp_lt_u32 s24, 140
  s_cbranch_scc1 mk_hf
  s_cmp_lt_u32 s24, 204
  s_cbranch_scc1 mk_hs
  s_branch mk_ho
mk_hu:
  v_and_b32 v3, 63, v0
  s_mul_i32 s30, s24, 4682
  s_lshr_b32 s30, s30, 16
  s_mul_i32 s31, s30, 14
  s_sub_u32 s31, s24, s31
  s_mov_b32 s40, 1000000
  s_mul_i32 s32, s30, 14
  s_lshr_b32 s33, s31, 1
  s_add_u32 s32, s32, s33
  s_lshl_b32 s32, s32, 4
  s_add_u32 s32, s32, 14944000
  s_cmp_lg_u32 s22, 0
  s_cbranch_scc1 wgw_56
  v_lshlrev_b32 v4, 2, v3
  v_min_u32 v4, 12, v4
  v_add_u32 v4, s32, v4
mk_wf_57:
  global_load_dword v5, v4, s[4:5] offset:0 sc1
  s_waitcnt vmcnt(0)
  v_xor_b32 v5, s20, v5
  v_cmp_ne_u32 vcc, 0, v5
  s_cbranch_vccz mk_wd_58
  s_sleep 10
  s_sub_u32 s40, s40, 1
  s_cbranch_scc0 mk_wf_57
  s_mov_b32 s40, 0
mk_wd_58:
  s_add_u32 s32, s32, 112
  v_lshlrev_b32 v4, 2, v3
  v_min_u32 v4, 12, v4
  v_add_u32 v4, s32, v4
mk_wf_59:
  global_load_dword v5, v4, s[4:5] offset:0 sc1
  s_waitcnt vmcnt(0)
  v_xor_b32 v5, s20, v5
  v_cmp_ne_u32 vcc, 0, v5
  s_cbranch_vccz mk_wd_60
  s_sleep 10
  s_sub_u32 s40, s40, 1
  s_cbranch_scc0 mk_wf_59
  s_mov_b32 s40, 0
mk_wd_60:
  v_lshlrev_b32 v4, 2, v3
  v_add_u32 v4, 14946304, v4
mk_wf_61:
  global_load_dword v5, v4, s[4:5] offset:0 sc1
  global_load_dword v6, v4, s[4:5] offset:256 sc1
  s_waitcnt vmcnt(0)
  v_xor_b32 v5, s20, v5
  v_xor_b32 v6, s20, v6
  v_or_b32 v5, v5, v6
  v_cmp_ne_u32 vcc, 0, v5
  s_cbranch_vccz mk_wd_62
  s_sleep 20
  s_sub_u32 s40, s40, 1
  s_cbranch_scc0 mk_wf_61
  s_mov_b32 s40, 0
mk_wd_62:
wgw_56:
  s_barrier
  s_mul_i32 s32, s30, 56
  s_lshl_b32 s33, s31, 1
  s_add_u32 s32, s32, s33
  s_mul_i32 s32, s32, 14336
  s_add_u32 s32, s32, 6422528
  v_lshlrev_b32 v4, 4, v3
  v_add_u32 v5, s32, v4
  v_bfe_u32 v6, v3, 3, 1
  v_mul_u32_u24 v6, 14336, v6
  v_and_b32 v7, 7, v3
  v_lshl_add_u32 v6, v7, 4, v6
  v_lshrrev_b32 v7, 4, v3
  v_lshl_add_u32 v6, v7, 8, v6
  s_mul_i32 s34, s22, 28672
  s_add_u32 s34, s34, 12849152
  v_add_u32 v11, s34, v6
  s_add_u32 s34, s34, 7168
  v_add_u32 v12, s34, v6
  s_add_u32 s34, s34, 7168
  global_load_dwordx4 v[16:19], v11, s[4:5] offset:-4096 sc1
  global_load_dwordx4 v[20:23], v11, s[4:5] offset:-3968 sc1
  global_load_dwordx4 v[24:27], v11, s[4:5] offset:-3072 sc1
  global_load_dwordx4 v[28:31], v11, s[4:5] offset:-2944 sc1
  global_load_dwordx4 v[32:35], v11, s[4:5] offset:-2048 sc1
  global_load_dwordx4 v[36:39], v11, s[4:5] offset:-1920 sc1
  global_load_dwordx4 v[40:43], v11, s[4:5] offset:-1024 sc1
  global_load_dwordx4 v[44:47], v11, s[4:5] offset:-896 sc1
  global_load_dwordx4 v[48:51], v11, s[4:5] offset:0 sc1
  global_load_dwordx4 v[52:55], v11, s[4:5] offset:128 sc1
  global_load_dwordx4 v[56:59], v11, s[4:5] offset:1024 sc1
  global_load_dwordx4 v[60:63], v11, s[4:5] offset:1152 sc1
  global_load_dwordx4 v[64:67], v11, s[4:5] offset:2048 sc1
  global_load_dwordx4 v[68:71], v11, s[4:5] offset:2176 sc1
  global_load_dwordx4 v[72:75], v12, s[4:5] offset:-4096 sc1
  global_load_dwordx4 v[76:79], v12, s[4:5] offset:-3968 sc1
  global_load_dwordx4 v[80:83], v12, s[4:5] offset:-3072 sc1
  global_load_dwordx4 v[84:87], v12, s[4:5] offset:-2944 sc1
  global_load_dwordx4 v[88:91], v12, s[4:5] offset:-2048 sc1
  global_load_dwordx4 v[92:95], v12, s[4:5] offset:-1920 sc1
  global_load_dwordx4 v[96:99], v12, s[4:5] offset:-1024 sc1
  global_load_dwordx4 v[100:103], v12, s[4:5] offset:-896 sc1
  global_load_dwordx4 v[104:107], v12, s[4:5] offset:0 sc1
  global_load_dwordx4 v[108:111], v12, s[4:5] offset:128 sc1
  global_load_dwordx4 v[112:115], v12, s[4:5] offset:1024 sc1
  global_load_dwordx4 v[116:119], v12, s[4:5] offset:1152 sc1
  global_load_dwordx4 v[120:123], v12, s[4:5] offset:2048 sc1
  global_load_dwordx4 v[124:127], v12, s[4:5] offset:2176 sc1
  v_add_u32 v8, 0, v5
  global_load_dwordx4 a[0:3], v8, s[4:5] offset:0 sc1
  global_load_dwordx4 a[4:7], v8, s[4:5] offset:1024 sc1
  global_load_dwordx4 a[8:11], v8, s[4:5] offset:2048 sc1
  global_load_dwordx4 a[12:15], v8, s[4:5] offset:3072 sc1
  v_add_u32 v8, 4096, v8
  global_load_dwordx4 a[16:19], v8, s[4:5] offset:0 sc1
  global_load_dwordx4 a[20:23], v8, s[4:5] offset:1024 sc1
  global_load_dwordx4 a[24:27], v8, s[4:5] offset:2048 sc1
  global_load_dwordx4 a[28:31], v8, s[4:5] offset:3072 sc1
  v_add_u32 v8, 4096, v8
  global_load_dwordx4 a[32:35], v8, s[4:5] offset:0 sc1
  global_load_dwordx4 a[36:39], v8, s[4:5] offset:1024 sc1
  global_load_dwordx4 a[40:43], v8, s[4:5] offset:2048 sc1
  global_load_dwordx4 a[44:47], v8, s[4:5] offset:3072 sc1
  v_add_u32 v8, 4096, v8
  global_load_dwordx4 a[48:51], v8, s[4:5] offset:0 sc1
  global_load_dwordx4 a[52:55], v8, s[4:5] offset:1024 sc1
  v_add_u32 v8, 14336, v5
  global_load_dwordx4 a[112:115], v8, s[4:5] offset:0 sc1
  global_load_dwordx4 a[116:119], v8, s[4:5] offset:1024 sc1
  global_load_dwordx4 a[120:123], v8, s[4:5] offset:2048 sc1
  global_load_dwordx4 a[124:127], v8, s[4:5] offset:3072 sc1
  v_add_u32 v8, 4096, v8
  global_load_dwordx4 a[128:131], v8, s[4:5] offset:0 sc1
  global_load_dwordx4 a[132:135], v8, s[4:5] offset:1024 sc1
  global_load_dwordx4 a[136:139], v8, s[4:5] offset:2048 sc1
  global_load_dwordx4 a[140:143], v8, s[4:5] offset:3072 sc1
  v_add_u32 v8, 4096, v8
  global_load_dwordx4 a[144:147], v8, s[4:5] offset:0 sc1
  global_load_dwordx4 a[148:151], v8, s[4:5] offset:1024 sc1
  global_load_dwordx4 a[152:155], v8, s[4:5] offset:2048 sc1
  global_load_dwordx4 a[156:159], v8, s[4:5] offset:3072 sc1
  v_add_u32 v8, 4096, v8
  global_load_dwordx4 a[160:163], v8, s[4:5] offset:0 sc1
  global_load_dwordx4 a[164:167], v8, s[4:5] offset:1024 sc1
  v_add_u32 v8, 401408, v5
  global_load_dwordx4 a[56:59], v8, s[4:5] offset:0 sc1
  global_load_dwordx4 a[60:63], v8, s[4:5] offset:1024 sc1
  global_load_dwordx4 a[64:67], v8, s[4:5] offset:2048 sc1
  global_load_dwordx4 a[68:71], v8, s[4:5] offset:3072 sc1
  v_add_u32 v8, 4096, v8
  global_load_dwordx4 a[72:75], v8, s[4:5] offset:0 sc1
  global_load_dwordx4 a[76:79], v8, s[4:5] offset:1024 sc1
  global_load_dwordx4 a[80:83], v8, s[4:5] offset:2048 sc1
  global_load_dwordx4 a[84:87], v8, s[4:5] offset:3072 sc1
  v_add_u32 v8, 4096, v8
  global_load_dwordx4 a[88:91], v8, s[4:5] offset:0 sc1
  global_load_dwordx4 a[92:95], v8, s[4:5] offset:1024 sc1
  global_load_dwordx4 a[96:99], v8, s[4:5] offset:2048 sc1
  global_load_dwordx4 a[100:103], v8, s[4:5] offset:3072 sc1
  v_add_u32 v8, 4096, v8
  global_load_dwordx4 a[104:107], v8, s[4:5] offset:0 sc1
  global_load_dwordx4 a[108:111], v8, s[4:5] offset:1024 sc1
  v_add_u32 v8, 415744, v5
  global_load_dwordx4 a[168:171], v8, s[4:5] offset:0 sc1
  global_load_dwordx4 a[172:175], v8, s[4:5] offset:1024 sc1
  global_load_dwordx4 a[176:179], v8, s[4:5] offset:2048 sc1
  global_load_dwordx4 a[180:183], v8, s[4:5] offset:3072 sc1
  v_add_u32 v8, 4096, v8
  global_load_dwordx4 a[184:187], v8, s[4:5] offset:0 sc1
  global_load_dwordx4 a[188:191], v8, s[4:5] offset:1024 sc1
  global_load_dwordx4 a[192:195], v8, s[4:5] offset:2048 sc1
  global_load_dwordx4 a[196:199], v8, s[4:5] offset:3072 sc1
  v_add_u32 v8, 4096, v8
  global_load_dwordx4 a[200:203], v8, s[4:5] offset:0 sc1
  global_load_dwordx4 a[204:207], v8, s[4:5] offset:1024 sc1
  global_load_dwordx4 a[208:211], v8, s[4:5] offset:2048 sc1
  global_load_dwordx4 a[212:215], v8, s[4:5] offset:3072 sc1
  v_add_u32 v8, 4096, v8
  global_load_dwordx4 a[216:219], v8, s[4:5] offset:0 sc1
  global_load_dwordx4 a[220:223], v8, s[4:5] offset:1024 sc1
  s_mul_i32 s35, s22, 28
  s_add_u32 s35, s35, s33
  s_lshl_b32 s35, s35, 3
  s_add_u32 s35, s35, s30
  s_lshl_b32 s35, s35, 11
  s_add_u32 s35, s35, 33554432
  v_add_u32 v9, s35, v4
  v_add_u32 v10, 16384, v9
  s_mul_i32 s38, s22, 14
  s_add_u32 s38, s38, s31
  s_lshl_b32 s38, s38, 3
  s_add_u32 s38, s38, s30
  s_lshl_b32 s38, s38, 2
  s_add_u32 s38, s38, 14950400
  s_lshl_b32 s39, s24, 2
  s_add_u32 s39, s39, s22
  s_lshl_b32 s39, s39, 7
  s_add_u32 s39, s39, 15007744
  v_mov_b32 v5, s39
  v_mov_b32 v6, s20
  s_mov_b32 s36, 0
  s_waitcnt vmcnt(0)
mk_uloop:
  s_cmp_lt_u32 s36, 2
  s_cbranch_scc1 upace_63
  s_lshl_b32 s39, s36, 2
  s_sub_i32 s39, s39, 9
  s_max_i32 s39, s39, 1
  s_waitcnt vmcnt(0)
  s_mov_b64 exec, 1
  global_store_dword v5, v6, s[4:5] sc1
  s_mov_b64 exec, -1
  s_cmp_lg_u32 s22, 0
  s_cbranch_scc1 wgw_64
  s_and_b32 s3, s2, 15
  s_lshl_b32 s3, s3, 8
  s_add_u32 s3, s3, 14995456
  v_mov_b32 v176, s3
mk_pg_65:
  global_load_dword v177, v176, s[4:5] sc1
  s_waitcnt vmcnt(0)
  v_readfirstlane_b32 s3, v177
  s_nop 0
  s_sub_u32 s3, s3, s20
  s_sub_u32 s3, s3, s39
  s_cmp_lt_u32 s3, 128
  s_cbranch_scc1 mk_pd_66
  s_sleep 50
  s_sub_u32 s40, s40, 1
  s_cbranch_scc0 mk_pg_65
  s_mov_b32 s40, 0
mk_pd_66:
wgw_64:
  s_barrier
upace_63:
  s_add_u32 s36, s36, 1
  s_cmp_lt_u32 s36, 16
  s_cselect_b32 s37, 114688, 0
  v_add_u32 v11, s37, v11
  v_add_u32 v12, s37, v12
  s_waitcnt vmcnt(27)
  v_mfma_f32_16x16x32_bf16 v[128:131], v[16:19], a[0:3], 0
  v_mfma_f32_16x16x32_bf16 v[132:135], v[16:19], a[56:59], 0
  v_mfma_f32_16x16x32_bf16 v[136:139], v[16:19], a[112:115], 0
  v_mfma_f32_16x16x32_bf16 v[140:143], v[16:19], a[168:171], 0
  global_load_dwordx4 v[16:19], v11, s[4:5] offset:-4096 sc1
  s_waitcnt vmcnt(27)
  v_mfma_f32_16x16x32_bf16 v[144:147], v[20:23], a[0:3], 0
  v_mfma_f32_16x16x32_bf16 v[148:151], v[20:23], a[56:59], 0
  v_mfma_f32_16x16x32_bf16 v[152:155], v[20:23], a[112:115], 0
  v_mfma_f32_16x16x32_bf16 v[156:159], v[20:23], a[168:171], 0
  global_load_dwordx4 v[20:23], v11, s[4:5] offset:-3968 sc1
  s_waitcnt vmcnt(27)
  v_mfma_f32_16x16x32_bf16 v[128:131], v[24:27], a[4:7], v[128:131]
  v_mfma_f32_16x16x32_bf16 v[132:135], v[24:27], a[60:63], v[132:135]
  v_mfma_f32_16x16x32_bf16 v[136:139], v[24:27], a[116:119], v[136:139]
  v_mfma_f32_16x16x32_bf16 v[140:143], v[24:27], a[172:175], v[140:143]
  global_load_dwordx4 v[24:27], v11, s[4:5] offset:-3072 sc1
  s_waitcnt vmcnt(27)
  v_mfma_f32_16x16x32_bf16 v[144:147], v[28:31], a[4:7], v[144:147]
  v_mfma_f32_16x16x32_bf16 v[148:151], v[28:31], a[60:63], v[148:151]
  v_mfma_f32_16x16x32_bf16 v[152:155], v[28:31], a[116:119], v[152:155]
  v_mfma_f32_16x16x32_bf16 v[156:159], v[28:31], a[172:175], v[156:159]
  global_load_dwordx4 v[28:31], v11, s[4:5] offset:-2944 sc1
  s_waitcnt vmcnt(27)
  v_mfma_f32_16x16x32_bf16 v[128:131], v[32:35], a[8:11], v[128:131]
  v_mfma_f32_16x16x32_bf16 v[132:135], v[32:35], a[64:67], v[132:135]
  v_mfma_f32_16x16x32_bf16 v[136:139], v[32:35], a[120:123], v[136:139]
  v_mfma_f32_16x16x32_bf16 v[140:143], v[32:35], a[176:179], v[140:143]
  global_load_dwordx4 v[32:35], v11, s[4:5] offset:-2048 sc1
  s_waitcnt vmcnt(27)
  v_mfma_f32_16x16x32_bf16 v[144:147], v[36:39], a[8:11], v[144:147]
  v_mfma_f32_16x16x32_bf16 v[148:151], v[36:39], a[64:67], v[148:151]
  v_mfma_f32_16x16x32_bf16 v[152:155], v[36:39], a[120:123], v[152:155]
  v_mfma_f32_16x16x32_bf16 v[156:159], v[36:39], a[176:179], v[156:159]
  global_load_dwordx4 v[36:39], v11, s[4:5] offset:-1920 sc1
  s_waitcnt vmcnt(27)
  v_mfma_f32_16x16x32_bf16 v[128:131], v[40:43], a[12:15], v[128:131]
  v_mfma_f32_16x16x32_bf16 v[132:135], v[40:43], a[68:71], v[132:135]
  v_mfma_f32_16x16x32_bf16 v[136:139], v[40:43], a[124:127], v[136:139]
  v_mfma_f32_16x16x32_bf16 v[140:143], v[40:43], a[180:183], v[140:143]
  global_load_dwordx4 v[40:43], v11, s[4:5] offset:-1024 sc1
  s_waitcnt vmcnt(27)
  v_mfma_f32_16x16x32_bf16 v[144:147], v[44:47], a[12:15], v[144:147]
  v_mfma_f32_16x16x32_bf16 v[148:151], v[44:47], a[68:71], v[148:151]
  v_mfma_f32_16x16x32_bf16 v[152:155], v[44:47], a[124:127], v[152:155]
  v_mfma_f32_16x16x32_bf16 v[156:159], v[44:47], a[180:183], v[156:159]
  global_load_dwordx4 v[44:47], v11, s[4:5] offset:-896 sc1
  s_waitcnt vmcnt(27)
  v_mfma_f32_16x16x32_bf16 v[128:131], v[48:51], a[16:19], v[128:131]
  v_mfma_f32_16x16x32_bf16 v[132:135], v[48:51], a[72:75], v[132:135]
  v_mfma_f32_16x16x32_bf16 v[136:139], v[48:51], a[128:131], v[136:139]
  v_mfma_f32_16x16x32_bf16 v[140:143], v[48:51], a[184:187], v[140:143]
  global_load_dwordx4 v[48:51], v11, s[4:5] offset:0 sc1
  s_waitcnt vmcnt(27)
  v_mfma_f32_16x16x32_bf16 v[144:147], v[52:55], a[16:19], v[144:147]
  v_mfma_f32_16x16x32_bf16 v[148:151], v[52:55], a[72:75], v[148:151]
  v_mfma_f32_16x16x32_bf16 v[152:155], v[52:55], a[128:131], v[152:155]
  v_mfma_f32_16x16x32_bf16 v[156:159], v[52:55], a[184:187], v[156:159]
  global_load_dwordx4 v[52:55], v11, s[4:5] offset:128 sc1
  s_waitcnt vmcnt(27)
  v_mfma_f32_16x16x32_bf16 v[128:131], v[56:59], a[20:23], v[128:131]
  v_mfma_f32_16x16x32_bf16 v[132:135], v[56:59], a[76:79], v[132:135]
  v_mfma_f32_16x16x32_bf16 v[136:139], v[56:59], a[132:135], v[136:139]
  v_mfma_f32_16x16x32_bf16 v[140:143], v[56:59], a[188:191], v[140:143]
  global_load_dwordx4 v[56:59], v11, s[4:5] offset:1024 sc1
  s_waitcnt vmcnt(27)
  v_mfma_f32_16x16x32_bf16 v[144:147], v[60:63], a[20:23], v[144:147]
  v_mfma_f32_16x16x32_bf16 v[148:151], v[60:63], a[76:79], v[148:151]
  v_mfma_f32_16x16x32_bf16 v[152:155], v[60:63], a[132:135], v[152:155]
  v_mfma_f32_16x16x32_bf16 v[156:159], v[60:63], a[188:191], v[156:159]
  global_load_dwordx4 v[60:63], v11, s[4:5] offset:1152 sc1
  s_waitcnt vmcnt(27)
  v_mfma_f32_16x16x32_bf16 v[128:131], v[64:67], a[24:27], v[128:131]
  v_mfma_f32_16x16x32_bf16 v[132:135], v[64:67], a[80:83], v[132:135]
  v_mfma_f32_16x16x32_bf16 v[136:139], v[64:67], a[136:139], v[136:139]
  v_mfma_f32_16x16x32_bf16 v[140:143], v[64:67], a[192:195], v[140:143]
  global_load_dwordx4 v[64:67], v11, s[4:5] offset:2048 sc1
  s_waitcnt vmcnt(27)
  v_mfma_f32_16x16x32_bf16 v[144:147], v[68:71], a[24:27], v[144:147]
  v_mfma_f32_16x16x32_bf16 v[148:151], v[68:71], a[80:83], v[148:151]
  v_mfma_f32_16x16x32_bf16 v[152:155], v[68:71], a[136:139], v[152:155]
  v_mfma_f32_16x16x32_bf16 v[156:159], v[68:71], a[192:195], v[156:159]
  global_load_dwordx4 v[68:71], v11, s[4:5] offset:2176 sc1
  s_waitcnt vmcnt(27)
  v_mfma_f32_16x16x32_bf16 v[128:131], v[72:75], a[28:31], v[128:131]
  v_mfma_f32_16x16x32_bf16 v[132:135], v[72:75], a[84:87], v[132:135]
  v_mfma_f32_16x16x32_bf16 v[136:139], v[72:75], a[140:143], v[136:139]
  v_mfma_f32_16x16x32_bf16 v[140:143], v[72:75], a[196:199], v[140:143]
  global_load_dwordx4 v[72:75], v12, s[4:5] offset:-4096 sc1
  s_waitcnt vmcnt(27)
  v_mfma_f32_16x16x32_bf16 v[144:147], v[76:79], a[28:31], v[144:147]
  v_mfma_f32_16x16x32_bf16 v[148:151], v[76:79], a[84:87], v[148:151]
  v_mfma_f32_16x16x32_bf16 v[152:155], v[76:79], a[140:143], v[152:155]
  v_mfma_f32_16x16x32_bf16 v[156:159], v[76:79], a[196:199], v[156:159]
  global_load_dwordx4 v[76:79], v12, s[4:5] offset:-3968 sc1
  s_waitcnt vmcnt(27)
  v_mfma_f32_16x16x32_bf16 v[128:131], v[80:83], a[32:35], v[128:131]
  v_mfma_f32_16x16x32_bf16 v[132:135], v[80:83], a[88:91], v[132:135]
  v_mfma_f32_16x16x32_bf16 v[136:139], v[80:83], a[144:147], v[136:139]
  v_mfma_f32_16x16x32_bf16 v[140:143], v[80:83], a[200:203], v[140:143]
  global_load_dwordx4 v[80:83], v12, s[4:5] offset:-3072 sc1
  s_waitcnt vmcnt(27)
  v_mfma_f32_16x16x32_bf16 v[144:147], v[84:87], a[32:35], v[144:147]
  v_mfma_f32_16x16x32_bf16 v[148:151], v[84:87], a[88:91], v[148:151]
  v_mfma_f32_16x16x32_bf16 v[152:155], v[84:87], a[144:147], v[152:155]
  v_mfma_f32_16x16x32_bf16 v[156:159], v[84:87], a[200:203], v[156:159]
  global_load_dwordx4 v[84:87], v12, s[4:5] offset:-2944 sc1
  s_waitcnt vmcnt(27)
  v_mfma_f32_16x16x32_bf16 v[128:131], v[88:91], a[36:39], v[128:131]
  v_mfma_f32_16x16x32_bf16 v[132:135], v[88:91], a[92:95], v[132:135]
  v_mfma_f32_16x16x32_bf16 v[136:139], v[88:91], a[148:151], v[136:139]
  v_mfma_f32_16x16x32_bf16 v[140:143], v[88:91], a[204:207], v[140:143]
  global_load_dwordx4 v[88:91], v12, s[4:5] offset:-2048 sc1
  s_waitcnt vmcnt(27)
  v_mfma_f32_16x16x32_bf16 v[144:147], v[92:95], a[36:39], v[144:147]
  v_mfma_f32_16x16x32_bf16 v[148:151], v[92:95], a[92:95], v[148:151]
  v_mfma_f32_16x16x32_bf16 v[152:155], v[92:95], a[148:151], v[152:155]
  v_mfma_f32_16x16x32_bf16 v[156:159], v[92:95], a[204:207], v[156:159]
  global_load_dwordx4 v[92:95], v12, s[4:5] offset:-1920 sc1
  s_waitcnt vmcnt(27)
  v_mfma_f32_16x16x32_bf16 v[128:131], v[96:99], a[40:43], v[128:131]
  v_mfma_f32_16x16x32_bf16 v[132:135], v[96:99], a[96:99], v[132:135]
  v_mfma_f32_16x16x32_bf16 v[136:139], v[96:99], a[152:155], v[136:139]
  v_mfma_f32_16x16x32_bf16 v[140:143], v[96:99], a[208:211], v[140:143]
  global_load_dwordx4 v[96:99], v12, s[4:5] offset:-1024 sc1
  s_waitcnt vmcnt(27)
  v_mfma_f32_16x16x32_bf16 v[144:147], v[100:103], a[40:43], v[144:147]
  v_mfma_f32_16x16x32_bf16 v[148:151], v[100:103], a[96:99], v[148:151]
  v_mfma_f32_16x16x32_bf16 v[152:155], v[100:103], a[152:155], v[152:155]
  v_mfma_f32_16x16x32_bf16 v[156:159], v[100:103], a[208:211], v[156:159]
  global_load_dwordx4 v[100:103], v12, s[4:5] offset:-896 sc1
  s_waitcnt vmcnt(27)
  v_mfma_f32_16x16x32_bf16 v[128:131], v[104:107], a[44:47], v[128:131]
  v_mfma_f32_16x16x32_bf16 v[132:135], v[104:107], a[100:103], v[132:135]
  v_mfma_f32_16x16x32_bf16 v[136:139], v[104:107], a[156:159], v[136:139]
  v_mfma_f32_16x16x32_bf16 v[140:143], v[104:107], a[212:215], v[140:143]
  global_load_dwordx4 v[104:107], v12, s[4:5] offset:0 sc1
  s_waitcnt vmcnt(27)
  v_mfma_f32_16x16x32_bf16 v[144:147], v[108:111], a[44:47], v[144:147]
  v_mfma_f32_16x16x32_bf16 v[148:151], v[108:111], a[100:103], v[148:151]
  v_mfma_f32_16x16x32_bf16 v[152:155], v[108:111], a[156:159], v[152:155]
  v_mfma_f32_16x16x32_bf16 v[156:159], v[108:111], a[212:215], v[156:159]
  global_load_dwordx4 v[108:111], v12, s[4:5] offset:128 sc1
  s_waitcnt vmcnt(27)
  v_mfma_f32_16x16x32_bf16 v[128:131], v[112:115], a[48:51], v[128:131]
  v_mfma_f32_16x16x32_bf16 v[132:135], v[112:115], a[104:107], v[132:135]
  v_mfma_f32_16x16x32_bf16 v[136:139], v[112:115], a[160:163], v[136:139]
  v_mfma_f32_16x16x32_bf16 v[140:143], v[112:115], a[216:219], v[140:143]
  global_load_dwordx4 v[112:115], v12, s[4:5] offset:1024 sc1
  s_waitcnt vmcnt(27)
  v_mfma_f32_16x16x32_bf16 v[144:147], v[116:119], a[48:51], v[144:147]
  v_mfma_f32_16x16x32_bf16 v[148:151], v[116:119], a[104:107], v[148:151]
  v_mfma_f32_16x16x32_bf16 v[152:155], v[116:119], a[160:163], v[152:155]
  v_mfma_f32_16x16x32_bf16 v[156:159], v[116:119], a[216:219], v[156:159]
  global_load_dwordx4 v[116:119], v12, s[4:5] offset:1152 sc1
  s_waitcnt vmcnt(27)
  v_mfma_f32_16x16x32_bf16 v[128:131], v[120:123], a[52:55], v[128:131]
  v_mfma_f32_16x16x32_bf16 v[132:135], v[120:123], a[108:111], v[132:135]
  v_mfma_f32_16x16x32_bf16 v[136:139], v[120:123], a[164:167], v[136:139]
  v_mfma_f32_16x16x32_bf16 v[140:143], v[120:123], a[220:223], v[140:143]
  global_load_dwordx4 v[120:123], v12, s[4:5] offset:2048 sc1
  s_waitcnt vmcnt(27)
  v_mfma_f32_16x16x32_bf16 v[144:147], v[124:127], a[52:55], v[144:147]
  v_mfma_f32_16x16x32_bf16 v[148:151], v[124:127], a[108:111], v[148:151]
  v_mfma_f32_16x16x32_bf16 v[152:155], v[124:127], a[164:167], v[152:155]
  v_mfma_f32_16x16x32_bf16 v[156:159], v[124:127], a[220:223], v[156:159]
  global_load_dwordx4 v[124:127], v12, s[4:5] offset:2176 sc1
  s_waitcnt vmcnt(27)
  s_mov_b64 exec, 1
  global_store_dword v5, v6, s[4:5] sc1
  v_mov_b32 v5, s38
  s_mov_b64 exec, -1
  s_add_u32 s38, s38, 1792
  v_cvt_pk_bf16_f32 v160, v128, v129
  v_cvt_pk_bf16_f32 v161, v144, v145
  v_cvt_pk_bf16_f32 v162, v130, v131
  v_cvt_pk_bf16_f32 v163, v146, v147
  global_store_dwordx4 v9, v[160:163], s[4:5] offset:0 sc1
  v_cvt_pk_bf16_f32 v164, v132, v133
  v_cvt_pk_bf16_f32 v165, v148, v149
  v_cvt_pk_bf16_f32 v166, v134, v135
  v_cvt_pk_bf16_f32 v167, v150, v151
  global_store_dwordx4 v9, v[164:167], s[4:5] offset:1024 sc1
  v_cvt_pk_bf16_f32 v168, v136, v137
  v_cvt_pk_bf16_f32 v169, v152, v153
  v_cvt_pk_bf16_f32 v170, v138, v139
  v_cvt_pk_bf16_f32 v171, v154, v155
  global_store_dwordx4 v10, v[168:171], s[4:5] offset:0 sc1
  v_cvt_pk_bf16_f32 v172, v140, v141
  v_cvt_pk_bf16_f32 v173, v156, v157
  v_cvt_pk_bf16_f32 v174, v142, v143
  v_cvt_pk_bf16_f32 v175, v158, v159
  global_store_dwordx4 v10, v[172:175], s[4:5] offset:1024 sc1
  s_cmp_lg_u32 s36, 1
  s_cbranch_scc1 uq_67
  s_waitcnt vmcnt(0)
  s_mov_b64 exec, 1
  global_store_dword v5, v6, s[4:5] sc1
  s_mov_b64 exec, -1
uq_67:
  v_add_u32 v9, 1835008, v9
  v_add_u32 v10, 1835008, v10
  s_cmp_lt_u32 s36, 16
  s_cbranch_scc1 mk_uloop
  s_waitcnt vmcnt(0)
  s_mov_b64 exec, 1
  global_store_dword v5, v6, s[4:5] sc1
  s_mov_b64 exec, -1
  s_cmp_lt_u32 s24, 28
  s_cbranch_scc0 mk_fin
  s_branch mk_ho
mk_hf:
  s_sub_u32 s24, s24, 112
  s_mov_b32 s40, 1000000
  v_and_b32 v3, 63, v0
  s_cmp_lg_u32 s22, 0
  s_cbranch_scc1 wgw_68
  s_and_b32 s3, s2, 15
  s_lshl_b32 s3, s3, 8
  s_add_u32 s3, s3, 14995456
  v_mov_b32 v4, s3
mk_pg_69:
  global_load_dword v5, v4, s[4:5] sc1
  s_waitcnt vmcnt(0)
  v_readfirstlane_b32 s3, v5
  s_nop 0
  s_sub_u32 s3, s3, s20
  s_sub_u32 s3, s3, 1
  s_cmp_lt_u32 s3, 128
  s_cbranch_scc1 mk_pd_70
  s_sleep 80
  s_sub_u32 s40, s40, 1
  s_cbranch_scc0 mk_pg_69
  s_mov_b32 s40, 0
mk_pd_70:
wgw_68:
  s_barrier
  s_load_dwordx2 s[8:9], s[0:1], 0
  s_load_dwordx4 s[12:15], s[0:1], 80
  s_load_dwordx2 s[10:11], s[0:1], 72
  v_lshlrev_b32 v1, 5, v0
  v_add_u32 v1, 14680064, v1
  global_load_dwordx4 v[4:7], v1, s[4:5] sc1
  global_load_dwordx4 v[8:11], v1, s[4:5] offset:16 sc1
  s_waitcnt vmcnt(0)
  v_max3_u32 v4, v4, v5, v6
  v_max3_u32 v8, v8, v9, v10
  v_max3_u32 v4, v4, v7, v11
  v_max_u32 v4, v4, v8
  s_nop 1
  v_max_u32_dpp v4, v4, v4 row_ror:8 row_mask:0xf bank_mask:0xf
  s_nop 1
  v_max_u32_dpp v4, v4, v4 row_ror:4 row_mask:0xf bank_mask:0xf
  s_nop 1
  v_max_u32_dpp v4, v4, v4 row_ror:2 row_mask:0xf bank_mask:0xf
  s_nop 1
  v_max_u32_dpp v4, v4, v4 row_ror:1 row_mask:0xf bank_mask:0xf
  v_mov_b32 v5, v4
  s_nop 1
  v_permlane16_swap_b32 v4, v5
  v_max_u32 v4, v4, v5
  v_mov_b32 v5, v4
  s_nop 1
  v_permlane32_swap_b32 v4, v5
  v_max_u32 v4, v4, v5
  v_lshrrev_b32 v2, 6, v0
  v_lshlrev_b32 v2, 2, v2
  s_barrier
  ds_write_b32 v2, v4
  s_waitcnt lgkmcnt(0)
  s_barrier
  v_mov_b32 v2, 0
  ds_read_b128 v[4:7], v2
  s_waitcnt lgkmcnt(0)
  v_max3_u32 v4, v4, v5, v6
  v_max_u32 v4, v4, v7
  s_nop 0
  v_readfirstlane_b32 s26, v4
  s_nop 0
  s_and_b32 s27, s26, 0x7ff
  s_sub_u32 s27, 2047, s27
  v_and_b32 v5, 0xffff0000, v4
  v_ashrrev_i32 v6, 31, v5
  v_not_b32 v6, v6
  v_or_b32 v6, 0x80000000, v6
  v_xor_b32 v5, v5, v6
  v_and_b32 v5, 0xffff0000, v5
  v_mul_f32 v5, 0xbfb8aa3b, v5
  v_exp_f32 v5, v5
  s_nop 0
  v_add_f32 v5, 1.0, v5
  v_rcp_f32 v5, v5
  s_nop 0
  v_cvt_pk_bf16_f32 v5, v5, v5
  v_and_b32 v5, 0xffff0000, v5
  s_nop 0
  v_readfirstlane_b32 s41, v5
  s_barrier
  v_and_b32 v1, 7, v0
  v_lshrrev_b32 v2, 3, v0
  v_mul_u32_u24 v3, 28, v2
  s_mul_i32 s28, s27, 896
  v_add_u32 v3, s28, v3
  global_load_dword v8, v3, s[8:9] offset:0
  global_load_dword v9, v3, s[8:9] offset:4
  global_load_dword v10, v3, s[8:9] offset:8
  global_load_dword v11, v3, s[8:9] offset:12
  global_load_dword v12, v3, s[8:9] offset:16
  global_load_dword v13, v3, s[8:9] offset:20
  global_load_dword v14, v3, s[8:9] offset:24
  v_mul_u32_u24 v4, 50176, v2
  v_lshl_add_u32 v4, v1, 4, v4
  s_lshl_b32 s28, s24, 7
  v_add_u32 v4, s28, v4
  global_load_dwordx4 v[64:67], v4, s[10:11]
  global_load_dwordx4 v[120:123], v4, s[12:13]
  v_add_u32 v4, 3584, v4
  global_load_dwordx4 v[68:71], v4, s[10:11]
  global_load_dwordx4 v[124:127], v4, s[12:13]
  v_add_u32 v4, 3584, v4
  global_load_dwordx4 v[72:75], v4, s[10:11]
  global_load_dwordx4 v[128:131], v4, s[12:13]
  v_add_u32 v4, 3584, v4
  global_load_dwordx4 v[76:79], v4, s[10:11]
  global_load_dwordx4 v[132:135], v4, s[12:13]
  v_add_u32 v4, 3584, v4
  global_load_dwordx4 v[80:83], v4, s[10:11]
  global_load_dwordx4 v[136:139], v4, s[12:13]
  v_add_u32 v4, 3584, v4
  global_load_dwordx4 v[84:87], v4, s[10:11]
  global_load_dwordx4 v[140:143], v4, s[12:13]
  v_add_u32 v4, 3584, v4
  global_load_dwordx4 v[88:91], v4, s[10:11]
  global_load_dwordx4 v[144:147], v4, s[12:13]
  v_add_u32 v4, 3584, v4
  global_load_dwordx4 v[92:95], v4, s[10:11]
  global_load_dwordx4 v[148:151], v4, s[12:13]
  v_add_u32 v4, 3584, v4
  global_load_dwordx4 v[96:99], v4, s[10:11]
  global_load_dwordx4 v[152:155], v4, s[12:13]
  v_add_u32 v4, 3584, v4
  global_load_dwordx4 v[100:103], v4, s[10:11]
  global_load_dwordx4 v[156:159], v4, s[12:13]
  v_add_u32 v4, 3584, v4
  global_load_dwordx4 v[104:107], v4, s[10:11]
  global_load_dwordx4 v[160:163], v4, s[12:13]
  v_add_u32 v4, 3584, v4
  global_load_dwordx4 v[108:111], v4, s[10:11]
  global_load_dwordx4 v[164:167], v4, s[12:13]
  v_add_u32 v4, 3584, v4
  global_load_dwordx4 v[112:115], v4, s[10:11]
  global_load_dwordx4 v[168:171], v4, s[12:13]
  v_add_u32 v4, 3584, v4
  global_load_dwordx4 v[116:119], v4, s[10:11]
  global_load_dwordx4 v[172:175], v4, s[12:13]
  v_mov_b32 v32, 0
  v_mov_b32 v33, 0
  v_mov_b32 v34, 0
  v_mov_b32 v35, 0
  v_mov_b32 v36, 0
  v_mov_b32 v37, 0
  v_mov_b32 v38, 0
  v_mov_b32 v39, 0
  v_mov_b32 v40, 0
  v_mov_b32 v41, 0
  v_mov_b32 v42, 0
  v_mov_b32 v43, 0
  v_mov_b32 v44, 0
  v_mov_b32 v45, 0
  v_mov_b32 v46, 0
  v_mov_b32 v47, 0
  s_waitcnt vmcnt(28)
  v_lshlrev_b32 v16, 16, v8
  v_and_b32 v17, 0xffff0000, v8
  v_lshlrev_b32 v18, 16, v9
  v_and_b32 v19, 0xffff0000, v9
  v_lshlrev_b32 v20, 16, v10
  v_and_b32 v21, 0xffff0000, v10
  v_lshlrev_b32 v22, 16, v11
  v_and_b32 v23, 0xffff0000, v11
  v_lshlrev_b32 v24, 16, v12
  v_and_b32 v25, 0xffff0000, v12
  v_lshlrev_b32 v26, 16, v13
  v_and_b32 v27, 0xffff0000, v13
  v_lshlrev_b32 v28, 16, v14
  v_and_b32 v29, 0xffff0000, v14
  s_waitcnt vmcnt(26)
  v_lshlrev_b32 v48, 16, v64
  v_and_b32 v49, 0xffff0000, v64
  v_fmac_f32 v32, v48, v16
  v_fmac_f32 v33, v49, v16
  v_lshlrev_b32 v48, 16, v65
  v_and_b32 v49, 0xffff0000, v65
  v_fmac_f32 v34, v48, v16
  v_fmac_f32 v35, v49, v16
  v_lshlrev_b32 v48, 16, v66
  v_and_b32 v49, 0xffff0000, v66
  v_fmac_f32 v36, v48, v16
  v_fmac_f32 v37, v49, v16
  v_lshlrev_b32 v48, 16, v67
  v_and_b32 v49, 0xffff0000, v67
  v_fmac_f32 v38, v48, v16
  v_fmac_f32 v39, v49, v16
  v_lshlrev_b32 v48, 16, v120
  v_and_b32 v49, 0xffff0000, v120
  v_fmac_f32 v40, v48, v16
  v_fmac_f32 v41, v49, v16
  v_lshlrev_b32 v48, 16, v121
  v_and_b32 v49, 0xffff0000, v121
  v_fmac_f32 v42, v48, v16
  v_fmac_f32 v43, v49, v16
  v_lshlrev_b32 v48, 16, v122
  v_and_b32 v49, 0xffff0000, v122
  v_fmac_f32 v44, v48, v16
  v_fmac_f32 v45, v49, v16
  v_lshlrev_b32 v48, 16, v123
  v_and_b32 v49, 0xffff0000, v123
  v_fmac_f32 v46, v48, v16
  v_fmac_f32 v47, v49, v16
  s_waitcnt vmcnt(24)
  v_lshlrev_b32 v48, 16, v68
  v_and_b32 v49, 0xffff0000, v68
  v_fmac_f32 v32, v48, v17
  v_fmac_f32 v33, v49, v17
  v_lshlrev_b32 v48, 16, v69
  v_and_b32 v49, 0xffff0000, v69
  v_fmac_f32 v34, v48, v17
  v_fmac_f32 v35, v49, v17
  v_lshlrev_b32 v48, 16, v70
  v_and_b32 v49, 0xffff0000, v70
  v_fmac_f32 v36, v48, v17
  v_fmac_f32 v37, v49, v17
  v_lshlrev_b32 v48, 16, v71
  v_and_b32 v49, 0xffff0000, v71
  v_fmac_f32 v38, v48, v17
  v_fmac_f32 v39, v49, v17
  v_lshlrev_b32 v48, 16, v124
  v_and_b32 v49, 0xffff0000, v124
  v_fmac_f32 v40, v48, v17
  v_fmac_f32 v41, v49, v17
  v_lshlrev_b32 v48, 16, v125
  v_and_b32 v49, 0xffff0000, v125
  v_fmac_f32 v42, v48, v17
  v_fmac_f32 v43, v49, v17
  v_lshlrev_b32 v48, 16, v126
  v_and_b32 v49, 0xffff0000, v126
  v_fmac_f32 v44, v48, v17
  v_fmac_f32 v45, v49, v17
  v_lshlrev_b32 v48, 16, v127
  v_and_b32 v49, 0xffff0000, v127
  v_fmac_f32 v46, v48, v17
  v_fmac_f32 v47, v49, v17
  s_waitcnt vmcnt(22)
  v_lshlrev_b32 v48, 16, v72
  v_and_b32 v49, 0xffff0000, v72
  v_fmac_f32 v32, v48, v18
  v_fmac_f32 v33, v49, v18
  v_lshlrev_b32 v48, 16, v73
  v_and_b32 v49, 0xffff0000, v73
  v_fmac_f32 v34, v48, v18
  v_fmac_f32 v35, v49, v18
  v_lshlrev_b32 v48, 16, v74
  v_and_b32 v49, 0xffff0000, v74
  v_fmac_f32 v36, v48, v18
  v_fmac_f32 v37, v49, v18
  v_lshlrev_b32 v48, 16, v75
  v_and_b32 v49, 0xffff0000, v75
  v_fmac_f32 v38, v48, v18
  v_fmac_f32 v39, v49, v18
  v_lshlrev_b32 v48, 16, v128
  v_and_b32 v49, 0xffff0000, v128
  v_fmac_f32 v40, v48, v18
  v_fmac_f32 v41, v49, v18
  v_lshlrev_b32 v48, 16, v129
  v_and_b32 v49, 0xffff0000, v129
  v_fmac_f32 v42, v48, v18
  v_fmac_f32 v43, v49, v18
  v_lshlrev_b32 v48, 16, v130
  v_and_b32 v49, 0xffff0000, v130
  v_fmac_f32 v44, v48, v18
  v_fmac_f32 v45, v49, v18
  v_lshlrev_b32 v48, 16, v131
  v_and_b32 v49, 0xffff0000, v131
  v_fmac_f32 v46, v48, v18
  v_fmac_f32 v47, v49, v18
  s_waitcnt vmcnt(20)
  v_lshlrev_b32 v48, 16, v76
  v_and_b32 v49, 0xffff0000, v76
  v_fmac_f32 v32, v48, v19
  v_fmac_f32 v33, v49, v19
  v_lshlrev_b32 v48, 16, v77
  v_and_b32 v49, 0xffff0000, v77
  v_fmac_f32 v34, v48, v19
  v_fmac_f32 v35, v49, v19
  v_lshlrev_b32 v48, 16, v78
  v_and_b32 v49, 0xffff0000, v78
  v_fmac_f32 v36, v48, v19
  v_fmac_f32 v37, v49, v19
  v_lshlrev_b32 v48, 16, v79
  v_and_b32 v49, 0xffff0000, v79
  v_fmac_f32 v38, v48, v19
  v_fmac_f32 v39, v49, v19
  v_lshlrev_b32 v48, 16, v132
  v_and_b32 v49, 0xffff0000, v132
  v_fmac_f32 v40, v48, v19
  v_fmac_f32 v41, v49, v19
  v_lshlrev_b32 v48, 16, v133
  v_and_b32 v49, 0xffff0000, v133
  v_fmac_f32 v42, v48, v19
  v_fmac_f32 v43, v49, v19
  v_lshlrev_b32 v48, 16, v134
  v_and_b32 v49, 0xffff0000, v134
  v_fmac_f32 v44, v48, v19
  v_fmac_f32 v45, v49, v19
  v_lshlrev_b32 v48, 16, v135
  v_and_b32 v49, 0xffff0000, v135
  v_fmac_f32 v46, v48, v19
  v_fmac_f32 v47, v49, v19
  s_waitcnt vmcnt(18)
  v_lshlrev_b32 v48, 16, v80
  v_and_b32 v49, 0xffff0000, v80
  v_fmac_f32 v32, v48, v20
  v_fmac_f32 v33, v49, v20
  v_lshlrev_b32 v48, 16, v81
  v_and_b32 v49, 0xffff0000, v81
  v_fmac_f32 v34, v48, v20
  v_fmac_f32 v35, v49, v20
  v_lshlrev_b32 v48, 16, v82
  v_and_b32 v49, 0xffff0000, v82
  v_fmac_f32 v36, v48, v20
  v_fmac_f32 v37, v49, v20
  v_lshlrev_b32 v48, 16, v83
  v_and_b32 v49, 0xffff0000, v83
  v_fmac_f32 v38, v48, v20
  v_fmac_f32 v39, v49, v20
  v_lshlrev_b32 v48, 16, v136
  v_and_b32 v49, 0xffff0000, v136
  v_fmac_f32 v40, v48, v20
  v_fmac_f32 v41, v49, v20
  v_lshlrev_b32 v48, 16, v137
  v_and_b32 v49, 0xffff0000, v137
  v_fmac_f32 v42, v48, v20
  v_fmac_f32 v43, v49, v20
  v_lshlrev_b32 v48, 16, v138
  v_and_b32 v49, 0xffff0000, v138
  v_fmac_f32 v44, v48, v20
  v_fmac_f32 v45, v49, v20
  v_lshlrev_b32 v48, 16, v139
  v_and_b32 v49, 0xffff0000, v139
  v_fmac_f32 v46, v48, v20
  v_fmac_f32 v47, v49, v20
  s_waitcnt vmcnt(16)
  v_lshlrev_b32 v48, 16, v84
  v_and_b32 v49, 0xffff0000, v84
  v_fmac_f32 v32, v48, v21
  v_fmac_f32 v33, v49, v21
  v_lshlrev_b32 v48, 16, v85
  v_and_b32 v49, 0xffff0000, v85
  v_fmac_f32 v34, v48, v21
  v_fmac_f32 v35, v49, v21
  v_lshlrev_b32 v48, 16, v86
  v_and_b32 v49, 0xffff0000, v86
  v_fmac_f32 v36, v48, v21
  v_fmac_f32 v37, v49, v21
  v_lshlrev_b32 v48, 16, v87
  v_and_b32 v49, 0xffff0000, v87
  v_fmac_f32 v38, v48, v21
  v_fmac_f32 v39, v49, v21
  v_lshlrev_b32 v48, 16, v140
  v_and_b32 v49, 0xffff0000, v140
  v_fmac_f32 v40, v48, v21
  v_fmac_f32 v41, v49, v21
  v_lshlrev_b32 v48, 16, v141
  v_and_b32 v49, 0xffff0000, v141
  v_fmac_f32 v42, v48, v21
  v_fmac_f32 v43, v49, v21
  v_lshlrev_b32 v48, 16, v142
  v_and_b32 v49, 0xffff0000, v142
  v_fmac_f32 v44, v48, v21
  v_fmac_f32 v45, v49, v21
  v_lshlrev_b32 v48, 16, v143
  v_and_b32 v49, 0xffff0000, v143
  v_fmac_f32 v46, v48, v21
  v_fmac_f32 v47, v49, v21
  s_waitcnt vmcnt(14)
  v_lshlrev_b32 v48, 16, v88
  v_and_b32 v49, 0xffff0000, v88
  v_fmac_f32 v32, v48, v22
  v_fmac_f32 v33, v49, v22
  v_lshlrev_b32 v48, 16, v89
  v_and_b32 v49, 0xffff0000, v89
  v_fmac_f32 v34, v48, v22
  v_fmac_f32 v35, v49, v22
  v_lshlrev_b32 v48, 16, v90
  v_and_b32 v49, 0xffff0000, v90
  v_fmac_f32 v36, v48, v22
  v_fmac_f32 v37, v49, v22
  v_lshlrev_b32 v48, 16, v91
  v_and_b32 v49, 0xffff0000, v91
  v_fmac_f32 v38, v48, v22
  v_fmac_f32 v39, v49, v22
  v_lshlrev_b32 v48, 16, v144
  v_and_b32 v49, 0xffff0000, v144
  v_fmac_f32 v40, v48, v22
  v_fmac_f32 v41, v49, v22
  v_lshlrev_b32 v48, 16, v145
  v_and_b32 v49, 0xffff0000, v145
  v_fmac_f32 v42, v48, v22
  v_fmac_f32 v43, v49, v22
  v_lshlrev_b32 v48, 16, v146
  v_and_b32 v49, 0xffff0000, v146
  v_fmac_f32 v44, v48, v22
  v_fmac_f32 v45, v49, v22
  v_lshlrev_b32 v48, 16, v147
  v_and_b32 v49, 0xffff0000, v147
  v_fmac_f32 v46, v48, v22
  v_fmac_f32 v47, v49, v22
  s_waitcnt vmcnt(12)
  v_lshlrev_b32 v48, 16, v92
  v_and_b32 v49, 0xffff0000, v92
  v_fmac_f32 v32, v48, v23
  v_fmac_f32 v33, v49, v23
  v_lshlrev_b32 v48, 16, v93
  v_and_b32 v49, 0xffff0000, v93
  v_fmac_f32 v34, v48, v23
  v_fmac_f32 v35, v49, v23
  v_lshlrev_b32 v48, 16, v94
  v_and_b32 v49, 0xffff0000, v94
  v_fmac_f32 v36, v48, v23
  v_fmac_f32 v37, v49, v23
  v_lshlrev_b32 v48, 16, v95
  v_and_b32 v49, 0xffff0000, v95
  v_fmac_f32 v38, v48, v23
  v_fmac_f32 v39, v49, v23
  v_lshlrev_b32 v48, 16, v148
  v_and_b32 v49, 0xffff0000, v148
  v_fmac_f32 v40, v48, v23
  v_fmac_f32 v41, v49, v23
  v_lshlrev_b32 v48, 16, v149
  v_and_b32 v49, 0xffff0000, v149
  v_fmac_f32 v42, v48, v23
  v_fmac_f32 v43, v49, v23
  v_lshlrev_b32 v48, 16, v150
  v_and_b32 v49, 0xffff0000, v150
  v_fmac_f32 v44, v48, v23
  v_fmac_f32 v45, v49, v23
  v_lshlrev_b32 v48, 16, v151
  v_and_b32 v49, 0xffff0000, v151
  v_fmac_f32 v46, v48, v23
  v_fmac_f32 v47, v49, v23
  s_waitcnt vmcnt(10)
  v_lshlrev_b32 v48, 16, v96
  v_and_b32 v49, 0xffff0000, v96
  v_fmac_f32 v32, v48, v24
  v_fmac_f32 v33, v49, v24
  v_lshlrev_b32 v48, 16, v97
  v_and_b32 v49, 0xffff0000, v97
  v_fmac_f32 v34, v48, v24
  v_fmac_f32 v35, v49, v24
  v_lshlrev_b32 v48, 16, v98
  v_and_b32 v49, 0xffff0000, v98
  v_fmac_f32 v36, v48, v24
  v_fmac_f32 v37, v49, v24
  v_lshlrev_b32 v48, 16, v99
  v_and_b32 v49, 0xffff0000, v99
  v_fmac_f32 v38, v48, v24
  v_fmac_f32 v39, v49, v24
  v_lshlrev_b32 v48, 16, v152
  v_and_b32 v49, 0xffff0000, v152
  v_fmac_f32 v40, v48, v24
  v_fmac_f32 v41, v49, v24
  v_lshlrev_b32 v48, 16, v153
  v_and_b32 v49, 0xffff0000, v153
  v_fmac_f32 v42, v48, v24
  v_fmac_f32 v43, v49, v24
  v_lshlrev_b32 v48, 16, v154
  v_and_b32 v49, 0xffff0000, v154
  v_fmac_f32 v44, v48, v24
  v_fmac_f32 v45, v49, v24
  v_lshlrev_b32 v48, 16, v155
  v_and_b32 v49, 0xffff0000, v155
  v_fmac_f32 v46, v48, v24
  v_fmac_f32 v47, v49, v24
  s_waitcnt vmcnt(8)
  v_lshlrev_b32 v48, 16, v100
  v_and_b32 v49, 0xffff0000, v100
  v_fmac_f32 v32, v48, v25
  v_fmac_f32 v33, v49, v25
  v_lshlrev_b32 v48, 16, v101
  v_and_b32 v49, 0xffff0000, v101
  v_fmac_f32 v34, v48, v25
  v_fmac_f32 v35, v49, v25
  v_lshlrev_b32 v48, 16, v102
  v_and_b32 v49, 0xffff0000, v102
  v_fmac_f32 v36, v48, v25
  v_fmac_f32 v37, v49, v25
  v_lshlrev_b32 v48, 16, v103
  v_and_b32 v49, 0xffff0000, v103
  v_fmac_f32 v38, v48, v25
  v_fmac_f32 v39, v49, v25
  v_lshlrev_b32 v48, 16, v156
  v_and_b32 v49, 0xffff0000, v156
  v_fmac_f32 v40, v48, v25
  v_fmac_f32 v41, v49, v25
  v_lshlrev_b32 v48, 16, v157
  v_and_b32 v49, 0xffff0000, v157
  v_fmac_f32 v42, v48, v25
  v_fmac_f32 v43, v49, v25
  v_lshlrev_b32 v48, 16, v158
  v_and_b32 v49, 0xffff0000, v158
  v_fmac_f32 v44, v48, v25
  v_fmac_f32 v45, v49, v25
  v_lshlrev_b32 v48, 16, v159
  v_and_b32 v49, 0xffff0000, v159
  v_fmac_f32 v46, v48, v25
  v_fmac_f32 v47, v49, v25
  s_waitcnt vmcnt(6)
  v_lshlrev_b32 v48, 16, v104
  v_and_b32 v49, 0xffff0000, v104
  v_fmac_f32 v32, v48, v26
  v_fmac_f32 v33, v49, v26
  v_lshlrev_b32 v48, 16, v105
  v_and_b32 v49, 0xffff0000, v105
  v_fmac_f32 v34, v48, v26
  v_fmac_f32 v35, v49, v26
  v_lshlrev_b32 v48, 16, v106
  v_and_b32 v49, 0xffff0000, v106
  v_fmac_f32 v36, v48, v26
  v_fmac_f32 v37, v49, v26
  v_lshlrev_b32 v48, 16, v107
  v_and_b32 v49, 0xffff0000, v107
  v_fmac_f32 v38, v48, v26
  v_fmac_f32 v39, v49, v26
  v_lshlrev_b32 v48, 16, v160
  v_and_b32 v49, 0xffff0000, v160
  v_fmac_f32 v40, v48, v26
  v_fmac_f32 v41, v49, v26
  v_lshlrev_b32 v48, 16, v161
  v_and_b32 v49, 0xffff0000, v161
  v_fmac_f32 v42, v48, v26
  v_fmac_f32 v43, v49, v26
  v_lshlrev_b32 v48, 16, v162
  v_and_b32 v49, 0xffff0000, v162
  v_fmac_f32 v44, v48, v26
  v_fmac_f32 v45, v49, v26
  v_lshlrev_b32 v48, 16, v163
  v_and_b32 v49, 0xffff0000, v163
  v_fmac_f32 v46, v48, v26
  v_fmac_f32 v47, v49, v26
  s_waitcnt vmcnt(4)
  v_lshlrev_b32 v48, 16, v108
  v_and_b32 v49, 0xffff0000, v108
  v_fmac_f32 v32, v48, v27
  v_fmac_f32 v33, v49, v27
  v_lshlrev_b32 v48, 16, v109
  v_and_b32 v49, 0xffff0000, v109
  v_fmac_f32 v34, v48, v27
  v_fmac_f32 v35, v49, v27
  v_lshlrev_b32 v48, 16, v110
  v_and_b32 v49, 0xffff0000, v110
  v_fmac_f32 v36, v48, v27
  v_fmac_f32 v37, v49, v27
  v_lshlrev_b32 v48, 16, v111
  v_and_b32 v49, 0xffff0000, v111
  v_fmac_f32 v38, v48, v27
  v_fmac_f32 v39, v49, v27
  v_lshlrev_b32 v48, 16, v164
  v_and_b32 v49, 0xffff0000, v164
  v_fmac_f32 v40, v48, v27
  v_fmac_f32 v41, v49, v27
  v_lshlrev_b32 v48, 16, v165
  v_and_b32 v49, 0xffff0000, v165
  v_fmac_f32 v42, v48, v27
  v_fmac_f32 v43, v49, v27
  v_lshlrev_b32 v48, 16, v166
  v_and_b32 v49, 0xffff0000, v166
  v_fmac_f32 v44, v48, v27
  v_fmac_f32 v45, v49, v27
  v_lshlrev_b32 v48, 16, v167
  v_and_b32 v49, 0xffff0000, v167
  v_fmac_f32 v46, v48, v27
  v_fmac_f32 v47, v49, v27
  s_waitcnt vmcnt(2)
  v_lshlrev_b32 v48, 16, v112
  v_and_b32 v49, 0xffff0000, v112
  v_fmac_f32 v32, v48, v28
  v_fmac_f32 v33, v49, v28
  v_lshlrev_b32 v48, 16, v113
  v_and_b32 v49, 0xffff0000, v113
  v_fmac_f32 v34, v48, v28
  v_fmac_f32 v35, v49, v28
  v_lshlrev_b32 v48, 16, v114
  v_and_b32 v49, 0xffff0000, v114
  v_fmac_f32 v36, v48, v28
  v_fmac_f32 v37, v49, v28
  v_lshlrev_b32 v48, 16, v115
  v_and_b32 v49, 0xffff0000, v115
  v_fmac_f32 v38, v48, v28
  v_fmac_f32 v39, v49, v28
  v_lshlrev_b32 v48, 16, v168
  v_and_b32 v49, 0xffff0000, v168
  v_fmac_f32 v40, v48, v28
  v_fmac_f32 v41, v49, v28
  v_lshlrev_b32 v48, 16, v169
  v_and_b32 v49, 0xffff0000, v169
  v_fmac_f32 v42, v48, v28
  v_fmac_f32 v43, v49, v28
  v_lshlrev_b32 v48, 16, v170
  v_and_b32 v49, 0xffff0000, v170
  v_fmac_f32 v44, v48, v28
  v_fmac_f32 v45, v49, v28
  v_lshlrev_b32 v48, 16, v171
  v_and_b32 v49, 0xffff0000, v171
  v_fmac_f32 v46, v48, v28
  v_fmac_f32 v47, v49, v28
  s_waitcnt vmcnt(0)
  v_lshlrev_b32 v48, 16, v116
  v_and_b32 v49, 0xffff0000, v116
  v_fmac_f32 v32, v48, v29
  v_fmac_f32 v33, v49, v29
  v_lshlrev_b32 v48, 16, v117
  v_and_b32 v49, 0xffff0000, v117
  v_fmac_f32 v34, v48, v29
  v_fmac_f32 v35, v49, v29
  v_lshlrev_b32 v48, 16, v118
  v_and_b32 v49, 0xffff0000, v118
  v_fmac_f32 v36, v48, v29
  v_fmac_f32 v37, v49, v29
  v_lshlrev_b32 v48, 16, v119
  v_and_b32 v49, 0xffff0000, v119
  v_fmac_f32 v38, v48, v29
  v_fmac_f32 v39, v49, v29
  v_lshlrev_b32 v48, 16, v172
  v_and_b32 v49, 0xffff0000, v172
  v_fmac_f32 v40, v48, v29
  v_fmac_f32 v41, v49, v29
  v_lshlrev_b32 v48, 16, v173
  v_and_b32 v49, 0xffff0000, v173
  v_fmac_f32 v42, v48, v29
  v_fmac_f32 v43, v49, v29
  v_lshlrev_b32 v48, 16, v174
  v_and_b32 v49, 0xffff0000, v174
  v_fmac_f32 v44, v48, v29
  v_fmac_f32 v45, v49, v29
  v_lshlrev_b32 v48, 16, v175
  v_and_b32 v49, 0xffff0000, v175
  v_fmac_f32 v46, v48, v29
  v_fmac_f32 v47, v49, v29
  v_lshlrev_b32 v4, 9, v2
  v_lshl_add_u32 v4, v1, 5, v4
  ds_write_b128 v4, v[32:35]
  ds_write_b128 v4, v[36:39] offset:16
  ds_write_b128 v4, v[40:43] offset:256
  ds_write_b128 v4, v[44:47] offset:272
  v_mul_u32_u24 v5, 1171, v0
  v_lshrrev_b32 v5, 16, v5
  v_mul_u32_u24 v6, 56, v5
  v_sub_u32 v6, v0, v6
  v_min_u32 v5, 3, v5
  v_mul_u32_u24 v7, 14336, v5
  v_lshl_add_u32 v7, v6, 4, v7
  s_mul_i32 s28, s24, 57344
  v_add_u32 v7, s28, v7
  global_load_dwordx4 v[64:67], v7, s[14:15] offset:0
  global_load_dwordx4 v[68:71], v7, s[14:15] offset:896
  global_load_dwordx4 v[72:75], v7, s[14:15] offset:1792
  global_load_dwordx4 v[76:79], v7, s[14:15] offset:2688
  v_add_u32 v7, 3584, v7
  global_load_dwordx4 v[80:83], v7, s[14:15] offset:0
  global_load_dwordx4 v[84:87], v7, s[14:15] offset:896
  global_load_dwordx4 v[88:91], v7, s[14:15] offset:1792
  global_load_dwordx4 v[92:95], v7, s[14:15] offset:2688
  v_add_u32 v7, 3584, v7
  global_load_dwordx4 v[96:99], v7, s[14:15] offset:0
  global_load_dwordx4 v[100:103], v7, s[14:15] offset:896
  global_load_dwordx4 v[104:107], v7, s[14:15] offset:1792
  global_load_dwordx4 v[108:111], v7, s[14:15] offset:2688
  v_add_u32 v7, 3584, v7
  global_load_dwordx4 v[112:115], v7, s[14:15] offset:0
  global_load_dwordx4 v[116:119], v7, s[14:15] offset:896
  global_load_dwordx4 v[120:123], v7, s[14:15] offset:1792
  global_load_dwordx4 v[124:127], v7, s[14:15] offset:2688
  s_waitcnt lgkmcnt(0)
  s_barrier
  v_lshlrev_b32 v4, 2, v0
  v_and_b32 v4, 255, v4
  v_mov_b32 v32, 0
  v_mov_b32 v33, 0
  ds_read_b32 v8, v4 offset:0
  ds_read_b32 v16, v4 offset:256
  ds_read_b32 v9, v4 offset:512
  ds_read_b32 v17, v4 offset:768
  ds_read_b32 v10, v4 offset:1024
  ds_read_b32 v18, v4 offset:1280
  ds_read_b32 v11, v4 offset:1536
  ds_read_b32 v19, v4 offset:1792
  ds_read_b32 v12, v4 offset:2048
  ds_read_b32 v20, v4 offset:2304
  ds_read_b32 v13, v4 offset:2560
  ds_read_b32 v21, v4 offset:2816
  ds_read_b32 v14, v4 offset:3072
  ds_read_b32 v22, v4 offset:3328
  ds_read_b32 v15, v4 offset:3584
  ds_read_b32 v23, v4 offset:3840
  s_waitcnt lgkmcnt(0)
  v_add_f32 v32, v32, v8
  v_add_f32 v33, v33, v16
  v_add_f32 v32, v32, v9
  v_add_f32 v33, v33, v17
  v_add_f32 v32, v32, v10
  v_add_f32 v33, v33, v18
  v_add_f32 v32, v32, v11
  v_add_f32 v33, v33, v19
  v_add_f32 v32, v32, v12
  v_add_f32 v33, v33, v20
  v_add_f32 v32, v32, v13
  v_add_f32 v33, v33, v21
  v_add_f32 v32, v32, v14
  v_add_f32 v33, v33, v22
  v_add_f32 v32, v32, v15
  v_add_f32 v33, v33, v23
  ds_read_b32 v8, v4 offset:4096
  ds_read_b32 v16, v4 offset:4352
  ds_read_b32 v9, v4 offset:4608
  ds_read_b32 v17, v4 offset:4864
  ds_read_b32 v10, v4 offset:5120
  ds_read_b32 v18, v4 offset:5376
  ds_read_b32 v11, v4 offset:5632
  ds_read_b32 v19, v4 offset:5888
  ds_read_b32 v12, v4 offset:6144
  ds_read_b32 v20, v4 offset:6400
  ds_read_b32 v13, v4 offset:6656
  ds_read_b32 v21, v4 offset:6912
  ds_read_b32 v14, v4 offset:7168
  ds_read_b32 v22, v4 offset:7424
  ds_read_b32 v15, v4 offset:7680
  ds_read_b32 v23, v4 offset:7936
  s_waitcnt lgkmcnt(0)
  v_add_f32 v32, v32, v8
  v_add_f32 v33, v33, v16
  v_add_f32 v32, v32, v9
  v_add_f32 v33, v33, v17
  v_add_f32 v32, v32, v10
  v_add_f32 v33, v33, v18
  v_add_f32 v32, v32, v11
  v_add_f32 v33, v33, v19
  v_add_f32 v32, v32, v12
  v_add_f32 v33, v33, v20
  v_add_f32 v32, v32, v13
  v_add_f32 v33, v33, v21
  v_add_f32 v32, v32, v14
  v_add_f32 v33, v33, v22
  v_add_f32 v32, v32, v15
  v_add_f32 v33, v33, v23
  ds_read_b32 v8, v4 offset:8192
  ds_read_b32 v16, v4 offset:8448
  ds_read_b32 v9, v4 offset:8704
  ds_read_b32 v17, v4 offset:8960
  ds_read_b32 v10, v4 offset:9216
  ds_read_b32 v18, v4 offset:9472
  ds_read_b32 v11, v4 offset:9728
  ds_read_b32 v19, v4 offset:9984
  ds_read_b32 v12, v4 offset:10240
  ds_read_b32 v20, v4 offset:10496
  ds_read_b32 v13, v4 offset:10752
  ds_read_b32 v21, v4 offset:11008
  ds_read_b32 v14, v4 offset:11264
  ds_read_b32 v22, v4 offset:11520
  ds_read_b32 v15, v4 offset:11776
  ds_read_b32 v23, v4 offset:12032
  s_waitcnt lgkmcnt(0)
  v_add_f32 v32, v32, v8
  v_add_f32 v33, v33, v16
  v_add_f32 v32, v32, v9
  v_add_f32 v33, v33, v17
  v_add_f32 v32, v32, v10
  v_add_f32 v33, v33, v18
  v_add_f32 v32, v32, v11
  v_add_f32 v33, v33, v19
  v_add_f32 v32, v32, v12
  v_add_f32 v33, v33, v20
  v_add_f32 v32, v32, v13
  v_add_f32 v33, v33, v21
  v_add_f32 v32, v32, v14
  v_add_f32 v33, v33, v22
  v_add_f32 v32, v32, v15
  v_add_f32 v33, v33, v23
  ds_read_b32 v8, v4 offset:12288
  ds_read_b32 v16, v4 offset:12544
  ds_read_b32 v9, v4 offset:12800
  ds_read_b32 v17, v4 offset:13056
  ds_read_b32 v10, v4 offset:13312
  ds_read_b32 v18, v4 offset:13568
  ds_read_b32 v11, v4 offset:13824
  ds_read_b32 v19, v4 offset:14080
  ds_read_b32 v12, v4 offset:14336
  ds_read_b32 v20, v4 offset:14592
  ds_read_b32 v13, v4 offset:14848
  ds_read_b32 v21, v4 offset:15104
  ds_read_b32 v14, v4 offset:15360
  ds_read_b32 v22, v4 offset:15616
  ds_read_b32 v15, v4 offset:15872
  ds_read_b32 v23, v4 offset:16128
  s_waitcnt lgkmcnt(0)
  v_add_f32 v32, v32, v8
  v_add_f32 v33, v33, v16
  v_add_f32 v32, v32, v9
  v_add_f32 v33, v33, v17
  v_add_f32 v32, v32, v10
  v_add_f32 v33, v33, v18
  v_add_f32 v32, v32, v11
  v_add_f32 v33, v33, v19
  v_add_f32 v32, v32, v12
  v_add_f32 v33, v33, v20
  v_add_f32 v32, v32, v13
  v_add_f32 v33, v33, v21
  v_add_f32 v32, v32, v14
  v_add_f32 v33, v33, v22
  v_add_f32 v32, v32, v15
  v_add_f32 v33, v33, v23
  v_cvt_pk_bf16_f32 v34, v32, v33
  v_lshlrev_b32 v32, 16, v34
  v_and_b32 v33, 0xffff0000, v34
  v_mul_f32 v35, 0xbfb8aa3b, v32
  v_exp_f32 v35, v35
  s_nop 0
  v_add_f32 v35, 1.0, v35
  v_rcp_f32 v35, v35
  s_nop 0
  v_mul_f32 v35, v32, v35
  v_cvt_pk_bf16_f32 v35, v35, v35
  v_and_b32 v35, 0xffff0000, v35
  v_mul_f32 v35, v35, v33
  v_cvt_pk_bf16_f32 v35, v35, v35
  v_and_b32 v35, 0xffff0000, v35
  ds_write_b32 v4, v35 offset:16384
  s_waitcnt lgkmcnt(0)
  s_barrier
  v_lshlrev_b32 v4, 6, v5
  ds_read_b128 v[8:11], v4 offset:16384
  ds_read_b128 v[12:15], v4 offset:16400
  ds_read_b128 v[16:19], v4 offset:16416
  ds_read_b128 v[20:23], v4 offset:16432
  v_mov_b32 v32, 0
  v_mov_b32 v33, 0
  v_mov_b32 v34, 0
  v_mov_b32 v35, 0
  v_mov_b32 v36, 0
  v_mov_b32 v37, 0
  v_mov_b32 v38, 0
  v_mov_b32 v39, 0
  s_waitcnt lgkmcnt(0)
  s_waitcnt vmcnt(15)
  v_lshlrev_b32 v48, 16, v64
  v_and_b32 v49, 0xffff0000, v64
  v_fmac_f32 v32, v48, v8
  v_fmac_f32 v33, v49, v8
  v_lshlrev_b32 v48, 16, v65
  v_and_b32 v49, 0xffff0000, v65
  v_fmac_f32 v34, v48, v8
  v_fmac_f32 v35, v49, v8
  v_lshlrev_b32 v48, 16, v66
  v_and_b32 v49, 0xffff0000, v66
  v_fmac_f32 v36, v48, v8
  v_fmac_f32 v37, v49, v8
  v_lshlrev_b32 v48, 16, v67
  v_and_b32 v49, 0xffff0000, v67
  v_fmac_f32 v38, v48, v8
  v_fmac_f32 v39, v49, v8
  s_waitcnt vmcnt(14)
  v_lshlrev_b32 v48, 16, v68
  v_and_b32 v49, 0xffff0000, v68
  v_fmac_f32 v32, v48, v9
  v_fmac_f32 v33, v49, v9
  v_lshlrev_b32 v48, 16, v69
  v_and_b32 v49, 0xffff0000, v69
  v_fmac_f32 v34, v48, v9
  v_fmac_f32 v35, v49, v9
  v_lshlrev_b32 v48, 16, v70
  v_and_b32 v49, 0xffff0000, v70
  v_fmac_f32 v36, v48, v9
  v_fmac_f32 v37, v49, v9
  v_lshlrev_b32 v48, 16, v71
  v_and_b32 v49, 0xffff0000, v71
  v_fmac_f32 v38, v48, v9
  v_fmac_f32 v39, v49, v9
  s_waitcnt vmcnt(13)
  v_lshlrev_b32 v48, 16, v72
  v_and_b32 v49, 0xffff0000, v72
  v_fmac_f32 v32, v48, v10
  v_fmac_f32 v33, v49, v10
  v_lshlrev_b32 v48, 16, v73
  v_and_b32 v49, 0xffff0000, v73
  v_fmac_f32 v34, v48, v10
  v_fmac_f32 v35, v49, v10
  v_lshlrev_b32 v48, 16, v74
  v_and_b32 v49, 0xffff0000, v74
  v_fmac_f32 v36, v48, v10
  v_fmac_f32 v37, v49, v10
  v_lshlrev_b32 v48, 16, v75
  v_and_b32 v49, 0xffff0000, v75
  v_fmac_f32 v38, v48, v10
  v_fmac_f32 v39, v49, v10
  s_waitcnt vmcnt(12)
  v_lshlrev_b32 v48, 16, v76
  v_and_b32 v49, 0xffff0000, v76
  v_fmac_f32 v32, v48, v11
  v_fmac_f32 v33, v49, v11
  v_lshlrev_b32 v48, 16, v77
  v_and_b32 v49, 0xffff0000, v77
  v_fmac_f32 v34, v48, v11
  v_fmac_f32 v35, v49, v11
  v_lshlrev_b32 v48, 16, v78
  v_and_b32 v49, 0xffff0000, v78
  v_fmac_f32 v36, v48, v11
  v_fmac_f32 v37, v49, v11
  v_lshlrev_b32 v48, 16, v79
  v_and_b32 v49, 0xffff0000, v79
  v_fmac_f32 v38, v48, v11
  v_fmac_f32 v39, v49, v11
  s_waitcnt vmcnt(11)
  v_lshlrev_b32 v48, 16, v80
  v_and_b32 v49, 0xffff0000, v80
  v_fmac_f32 v32, v48, v12
  v_fmac_f32 v33, v49, v12
  v_lshlrev_b32 v48, 16, v81
  v_and_b32 v49, 0xffff0000, v81
  v_fmac_f32 v34, v48, v12
  v_fmac_f32 v35, v49, v12
  v_lshlrev_b32 v48, 16, v82
  v_and_b32 v49, 0xffff0000, v82
  v_fmac_f32 v36, v48, v12
  v_fmac_f32 v37, v49, v12
  v_lshlrev_b32 v48, 16, v83
  v_and_b32 v49, 0xffff0000, v83
  v_fmac_f32 v38, v48, v12
  v_fmac_f32 v39, v49, v12
  s_waitcnt vmcnt(10)
  v_lshlrev_b32 v48, 16, v84
  v_and_b32 v49, 0xffff0000, v84
  v_fmac_f32 v32, v48, v13
  v_fmac_f32 v33, v49, v13
  v_lshlrev_b32 v48, 16, v85
  v_and_b32 v49, 0xffff0000, v85
  v_fmac_f32 v34, v48, v13
  v_fmac_f32 v35, v49, v13
  v_lshlrev_b32 v48, 16, v86
  v_and_b32 v49, 0xffff0000, v86
  v_fmac_f32 v36, v48, v13
  v_fmac_f32 v37, v49, v13
  v_lshlrev_b32 v48, 16, v87
  v_and_b32 v49, 0xffff0000, v87
  v_fmac_f32 v38, v48, v13
  v_fmac_f32 v39, v49, v13
  s_waitcnt vmcnt(9)
  v_lshlrev_b32 v48, 16, v88
  v_and_b32 v49, 0xffff0000, v88
  v_fmac_f32 v32, v48, v14
  v_fmac_f32 v33, v49, v14
  v_lshlrev_b32 v48, 16, v89
  v_and_b32 v49, 0xffff0000, v89
  v_fmac_f32 v34, v48, v14
  v_fmac_f32 v35, v49, v14
  v_lshlrev_b32 v48, 16, v90
  v_and_b32 v49, 0xffff0000, v90
  v_fmac_f32 v36, v48, v14
  v_fmac_f32 v37, v49, v14
  v_lshlrev_b32 v48, 16, v91
  v_and_b32 v49, 0xffff0000, v91
  v_fmac_f32 v38, v48, v14
  v_fmac_f32 v39, v49, v14
  s_waitcnt vmcnt(8)
  v_lshlrev_b32 v48, 16, v92
  v_and_b32 v49, 0xffff0000, v92
  v_fmac_f32 v32, v48, v15
  v_fmac_f32 v33, v49, v15
  v_lshlrev_b32 v48, 16, v93
  v_and_b32 v49, 0xffff0000, v93
  v_fmac_f32 v34, v48, v15
  v_fmac_f32 v35, v49, v15
  v_lshlrev_b32 v48, 16, v94
  v_and_b32 v49, 0xffff0000, v94
  v_fmac_f32 v36, v48, v15
  v_fmac_f32 v37, v49, v15
  v_lshlrev_b32 v48, 16, v95
  v_and_b32 v49, 0xffff0000, v95
  v_fmac_f32 v38, v48, v15
  v_fmac_f32 v39, v49, v15
  s_waitcnt vmcnt(7)
  v_lshlrev_b32 v48, 16, v96
  v_and_b32 v49, 0xffff0000, v96
  v_fmac_f32 v32, v48, v16
  v_fmac_f32 v33, v49, v16
  v_lshlrev_b32 v48, 16, v97
  v_and_b32 v49, 0xffff0000, v97
  v_fmac_f32 v34, v48, v16
  v_fmac_f32 v35, v49, v16
  v_lshlrev_b32 v48, 16, v98
  v_and_b32 v49, 0xffff0000, v98
  v_fmac_f32 v36, v48, v16
  v_fmac_f32 v37, v49, v16
  v_lshlrev_b32 v48, 16, v99
  v_and_b32 v49, 0xffff0000, v99
  v_fmac_f32 v38, v48, v16
  v_fmac_f32 v39, v49, v16
  s_waitcnt vmcnt(6)
  v_lshlrev_b32 v48, 16, v100
  v_and_b32 v49, 0xffff0000, v100
  v_fmac_f32 v32, v48, v17
  v_fmac_f32 v33, v49, v17
  v_lshlrev_b32 v48, 16, v101
  v_and_b32 v49, 0xffff0000, v101
  v_fmac_f32 v34, v48, v17
  v_fmac_f32 v35, v49, v17
  v_lshlrev_b32 v48, 16, v102
  v_and_b32 v49, 0xffff0000, v102
  v_fmac_f32 v36, v48, v17
  v_fmac_f32 v37, v49, v17
  v_lshlrev_b32 v48, 16, v103
  v_and_b32 v49, 0xffff0000, v103
  v_fmac_f32 v38, v48, v17
  v_fmac_f32 v39, v49, v17
  s_waitcnt vmcnt(5)
  v_lshlrev_b32 v48, 16, v104
  v_and_b32 v49, 0xffff0000, v104
  v_fmac_f32 v32, v48, v18
  v_fmac_f32 v33, v49, v18
  v_lshlrev_b32 v48, 16, v105
  v_and_b32 v49, 0xffff0000, v105
  v_fmac_f32 v34, v48, v18
  v_fmac_f32 v35, v49, v18
  v_lshlrev_b32 v48, 16, v106
  v_and_b32 v49, 0xffff0000, v106
  v_fmac_f32 v36, v48, v18
  v_fmac_f32 v37, v49, v18
  v_lshlrev_b32 v48, 16, v107
  v_and_b32 v49, 0xffff0000, v107
  v_fmac_f32 v38, v48, v18
  v_fmac_f32 v39, v49, v18
  s_waitcnt vmcnt(4)
  v_lshlrev_b32 v48, 16, v108
  v_and_b32 v49, 0xffff0000, v108
  v_fmac_f32 v32, v48, v19
  v_fmac_f32 v33, v49, v19
  v_lshlrev_b32 v48, 16, v109
  v_and_b32 v49, 0xffff0000, v109
  v_fmac_f32 v34, v48, v19
  v_fmac_f32 v35, v49, v19
  v_lshlrev_b32 v48, 16, v110
  v_and_b32 v49, 0xffff0000, v110
  v_fmac_f32 v36, v48, v19
  v_fmac_f32 v37, v49, v19
  v_lshlrev_b32 v48, 16, v111
  v_and_b32 v49, 0xffff0000, v111
  v_fmac_f32 v38, v48, v19
  v_fmac_f32 v39, v49, v19
  s_waitcnt vmcnt(3)
  v_lshlrev_b32 v48, 16, v112
  v_and_b32 v49, 0xffff0000, v112
  v_fmac_f32 v32, v48, v20
  v_fmac_f32 v33, v49, v20
  v_lshlrev_b32 v48, 16, v113
  v_and_b32 v49, 0xffff0000, v113
  v_fmac_f32 v34, v48, v20
  v_fmac_f32 v35, v49, v20
  v_lshlrev_b32 v48, 16, v114
  v_and_b32 v49, 0xffff0000, v114
  v_fmac_f32 v36, v48, v20
  v_fmac_f32 v37, v49, v20
  v_lshlrev_b32 v48, 16, v115
  v_and_b32 v49, 0xffff0000, v115
  v_fmac_f32 v38, v48, v20
  v_fmac_f32 v39, v49, v20
  s_waitcnt vmcnt(2)
  v_lshlrev_b32 v48, 16, v116
  v_and_b32 v49, 0xffff0000, v116
  v_fmac_f32 v32, v48, v21
  v_fmac_f32 v33, v49, v21
  v_lshlrev_b32 v48, 16, v117
  v_and_b32 v49, 0xffff0000, v117
  v_fmac_f32 v34, v48, v21
  v_fmac_f32 v35, v49, v21
  v_lshlrev_b32 v48, 16, v118
  v_and_b32 v49, 0xffff0000, v118
  v_fmac_f32 v36, v48, v21
  v_fmac_f32 v37, v49, v21
  v_lshlrev_b32 v48, 16, v119
  v_and_b32 v49, 0xffff0000, v119
  v_fmac_f32 v38, v48, v21
  v_fmac_f32 v39, v49, v21
  s_waitcnt vmcnt(1)
  v_lshlrev_b32 v48, 16, v120
  v_and_b32 v49, 0xffff0000, v120
  v_fmac_f32 v32, v48, v22
  v_fmac_f32 v33, v49, v22
  v_lshlrev_b32 v48, 16, v121
  v_and_b32 v49, 0xffff0000, v121
  v_fmac_f32 v34, v48, v22
  v_fmac_f32 v35, v49, v22
  v_lshlrev_b32 v48, 16, v122
  v_and_b32 v49, 0xffff0000, v122
  v_fmac_f32 v36, v48, v22
  v_fmac_f32 v37, v49, v22
  v_lshlrev_b32 v48, 16, v123
  v_and_b32 v49, 0xffff0000, v123
  v_fmac_f32 v38, v48, v22
  v_fmac_f32 v39, v49, v22
  s_waitcnt vmcnt(0)
  v_lshlrev_b32 v48, 16, v124
  v_and_b32 v49, 0xffff0000, v124
  v_fmac_f32 v32, v48, v23
  v_fmac_f32 v33, v49, v23
  v_lshlrev_b32 v48, 16, v125
  v_and_b32 v49, 0xffff0000, v125
  v_fmac_f32 v34, v48, v23
  v_fmac_f32 v35, v49, v23
  v_lshlrev_b32 v48, 16, v126
  v_and_b32 v49, 0xffff0000, v126
  v_fmac_f32 v36, v48, v23
  v_fmac_f32 v37, v49, v23
  v_lshlrev_b32 v48, 16, v127
  v_and_b32 v49, 0xffff0000, v127
  v_fmac_f32 v38, v48, v23
  v_fmac_f32 v39, v49, v23
  v_mul_u32_u24 v4, 1792, v5
  v_lshl_add_u32 v4, v6, 5, v4
  v_cmp_gt_u32 vcc, 224, v0
  s_nop 0
  s_and_saveexec_b64 s[28:29], vcc
  ds_write_b128 v4, v[32:35]
  ds_write_b128 v4, v[36:39] offset:16
  s_mov_b64 exec, s[28:29]
  s_waitcnt lgkmcnt(0)
  s_barrier
  v_lshlrev_b32 v4, 3, v0
  v_min_u32 v4, 1784, v4
  ds_read_b64 v[8:9], v4 offset:0
  ds_read_b64 v[10:11], v4 offset:1792
  ds_read_b64 v[12:13], v4 offset:3584
  ds_read_b64 v[14:15], v4 offset:5376
  s_waitcnt lgkmcnt(0)
  v_add_f32 v8, v8, v10
  v_add_f32 v12, v12, v14
  v_add_f32 v8, v8, v12
  v_add_f32 v9, v9, v11
  v_add_f32 v13, v13, v15
  v_add_f32 v9, v9, v13
  s_mul_i32 s28, s24, 1792
  s_add_u32 s28, s28, 14712832
  v_add_u32 v4, s28, v4
  global_store_dwordx2 v4, v[8:9], s[4:5] sc1
  s_waitcnt vmcnt(0)
  s_barrier
  s_lshl_b32 s28, s24, 2
  s_add_u32 s28, s28, 14947328
  s_waitcnt vmcnt(0)
  v_mov_b32 v5, s28
  v_mov_b32 v6, s20
  s_mov_b64 exec, 1
  global_store_dword v5, v6, s[4:5] sc1
  s_mov_b64 exec, -1
  v_and_b32 v3, 63, v0
  s_lshl_b32 s29, s24, 2
  s_add_u32 s29, s29, s22
  s_mul_i32 s30, s29, 4682
  s_lshr_b32 s30, s30, 16
  s_mul_i32 s31, s30, 14
  s_sub_u32 s31, s29, s31
  s_mov_b32 s40, 2000000
  s_cmp_lg_u32 s22, 0
  s_cbranch_scc1 wgw_71
  v_lshlrev_b32 v4, 2, v3
  v_add_u32 v4, 14942208, v4
mk_wf_72:
  global_load_dword v5, v4, s[4:5] offset:0 sc1
  global_load_dword v6, v4, s[4:5] offset:256 sc1
  global_load_dword v7, v4, s[4:5] offset:512 sc1
  global_load_dword v8, v4, s[4:5] offset:768 sc1
  global_load_dword v9, v4, s[4:5] offset:1024 sc1
  global_load_dword v10, v4, s[4:5] offset:1280 sc1
  global_load_dword v11, v4, s[4:5] offset:1536 sc1
  global_load_dword v12, v4, s[4:5] offset:1792 sc1
  global_load_dword v13, v4, s[4:5] offset:2048 sc1
  global_load_dword v14, v4, s[4:5] offset:2304 sc1
  global_load_dword v15, v4, s[4:5] offset:2560 sc1
  global_load_dword v16, v4, s[4:5] offset:2816 sc1
  global_load_dword v17, v4, s[4:5] offset:3072 sc1
  global_load_dword v18, v4, s[4:5] offset:3328 sc1
  s_waitcnt vmcnt(0)
  v_xor_b32 v5, s20, v5
  v_xor_b32 v6, s20, v6
  v_or_b32 v5, v5, v6
  v_xor_b32 v7, s20, v7
  v_or_b32 v5, v5, v7
  v_xor_b32 v8, s20, v8
  v_or_b32 v5, v5, v8
  v_xor_b32 v9, s20, v9
  v_or_b32 v5, v5, v9
  v_xor_b32 v10, s20, v10
  v_or_b32 v5, v5, v10
  v_xor_b32 v11, s20, v11
  v_or_b32 v5, v5, v11
  v_xor_b32 v12, s20, v12
  v_or_b32 v5, v5, v12
  v_xor_b32 v13, s20, v13
  v_or_b32 v5, v5, v13
  v_xor_b32 v14, s20, v14
  v_or_b32 v5, v5, v14
  v_xor_b32 v15, s20, v15
  v_or_b32 v5, v5, v15
  v_xor_b32 v16, s20, v16
  v_or_b32 v5, v5, v16
  v_xor_b32 v17, s20, v17
  v_or_b32 v5, v5, v17
  v_xor_b32 v18, s20, v18
  v_or_b32 v5, v5, v18
  v_cmp_ne_u32 vcc, 0, v5
  s_cbranch_vccz mk_wd_73
  s_sleep 20
  s_sub_u32 s40, s40, 1
  s_cbranch_scc0 mk_wf_72
  s_mov_b32 s40, 0
mk_wd_73:
  buffer_inv sc1
  s_waitcnt vmcnt(0)
wgw_71:
  s_barrier
  s_mul_i32 s32, s30, 56
  s_lshl_b32 s33, s31, 1
  s_add_u32 s32, s32, s33
  s_mul_i32 s32, s32, 14336
  s_add_u32 s32, s32, 6422528
  v_lshlrev_b32 v4, 4, v3
  v_add_u32 v5, s32, v4
  v_add_u32 v8, 0, v5
  global_load_dwordx4 a[0:3], v8, s[4:5] offset:0
  global_load_dwordx4 a[4:7], v8, s[4:5] offset:1024
  global_load_dwordx4 a[8:11], v8, s[4:5] offset:2048
  global_load_dwordx4 a[12:15], v8, s[4:5] offset:3072
  v_add_u32 v8, 4096, v8
  global_load_dwordx4 a[16:19], v8, s[4:5] offset:0
  global_load_dwordx4 a[20:23], v8, s[4:5] offset:1024
  global_load_dwordx4 a[24:27], v8, s[4:5] offset:2048
  global_load_dwordx4 a[28:31], v8, s[4:5] offset:3072
  v_add_u32 v8, 4096, v8
  global_load_dwordx4 a[32:35], v8, s[4:5] offset:0
  global_load_dwordx4 a[36:39], v8, s[4:5] offset:1024
  global_load_dwordx4 a[40:43], v8, s[4:5] offset:2048
  global_load_dwordx4 a[44:47], v8, s[4:5] offset:3072
  v_add_u32 v8, 4096, v8
  global_load_dwordx4 a[48:51], v8, s[4:5] offset:0
  global_load_dwordx4 a[52:55], v8, s[4:5] offset:1024
  v_add_u32 v8, 14336, v5
  global_load_dwordx4 a[112:115], v8, s[4:5] offset:0
  global_load_dwordx4 a[116:119], v8, s[4:5] offset:1024
  global_load_dwordx4 a[120:123], v8, s[4:5] offset:2048
  global_load_dwordx4 a[124:127], v8, s[4:5] offset:3072
  v_add_u32 v8, 4096, v8
  global_load_dwordx4 a[128:131], v8, s[4:5] offset:0
  global_load_dwordx4 a[132:135], v8, s[4:5] offset:1024
  global_load_dwordx4 a[136:139], v8, s[4:5] offset:2048
  global_load_dwordx4 a[140:143], v8, s[4:5] offset:3072
  v_add_u32 v8, 4096, v8
  global_load_dwordx4 a[144:147], v8, s[4:5] offset:0
  global_load_dwordx4 a[148:151], v8, s[4:5] offset:1024
  global_load_dwordx4 a[152:155], v8, s[4:5] offset:2048
  global_load_dwordx4 a[156:159], v8, s[4:5] offset:3072
  v_add_u32 v8, 4096, v8
  global_load_dwordx4 a[160:163], v8, s[4:5] offset:0
  global_load_dwordx4 a[164:167], v8, s[4:5] offset:1024
  v_add_u32 v8, 401408, v5
  global_load_dwordx4 a[56:59], v8, s[4:5] offset:0
  global_load_dwordx4 a[60:63], v8, s[4:5] offset:1024
  global_load_dwordx4 a[64:67], v8, s[4:5] offset:2048
  global_load_dwordx4 a[68:71], v8, s[4:5] offset:3072
  v_add_u32 v8, 4096, v8
  global_load_dwordx4 a[72:75], v8, s[4:5] offset:0
  global_load_dwordx4 a[76:79], v8, s[4:5] offset:1024
  global_load_dwordx4 a[80:83], v8, s[4:5] offset:2048
  global_load_dwordx4 a[84:87], v8, s[4:5] offset:3072
  v_add_u32 v8, 4096, v8
  global_load_dwordx4 a[88:91], v8, s[4:5] offset:0
  global_load_dwordx4 a[92:95], v8, s[4:5] offset:1024
  global_load_dwordx4 a[96:99], v8, s[4:5] offset:2048
  global_load_dwordx4 a[100:103], v8, s[4:5] offset:3072
  v_add_u32 v8, 4096, v8
  global_load_dwordx4 a[104:107], v8, s[4:5] offset:0
  global_load_dwordx4 a[108:111], v8, s[4:5] offset:1024
  v_add_u32 v8, 415744, v5
  global_load_dwordx4 a[168:171], v8, s[4:5] offset:0
  global_load_dwordx4 a[172:175], v8, s[4:5] offset:1024
  global_load_dwordx4 a[176:179], v8, s[4:5] offset:2048
  global_load_dwordx4 a[180:183], v8, s[4:5] offset:3072
  v_add_u32 v8, 4096, v8
  global_load_dwordx4 a[184:187], v8, s[4:5] offset:0
  global_load_dwordx4 a[188:191], v8, s[4:5] offset:1024
  global_load_dwordx4 a[192:195], v8, s[4:5] offset:2048
  global_load_dwordx4 a[196:199], v8, s[4:5] offset:3072
  v_add_u32 v8, 4096, v8
  global_load_dwordx4 a[200:203], v8, s[4:5] offset:0
  global_load_dwordx4 a[204:207], v8, s[4:5] offset:1024
  global_load_dwordx4 a[208:211], v8, s[4:5] offset:2048
  global_load_dwordx4 a[212:215], v8, s[4:5] offset:3072
  v_add_u32 v8, 4096, v8
  global_load_dwordx4 a[216:219], v8, s[4:5] offset:0
  global_load_dwordx4 a[220:223], v8, s[4:5] offset:1024
  v_lshrrev_b32 v6, 5, v3
  v_lshlrev_b32 v6, 8, v6
  v_bfe_u32 v7, v3, 4, 1
  v_lshl_add_u32 v6, v7, 3, v6
  v_and_b32 v7, 7, v3
  v_lshl_add_u32 v6, v7, 5, v6
  v_add_u32 v6, 16777216, v6
  v_add_u32 v7, 3584, v6
  s_lshl_b32 s32, s33, 12
  s_lshl_b32 s34, s30, 9
  s_add_u32 s32, s32, s34
  s_add_u32 s32, s32, 63045632
  v_lshlrev_b32 v9, 3, v3
  v_add_u32 v9, s32, v9
  v_add_u32 v10, 4096, v9
  s_lshl_b32 s34, s31, 3
  s_add_u32 s34, s34, s30
  s_lshl_b32 s34, s34, 2
  s_add_u32 s34, s34, 15073280
  v_mov_b32 v11, s34
  v_mov_b32 v12, s20
  s_mov_b32 s36, 0
  v_mov_b32 v13, 15003648
  v_lshl_add_u32 v13, v3, 0, v13
  s_lshl_b32 s34, s29, 5
  v_mov_b32 v13, s34
  v_add_u32 v13, 14999552, v13
  s_branch mk_mg
mk_ml:
  global_load_dwordx2 v[14:15], v7, s[4:5] offset:3088 sc1
  s_waitcnt vmcnt(0)
  v_cmp_eq_u32 vcc, -1, v15
  s_cbranch_vccz mk_mg
  s_sleep 3
  s_cmp_ge_u32 s36, 63
  s_cbranch_scc1 mk_mss
  s_sleep 12
mk_mss:
  s_sub_u32 s40, s40, 1
  s_cbranch_scc0 mk_ml
  s_mov_b32 s40, 0
mk_mg:
  global_load_dwordx2 v[16:17], v6, s[4:5] offset:0 sc1
  global_load_dwordx2 v[18:19], v6, s[4:5] offset:16 sc1
  global_load_dwordx2 v[20:21], v6, s[4:5] offset:512 sc1
  global_load_dwordx2 v[22:23], v6, s[4:5] offset:528 sc1
  global_load_dwordx2 v[24:25], v6, s[4:5] offset:1024 sc1
  global_load_dwordx2 v[26:27], v6, s[4:5] offset:1040 sc1
  global_load_dwordx2 v[28:29], v6, s[4:5] offset:1536 sc1
  global_load_dwordx2 v[30:31], v6, s[4:5] offset:1552 sc1
  global_load_dwordx2 v[32:33], v6, s[4:5] offset:2048 sc1
  global_load_dwordx2 v[34:35], v6, s[4:5] offset:2064 sc1
  global_load_dwordx2 v[36:37], v6, s[4:5] offset:2560 sc1
  global_load_dwordx2 v[38:39], v6, s[4:5] offset:2576 sc1
  global_load_dwordx2 v[40:41], v6, s[4:5] offset:3072 sc1
  global_load_dwordx2 v[42:43], v6, s[4:5] offset:3088 sc1
  global_load_dwordx2 v[44:45], v7, s[4:5] offset:0 sc1
  global_load_dwordx2 v[46:47], v7, s[4:5] offset:16 sc1
  global_load_dwordx2 v[48:49], v7, s[4:5] offset:512 sc1
  global_load_dwordx2 v[50:51], v7, s[4:5] offset:528 sc1
  global_load_dwordx2 v[52:53], v7, s[4:5] offset:1024 sc1
  global_load_dwordx2 v[54:55], v7, s[4:5] offset:1040 sc1
  global_load_dwordx2 v[56:57], v7, s[4:5] offset:1536 sc1
  global_load_dwordx2 v[58:59], v7, s[4:5] offset:1552 sc1
  global_load_dwordx2 v[60:61], v7, s[4:5] offset:2048 sc1
  global_load_dwordx2 v[62:63], v7, s[4:5] offset:2064 sc1
  global_load_dwordx2 v[64:65], v7, s[4:5] offset:2560 sc1
  global_load_dwordx2 v[66:67], v7, s[4:5] offset:2576 sc1
  global_load_dwordx2 v[68:69], v7, s[4:5] offset:3072 sc1
  global_load_dwordx2 v[70:71], v7, s[4:5] offset:3088 sc1
  s_waitcnt vmcnt(26)
  s_mov_b64 exec, 1
  global_store_dword v13, v12, s[4:5] sc1
  s_mov_b64 exec, -1
  v_swap_b32 v17, v18
  s_nop 1
  v_mfma_f32_16x16x32_bf16 v[80:83], v[16:19], a[0:3], 0
  v_mfma_f32_16x16x32_bf16 v[84:87], v[16:19], a[56:59], 0
  v_mfma_f32_16x16x32_bf16 v[88:91], v[16:19], a[112:115], 0
  v_mfma_f32_16x16x32_bf16 v[92:95], v[16:19], a[168:171], 0
  s_waitcnt vmcnt(25)
  v_swap_b32 v21, v22
  s_nop 1
  v_mfma_f32_16x16x32_bf16 v[80:83], v[20:23], a[4:7], v[80:83]
  v_mfma_f32_16x16x32_bf16 v[84:87], v[20:23], a[60:63], v[84:87]
  v_mfma_f32_16x16x32_bf16 v[88:91], v[20:23], a[116:119], v[88:91]
  v_mfma_f32_16x16x32_bf16 v[92:95], v[20:23], a[172:175], v[92:95]
  s_waitcnt vmcnt(23)
  v_swap_b32 v25, v26
  s_nop 1
  v_mfma_f32_16x16x32_bf16 v[80:83], v[24:27], a[8:11], v[80:83]
  v_mfma_f32_16x16x32_bf16 v[84:87], v[24:27], a[64:67], v[84:87]
  v_mfma_f32_16x16x32_bf16 v[88:91], v[24:27], a[120:123], v[88:91]
  v_mfma_f32_16x16x32_bf16 v[92:95], v[24:27], a[176:179], v[92:95]
  s_waitcnt vmcnt(21)
  v_swap_b32 v29, v30
  s_nop 1
  v_mfma_f32_16x16x32_bf16 v[80:83], v[28:31], a[12:15], v[80:83]
  v_mfma_f32_16x16x32_bf16 v[84:87], v[28:31], a[68:71], v[84:87]
  v_mfma_f32_16x16x32_bf16 v[88:91], v[28:31], a[124:127], v[88:91]
  v_mfma_f32_16x16x32_bf16 v[92:95], v[28:31], a[180:183], v[92:95]
  s_waitcnt vmcnt(19)
  v_swap_b32 v33, v34
  s_nop 1
  v_mfma_f32_16x16x32_bf16 v[80:83], v[32:35], a[16:19], v[80:83]
  v_mfma_f32_16x16x32_bf16 v[84:87], v[32:35], a[72:75], v[84:87]
  v_mfma_f32_16x16x32_bf16 v[88:91], v[32:35], a[128:131], v[88:91]
  v_mfma_f32_16x16x32_bf16 v[92:95], v[32:35], a[184:187], v[92:95]
  s_waitcnt vmcnt(17)
  v_swap_b32 v37, v38
  s_nop 1
  v_mfma_f32_16x16x32_bf16 v[80:83], v[36:39], a[20:23], v[80:83]
  v_mfma_f32_16x16x32_bf16 v[84:87], v[36:39], a[76:79], v[84:87]
  v_mfma_f32_16x16x32_bf16 v[88:91], v[36:39], a[132:135], v[88:91]
  v_mfma_f32_16x16x32_bf16 v[92:95], v[36:39], a[188:191], v[92:95]
  s_waitcnt vmcnt(15)
  v_swap_b32 v41, v42
  s_nop 1
  v_mfma_f32_16x16x32_bf16 v[80:83], v[40:43], a[24:27], v[80:83]
  v_mfma_f32_16x16x32_bf16 v[84:87], v[40:43], a[80:83], v[84:87]
  v_mfma_f32_16x16x32_bf16 v[88:91], v[40:43], a[136:139], v[88:91]
  v_mfma_f32_16x16x32_bf16 v[92:95], v[40:43], a[192:195], v[92:95]
  s_waitcnt vmcnt(13)
  v_swap_b32 v45, v46
  s_nop 1
  v_mfma_f32_16x16x32_bf16 v[80:83], v[44:47], a[28:31], v[80:83]
  v_mfma_f32_16x16x32_bf16 v[84:87], v[44:47], a[84:87], v[84:87]
  v_mfma_f32_16x16x32_bf16 v[88:91], v[44:47], a[140:143], v[88:91]
  v_mfma_f32_16x16x32_bf16 v[92:95], v[44:47], a[196:199], v[92:95]
  s_waitcnt vmcnt(11)
  v_swap_b32 v49, v50
  s_nop 1
  v_mfma_f32_16x16x32_bf16 v[80:83], v[48:51], a[32:35], v[80:83]
  v_mfma_f32_16x16x32_bf16 v[84:87], v[48:51], a[88:91], v[84:87]
  v_mfma_f32_16x16x32_bf16 v[88:91], v[48:51], a[144:147], v[88:91]
  v_mfma_f32_16x16x32_bf16 v[92:95], v[48:51], a[200:203], v[92:95]
  s_waitcnt vmcnt(9)
  v_swap_b32 v53, v54
  s_nop 1
  v_mfma_f32_16x16x32_bf16 v[80:83], v[52:55], a[36:39], v[80:83]
  v_mfma_f32_16x16x32_bf16 v[84:87], v[52:55], a[92:95], v[84:87]
  v_mfma_f32_16x16x32_bf16 v[88:91], v[52:55], a[148:151], v[88:91]
  v_mfma_f32_16x16x32_bf16 v[92:95], v[52:55], a[204:207], v[92:95]
  s_waitcnt vmcnt(7)
  v_swap_b32 v57, v58
  s_nop 1
  v_mfma_f32_16x16x32_bf16 v[80:83], v[56:59], a[40:43], v[80:83]
  v_mfma_f32_16x16x32_bf16 v[84:87], v[56:59], a[96:99], v[84:87]
  v_mfma_f32_16x16x32_bf16 v[88:91], v[56:59], a[152:155], v[88:91]
  v_mfma_f32_16x16x32_bf16 v[92:95], v[56:59], a[208:211], v[92:95]
  s_waitcnt vmcnt(5)
  v_swap_b32 v61, v62
  s_nop 1
  v_mfma_f32_16x16x32_bf16 v[80:83], v[60:63], a[44:47], v[80:83]
  v_mfma_f32_16x16x32_bf16 v[84:87], v[60:63], a[100:103], v[84:87]
  v_mfma_f32_16x16x32_bf16 v[88:91], v[60:63], a[156:159], v[88:91]
  v_mfma_f32_16x16x32_bf16 v[92:95], v[60:63], a[212:215], v[92:95]
  s_waitcnt vmcnt(3)
  v_swap_b32 v65, v66
  s_nop 1
  v_mfma_f32_16x16x32_bf16 v[80:83], v[64:67], a[48:51], v[80:83]
  v_mfma_f32_16x16x32_bf16 v[84:87], v[64:67], a[104:107], v[84:87]
  v_mfma_f32_16x16x32_bf16 v[88:91], v[64:67], a[160:163], v[88:91]
  v_mfma_f32_16x16x32_bf16 v[92:95], v[64:67], a[216:219], v[92:95]
  s_waitcnt vmcnt(1)
  v_swap_b32 v69, v70
  s_nop 1
  v_mfma_f32_16x16x32_bf16 v[80:83], v[68:71], a[52:55], v[80:83]
  v_mfma_f32_16x16x32_bf16 v[84:87], v[68:71], a[108:111], v[84:87]
  v_mfma_f32_16x16x32_bf16 v[88:91], v[68:71], a[164:167], v[88:91]
  v_mfma_f32_16x16x32_bf16 v[92:95], v[68:71], a[220:223], v[92:95]
  v_add_f32 v14, v80, v81
  v_add_f32 v15, v82, v83
  v_cmp_u_f32 vcc, v14, v15
  s_nop 0
  s_cbranch_vccz mk_mk
  s_sub_u32 s40, s40, 16
  s_cbranch_scc0 mk_ml
  s_mov_b32 s40, 0
mk_mk:
  v_cvt_pk_bf16_f32 v96, v80, v81
  v_cvt_pk_bf16_f32 v97, v82, v83
  v_cvt_pk_bf16_f32 v98, v84, v85
  v_cvt_pk_bf16_f32 v99, v86, v87
  v_cvt_pk_bf16_f32 v100, v88, v89
  v_cvt_pk_bf16_f32 v101, v90, v91
  v_cvt_pk_bf16_f32 v102, v92, v93
  v_cvt_pk_bf16_f32 v103, v94, v95
  s_mov_b32 exec_hi, 0
  global_store_dwordx2 v9, v[96:97], s[4:5] offset:0 sc1
  global_store_dwordx2 v9, v[98:99], s[4:5] offset:256 sc1
  global_store_dwordx2 v10, v[100:101], s[4:5] offset:0 sc1
  global_store_dwordx2 v10, v[102:103], s[4:5] offset:256 sc1
  s_mov_b32 exec_hi, -1
  v_mov_b32 v13, v11
  v_add_u32 v6, 7168, v6
  v_add_u32 v7, 7168, v7
  v_add_u32 v9, 114688, v9
  v_add_u32 v10, 114688, v10
  v_add_u32 v11, 448, v11
  s_add_u32 s36, s36, 1
  s_cmp_lt_u32 s36, 64
  s_cbranch_scc1 mk_mg
  s_waitcnt vmcnt(0)
  s_mov_b64 exec, 1
  global_store_dword v13, v12, s[4:5] sc1
  s_mov_b64 exec, -1
  s_branch mk_fin
mk_hs:
  s_sub_u32 s24, s24, 140
  s_lshr_b32 s25, s24, 4
  s_and_b32 s24, s24, 15
  s_mov_b32 s40, 1000000
  v_and_b32 v3, 63, v0
  s_mul_i32 s26, s24, 112
  s_add_u32 s26, s26, 14942208
  s_cmp_lg_u32 s22, 0
  s_cbranch_scc1 wgw_74
  s_and_b32 s3, s2, 15
  s_lshl_b32 s3, s3, 8
  s_add_u32 s3, s3, 14995456
  v_mov_b32 v4, s3
mk_pg_75:
  global_load_dword v5, v4, s[4:5] sc1
  s_waitcnt vmcnt(0)
  v_readfirstlane_b32 s3, v5
  s_nop 0
  s_sub_u32 s3, s3, s20
  s_sub_u32 s3, s3, 1
  s_cmp_lt_u32 s3, 128
  s_cbranch_scc1 mk_pd_76
  s_sleep 80
  s_sub_u32 s40, s40, 1
  s_cbranch_scc0 mk_pg_75
  s_mov_b32 s40, 0
mk_pd_76:
  v_lshlrev_b32 v4, 2, v3
  v_min_u32 v4, 108, v4
  v_add_u32 v4, s26, v4
mk_wf_77:
  global_load_dword v5, v4, s[4:5] offset:0 sc1
  s_waitcnt vmcnt(0)
  v_xor_b32 v5, s20, v5
  v_cmp_ne_u32 vcc, 0, v5
  s_cbranch_vccz mk_wd_78
  s_sleep 8
  s_sub_u32 s40, s40, 1
  s_cbranch_scc0 mk_wf_77
  s_mov_b32 s40, 0
mk_wd_78:
  buffer_inv sc1
  s_waitcnt vmcnt(0)
wgw_74:
  s_barrier
  v_and_b32 v0, 63, v0
  v_lshlrev_b32 v1, 4, v0
  s_mul_i32 s27, s24, 28
  s_mul_i32 s28, s22, 7
  s_add_u32 s27, s27, s28
  s_mul_i32 s27, s27, 14336
  s_add_u32 s27, s27, 0
  v_add_u32 v2, s27, v1
  global_load_dwordx4 a[0:3], v2, s[4:5] offset:0
  global_load_dwordx4 a[4:7], v2, s[4:5] offset:1024
  global_load_dwordx4 a[8:11], v2, s[4:5] offset:2048
  global_load_dwordx4 a[12:15], v2, s[4:5] offset:3072
  v_add_u32 v2, 4096, v2
  global_load_dwordx4 a[16:19], v2, s[4:5] offset:0
  global_load_dwordx4 a[20:23], v2, s[4:5] offset:1024
  global_load_dwordx4 a[24:27], v2, s[4:5] offset:2048
  global_load_dwordx4 a[28:31], v2, s[4:5] offset:3072
  v_add_u32 v2, 4096, v2
  global_load_dwordx4 a[32:35], v2, s[4:5] offset:0
  global_load_dwordx4 a[36:39], v2, s[4:5] offset:1024
  global_load_dwordx4 a[40:43], v2, s[4:5] offset:2048
  global_load_dwordx4 a[44:47], v2, s[4:5] offset:3072
  v_add_u32 v2, 4096, v2
  global_load_dwordx4 a[48:51], v2, s[4:5] offset:0
  global_load_dwordx4 a[52:55], v2, s[4:5] offset:1024
  global_load_dwordx4 a[56:59], v2, s[4:5] offset:2048
  global_load_dwordx4 a[60:63], v2, s[4:5] offset:3072
  v_add_u32 v2, 4096, v2
  global_load_dwordx4 a[64:67], v2, s[4:5] offset:0
  global_load_dwordx4 a[68:71], v2, s[4:5] offset:1024
  global_load_dwordx4 a[72:75], v2, s[4:5] offset:2048
  global_load_dwordx4 a[76:79], v2, s[4:5] offset:3072
  v_add_u32 v2, 4096, v2
  global_load_dwordx4 a[80:83], v2, s[4:5] offset:0
  global_load_dwordx4 a[84:87], v2, s[4:5] offset:1024
  global_load_dwordx4 a[88:91], v2, s[4:5] offset:2048
  global_load_dwordx4 a[92:95], v2, s[4:5] offset:3072
  v_add_u32 v2, 4096, v2
  global_load_dwordx4 a[96:99], v2, s[4:5] offset:0
  global_load_dwordx4 a[100:103], v2, s[4:5] offset:1024
  global_load_dwordx4 a[104:107], v2, s[4:5] offset:2048
  global_load_dwordx4 a[108:111], v2, s[4:5] offset:3072
  v_add_u32 v2, 4096, v2
  global_load_dwordx4 a[112:115], v2, s[4:5] offset:0
  global_load_dwordx4 a[116:119], v2, s[4:5] offset:1024
  global_load_dwordx4 a[120:123], v2, s[4:5] offset:2048
  global_load_dwordx4 a[124:127], v2, s[4:5] offset:3072
  v_add_u32 v2, 4096, v2
  global_load_dwordx4 a[128:131], v2, s[4:5] offset:0
  global_load_dwordx4 a[132:135], v2, s[4:5] offset:1024
  global_load_dwordx4 a[136:139], v2, s[4:5] offset:2048
  global_load_dwordx4 a[140:143], v2, s[4:5] offset:3072
  v_add_u32 v2, 4096, v2
  global_load_dwordx4 a[144:147], v2, s[4:5] offset:0
  global_load_dwordx4 a[148:151], v2, s[4:5] offset:1024
  global_load_dwordx4 a[152:155], v2, s[4:5] offset:2048
  global_load_dwordx4 a[156:159], v2, s[4:5] offset:3072
  v_add_u32 v2, 4096, v2
  global_load_dwordx4 a[160:163], v2, s[4:5] offset:0
  global_load_dwordx4 a[164:167], v2, s[4:5] offset:1024
  global_load_dwordx4 a[168:171], v2, s[4:5] offset:2048
  global_load_dwordx4 a[172:175], v2, s[4:5] offset:3072
  v_add_u32 v2, 4096, v2
  global_load_dwordx4 a[176:179], v2, s[4:5] offset:0
  global_load_dwordx4 a[180:183], v2, s[4:5] offset:1024
  global_load_dwordx4 a[184:187], v2, s[4:5] offset:2048
  global_load_dwordx4 a[188:191], v2, s[4:5] offset:3072
  v_add_u32 v2, 4096, v2
  global_load_dwordx4 a[192:195], v2, s[4:5] offset:0
  global_load_dwordx4 a[196:199], v2, s[4:5] offset:1024
  global_load_dwordx4 a[200:203], v2, s[4:5] offset:2048
  global_load_dwordx4 a[204:207], v2, s[4:5] offset:3072
  v_add_u32 v2, 4096, v2
  global_load_dwordx4 a[208:211], v2, s[4:5] offset:0
  global_load_dwordx4 a[212:215], v2, s[4:5] offset:1024
  global_load_dwordx4 a[216:219], v2, s[4:5] offset:2048
  global_load_dwordx4 a[220:223], v2, s[4:5] offset:3072
  v_add_u32 v2, 4096, v2
  global_load_dwordx4 a[224:227], v2, s[4:5] offset:0
  global_load_dwordx4 a[228:231], v2, s[4:5] offset:1024
  global_load_dwordx4 a[232:235], v2, s[4:5] offset:2048
  global_load_dwordx4 a[236:239], v2, s[4:5] offset:3072
  v_add_u32 v2, 4096, v2
  global_load_dwordx4 a[240:243], v2, s[4:5] offset:0
  global_load_dwordx4 a[244:247], v2, s[4:5] offset:1024
  global_load_dwordx4 a[248:251], v2, s[4:5] offset:2048
  global_load_dwordx4 a[252:255], v2, s[4:5] offset:3072
  v_add_u32 v2, 4096, v2
  global_load_dwordx4 v[120:123], v2, s[4:5] offset:0
  global_load_dwordx4 v[124:127], v2, s[4:5] offset:1024
  global_load_dwordx4 v[128:131], v2, s[4:5] offset:2048
  global_load_dwordx4 v[132:135], v2, s[4:5] offset:3072
  v_add_u32 v2, 4096, v2
  global_load_dwordx4 v[136:139], v2, s[4:5] offset:0
  global_load_dwordx4 v[140:143], v2, s[4:5] offset:1024
  global_load_dwordx4 v[144:147], v2, s[4:5] offset:2048
  global_load_dwordx4 v[148:151], v2, s[4:5] offset:3072
  v_add_u32 v2, 4096, v2
  global_load_dwordx4 v[152:155], v2, s[4:5] offset:0
  global_load_dwordx4 v[156:159], v2, s[4:5] offset:1024
  global_load_dwordx4 v[160:163], v2, s[4:5] offset:2048
  global_load_dwordx4 v[164:167], v2, s[4:5] offset:3072
  v_add_u32 v2, 4096, v2
  global_load_dwordx4 v[168:171], v2, s[4:5] offset:0
  global_load_dwordx4 v[172:175], v2, s[4:5] offset:1024
  global_load_dwordx4 v[176:179], v2, s[4:5] offset:2048
  global_load_dwordx4 v[180:183], v2, s[4:5] offset:3072
  v_add_u32 v2, 4096, v2
  global_load_dwordx4 v[184:187], v2, s[4:5] offset:0
  global_load_dwordx4 v[188:191], v2, s[4:5] offset:1024
  global_load_dwordx4 v[192:195], v2, s[4:5] offset:2048
  global_load_dwordx4 v[196:199], v2, s[4:5] offset:3072
  v_add_u32 v2, 4096, v2
  global_load_dwordx4 v[200:203], v2, s[4:5] offset:0
  global_load_dwordx4 v[204:207], v2, s[4:5] offset:1024
  global_load_dwordx4 v[208:211], v2, s[4:5] offset:2048
  global_load_dwordx4 v[212:215], v2, s[4:5] offset:3072
  v_add_u32 v2, 4096, v2
  global_load_dwordx4 v[216:219], v2, s[4:5] offset:0
  global_load_dwordx4 v[220:223], v2, s[4:5] offset:1024
  global_load_dwordx4 v[224:227], v2, s[4:5] offset:2048
  global_load_dwordx4 v[228:231], v2, s[4:5] offset:3072
  v_add_u32 v2, 4096, v2
  global_load_dwordx4 v[232:235], v2, s[4:5] offset:0
  global_load_dwordx4 v[236:239], v2, s[4:5] offset:1024
  global_load_dwordx4 v[240:243], v2, s[4:5] offset:2048
  global_load_dwordx4 v[244:247], v2, s[4:5] offset:3072
  v_add_u32 v2, 4096, v2
  global_load_dwordx4 v[248:251], v2, s[4:5] offset:0
  global_load_dwordx4 v[252:255], v2, s[4:5] offset:1024
  v_and_b32 v112, 15, v0
  v_lshrrev_b32 v113, 4, v0
  v_add_u32 v3, 4096, v1
  v_lshrrev_b32 v4, 1, v113
  v_lshlrev_b32 v4, 4, v4
  v_and_b32 v5, 1, v113
  v_lshl_add_u32 v4, v5, 3, v4
  v_and_b32 v5, 7, v0
  v_lshl_add_u32 v4, v5, 5, v4
  s_mul_i32 s28, s22, 1792
  v_add_u32 v4, s28, v4
  v_mul_u32_u24 v5, 208, v112
  v_lshl_add_u32 v5, v113, 4, v5
  s_and_b32 s29, s22, 1
  s_mul_i32 s29, s29, 3328
  v_add_u32 v6, s29, v5
  s_mul_i32 s28, s22, 6656
  v_add_u32 v5, s28, v5
  v_lshlrev_b32 v7, 3, v0
  s_and_b32 s29, s22, 1
  s_lshl_b32 s28, s29, 9
  v_add_u32 v7, s28, v7
  s_lshl_b32 s28, s29, 8
  v_lshlrev_b32 v114, 3, v0
  v_add_u32 v114, s28, v114
  v_add_u32 v114, 2048, v114
  s_lshl_b32 s28, s29, 4
  v_add_u32 v115, s28, v112
  v_lshlrev_b32 v116, 2, v113
  v_sub_u32 v115, v115, v116
  s_mul_i32 s28, s25, 28672
  s_add_u32 s28, s28, 12845056
  s_add_u32 s44, s4, s28
  s_addc_u32 s45, s5, 0
  s_lshl_b32 s30, s22, 13
  s_mul_i32 s28, s25, 32768
  s_add_u32 s28, s28, 29360128
  s_add_u32 s28, s28, s30
  s_add_u32 s46, s4, s28
  s_addc_u32 s47, s5, 0
  s_mul_i32 s28, s25, 7168
  s_add_u32 s28, s28, 16777216
  s_add_u32 s48, s4, s28
  s_addc_u32 s49, s5, 0
  s_mul_i32 s30, s24, 2560
  s_mul_i32 s28, s25, 40960
  s_add_u32 s28, s28, 17301504
  s_add_u32 s28, s28, s30
  s_add_u32 s50, s4, s28
  s_addc_u32 s51, s5, 0
  s_mov_b32 s36, 0
  s_mov_b32 s40, 1000000
  s_mov_b32 s37, s25
  s_waitcnt vmcnt(0)
mk_hsloop:
  s_add_u32 s52, s44, 0
  s_addc_u32 s53, s45, 0
  s_add_u32 s54, s44, 8192
  s_addc_u32 s55, s45, 0
  s_add_u32 s56, s44, 16384
  s_addc_u32 s57, s45, 0
  s_add_u32 s58, s44, 24576
  s_addc_u32 s59, s45, 0
  global_load_dwordx4 v[64:67], v1, s[52:53] offset:0
  global_load_dwordx4 v[68:71], v3, s[54:55] offset:2048
  global_load_dwordx4 v[72:75], v1, s[52:53] offset:1024
  global_load_dwordx4 v[76:79], v3, s[54:55] offset:3072
  s_waitcnt vmcnt(3)
  v_mfma_f32_16x16x32_bf16 v[8:11], a[0:3], v[64:67], 0
  v_mfma_f32_16x16x32_bf16 v[16:19], a[56:59], v[64:67], 0
  v_mfma_f32_16x16x32_bf16 v[24:27], a[112:115], v[64:67], 0
  v_mfma_f32_16x16x32_bf16 v[32:35], a[168:171], v[64:67], 0
  v_mfma_f32_16x16x32_bf16 v[40:43], a[224:227], v[64:67], 0
  v_mfma_f32_16x16x32_bf16 v[48:51], v[144:147], v[64:67], 0
  v_mfma_f32_16x16x32_bf16 v[56:59], v[200:203], v[64:67], 0
  global_load_dwordx4 v[64:67], v1, s[52:53] offset:2048
  s_waitcnt vmcnt(3)
  v_mfma_f32_16x16x32_bf16 v[12:15], a[0:3], v[68:71], 0
  v_mfma_f32_16x16x32_bf16 v[20:23], a[56:59], v[68:71], 0
  v_mfma_f32_16x16x32_bf16 v[28:31], a[112:115], v[68:71], 0
  v_mfma_f32_16x16x32_bf16 v[36:39], a[168:171], v[68:71], 0
  v_mfma_f32_16x16x32_bf16 v[44:47], a[224:227], v[68:71], 0
  v_mfma_f32_16x16x32_bf16 v[52:55], v[144:147], v[68:71], 0
  v_mfma_f32_16x16x32_bf16 v[60:63], v[200:203], v[68:71], 0
  global_load_dwordx4 v[68:71], v1, s[56:57] offset:0
  s_waitcnt vmcnt(3)
  v_mfma_f32_16x16x32_bf16 v[8:11], a[4:7], v[72:75], v[8:11]
  v_mfma_f32_16x16x32_bf16 v[16:19], a[60:63], v[72:75], v[16:19]
  v_mfma_f32_16x16x32_bf16 v[24:27], a[116:119], v[72:75], v[24:27]
  v_mfma_f32_16x16x32_bf16 v[32:35], a[172:175], v[72:75], v[32:35]
  v_mfma_f32_16x16x32_bf16 v[40:43], a[228:231], v[72:75], v[40:43]
  v_mfma_f32_16x16x32_bf16 v[48:51], v[148:151], v[72:75], v[48:51]
  v_mfma_f32_16x16x32_bf16 v[56:59], v[204:207], v[72:75], v[56:59]
  global_load_dwordx4 v[72:75], v1, s[52:53] offset:3072
  s_waitcnt vmcnt(3)
  v_mfma_f32_16x16x32_bf16 v[12:15], a[4:7], v[76:79], v[12:15]
  v_mfma_f32_16x16x32_bf16 v[20:23], a[60:63], v[76:79], v[20:23]
  v_mfma_f32_16x16x32_bf16 v[28:31], a[116:119], v[76:79], v[28:31]
  v_mfma_f32_16x16x32_bf16 v[36:39], a[172:175], v[76:79], v[36:39]
  v_mfma_f32_16x16x32_bf16 v[44:47], a[228:231], v[76:79], v[44:47]
  v_mfma_f32_16x16x32_bf16 v[52:55], v[148:151], v[76:79], v[52:55]
  v_mfma_f32_16x16x32_bf16 v[60:63], v[204:207], v[76:79], v[60:63]
  global_load_dwordx4 v[76:79], v1, s[56:57] offset:1024
  s_waitcnt vmcnt(3)
  v_mfma_f32_16x16x32_bf16 v[8:11], a[8:11], v[64:67], v[8:11]
  v_mfma_f32_16x16x32_bf16 v[16:19], a[64:67], v[64:67], v[16:19]
  v_mfma_f32_16x16x32_bf16 v[24:27], a[120:123], v[64:67], v[24:27]
  v_mfma_f32_16x16x32_bf16 v[32:35], a[176:179], v[64:67], v[32:35]
  v_mfma_f32_16x16x32_bf16 v[40:43], a[232:235], v[64:67], v[40:43]
  v_mfma_f32_16x16x32_bf16 v[48:51], v[152:155], v[64:67], v[48:51]
  v_mfma_f32_16x16x32_bf16 v[56:59], v[208:211], v[64:67], v[56:59]
  global_load_dwordx4 v[64:67], v3, s[52:53] offset:0
  s_waitcnt vmcnt(3)
  v_mfma_f32_16x16x32_bf16 v[12:15], a[8:11], v[68:71], v[12:15]
  v_mfma_f32_16x16x32_bf16 v[20:23], a[64:67], v[68:71], v[20:23]
  v_mfma_f32_16x16x32_bf16 v[28:31], a[120:123], v[68:71], v[28:31]
  v_mfma_f32_16x16x32_bf16 v[36:39], a[176:179], v[68:71], v[36:39]
  v_mfma_f32_16x16x32_bf16 v[44:47], a[232:235], v[68:71], v[44:47]
  v_mfma_f32_16x16x32_bf16 v[52:55], v[152:155], v[68:71], v[52:55]
  v_mfma_f32_16x16x32_bf16 v[60:63], v[208:211], v[68:71], v[60:63]
  global_load_dwordx4 v[68:71], v1, s[56:57] offset:2048
  s_waitcnt vmcnt(3)
  v_mfma_f32_16x16x32_bf16 v[8:11], a[12:15], v[72:75], v[8:11]
  v_mfma_f32_16x16x32_bf16 v[16:19], a[68:71], v[72:75], v[16:19]
  v_mfma_f32_16x16x32_bf16 v[24:27], a[124:127], v[72:75], v[24:27]
  v_mfma_f32_16x16x32_bf16 v[32:35], a[180:183], v[72:75], v[32:35]
  v_mfma_f32_16x16x32_bf16 v[40:43], a[236:239], v[72:75], v[40:43]
  v_mfma_f32_16x16x32_bf16 v[48:51], v[156:159], v[72:75], v[48:51]
  v_mfma_f32_16x16x32_bf16 v[56:59], v[212:215], v[72:75], v[56:59]
  global_load_dwordx4 v[72:75], v3, s[52:53] offset:1024
  s_waitcnt vmcnt(3)
  v_mfma_f32_16x16x32_bf16 v[12:15], a[12:15], v[76:79], v[12:15]
  v_mfma_f32_16x16x32_bf16 v[20:23], a[68:71], v[76:79], v[20:23]
  v_mfma_f32_16x16x32_bf16 v[28:31], a[124:127], v[76:79], v[28:31]
  v_mfma_f32_16x16x32_bf16 v[36:39], a[180:183], v[76:79], v[36:39]
  v_mfma_f32_16x16x32_bf16 v[44:47], a[236:239], v[76:79], v[44:47]
  v_mfma_f32_16x16x32_bf16 v[52:55], v[156:159], v[76:79], v[52:55]
  v_mfma_f32_16x16x32_bf16 v[60:63], v[212:215], v[76:79], v[60:63]
  global_load_dwordx4 v[76:79], v1, s[56:57] offset:3072
  s_waitcnt vmcnt(3)
  v_mfma_f32_16x16x32_bf16 v[8:11], a[16:19], v[64:67], v[8:11]
  v_mfma_f32_16x16x32_bf16 v[16:19], a[72:75], v[64:67], v[16:19]
  v_mfma_f32_16x16x32_bf16 v[24:27], a[128:131], v[64:67], v[24:27]
  v_mfma_f32_16x16x32_bf16 v[32:35], a[184:187], v[64:67], v[32:35]
  v_mfma_f32_16x16x32_bf16 v[40:43], a[240:243], v[64:67], v[40:43]
  v_mfma_f32_16x16x32_bf16 v[48:51], v[160:163], v[64:67], v[48:51]
  v_mfma_f32_16x16x32_bf16 v[56:59], v[216:219], v[64:67], v[56:59]
  global_load_dwordx4 v[64:67], v3, s[52:53] offset:2048
  s_waitcnt vmcnt(3)
  v_mfma_f32_16x16x32_bf16 v[12:15], a[16:19], v[68:71], v[12:15]
  v_mfma_f32_16x16x32_bf16 v[20:23], a[72:75], v[68:71], v[20:23]
  v_mfma_f32_16x16x32_bf16 v[28:31], a[128:131], v[68:71], v[28:31]
  v_mfma_f32_16x16x32_bf16 v[36:39], a[184:187], v[68:71], v[36:39]
  v_mfma_f32_16x16x32_bf16 v[44:47], a[240:243], v[68:71], v[44:47]
  v_mfma_f32_16x16x32_bf16 v[52:55], v[160:163], v[68:71], v[52:55]
  v_mfma_f32_16x16x32_bf16 v[60:63], v[216:219], v[68:71], v[60:63]
  global_load_dwordx4 v[68:71], v3, s[56:57] offset:0
  s_waitcnt vmcnt(3)
  v_mfma_f32_16x16x32_bf16 v[8:11], a[20:23], v[72:75], v[8:11]
  v_mfma_f32_16x16x32_bf16 v[16:19], a[76:79], v[72:75], v[16:19]
  v_mfma_f32_16x16x32_bf16 v[24:27], a[132:135], v[72:75], v[24:27]
  v_mfma_f32_16x16x32_bf16 v[32:35], a[188:191], v[72:75], v[32:35]
  v_mfma_f32_16x16x32_bf16 v[40:43], a[244:247], v[72:75], v[40:43]
  v_mfma_f32_16x16x32_bf16 v[48:51], v[164:167], v[72:75], v[48:51]
  v_mfma_f32_16x16x32_bf16 v[56:59], v[220:223], v[72:75], v[56:59]
  global_load_dwordx4 v[72:75], v3, s[52:53] offset:3072
  s_waitcnt vmcnt(3)
  v_mfma_f32_16x16x32_bf16 v[12:15], a[20:23], v[76:79], v[12:15]
  v_mfma_f32_16x16x32_bf16 v[20:23], a[76:79], v[76:79], v[20:23]
  v_mfma_f32_16x16x32_bf16 v[28:31], a[132:135], v[76:79], v[28:31]
  v_mfma_f32_16x16x32_bf16 v[36:39], a[188:191], v[76:79], v[36:39]
  v_mfma_f32_16x16x32_bf16 v[44:47], a[244:247], v[76:79], v[44:47]
  v_mfma_f32_16x16x32_bf16 v[52:55], v[164:167], v[76:79], v[52:55]
  v_mfma_f32_16x16x32_bf16 v[60:63], v[220:223], v[76:79], v[60:63]
  global_load_dwordx4 v[76:79], v3, s[56:57] offset:1024
  s_waitcnt vmcnt(3)
  v_mfma_f32_16x16x32_bf16 v[8:11], a[24:27], v[64:67], v[8:11]
  v_mfma_f32_16x16x32_bf16 v[16:19], a[80:83], v[64:67], v[16:19]
  v_mfma_f32_16x16x32_bf16 v[24:27], a[136:139], v[64:67], v[24:27]
  v_mfma_f32_16x16x32_bf16 v[32:35], a[192:195], v[64:67], v[32:35]
  v_mfma_f32_16x16x32_bf16 v[40:43], a[248:251], v[64:67], v[40:43]
  v_mfma_f32_16x16x32_bf16 v[48:51], v[168:171], v[64:67], v[48:51]
  v_mfma_f32_16x16x32_bf16 v[56:59], v[224:227], v[64:67], v[56:59]
  global_load_dwordx4 v[64:67], v1, s[54:55] offset:0
  s_waitcnt vmcnt(3)
  v_mfma_f32_16x16x32_bf16 v[12:15], a[24:27], v[68:71], v[12:15]
  v_mfma_f32_16x16x32_bf16 v[20:23], a[80:83], v[68:71], v[20:23]
  v_mfma_f32_16x16x32_bf16 v[28:31], a[136:139], v[68:71], v[28:31]
  v_mfma_f32_16x16x32_bf16 v[36:39], a[192:195], v[68:71], v[36:39]
  v_mfma_f32_16x16x32_bf16 v[44:47], a[248:251], v[68:71], v[44:47]
  v_mfma_f32_16x16x32_bf16 v[52:55], v[168:171], v[68:71], v[52:55]
  v_mfma_f32_16x16x32_bf16 v[60:63], v[224:227], v[68:71], v[60:63]
  global_load_dwordx4 v[68:71], v3, s[56:57] offset:2048
  s_waitcnt vmcnt(3)
  v_mfma_f32_16x16x32_bf16 v[8:11], a[28:31], v[72:75], v[8:11]
  v_mfma_f32_16x16x32_bf16 v[16:19], a[84:87], v[72:75], v[16:19]
  v_mfma_f32_16x16x32_bf16 v[24:27], a[140:143], v[72:75], v[24:27]
  v_mfma_f32_16x16x32_bf16 v[32:35], a[196:199], v[72:75], v[32:35]
  v_mfma_f32_16x16x32_bf16 v[40:43], a[252:255], v[72:75], v[40:43]
  v_mfma_f32_16x16x32_bf16 v[48:51], v[172:175], v[72:75], v[48:51]
  v_mfma_f32_16x16x32_bf16 v[56:59], v[228:231], v[72:75], v[56:59]
  global_load_dwordx4 v[72:75], v1, s[54:55] offset:1024
  s_waitcnt vmcnt(3)
  v_mfma_f32_16x16x32_bf16 v[12:15], a[28:31], v[76:79], v[12:15]
  v_mfma_f32_16x16x32_bf16 v[20:23], a[84:87], v[76:79], v[20:23]
  v_mfma_f32_16x16x32_bf16 v[28:31], a[140:143], v[76:79], v[28:31]
  v_mfma_f32_16x16x32_bf16 v[36:39], a[196:199], v[76:79], v[36:39]
  v_mfma_f32_16x16x32_bf16 v[44:47], a[252:255], v[76:79], v[44:47]
  v_mfma_f32_16x16x32_bf16 v[52:55], v[172:175], v[76:79], v[52:55]
  v_mfma_f32_16x16x32_bf16 v[60:63], v[228:231], v[76:79], v[60:63]
  global_load_dwordx4 v[76:79], v3, s[56:57] offset:3072
  s_waitcnt vmcnt(3)
  v_mfma_f32_16x16x32_bf16 v[8:11], a[32:35], v[64:67], v[8:11]
  v_mfma_f32_16x16x32_bf16 v[16:19], a[88:91], v[64:67], v[16:19]
  v_mfma_f32_16x16x32_bf16 v[24:27], a[144:147], v[64:67], v[24:27]
  v_mfma_f32_16x16x32_bf16 v[32:35], a[200:203], v[64:67], v[32:35]
  v_mfma_f32_16x16x32_bf16 v[40:43], v[120:123], v[64:67], v[40:43]
  v_mfma_f32_16x16x32_bf16 v[48:51], v[176:179], v[64:67], v[48:51]
  v_mfma_f32_16x16x32_bf16 v[56:59], v[232:235], v[64:67], v[56:59]
  global_load_dwordx4 v[64:67], v1, s[54:55] offset:2048
  s_waitcnt vmcnt(3)
  v_mfma_f32_16x16x32_bf16 v[12:15], a[32:35], v[68:71], v[12:15]
  v_mfma_f32_16x16x32_bf16 v[20:23], a[88:91], v[68:71], v[20:23]
  v_mfma_f32_16x16x32_bf16 v[28:31], a[144:147], v[68:71], v[28:31]
  v_mfma_f32_16x16x32_bf16 v[36:39], a[200:203], v[68:71], v[36:39]
  v_mfma_f32_16x16x32_bf16 v[44:47], v[120:123], v[68:71], v[44:47]
  v_mfma_f32_16x16x32_bf16 v[52:55], v[176:179], v[68:71], v[52:55]
  v_mfma_f32_16x16x32_bf16 v[60:63], v[232:235], v[68:71], v[60:63]
  global_load_dwordx4 v[68:71], v1, s[58:59] offset:0
  s_waitcnt vmcnt(3)
  v_mfma_f32_16x16x32_bf16 v[8:11], a[36:39], v[72:75], v[8:11]
  v_mfma_f32_16x16x32_bf16 v[16:19], a[92:95], v[72:75], v[16:19]
  v_mfma_f32_16x16x32_bf16 v[24:27], a[148:151], v[72:75], v[24:27]
  v_mfma_f32_16x16x32_bf16 v[32:35], a[204:207], v[72:75], v[32:35]
  v_mfma_f32_16x16x32_bf16 v[40:43], v[124:127], v[72:75], v[40:43]
  v_mfma_f32_16x16x32_bf16 v[48:51], v[180:183], v[72:75], v[48:51]
  v_mfma_f32_16x16x32_bf16 v[56:59], v[236:239], v[72:75], v[56:59]
  global_load_dwordx4 v[72:75], v1, s[54:55] offset:3072
  s_waitcnt vmcnt(3)
  v_mfma_f32_16x16x32_bf16 v[12:15], a[36:39], v[76:79], v[12:15]
  v_mfma_f32_16x16x32_bf16 v[20:23], a[92:95], v[76:79], v[20:23]
  v_mfma_f32_16x16x32_bf16 v[28:31], a[148:151], v[76:79], v[28:31]
  v_mfma_f32_16x16x32_bf16 v[36:39], a[204:207], v[76:79], v[36:39]
  v_mfma_f32_16x16x32_bf16 v[44:47], v[124:127], v[76:79], v[44:47]
  v_mfma_f32_16x16x32_bf16 v[52:55], v[180:183], v[76:79], v[52:55]
  v_mfma_f32_16x16x32_bf16 v[60:63], v[236:239], v[76:79], v[60:63]
  global_load_dwordx4 v[76:79], v1, s[58:59] offset:1024
  s_waitcnt vmcnt(3)
  v_mfma_f32_16x16x32_bf16 v[8:11], a[40:43], v[64:67], v[8:11]
  v_mfma_f32_16x16x32_bf16 v[16:19], a[96:99], v[64:67], v[16:19]
  v_mfma_f32_16x16x32_bf16 v[24:27], a[152:155], v[64:67], v[24:27]
  v_mfma_f32_16x16x32_bf16 v[32:35], a[208:211], v[64:67], v[32:35]
  v_mfma_f32_16x16x32_bf16 v[40:43], v[128:131], v[64:67], v[40:43]
  v_mfma_f32_16x16x32_bf16 v[48:51], v[184:187], v[64:67], v[48:51]
  v_mfma_f32_16x16x32_bf16 v[56:59], v[240:243], v[64:67], v[56:59]
  global_load_dwordx4 v[64:67], v3, s[54:55] offset:0
  s_waitcnt vmcnt(3)
  v_mfma_f32_16x16x32_bf16 v[12:15], a[40:43], v[68:71], v[12:15]
  v_mfma_f32_16x16x32_bf16 v[20:23], a[96:99], v[68:71], v[20:23]
  v_mfma_f32_16x16x32_bf16 v[28:31], a[152:155], v[68:71], v[28:31]
  v_mfma_f32_16x16x32_bf16 v[36:39], a[208:211], v[68:71], v[36:39]
  v_mfma_f32_16x16x32_bf16 v[44:47], v[128:131], v[68:71], v[44:47]
  v_mfma_f32_16x16x32_bf16 v[52:55], v[184:187], v[68:71], v[52:55]
  v_mfma_f32_16x16x32_bf16 v[60:63], v[240:243], v[68:71], v[60:63]
  global_load_dwordx4 v[68:71], v1, s[58:59] offset:2048
  s_waitcnt vmcnt(3)
  v_mfma_f32_16x16x32_bf16 v[8:11], a[44:47], v[72:75], v[8:11]
  v_mfma_f32_16x16x32_bf16 v[16:19], a[100:103], v[72:75], v[16:19]
  v_mfma_f32_16x16x32_bf16 v[24:27], a[156:159], v[72:75], v[24:27]
  v_mfma_f32_16x16x32_bf16 v[32:35], a[212:215], v[72:75], v[32:35]
  v_mfma_f32_16x16x32_bf16 v[40:43], v[132:135], v[72:75], v[40:43]
  v_mfma_f32_16x16x32_bf16 v[48:51], v[188:191], v[72:75], v[48:51]
  v_mfma_f32_16x16x32_bf16 v[56:59], v[244:247], v[72:75], v[56:59]
  global_load_dwordx4 v[72:75], v3, s[54:55] offset:1024
  s_waitcnt vmcnt(3)
  v_mfma_f32_16x16x32_bf16 v[12:15], a[44:47], v[76:79], v[12:15]
  v_mfma_f32_16x16x32_bf16 v[20:23], a[100:103], v[76:79], v[20:23]
  v_mfma_f32_16x16x32_bf16 v[28:31], a[156:159], v[76:79], v[28:31]
  v_mfma_f32_16x16x32_bf16 v[36:39], a[212:215], v[76:79], v[36:39]
  v_mfma_f32_16x16x32_bf16 v[44:47], v[132:135], v[76:79], v[44:47]
  v_mfma_f32_16x16x32_bf16 v[52:55], v[188:191], v[76:79], v[52:55]
  v_mfma_f32_16x16x32_bf16 v[60:63], v[244:247], v[76:79], v[60:63]
  global_load_dwordx4 v[76:79], v1, s[58:59] offset:3072
  s_waitcnt vmcnt(3)
  v_mfma_f32_16x16x32_bf16 v[8:11], a[48:51], v[64:67], v[8:11]
  v_mfma_f32_16x16x32_bf16 v[16:19], a[104:107], v[64:67], v[16:19]
  v_mfma_f32_16x16x32_bf16 v[24:27], a[160:163], v[64:67], v[24:27]
  v_mfma_f32_16x16x32_bf16 v[32:35], a[216:219], v[64:67], v[32:35]
  v_mfma_f32_16x16x32_bf16 v[40:43], v[136:139], v[64:67], v[40:43]
  v_mfma_f32_16x16x32_bf16 v[48:51], v[192:195], v[64:67], v[48:51]
  v_mfma_f32_16x16x32_bf16 v[56:59], v[248:251], v[64:67], v[56:59]
  s_waitcnt vmcnt(2)
  v_mfma_f32_16x16x32_bf16 v[12:15], a[48:51], v[68:71], v[12:15]
  v_mfma_f32_16x16x32_bf16 v[20:23], a[104:107], v[68:71], v[20:23]
  v_mfma_f32_16x16x32_bf16 v[28:31], a[160:163], v[68:71], v[28:31]
  v_mfma_f32_16x16x32_bf16 v[36:39], a[216:219], v[68:71], v[36:39]
  v_mfma_f32_16x16x32_bf16 v[44:47], v[136:139], v[68:71], v[44:47]
  v_mfma_f32_16x16x32_bf16 v[52:55], v[192:195], v[68:71], v[52:55]
  v_mfma_f32_16x16x32_bf16 v[60:63], v[248:251], v[68:71], v[60:63]
  s_waitcnt vmcnt(1)
  v_mfma_f32_16x16x32_bf16 v[8:11], a[52:55], v[72:75], v[8:11]
  v_mfma_f32_16x16x32_bf16 v[16:19], a[108:111], v[72:75], v[16:19]
  v_mfma_f32_16x16x32_bf16 v[24:27], a[164:167], v[72:75], v[24:27]
  v_mfma_f32_16x16x32_bf16 v[32:35], a[220:223], v[72:75], v[32:35]
  v_mfma_f32_16x16x32_bf16 v[40:43], v[140:143], v[72:75], v[40:43]
  v_mfma_f32_16x16x32_bf16 v[48:51], v[196:199], v[72:75], v[48:51]
  v_mfma_f32_16x16x32_bf16 v[56:59], v[252:255], v[72:75], v[56:59]
  s_waitcnt vmcnt(0)
  v_mfma_f32_16x16x32_bf16 v[12:15], a[52:55], v[76:79], v[12:15]
  v_mfma_f32_16x16x32_bf16 v[20:23], a[108:111], v[76:79], v[20:23]
  v_mfma_f32_16x16x32_bf16 v[28:31], a[164:167], v[76:79], v[28:31]
  v_mfma_f32_16x16x32_bf16 v[36:39], a[220:223], v[76:79], v[36:39]
  v_mfma_f32_16x16x32_bf16 v[44:47], v[140:143], v[76:79], v[44:47]
  v_mfma_f32_16x16x32_bf16 v[52:55], v[196:199], v[76:79], v[52:55]
  v_mfma_f32_16x16x32_bf16 v[60:63], v[252:255], v[76:79], v[60:63]
  v_cvt_pk_bf16_f32 v80, v8, v9
  v_cvt_pk_bf16_f32 v81, v10, v11
  v_cvt_pk_bf16_f32 v82, v16, v17
  v_cvt_pk_bf16_f32 v83, v18, v19
  v_cvt_pk_bf16_f32 v84, v24, v25
  v_cvt_pk_bf16_f32 v85, v26, v27
  v_cvt_pk_bf16_f32 v86, v32, v33
  v_cvt_pk_bf16_f32 v87, v34, v35
  v_cvt_pk_bf16_f32 v88, v40, v41
  v_cvt_pk_bf16_f32 v89, v42, v43
  v_cvt_pk_bf16_f32 v90, v48, v49
  v_cvt_pk_bf16_f32 v91, v50, v51
  v_cvt_pk_bf16_f32 v92, v56, v57
  v_cvt_pk_bf16_f32 v93, v58, v59
  v_cvt_pk_bf16_f32 v96, v12, v13
  v_cvt_pk_bf16_f32 v97, v14, v15
  v_cvt_pk_bf16_f32 v98, v20, v21
  v_cvt_pk_bf16_f32 v99, v22, v23
  v_cvt_pk_bf16_f32 v100, v28, v29
  v_cvt_pk_bf16_f32 v101, v30, v31
  v_cvt_pk_bf16_f32 v102, v36, v37
  v_cvt_pk_bf16_f32 v103, v38, v39
  v_cvt_pk_bf16_f32 v104, v44, v45
  v_cvt_pk_bf16_f32 v105, v46, v47
  v_cvt_pk_bf16_f32 v106, v52, v53
  v_cvt_pk_bf16_f32 v107, v54, v55
  v_cvt_pk_bf16_f32 v108, v60, v61
  v_cvt_pk_bf16_f32 v109, v62, v63
  global_load_dwordx4 v[8:11], v1, s[46:47] offset:0
  global_load_dwordx4 v[12:15], v1, s[46:47] offset:1024
  global_load_dwordx4 v[16:19], v1, s[46:47] offset:2048
  global_load_dwordx2 v[20:21], v1, s[46:47] offset:3072
  global_load_dwordx4 v[24:27], v3, s[46:47] offset:0
  global_load_dwordx4 v[28:31], v3, s[46:47] offset:1024
  global_load_dwordx4 v[32:35], v3, s[46:47] offset:2048
  global_load_dwordx2 v[36:37], v3, s[46:47] offset:3072
mk_hsmem:
  global_load_dwordx2 v[64:65], v4, s[48:49] offset:0 sc1
  global_load_dwordx2 v[66:67], v4, s[48:49] offset:256 sc1
  global_load_dwordx2 v[68:69], v4, s[48:49] offset:512 sc1
  global_load_dwordx2 v[70:71], v4, s[48:49] offset:768 sc1
  global_load_dwordx2 v[72:73], v4, s[48:49] offset:1024 sc1
  global_load_dwordx2 v[74:75], v4, s[48:49] offset:1280 sc1
  global_load_dwordx2 v[76:77], v4, s[48:49] offset:1536 sc1
  s_waitcnt vmcnt(0)
  v_max3_u32 v117, v64, v65, v66
  v_max3_u32 v117, v117, v67, v68
  v_max3_u32 v117, v117, v69, v70
  v_max3_u32 v117, v117, v71, v72
  v_max3_u32 v117, v117, v73, v74
  v_max3_u32 v117, v117, v75, v76
  v_max_u32 v117, v117, v77
  v_cmp_eq_u32 vcc, -1, v117
  s_cbranch_vccz mk_hsok
  s_sleep 2
  s_cmp_ge_u32 s37, 62
  s_cbranch_scc1 mk_hss
  s_sleep 16
mk_hss:
  s_sub_u32 s40, s40, 1
  s_cbranch_scc0 mk_hsmem
  s_mov_b32 s40, 0
mk_hsok:
  v_mfma_f32_16x16x32_bf16 v[40:43], v[8:11], v[80:83], 0
  v_mfma_f32_16x16x32_bf16 v[44:47], v[8:11], v[96:99], 0
  v_mfma_f32_16x16x32_bf16 v[48:51], v[24:27], v[80:83], 0
  v_mfma_f32_16x16x32_bf16 v[52:55], v[24:27], v[96:99], 0
  v_mfma_f32_16x16x32_bf16 v[56:59], v[64:67], v[80:83], 0
  v_mfma_f32_16x16x32_bf16 v[60:63], v[64:67], v[96:99], 0
  v_mfma_f32_16x16x32_bf16 v[40:43], v[12:15], v[84:87], v[40:43]
  v_mfma_f32_16x16x32_bf16 v[44:47], v[12:15], v[100:103], v[44:47]
  v_mfma_f32_16x16x32_bf16 v[48:51], v[28:31], v[84:87], v[48:51]
  v_mfma_f32_16x16x32_bf16 v[52:55], v[28:31], v[100:103], v[52:55]
  v_mfma_f32_16x16x32_bf16 v[56:59], v[68:71], v[84:87], v[56:59]
  v_mfma_f32_16x16x32_bf16 v[60:63], v[68:71], v[100:103], v[60:63]
  v_mfma_f32_16x16x32_bf16 v[40:43], v[16:19], v[88:91], v[40:43]
  v_mfma_f32_16x16x32_bf16 v[44:47], v[16:19], v[104:107], v[44:47]
  v_mfma_f32_16x16x32_bf16 v[48:51], v[32:35], v[88:91], v[48:51]
  v_mfma_f32_16x16x32_bf16 v[52:55], v[32:35], v[104:107], v[52:55]
  v_mfma_f32_16x16x32_bf16 v[56:59], v[72:75], v[88:91], v[56:59]
  v_mfma_f32_16x16x32_bf16 v[60:63], v[72:75], v[104:107], v[60:63]
  v_mfma_f32_16x16x16_bf16 v[40:43], v[20:21], v[92:93], v[40:43]
  v_mfma_f32_16x16x16_bf16 v[44:47], v[20:21], v[108:109], v[44:47]
  v_mfma_f32_16x16x16_bf16 v[48:51], v[36:37], v[92:93], v[48:51]
  v_mfma_f32_16x16x16_bf16 v[52:55], v[36:37], v[108:109], v[52:55]
  v_mfma_f32_16x16x16_bf16 v[56:59], v[76:77], v[92:93], v[56:59]
  v_mfma_f32_16x16x16_bf16 v[60:63], v[76:77], v[108:109], v[60:63]
  s_barrier
  ds_write_b128 v5, v[40:43] offset:0
  ds_write_b128 v5, v[44:47] offset:3328
  ds_write_b128 v5, v[48:51] offset:64
  ds_write_b128 v5, v[52:55] offset:3392
  s_nop 0
  ds_write_b128 v5, v[56:59] offset:128
  s_nop 0
  ds_write_b128 v5, v[60:63] offset:3456
  s_waitcnt lgkmcnt(0)
  s_barrier
  s_cmp_ge_u32 s22, 2
  s_cbranch_scc1 mk_hsnext
  ds_read_b128 v[64:67], v6 offset:0
  ds_read_b128 v[68:71], v6 offset:64
  ds_read_b128 v[72:75], v6 offset:128
  ds_read_b128 v[76:79], v6 offset:6656
  ds_read_b128 v[80:83], v6 offset:6720
  ds_read_b128 v[84:87], v6 offset:6784
  ds_read_b128 v[88:91], v6 offset:13312
  ds_read_b128 v[92:95], v6 offset:13376
  ds_read_b128 v[96:99], v6 offset:13440
  ds_read_b128 v[100:103], v6 offset:19968
  ds_read_b128 v[104:107], v6 offset:20032
  ds_read_b128 v[108:111], v6 offset:20096
  s_waitcnt lgkmcnt(0)
  v_pk_add_f32 v[64:65], v[64:65], v[76:77]
  v_pk_add_f32 v[88:89], v[88:89], v[100:101]
  v_pk_add_f32 v[64:65], v[64:65], v[88:89]
  v_pk_add_f32 v[66:67], v[66:67], v[78:79]
  v_pk_add_f32 v[90:91], v[90:91], v[102:103]
  v_pk_add_f32 v[66:67], v[66:67], v[90:91]
  v_pk_add_f32 v[68:69], v[68:69], v[80:81]
  v_pk_add_f32 v[92:93], v[92:93], v[104:105]
  v_pk_add_f32 v[68:69], v[68:69], v[92:93]
  v_pk_add_f32 v[70:71], v[70:71], v[82:83]
  v_pk_add_f32 v[94:95], v[94:95], v[106:107]
  v_pk_add_f32 v[70:71], v[70:71], v[94:95]
  v_pk_add_f32 v[72:73], v[72:73], v[84:85]
  v_pk_add_f32 v[96:97], v[96:97], v[108:109]
  v_pk_add_f32 v[72:73], v[72:73], v[96:97]
  v_pk_add_f32 v[74:75], v[74:75], v[86:87]
  v_pk_add_f32 v[98:99], v[98:99], v[110:111]
  v_pk_add_f32 v[74:75], v[74:75], v[98:99]
  v_mov_b32 v8, 0xff800000
  v_cmp_le_i32 vcc, 0, v115
  s_nop 1
  v_cndmask_b32 v64, v8, v64, vcc
  v_cmp_le_i32 vcc, 1, v115
  s_nop 1
  v_cndmask_b32 v65, v8, v65, vcc
  v_cmp_le_i32 vcc, 2, v115
  s_nop 1
  v_cndmask_b32 v66, v8, v66, vcc
  v_cmp_le_i32 vcc, 3, v115
  s_nop 1
  v_cndmask_b32 v67, v8, v67, vcc
  v_cmp_le_i32 vcc, 16, v115
  s_nop 1
  v_cndmask_b32 v68, v8, v68, vcc
  v_cmp_le_i32 vcc, 17, v115
  s_nop 1
  v_cndmask_b32 v69, v8, v69, vcc
  v_cmp_le_i32 vcc, 18, v115
  s_nop 1
  v_cndmask_b32 v70, v8, v70, vcc
  v_cmp_le_i32 vcc, 19, v115
  s_nop 1
  v_cndmask_b32 v71, v8, v71, vcc
  v_cmp_gt_u32 vcc, 32, v0
  s_nop 1
  v_cndmask_b32 v72, v8, v72, vcc
  v_cndmask_b32 v73, v8, v73, vcc
  v_cndmask_b32 v74, v8, v74, vcc
  v_cndmask_b32 v75, v8, v75, vcc
  v_max3_f32 v9, v64, v65, v66
  v_max3_f32 v9, v9, v67, v68
  v_max3_f32 v9, v9, v69, v70
  v_max3_f32 v9, v9, v71, v72
  v_max3_f32 v9, v9, v73, v74
  v_max_f32 v9, v9, v75
  v_mov_b32 v10, v9
  s_nop 1
  v_permlane16_swap_b32 v9, v10
  v_max_f32 v9, v9, v10
  v_mov_b32 v10, v9
  s_nop 1
  v_permlane32_swap_b32 v9, v10
  v_max_f32 v9, v9, v10
  v_sub_f32 v64, v64, v9
  v_exp_f32 v64, v64
  v_sub_f32 v65, v65, v9
  v_exp_f32 v65, v65
  v_sub_f32 v66, v66, v9
  v_exp_f32 v66, v66
  v_sub_f32 v67, v67, v9
  v_exp_f32 v67, v67
  v_sub_f32 v68, v68, v9
  v_exp_f32 v68, v68
  v_sub_f32 v69, v69, v9
  v_exp_f32 v69, v69
  v_sub_f32 v70, v70, v9
  v_exp_f32 v70, v70
  v_sub_f32 v71, v71, v9
  v_exp_f32 v71, v71
  v_sub_f32 v72, v72, v9
  v_exp_f32 v72, v72
  v_sub_f32 v73, v73, v9
  v_exp_f32 v73, v73
  v_sub_f32 v74, v74, v9
  v_exp_f32 v74, v74
  v_sub_f32 v75, v75, v9
  v_exp_f32 v75, v75
  v_add_f32 v9, v64, v65
  v_add_f32 v9, v9, v66
  v_add_f32 v9, v9, v67
  v_add_f32 v9, v9, v68
  v_add_f32 v9, v9, v69
  v_add_f32 v9, v9, v70
  v_add_f32 v9, v9, v71
  v_add_f32 v9, v9, v72
  v_add_f32 v9, v9, v73
  v_add_f32 v9, v9, v74
  v_add_f32 v9, v9, v75
  v_mov_b32 v10, v9
  s_nop 1
  v_permlane16_swap_b32 v9, v10
  v_add_f32 v9, v9, v10
  v_mov_b32 v10, v9
  s_nop 1
  v_permlane32_swap_b32 v9, v10
  v_add_f32 v9, v9, v10
  v_rcp_f32 v9, v9
  s_nop 0
  v_mul_f32 v64, v64, v9
  v_mul_f32 v65, v65, v9
  v_mul_f32 v66, v66, v9
  v_mul_f32 v67, v67, v9
  v_mul_f32 v68, v68, v9
  v_mul_f32 v69, v69, v9
  v_mul_f32 v70, v70, v9
  v_mul_f32 v71, v71, v9
  v_mul_f32 v72, v72, v9
  v_mul_f32 v73, v73, v9
  v_mul_f32 v74, v74, v9
  v_mul_f32 v75, v75, v9
  v_cvt_pk_bf16_f32 v12, v64, v65
  v_cvt_pk_bf16_f32 v13, v66, v67
  v_cvt_pk_bf16_f32 v14, v68, v69
  v_cvt_pk_bf16_f32 v15, v70, v71
  v_cvt_pk_bf16_f32 v16, v72, v73
  v_cvt_pk_bf16_f32 v17, v74, v75
  global_store_dwordx2 v7, v[12:13], s[50:51] sc1
  global_store_dwordx2 v7, v[14:15], s[50:51] offset:1024 sc1
  s_mov_b32 exec_hi, 0
  global_store_dwordx2 v114, v[16:17], s[50:51] sc1
  s_mov_b32 exec_hi, -1
mk_hsnext:
  s_add_u32 s44, s44, 114688
  s_addc_u32 s45, s45, 0
  s_add_u32 s46, s46, 131072
  s_addc_u32 s47, s47, 0
  s_add_u32 s48, s48, 28672
  s_addc_u32 s49, s49, 0
  s_add_u32 s50, s50, 163840
  s_addc_u32 s51, s51, 0
  s_add_u32 s37, s37, 4
  s_add_u32 s36, s36, 1
  s_cmp_lt_u32 s36, 16
  s_cbranch_scc1 mk_hsloop
  s_branch mk_fin
mk_ho:
  s_waitcnt vmcnt(0) lgkmcnt(0)
  v_mov_b32 v0, v250
  s_mov_b32 s40, 1000000
  v_and_b32 v3, 63, v0
  s_cmp_lg_u32 s22, 0
  s_cbranch_scc1 wgw_79
  s_and_b32 s3, s2, 15
  s_lshl_b32 s3, s3, 8
  s_add_u32 s3, s3, 14995456
  v_mov_b32 v4, s3
mk_pg_80:
  global_load_dword v5, v4, s[4:5] sc1
  s_waitcnt vmcnt(0)
  v_readfirstlane_b32 s3, v5
  s_nop 0
  s_sub_u32 s3, s3, s20
  s_sub_u32 s3, s3, 1
  s_cmp_lt_u32 s3, 128
  s_cbranch_scc1 mk_pd_81
  s_sleep 80
  s_sub_u32 s40, s40, 1
  s_cbranch_scc0 mk_pg_80
  s_mov_b32 s40, 0
mk_pd_81:
  v_lshlrev_b32 v4, 2, v3
  v_add_u32 v4, 14942208, v4
mk_wf_82:
  global_load_dword v5, v4, s[4:5] offset:0 sc1
  global_load_dword v6, v4, s[4:5] offset:256 sc1
  global_load_dword v7, v4, s[4:5] offset:512 sc1
  global_load_dword v8, v4, s[4:5] offset:768 sc1
  global_load_dword v9, v4, s[4:5] offset:1024 sc1
  global_load_dword v10, v4, s[4:5] offset:1280 sc1
  global_load_dword v11, v4, s[4:5] offset:1536 sc1
  global_load_dword v12, v4, s[4:5] offset:1792 sc1
  global_load_dword v13, v4, s[4:5] offset:2048 sc1
  global_load_dword v14, v4, s[4:5] offset:2304 sc1
  global_load_dword v15, v4, s[4:5] offset:2560 sc1
  global_load_dword v16, v4, s[4:5] offset:2816 sc1
  global_load_dword v17, v4, s[4:5] offset:3072 sc1
  global_load_dword v18, v4, s[4:5] offset:3328 sc1
  s_waitcnt vmcnt(0)
  v_xor_b32 v5, s20, v5
  v_xor_b32 v6, s20, v6
  v_or_b32 v5, v5, v6
  v_xor_b32 v7, s20, v7
  v_or_b32 v5, v5, v7
  v_xor_b32 v8, s20, v8
  v_or_b32 v5, v5, v8
  v_xor_b32 v9, s20, v9
  v_or_b32 v5, v5, v9
  v_xor_b32 v10, s20, v10
  v_or_b32 v5, v5, v10
  v_xor_b32 v11, s20, v11
  v_or_b32 v5, v5, v11
  v_xor_b32 v12, s20, v12
  v_or_b32 v5, v5, v12
  v_xor_b32 v13, s20, v13
  v_or_b32 v5, v5, v13
  v_xor_b32 v14, s20, v14
  v_or_b32 v5, v5, v14
  v_xor_b32 v15, s20, v15
  v_or_b32 v5, v5, v15
  v_xor_b32 v16, s20, v16
  v_or_b32 v5, v5, v16
  v_xor_b32 v17, s20, v17
  v_or_b32 v5, v5, v17
  v_xor_b32 v18, s20, v18
  v_or_b32 v5, v5, v18
  v_cmp_ne_u32 vcc, 0, v5
  s_cbranch_vccz mk_wd_83
  s_sleep 40
  s_sub_u32 s40, s40, 1
  s_cbranch_scc0 mk_wf_82
  s_mov_b32 s40, 0
mk_wd_83:
wgw_79:
  s_barrier
  v_lshlrev_b32 v1, 5, v0
  v_add_u32 v1, 14680064, v1
  global_load_dwordx4 v[4:7], v1, s[4:5] sc1
  global_load_dwordx4 v[8:11], v1, s[4:5] offset:16 sc1
  s_waitcnt vmcnt(0)
  v_max3_u32 v4, v4, v5, v6
  v_max3_u32 v8, v8, v9, v10
  v_max3_u32 v4, v4, v7, v11
  v_max_u32 v4, v4, v8
  s_nop 1
  v_max_u32_dpp v4, v4, v4 row_ror:8 row_mask:0xf bank_mask:0xf
  s_nop 1
  v_max_u32_dpp v4, v4, v4 row_ror:4 row_mask:0xf bank_mask:0xf
  s_nop 1
  v_max_u32_dpp v4, v4, v4 row_ror:2 row_mask:0xf bank_mask:0xf
  s_nop 1
  v_max_u32_dpp v4, v4, v4 row_ror:1 row_mask:0xf bank_mask:0xf
  v_mov_b32 v5, v4
  s_nop 1
  v_permlane16_swap_b32 v4, v5
  v_max_u32 v4, v4, v5
  v_mov_b32 v5, v4
  s_nop 1
  v_permlane32_swap_b32 v4, v5
  v_max_u32 v4, v4, v5
  v_lshrrev_b32 v2, 6, v0
  v_lshlrev_b32 v2, 2, v2
  s_barrier
  ds_write_b32 v2, v4
  s_waitcnt lgkmcnt(0)
  s_barrier
  v_mov_b32 v2, 0
  ds_read_b128 v[4:7], v2
  s_waitcnt lgkmcnt(0)
  v_max3_u32 v4, v4, v5, v6
  v_max_u32 v4, v4, v7
  s_nop 0
  v_readfirstlane_b32 s26, v4
  s_nop 0
  s_and_b32 s27, s26, 0x7ff
  s_sub_u32 s27, 2047, s27
  v_and_b32 v5, 0xffff0000, v4
  v_ashrrev_i32 v6, 31, v5
  v_not_b32 v6, v6
  v_or_b32 v6, 0x80000000, v6
  v_xor_b32 v5, v5, v6
  v_and_b32 v5, 0xffff0000, v5
  v_mul_f32 v5, 0xbfb8aa3b, v5
  v_exp_f32 v5, v5
  s_nop 0
  v_add_f32 v5, 1.0, v5
  v_rcp_f32 v5, v5
  s_nop 0
  v_cvt_pk_bf16_f32 v5, v5, v5
  v_and_b32 v5, 0xffff0000, v5
  s_nop 0
  v_readfirstlane_b32 s41, v5
  s_barrier
  s_mov_b32 s40, s27
  s_load_dwordx2 s[8:9], s[0:1], 0
  s_load_dwordx2 s[10:11], s[0:1], 104
  v_and_b32 v0, 63, v0
  v_lshlrev_b32 v1, 4, v0
  v_and_b32 v2, 15, v0
  v_lshrrev_b32 v3, 4, v0
  v_lshrrev_b32 v4, 1, v3
  v_lshlrev_b32 v4, 9, v4
  v_and_b32 v5, 1, v3
  v_lshl_add_u32 v4, v5, 7, v4
  v_lshl_add_u32 v4, v2, 3, v4
  v_lshrrev_b32 v129, 1, v3
  v_mul_u32_u24 v129, 5120, v129
  v_lshl_add_u32 v129, v5, 7, v129
  v_lshl_add_u32 v129, v2, 3, v129
  v_and_b32 v128, 31, v0
  v_lshlrev_b32 v128, 3, v128
  v_lshrrev_b32 v130, 5, v0
  v_lshl_add_u32 v128, v130, 10, v128
  v_mul_u32_u24 v5, 896, v2
  v_lshl_add_u32 v5, v3, 3, v5
  v_lshlrev_b32 v6, 3, v2
  v_and_b32 v130, 31, v0
  v_lshrrev_b32 v131, 1, v130
  v_mul_u32_u24 v131, 2560, v131
  v_and_b32 v130, 1, v130
  v_lshl_add_u32 v130, v130, 8, v131
  v_add_u32 v130, 2048, v130
  s_mov_b32 s42, 2000000
  v_cmp_gt_u32 s[48:49], 32, v0
  v_and_b32 v131, 15, v0
  v_lshlrev_b32 v131, 2, v131
  v_add_u32 v131, 15073280, v131
  s_waitcnt lgkmcnt(0)
mk_oloop:
  s_waitcnt vmcnt(0)
  s_cmp_lg_u32 s22, 0
  s_cbranch_scc1 wgw_84
  s_mov_b64 exec, 1
  v_mov_b32 v2, 0
  v_mov_b32 v3, 1
  global_atomic_add v7, v2, v3, s[6:7] offset:136 sc0
  s_waitcnt vmcnt(0)
  ds_write_b32 v2, v7 offset:64
  s_mov_b64 exec, -1
  v_readfirstlane_b32 s26, v7
  s_nop 0
  s_min_u32 s26, s26, 447
  s_mul_i32 s24, s26, 9363
  s_lshr_b32 s24, s24, 16
  s_mul_i32 s25, s24, 7
  s_sub_u32 s25, s26, s25
  s_mul_i32 s30, s24, 448
  s_lshl_b32 s31, s25, 6
  s_add_u32 s30, s30, s31
  s_add_u32 s30, s30, 14950400
  v_lshlrev_b32 v140, 2, v0
  v_min_u32 v140, 60, v140
  v_add_u32 v140, s30, v140
mk_wf_85:
  global_load_dword v141, v140, s[4:5] offset:0 sc1
  s_waitcnt vmcnt(0)
  v_xor_b32 v141, s20, v141
  v_cmp_ne_u32 vcc, 0, v141
  s_cbranch_vccz mk_wd_86
  s_sleep 30
  s_sub_u32 s42, s42, 1
  s_cbranch_scc0 mk_wf_85
  s_mov_b32 s42, 0
mk_wd_86:
  s_waitcnt lgkmcnt(0)
wgw_84:
  s_barrier
  v_mov_b32 v2, 0
  ds_read_b32 v7, v2 offset:64
  s_waitcnt lgkmcnt(0)
  v_readfirstlane_b32 s26, v7
  s_nop 0
  s_cmp_ge_u32 s26, 448
  s_cbranch_scc1 mk_fin
  s_mul_i32 s24, s26, 9363
  s_lshr_b32 s24, s24, 16
  s_mul_i32 s25, s24, 7
  s_sub_u32 s25, s26, s25
  s_mov_b32 s43, 0
  s_lshl_b32 s30, s25, 2
  s_add_u32 s30, s30, s22
  s_mul_i32 s31, s24, 28
  s_add_u32 s31, s31, s30
  s_lshl_b32 s32, s31, 14
  s_add_u32 s32, s32, 33558528
  v_add_u32 v2, s32, v1
  global_load_dwordx4 v[16:19], v2, s[4:5] offset:-4096 sc1
  global_load_dwordx4 v[20:23], v2, s[4:5] offset:-3072 sc1
  global_load_dwordx4 v[24:27], v2, s[4:5] offset:-2048 sc1
  global_load_dwordx4 v[28:31], v2, s[4:5] offset:-1024 sc1
  global_load_dwordx4 v[32:35], v2, s[4:5] offset:0 sc1
  global_load_dwordx4 v[36:39], v2, s[4:5] offset:1024 sc1
  global_load_dwordx4 v[40:43], v2, s[4:5] offset:2048 sc1
  global_load_dwordx4 v[44:47], v2, s[4:5] offset:3072 sc1
  v_add_u32 v2, 8192, v2
  global_load_dwordx4 v[48:51], v2, s[4:5] offset:-4096 sc1
  global_load_dwordx4 v[52:55], v2, s[4:5] offset:-3072 sc1
  global_load_dwordx4 v[56:59], v2, s[4:5] offset:-2048 sc1
  global_load_dwordx4 v[60:63], v2, s[4:5] offset:-1024 sc1
  global_load_dwordx4 v[64:67], v2, s[4:5] offset:0 sc1
  global_load_dwordx4 v[68:71], v2, s[4:5] offset:1024 sc1
  global_load_dwordx4 v[72:75], v2, s[4:5] offset:2048 sc1
  global_load_dwordx4 v[76:79], v2, s[4:5] offset:3072 sc1
  s_mul_i32 s32, s24, 40960
  s_add_u32 s32, s32, 17301504
  s_add_u32 s44, s4, s32
  s_addc_u32 s45, s5, 0
  s_lshl_b32 s33, s24, 5
  s_mul_i32 s32, s33, 896
  s_lshl_b32 s34, s30, 5
  s_add_u32 s32, s32, s34
  v_add_u32 v3, s32, v5
  v_add_u32 v7, 14336, v3
  global_load_dwordx2 v[132:133], v3, s[8:9]
  global_load_dwordx2 v[134:135], v7, s[8:9]
  s_lshl_b32 s32, s33, 3
  s_add_u32 s32, s32, 14688256
  v_add_u32 v2, s32, v6
  global_load_dwordx2 v[136:137], v2, s[4:5] sc1
  global_load_dwordx2 v[138:139], v2, s[4:5] offset:128 sc1
  s_cmp_lg_u32 s22, 0
  s_cbranch_scc1 wgw_87
  s_mul_i32 s32, s24, 40960
  s_add_u32 s32, s32, 17301504
  v_add_u32 v140, s32, v130
  s_mul_i32 s32, s24, 448
  s_lshl_b32 s35, s25, 6
  s_add_u32 s32, s32, s35
  v_add_u32 v141, s32, v131
  v_cndmask_b32 v140, v141, v140, s[48:49]
  s_cmp_eq_u32 s24, 63
  s_cselect_b32 s35, 0, -1
mk_pw:
  global_load_dword v141, v140, s[4:5] sc1
  s_waitcnt vmcnt(0)
  v_cmp_eq_u32 vcc, -1, v141
  v_cmp_ne_u32 s[50:51], s20, v141
  s_nop 0
  s_and_b32 vcc_hi, s51, s35
  s_cmp_eq_u64 vcc, 0
  s_cbranch_scc1 mk_cwd
  s_sleep 2
  s_cmp_ge_u32 s24, 61
  s_cbranch_scc1 mk_pws
  s_sleep 24
mk_pws:
  s_sub_u32 s42, s42, 1
  s_cbranch_scc0 mk_pw
  s_mov_b32 s42, 0
mk_cwd:
wgw_87:
  s_barrier
  s_lshl_b32 s32, s31, 12
  s_add_u32 s32, s32, 63045632
  v_add_u32 v2, s32, v4
  global_load_dwordx2 v[80:81], v2, s[4:5] offset:0 sc1
  global_load_dwordx2 v[82:83], v2, s[4:5] offset:256 sc1
  global_load_dwordx2 v[84:85], v2, s[4:5] offset:1024 sc1
  global_load_dwordx2 v[86:87], v2, s[4:5] offset:1280 sc1
  global_load_dwordx2 v[88:89], v2, s[4:5] offset:2048 sc1
  global_load_dwordx2 v[90:91], v2, s[4:5] offset:2304 sc1
  global_load_dwordx2 v[92:93], v2, s[4:5] offset:3072 sc1
  global_load_dwordx2 v[94:95], v2, s[4:5] offset:3328 sc1
  s_mul_i32 s32, s22, 10240
  s_add_u32 s46, s44, s32
  s_addc_u32 s47, s45, 0
  s_add_u32 s32, s32, 4096
  s_add_u32 m0, s32, 0
  s_nop 0
  global_load_lds_dwordx4 v1, s[46:47] offset:0 sc1
  global_load_lds_dwordx4 v1, s[46:47] offset:1024 sc1
  global_load_lds_dwordx4 v1, s[46:47] offset:2048 sc1
  global_load_lds_dwordx4 v1, s[46:47] offset:3072 sc1
  s_add_u32 m0, s32, 4096
  s_add_u32 s46, s46, 4096
  s_addc_u32 s47, s47, 0
  global_load_lds_dwordx4 v1, s[46:47] offset:0 sc1
  global_load_lds_dwordx4 v1, s[46:47] offset:1024 sc1
  global_load_lds_dwordx4 v1, s[46:47] offset:2048 sc1
  global_load_lds_dwordx4 v1, s[46:47] offset:3072 sc1
  s_add_u32 m0, s32, 8192
  s_add_u32 s46, s46, 4096
  s_addc_u32 s47, s47, 0
  global_load_lds_dwordx4 v1, s[46:47] offset:0 sc1
  global_load_lds_dwordx4 v1, s[46:47] offset:1024 sc1
  s_waitcnt vmcnt(0)
  s_barrier
  v_swap_b32 v17, v18
  v_swap_b32 v21, v22
  v_swap_b32 v25, v26
  v_swap_b32 v29, v30
  v_swap_b32 v33, v34
  v_swap_b32 v37, v38
  v_swap_b32 v41, v42
  v_swap_b32 v45, v46
  v_swap_b32 v49, v50
  v_swap_b32 v53, v54
  v_swap_b32 v57, v58
  v_swap_b32 v61, v62
  v_swap_b32 v65, v66
  v_swap_b32 v69, v70
  v_swap_b32 v73, v74
  v_swap_b32 v77, v78
  ds_read_b64 a[0:1], v128 offset:4096
  ds_read_b64 a[4:5], v128 offset:4608
  ds_read_b64 a[2:3], v128 offset:4352
  ds_read_b64 a[6:7], v128 offset:4864
  ds_read_b64 a[8:9], v128 offset:6656
  ds_read_b64 a[12:13], v128 offset:7168
  ds_read_b64 a[10:11], v128 offset:6912
  ds_read_b64 a[14:15], v128 offset:7424
  ds_read_b64 a[16:17], v128 offset:9216
  ds_read_b64 a[20:21], v128 offset:9728
  ds_read_b64 a[18:19], v128 offset:9472
  ds_read_b64 a[22:23], v128 offset:9984
  ds_read_b64 a[24:25], v128 offset:11776
  ds_read_b64 a[28:29], v128 offset:12288
  ds_read_b64 a[26:27], v128 offset:12032
  ds_read_b64 a[30:31], v128 offset:12544
  s_waitcnt lgkmcnt(12)
  v_mfma_f32_16x16x32_bf16 v[8:11], v[16:19], a[0:3], 0
  v_mfma_f32_16x16x32_bf16 v[12:15], v[16:19], a[4:7], 0
  ds_read_b64 a[32:33], v128 offset:14336
  ds_read_b64 a[36:37], v128 offset:14848
  ds_read_b64 a[34:35], v128 offset:14592
  ds_read_b64 a[38:39], v128 offset:15104
  s_waitcnt lgkmcnt(12)
  v_mfma_f32_16x16x32_bf16 v[8:11], v[20:23], a[8:11], v[8:11]
  v_mfma_f32_16x16x32_bf16 v[12:15], v[20:23], a[12:15], v[12:15]
  ds_read_b64 a[40:41], v128 offset:16896
  ds_read_b64 a[44:45], v128 offset:17408
  ds_read_b64 a[42:43], v128 offset:17152
  ds_read_b64 a[46:47], v128 offset:17664
  s_waitcnt lgkmcnt(12)
  v_mfma_f32_16x16x32_bf16 v[8:11], v[24:27], a[16:19], v[8:11]
  v_mfma_f32_16x16x32_bf16 v[12:15], v[24:27], a[20:23], v[12:15]
  ds_read_b64 a[48:49], v128 offset:19456
  ds_read_b64 a[52:53], v128 offset:19968
  ds_read_b64 a[50:51], v128 offset:19712
  ds_read_b64 a[54:55], v128 offset:20224
  s_waitcnt lgkmcnt(12)
  v_mfma_f32_16x16x32_bf16 v[8:11], v[28:31], a[24:27], v[8:11]
  v_mfma_f32_16x16x32_bf16 v[12:15], v[28:31], a[28:31], v[12:15]
  ds_read_b64 a[56:57], v128 offset:22016
  ds_read_b64 a[60:61], v128 offset:22528
  ds_read_b64 a[58:59], v128 offset:22272
  ds_read_b64 a[62:63], v128 offset:22784
  s_waitcnt lgkmcnt(12)
  v_mfma_f32_16x16x32_bf16 v[8:11], v[32:35], a[32:35], v[8:11]
  v_mfma_f32_16x16x32_bf16 v[12:15], v[32:35], a[36:39], v[12:15]
  ds_read_b64 a[64:65], v128 offset:24576
  ds_read_b64 a[68:69], v128 offset:25088
  ds_read_b64 a[66:67], v128 offset:24832
  ds_read_b64 a[70:71], v128 offset:25344
  s_waitcnt lgkmcnt(12)
  v_mfma_f32_16x16x32_bf16 v[8:11], v[36:39], a[40:43], v[8:11]
  v_mfma_f32_16x16x32_bf16 v[12:15], v[36:39], a[44:47], v[12:15]
  ds_read_b64 a[72:73], v128 offset:27136
  ds_read_b64 a[76:77], v128 offset:27648
  ds_read_b64 a[74:75], v128 offset:27392
  ds_read_b64 a[78:79], v128 offset:27904
  s_waitcnt lgkmcnt(12)
  v_mfma_f32_16x16x32_bf16 v[8:11], v[40:43], a[48:51], v[8:11]
  v_mfma_f32_16x16x32_bf16 v[12:15], v[40:43], a[52:55], v[12:15]
  ds_read_b64 a[80:81], v128 offset:29696
  ds_read_b64 a[84:85], v128 offset:30208
  ds_read_b64 a[82:83], v128 offset:29952
  ds_read_b64 a[86:87], v128 offset:30464
  s_waitcnt lgkmcnt(12)
  v_mfma_f32_16x16x32_bf16 v[8:11], v[44:47], a[56:59], v[8:11]
  v_mfma_f32_16x16x32_bf16 v[12:15], v[44:47], a[60:63], v[12:15]
  ds_read_b64 a[88:89], v128 offset:32256
  ds_read_b64 a[92:93], v128 offset:32768
  ds_read_b64 a[90:91], v128 offset:32512
  ds_read_b64 a[94:95], v128 offset:33024
  s_waitcnt lgkmcnt(12)
  v_mfma_f32_16x16x32_bf16 v[8:11], v[48:51], a[64:67], v[8:11]
  v_mfma_f32_16x16x32_bf16 v[12:15], v[48:51], a[68:71], v[12:15]
  ds_read_b64 a[96:97], v128 offset:34816
  ds_read_b64 a[100:101], v128 offset:35328
  ds_read_b64 a[98:99], v128 offset:35072
  ds_read_b64 a[102:103], v128 offset:35584
  s_waitcnt lgkmcnt(12)
  v_mfma_f32_16x16x32_bf16 v[8:11], v[52:55], a[72:75], v[8:11]
  v_mfma_f32_16x16x32_bf16 v[12:15], v[52:55], a[76:79], v[12:15]
  ds_read_b64 a[104:105], v128 offset:37376
  ds_read_b64 a[108:109], v128 offset:37888
  ds_read_b64 a[106:107], v128 offset:37632
  ds_read_b64 a[110:111], v128 offset:38144
  s_waitcnt lgkmcnt(12)
  v_mfma_f32_16x16x32_bf16 v[8:11], v[56:59], a[80:83], v[8:11]
  v_mfma_f32_16x16x32_bf16 v[12:15], v[56:59], a[84:87], v[12:15]
  ds_read_b64 a[112:113], v128 offset:39936
  ds_read_b64 a[116:117], v128 offset:40448
  ds_read_b64 a[114:115], v128 offset:40192
  ds_read_b64 a[118:119], v128 offset:40704
  s_waitcnt lgkmcnt(12)
  v_mfma_f32_16x16x32_bf16 v[8:11], v[60:63], a[88:91], v[8:11]
  v_mfma_f32_16x16x32_bf16 v[12:15], v[60:63], a[92:95], v[12:15]
  ds_read_b64 a[120:121], v128 offset:42496
  ds_read_b64 a[124:125], v128 offset:43008
  ds_read_b64 a[122:123], v128 offset:42752
  ds_read_b64 a[126:127], v128 offset:43264
  s_waitcnt lgkmcnt(12)
  v_mfma_f32_16x16x32_bf16 v[8:11], v[64:67], a[96:99], v[8:11]
  v_mfma_f32_16x16x32_bf16 v[12:15], v[64:67], a[100:103], v[12:15]
  ds_read_b64 a[128:129], v129 offset:6144
  ds_read_b64 a[132:133], v129 offset:6400
  ds_read_b64 a[130:131], v129 offset:8704
  ds_read_b64 a[134:135], v129 offset:8960
  s_waitcnt lgkmcnt(12)
  v_mfma_f32_16x16x32_bf16 v[8:11], v[68:71], a[104:107], v[8:11]
  v_mfma_f32_16x16x32_bf16 v[12:15], v[68:71], a[108:111], v[12:15]
  ds_read_b64 a[136:137], v129 offset:16384
  ds_read_b64 a[140:141], v129 offset:16640
  ds_read_b64 a[138:139], v129 offset:18944
  ds_read_b64 a[142:143], v129 offset:19200
  s_waitcnt lgkmcnt(12)
  v_mfma_f32_16x16x32_bf16 v[8:11], v[72:75], a[112:115], v[8:11]
  v_mfma_f32_16x16x32_bf16 v[12:15], v[72:75], a[116:119], v[12:15]
  ds_read_b64 a[144:145], v129 offset:26624
  ds_read_b64 a[148:149], v129 offset:26880
  ds_read_b64 a[146:147], v129 offset:29184
  ds_read_b64 a[150:151], v129 offset:29440
  s_waitcnt lgkmcnt(12)
  v_mfma_f32_16x16x32_bf16 v[8:11], v[76:79], a[120:123], v[8:11]
  v_mfma_f32_16x16x32_bf16 v[12:15], v[76:79], a[124:127], v[12:15]
  ds_read_b64 a[152:153], v129 offset:36864
  ds_read_b64 a[156:157], v129 offset:37120
  ds_read_b64 a[154:155], v129 offset:39424
  ds_read_b64 a[158:159], v129 offset:39680
  s_waitcnt lgkmcnt(12)
  v_mfma_f32_16x16x32_bf16 v[8:11], v[80:83], a[128:131], v[8:11]
  v_mfma_f32_16x16x32_bf16 v[12:15], v[80:83], a[132:135], v[12:15]
  s_waitcnt lgkmcnt(8)
  v_mfma_f32_16x16x32_bf16 v[8:11], v[84:87], a[136:139], v[8:11]
  v_mfma_f32_16x16x32_bf16 v[12:15], v[84:87], a[140:143], v[12:15]
  s_waitcnt lgkmcnt(4)
  v_mfma_f32_16x16x32_bf16 v[8:11], v[88:91], a[144:147], v[8:11]
  v_mfma_f32_16x16x32_bf16 v[12:15], v[88:91], a[148:151], v[12:15]
  s_waitcnt lgkmcnt(0)
  v_mfma_f32_16x16x32_bf16 v[8:11], v[92:95], a[152:155], v[8:11]
  v_mfma_f32_16x16x32_bf16 v[12:15], v[92:95], a[156:159], v[12:15]
mk_pchk:
  s_nop 7
  v_add_f32 v140, v8, v12
  v_add_f32 v141, v9, v10
  v_add_f32 v140, v140, v11
  v_add_f32 v140, v140, v141
  v_cmp_u_f32 vcc, v140, v140
  s_cbranch_vccz mk_pok
  s_sub_u32 s42, s42, 2000
  s_cbranch_scc1 mk_pgv
  s_sleep 2
  s_lshl_b32 s32, s31, 12
  s_add_u32 s32, s32, 63045632
  v_add_u32 v2, s32, v4
  global_load_dwordx2 v[80:81], v2, s[4:5] offset:0 sc1
  global_load_dwordx2 v[82:83], v2, s[4:5] offset:256 sc1
  global_load_dwordx2 v[84:85], v2, s[4:5] offset:1024 sc1
  global_load_dwordx2 v[86:87], v2, s[4:5] offset:1280 sc1
  global_load_dwordx2 v[88:89], v2, s[4:5] offset:2048 sc1
  global_load_dwordx2 v[90:91], v2, s[4:5] offset:2304 sc1
  global_load_dwordx2 v[92:93], v2, s[4:5] offset:3072 sc1
  global_load_dwordx2 v[94:95], v2, s[4:5] offset:3328 sc1
  s_add_u32 s46, s44, 0
  s_addc_u32 s47, s45, 0
  global_load_dwordx2 a[0:1], v128, s[46:47] offset:0 sc1
  global_load_dwordx2 a[4:5], v128, s[46:47] offset:512 sc1
  global_load_dwordx2 a[2:3], v128, s[46:47] offset:256 sc1
  global_load_dwordx2 a[6:7], v128, s[46:47] offset:768 sc1
  global_load_dwordx2 a[8:9], v128, s[46:47] offset:2560 sc1
  global_load_dwordx2 a[12:13], v128, s[46:47] offset:3072 sc1
  global_load_dwordx2 a[10:11], v128, s[46:47] offset:2816 sc1
  global_load_dwordx2 a[14:15], v128, s[46:47] offset:3328 sc1
  s_add_u32 s46, s44, 4096
  s_addc_u32 s47, s45, 0
  global_load_dwordx2 a[16:17], v128, s[46:47] offset:1024 sc1
  global_load_dwordx2 a[20:21], v128, s[46:47] offset:1536 sc1
  global_load_dwordx2 a[18:19], v128, s[46:47] offset:1280 sc1
  global_load_dwordx2 a[22:23], v128, s[46:47] offset:1792 sc1
  global_load_dwordx2 a[24:25], v128, s[46:47] offset:3584 sc1
  s_add_u32 s46, s44, 8192
  s_addc_u32 s47, s45, 0
  global_load_dwordx2 a[28:29], v128, s[46:47] offset:0 sc1
  s_add_u32 s46, s44, 4096
  s_addc_u32 s47, s45, 0
  global_load_dwordx2 a[26:27], v128, s[46:47] offset:3840 sc1
  s_add_u32 s46, s44, 8192
  s_addc_u32 s47, s45, 0
  global_load_dwordx2 a[30:31], v128, s[46:47] offset:256 sc1
  global_load_dwordx2 a[32:33], v128, s[46:47] offset:2048 sc1
  global_load_dwordx2 a[36:37], v128, s[46:47] offset:2560 sc1
  global_load_dwordx2 a[34:35], v128, s[46:47] offset:2304 sc1
  global_load_dwordx2 a[38:39], v128, s[46:47] offset:2816 sc1
  s_add_u32 s46, s44, 12288
  s_addc_u32 s47, s45, 0
  global_load_dwordx2 a[40:41], v128, s[46:47] offset:512 sc1
  global_load_dwordx2 a[44:45], v128, s[46:47] offset:1024 sc1
  global_load_dwordx2 a[42:43], v128, s[46:47] offset:768 sc1
  global_load_dwordx2 a[46:47], v128, s[46:47] offset:1280 sc1
  global_load_dwordx2 a[48:49], v128, s[46:47] offset:3072 sc1
  global_load_dwordx2 a[52:53], v128, s[46:47] offset:3584 sc1
  global_load_dwordx2 a[50:51], v128, s[46:47] offset:3328 sc1
  global_load_dwordx2 a[54:55], v128, s[46:47] offset:3840 sc1
  s_add_u32 s46, s44, 16384
  s_addc_u32 s47, s45, 0
  global_load_dwordx2 a[56:57], v128, s[46:47] offset:1536 sc1
  global_load_dwordx2 a[60:61], v128, s[46:47] offset:2048 sc1
  global_load_dwordx2 a[58:59], v128, s[46:47] offset:1792 sc1
  global_load_dwordx2 a[62:63], v128, s[46:47] offset:2304 sc1
  s_add_u32 s46, s44, 20480
  s_addc_u32 s47, s45, 0
  global_load_dwordx2 a[64:65], v128, s[46:47] offset:0 sc1
  global_load_dwordx2 a[68:69], v128, s[46:47] offset:512 sc1
  global_load_dwordx2 a[66:67], v128, s[46:47] offset:256 sc1
  global_load_dwordx2 a[70:71], v128, s[46:47] offset:768 sc1
  global_load_dwordx2 a[72:73], v128, s[46:47] offset:2560 sc1
  global_load_dwordx2 a[76:77], v128, s[46:47] offset:3072 sc1
  global_load_dwordx2 a[74:75], v128, s[46:47] offset:2816 sc1
  global_load_dwordx2 a[78:79], v128, s[46:47] offset:3328 sc1
  s_add_u32 s46, s44, 24576
  s_addc_u32 s47, s45, 0
  global_load_dwordx2 a[80:81], v128, s[46:47] offset:1024 sc1
  global_load_dwordx2 a[84:85], v128, s[46:47] offset:1536 sc1
  global_load_dwordx2 a[82:83], v128, s[46:47] offset:1280 sc1
  global_load_dwordx2 a[86:87], v128, s[46:47] offset:1792 sc1
  global_load_dwordx2 a[88:89], v128, s[46:47] offset:3584 sc1
  s_add_u32 s46, s44, 28672
  s_addc_u32 s47, s45, 0
  global_load_dwordx2 a[92:93], v128, s[46:47] offset:0 sc1
  s_add_u32 s46, s44, 24576
  s_addc_u32 s47, s45, 0
  global_load_dwordx2 a[90:91], v128, s[46:47] offset:3840 sc1
  s_add_u32 s46, s44, 28672
  s_addc_u32 s47, s45, 0
  global_load_dwordx2 a[94:95], v128, s[46:47] offset:256 sc1
  global_load_dwordx2 a[96:97], v128, s[46:47] offset:2048 sc1
  global_load_dwordx2 a[100:101], v128, s[46:47] offset:2560 sc1
  global_load_dwordx2 a[98:99], v128, s[46:47] offset:2304 sc1
  global_load_dwordx2 a[102:103], v128, s[46:47] offset:2816 sc1
  s_add_u32 s46, s44, 32768
  s_addc_u32 s47, s45, 0
  global_load_dwordx2 a[104:105], v128, s[46:47] offset:512 sc1
  global_load_dwordx2 a[108:109], v128, s[46:47] offset:1024 sc1
  global_load_dwordx2 a[106:107], v128, s[46:47] offset:768 sc1
  global_load_dwordx2 a[110:111], v128, s[46:47] offset:1280 sc1
  global_load_dwordx2 a[112:113], v128, s[46:47] offset:3072 sc1
  global_load_dwordx2 a[116:117], v128, s[46:47] offset:3584 sc1
  global_load_dwordx2 a[114:115], v128, s[46:47] offset:3328 sc1
  global_load_dwordx2 a[118:119], v128, s[46:47] offset:3840 sc1
  s_add_u32 s46, s44, 36864
  s_addc_u32 s47, s45, 0
  global_load_dwordx2 a[120:121], v128, s[46:47] offset:1536 sc1
  global_load_dwordx2 a[124:125], v128, s[46:47] offset:2048 sc1
  global_load_dwordx2 a[122:123], v128, s[46:47] offset:1792 sc1
  global_load_dwordx2 a[126:127], v128, s[46:47] offset:2304 sc1
  s_add_u32 s46, s44, 0
  s_addc_u32 s47, s45, 0
  global_load_dwordx2 a[128:129], v129, s[46:47] offset:2048 sc1
  global_load_dwordx2 a[132:133], v129, s[46:47] offset:2304 sc1
  s_add_u32 s46, s44, 4096
  s_addc_u32 s47, s45, 0
  global_load_dwordx2 a[130:131], v129, s[46:47] offset:512 sc1
  global_load_dwordx2 a[134:135], v129, s[46:47] offset:768 sc1
  s_add_u32 s46, s44, 12288
  s_addc_u32 s47, s45, 0
  global_load_dwordx2 a[136:137], v129, s[46:47] offset:0 sc1
  global_load_dwordx2 a[140:141], v129, s[46:47] offset:256 sc1
  global_load_dwordx2 a[138:139], v129, s[46:47] offset:2560 sc1
  global_load_dwordx2 a[142:143], v129, s[46:47] offset:2816 sc1
  s_add_u32 s46, s44, 20480
  s_addc_u32 s47, s45, 0
  global_load_dwordx2 a[144:145], v129, s[46:47] offset:2048 sc1
  global_load_dwordx2 a[148:149], v129, s[46:47] offset:2304 sc1
  s_add_u32 s46, s44, 24576
  s_addc_u32 s47, s45, 0
  global_load_dwordx2 a[146:147], v129, s[46:47] offset:512 sc1
  global_load_dwordx2 a[150:151], v129, s[46:47] offset:768 sc1
  s_add_u32 s46, s44, 32768
  s_addc_u32 s47, s45, 0
  global_load_dwordx2 a[152:153], v129, s[46:47] offset:0 sc1
  global_load_dwordx2 a[156:157], v129, s[46:47] offset:256 sc1
  global_load_dwordx2 a[154:155], v129, s[46:47] offset:2560 sc1
  global_load_dwordx2 a[158:159], v129, s[46:47] offset:2816 sc1
  s_waitcnt vmcnt(0)
  v_mfma_f32_16x16x32_bf16 v[8:11], v[16:19], a[0:3], 0
  v_mfma_f32_16x16x32_bf16 v[12:15], v[16:19], a[4:7], 0
  v_mfma_f32_16x16x32_bf16 v[8:11], v[20:23], a[8:11], v[8:11]
  v_mfma_f32_16x16x32_bf16 v[12:15], v[20:23], a[12:15], v[12:15]
  v_mfma_f32_16x16x32_bf16 v[8:11], v[24:27], a[16:19], v[8:11]
  v_mfma_f32_16x16x32_bf16 v[12:15], v[24:27], a[20:23], v[12:15]
  v_mfma_f32_16x16x32_bf16 v[8:11], v[28:31], a[24:27], v[8:11]
  v_mfma_f32_16x16x32_bf16 v[12:15], v[28:31], a[28:31], v[12:15]
  v_mfma_f32_16x16x32_bf16 v[8:11], v[32:35], a[32:35], v[8:11]
  v_mfma_f32_16x16x32_bf16 v[12:15], v[32:35], a[36:39], v[12:15]
  v_mfma_f32_16x16x32_bf16 v[8:11], v[36:39], a[40:43], v[8:11]
  v_mfma_f32_16x16x32_bf16 v[12:15], v[36:39], a[44:47], v[12:15]
  v_mfma_f32_16x16x32_bf16 v[8:11], v[40:43], a[48:51], v[8:11]
  v_mfma_f32_16x16x32_bf16 v[12:15], v[40:43], a[52:55], v[12:15]
  v_mfma_f32_16x16x32_bf16 v[8:11], v[44:47], a[56:59], v[8:11]
  v_mfma_f32_16x16x32_bf16 v[12:15], v[44:47], a[60:63], v[12:15]
  v_mfma_f32_16x16x32_bf16 v[8:11], v[48:51], a[64:67], v[8:11]
  v_mfma_f32_16x16x32_bf16 v[12:15], v[48:51], a[68:71], v[12:15]
  v_mfma_f32_16x16x32_bf16 v[8:11], v[52:55], a[72:75], v[8:11]
  v_mfma_f32_16x16x32_bf16 v[12:15], v[52:55], a[76:79], v[12:15]
  v_mfma_f32_16x16x32_bf16 v[8:11], v[56:59], a[80:83], v[8:11]
  v_mfma_f32_16x16x32_bf16 v[12:15], v[56:59], a[84:87], v[12:15]
  v_mfma_f32_16x16x32_bf16 v[8:11], v[60:63], a[88:91], v[8:11]
  v_mfma_f32_16x16x32_bf16 v[12:15], v[60:63], a[92:95], v[12:15]
  v_mfma_f32_16x16x32_bf16 v[8:11], v[64:67], a[96:99], v[8:11]
  v_mfma_f32_16x16x32_bf16 v[12:15], v[64:67], a[100:103], v[12:15]
  v_mfma_f32_16x16x32_bf16 v[8:11], v[68:71], a[104:107], v[8:11]
  v_mfma_f32_16x16x32_bf16 v[12:15], v[68:71], a[108:111], v[12:15]
  v_mfma_f32_16x16x32_bf16 v[8:11], v[72:75], a[112:115], v[8:11]
  v_mfma_f32_16x16x32_bf16 v[12:15], v[72:75], a[116:119], v[12:15]
  v_mfma_f32_16x16x32_bf16 v[8:11], v[76:79], a[120:123], v[8:11]
  v_mfma_f32_16x16x32_bf16 v[12:15], v[76:79], a[124:127], v[12:15]
  v_mfma_f32_16x16x32_bf16 v[8:11], v[80:83], a[128:131], v[8:11]
  v_mfma_f32_16x16x32_bf16 v[12:15], v[80:83], a[132:135], v[12:15]
  v_mfma_f32_16x16x32_bf16 v[8:11], v[84:87], a[136:139], v[8:11]
  v_mfma_f32_16x16x32_bf16 v[12:15], v[84:87], a[140:143], v[12:15]
  v_mfma_f32_16x16x32_bf16 v[8:11], v[88:91], a[144:147], v[8:11]
  v_mfma_f32_16x16x32_bf16 v[12:15], v[88:91], a[148:151], v[12:15]
  v_mfma_f32_16x16x32_bf16 v[8:11], v[92:95], a[152:155], v[8:11]
  v_mfma_f32_16x16x32_bf16 v[12:15], v[92:95], a[156:159], v[12:15]
  s_branch mk_pchk
mk_pgv:
  s_mov_b32 s42, 0
mk_pok:
  s_sub_u32 s34, s40, s33
  s_cmp_lt_u32 s34, 32
  s_cbranch_scc1 mk_ffnrow
mk_ffnret:
  v_lshlrev_b32 v16, 16, v132
  v_and_b32 v17, 0xffff0000, v132
  v_lshlrev_b32 v18, 16, v133
  v_and_b32 v19, 0xffff0000, v133
  v_cvt_pk_bf16_f32 v20, v8, v9
  v_cvt_pk_bf16_f32 v21, v10, v11
  v_lshlrev_b32 v22, 16, v20
  v_and_b32 v23, 0xffff0000, v20
  v_lshlrev_b32 v24, 16, v21
  v_and_b32 v25, 0xffff0000, v21
  v_mul_f32 v22, v136, v22
  v_mul_f32 v16, v137, v16
  v_mul_f32 v23, v136, v23
  v_mul_f32 v17, v137, v17
  v_mul_f32 v24, v136, v24
  v_mul_f32 v18, v137, v18
  v_mul_f32 v25, v136, v25
  v_mul_f32 v19, v137, v19
  v_cvt_pk_bf16_f32 v20, v22, v23
  v_cvt_pk_bf16_f32 v21, v24, v25
  v_cvt_pk_bf16_f32 v26, v16, v17
  v_cvt_pk_bf16_f32 v27, v18, v19
  v_lshlrev_b32 v22, 16, v20
  v_and_b32 v23, 0xffff0000, v20
  v_lshlrev_b32 v24, 16, v26
  v_and_b32 v25, 0xffff0000, v26
  v_add_f32 v22, v22, v24
  v_add_f32 v23, v23, v25
  v_cvt_pk_bf16_f32 v28, v22, v23
  v_lshlrev_b32 v22, 16, v21
  v_and_b32 v23, 0xffff0000, v21
  v_lshlrev_b32 v24, 16, v27
  v_and_b32 v25, 0xffff0000, v27
  v_add_f32 v22, v22, v24
  v_add_f32 v23, v23, v25
  v_cvt_pk_bf16_f32 v29, v22, v23
  global_store_dwordx2 v3, v[28:29], s[10:11]
  v_lshlrev_b32 v16, 16, v134
  v_and_b32 v17, 0xffff0000, v134
  v_lshlrev_b32 v18, 16, v135
  v_and_b32 v19, 0xffff0000, v135
  v_cvt_pk_bf16_f32 v20, v12, v13
  v_cvt_pk_bf16_f32 v21, v14, v15
  v_lshlrev_b32 v22, 16, v20
  v_and_b32 v23, 0xffff0000, v20
  v_lshlrev_b32 v24, 16, v21
  v_and_b32 v25, 0xffff0000, v21
  v_mul_f32 v22, v138, v22
  v_mul_f32 v16, v139, v16
  v_mul_f32 v23, v138, v23
  v_mul_f32 v17, v139, v17
  v_mul_f32 v24, v138, v24
  v_mul_f32 v18, v139, v18
  v_mul_f32 v25, v138, v25
  v_mul_f32 v19, v139, v19
  v_cvt_pk_bf16_f32 v20, v22, v23
  v_cvt_pk_bf16_f32 v21, v24, v25
  v_cvt_pk_bf16_f32 v26, v16, v17
  v_cvt_pk_bf16_f32 v27, v18, v19
  v_lshlrev_b32 v22, 16, v20
  v_and_b32 v23, 0xffff0000, v20
  v_lshlrev_b32 v24, 16, v26
  v_and_b32 v25, 0xffff0000, v26
  v_add_f32 v22, v22, v24
  v_add_f32 v23, v23, v25
  v_cvt_pk_bf16_f32 v30, v22, v23
  v_lshlrev_b32 v22, 16, v21
  v_and_b32 v23, 0xffff0000, v21
  v_lshlrev_b32 v24, 16, v27
  v_and_b32 v25, 0xffff0000, v27
  v_add_f32 v22, v22, v24
  v_add_f32 v23, v23, v25
  v_cvt_pk_bf16_f32 v31, v22, v23
  global_store_dwordx2 v7, v[30:31], s[10:11]
  s_branch mk_oloop
mk_ffnrow:
  v_lshlrev_b32 v16, 2, v0
  v_min_u32 v16, 108, v16
  v_add_u32 v16, 14947328, v16
mk_wf_88:
  global_load_dword v17, v16, s[4:5] offset:0 sc1
  s_waitcnt vmcnt(0)
  v_xor_b32 v17, s20, v17
  v_cmp_ne_u32 vcc, 0, v17
  s_cbranch_vccz mk_wd_89
  s_sleep 8
  s_sub_u32 s42, s42, 1
  s_cbranch_scc0 mk_wf_88
  s_mov_b32 s42, 0
mk_wd_89:
  v_lshrrev_b32 v2, 4, v0
  v_lshlrev_b32 v2, 4, v2
  s_lshl_b32 s35, s30, 6
  s_add_u32 s35, s35, 14712832
  v_add_u32 v2, s35, v2
  v_mov_b32 v16, 0
  v_mov_b32 v17, 0
  v_mov_b32 v18, 0
  v_mov_b32 v19, 0
  global_load_dwordx4 v[32:35], v2, s[4:5] offset:0 sc1
  global_load_dwordx4 v[36:39], v2, s[4:5] offset:1792 sc1
  v_add_u32 v2, 3584, v2
  global_load_dwordx4 v[40:43], v2, s[4:5] offset:0 sc1
  global_load_dwordx4 v[44:47], v2, s[4:5] offset:1792 sc1
  v_add_u32 v2, 3584, v2
  global_load_dwordx4 v[48:51], v2, s[4:5] offset:0 sc1
  global_load_dwordx4 v[52:55], v2, s[4:5] offset:1792 sc1
  v_add_u32 v2, 3584, v2
  global_load_dwordx4 v[56:59], v2, s[4:5] offset:0 sc1
  global_load_dwordx4 v[60:63], v2, s[4:5] offset:1792 sc1
  v_add_u32 v2, 3584, v2
  global_load_dwordx4 v[64:67], v2, s[4:5] offset:0 sc1
  global_load_dwordx4 v[68:71], v2, s[4:5] offset:1792 sc1
  v_add_u32 v2, 3584, v2
  global_load_dwordx4 v[72:75], v2, s[4:5] offset:0 sc1
  global_load_dwordx4 v[76:79], v2, s[4:5] offset:1792 sc1
  v_add_u32 v2, 3584, v2
  global_load_dwordx4 v[80:83], v2, s[4:5] offset:0 sc1
  global_load_dwordx4 v[84:87], v2, s[4:5] offset:1792 sc1
  s_waitcnt vmcnt(0)
  v_add_f32 v16, v16, v32
  v_add_f32 v17, v17, v33
  v_add_f32 v18, v18, v34
  v_add_f32 v19, v19, v35
  v_add_f32 v16, v16, v36
  v_add_f32 v17, v17, v37
  v_add_f32 v18, v18, v38
  v_add_f32 v19, v19, v39
  v_add_f32 v16, v16, v40
  v_add_f32 v17, v17, v41
  v_add_f32 v18, v18, v42
  v_add_f32 v19, v19, v43
  v_add_f32 v16, v16, v44
  v_add_f32 v17, v17, v45
  v_add_f32 v18, v18, v46
  v_add_f32 v19, v19, v47
  v_add_f32 v16, v16, v48
  v_add_f32 v17, v17, v49
  v_add_f32 v18, v18, v50
  v_add_f32 v19, v19, v51
  v_add_f32 v16, v16, v52
  v_add_f32 v17, v17, v53
  v_add_f32 v18, v18, v54
  v_add_f32 v19, v19, v55
  v_add_f32 v16, v16, v56
  v_add_f32 v17, v17, v57
  v_add_f32 v18, v18, v58
  v_add_f32 v19, v19, v59
  v_add_f32 v16, v16, v60
  v_add_f32 v17, v17, v61
  v_add_f32 v18, v18, v62
  v_add_f32 v19, v19, v63
  v_add_f32 v16, v16, v64
  v_add_f32 v17, v17, v65
  v_add_f32 v18, v18, v66
  v_add_f32 v19, v19, v67
  v_add_f32 v16, v16, v68
  v_add_f32 v17, v17, v69
  v_add_f32 v18, v18, v70
  v_add_f32 v19, v19, v71
  v_add_f32 v16, v16, v72
  v_add_f32 v17, v17, v73
  v_add_f32 v18, v18, v74
  v_add_f32 v19, v19, v75
  v_add_f32 v16, v16, v76
  v_add_f32 v17, v17, v77
  v_add_f32 v18, v18, v78
  v_add_f32 v19, v19, v79
  v_add_f32 v16, v16, v80
  v_add_f32 v17, v17, v81
  v_add_f32 v18, v18, v82
  v_add_f32 v19, v19, v83
  v_add_f32 v16, v16, v84
  v_add_f32 v17, v17, v85
  v_add_f32 v18, v18, v86
  v_add_f32 v19, v19, v87
  v_add_u32 v2, 3584, v2
  global_load_dwordx4 v[32:35], v2, s[4:5] offset:0 sc1
  global_load_dwordx4 v[36:39], v2, s[4:5] offset:1792 sc1
  v_add_u32 v2, 3584, v2
  global_load_dwordx4 v[40:43], v2, s[4:5] offset:0 sc1
  global_load_dwordx4 v[44:47], v2, s[4:5] offset:1792 sc1
  v_add_u32 v2, 3584, v2
  global_load_dwordx4 v[48:51], v2, s[4:5] offset:0 sc1
  global_load_dwordx4 v[52:55], v2, s[4:5] offset:1792 sc1
  v_add_u32 v2, 3584, v2
  global_load_dwordx4 v[56:59], v2, s[4:5] offset:0 sc1
  global_load_dwordx4 v[60:63], v2, s[4:5] offset:1792 sc1
  v_add_u32 v2, 3584, v2
  global_load_dwordx4 v[64:67], v2, s[4:5] offset:0 sc1
  global_load_dwordx4 v[68:71], v2, s[4:5] offset:1792 sc1
  v_add_u32 v2, 3584, v2
  global_load_dwordx4 v[72:75], v2, s[4:5] offset:0 sc1
  global_load_dwordx4 v[76:79], v2, s[4:5] offset:1792 sc1
  v_add_u32 v2, 3584, v2
  global_load_dwordx4 v[80:83], v2, s[4:5] offset:0 sc1
  global_load_dwordx4 v[84:87], v2, s[4:5] offset:1792 sc1
  s_waitcnt vmcnt(0)
  v_add_f32 v16, v16, v32
  v_add_f32 v17, v17, v33
  v_add_f32 v18, v18, v34
  v_add_f32 v19, v19, v35
  v_add_f32 v16, v16, v36
  v_add_f32 v17, v17, v37
  v_add_f32 v18, v18, v38
  v_add_f32 v19, v19, v39
  v_add_f32 v16, v16, v40
  v_add_f32 v17, v17, v41
  v_add_f32 v18, v18, v42
  v_add_f32 v19, v19, v43
  v_add_f32 v16, v16, v44
  v_add_f32 v17, v17, v45
  v_add_f32 v18, v18, v46
  v_add_f32 v19, v19, v47
  v_add_f32 v16, v16, v48
  v_add_f32 v17, v17, v49
  v_add_f32 v18, v18, v50
  v_add_f32 v19, v19, v51
  v_add_f32 v16, v16, v52
  v_add_f32 v17, v17, v53
  v_add_f32 v18, v18, v54
  v_add_f32 v19, v19, v55
  v_add_f32 v16, v16, v56
  v_add_f32 v17, v17, v57
  v_add_f32 v18, v18, v58
  v_add_f32 v19, v19, v59
  v_add_f32 v16, v16, v60
  v_add_f32 v17, v17, v61
  v_add_f32 v18, v18, v62
  v_add_f32 v19, v19, v63
  v_add_f32 v16, v16, v64
  v_add_f32 v17, v17, v65
  v_add_f32 v18, v18, v66
  v_add_f32 v19, v19, v67
  v_add_f32 v16, v16, v68
  v_add_f32 v17, v17, v69
  v_add_f32 v18, v18, v70
  v_add_f32 v19, v19, v71
  v_add_f32 v16, v16, v72
  v_add_f32 v17, v17, v73
  v_add_f32 v18, v18, v74
  v_add_f32 v19, v19, v75
  v_add_f32 v16, v16, v76
  v_add_f32 v17, v17, v77
  v_add_f32 v18, v18, v78
  v_add_f32 v19, v19, v79
  v_add_f32 v16, v16, v80
  v_add_f32 v17, v17, v81
  v_add_f32 v18, v18, v82
  v_add_f32 v19, v19, v83
  v_add_f32 v16, v16, v84
  v_add_f32 v17, v17, v85
  v_add_f32 v18, v18, v86
  v_add_f32 v19, v19, v87
  v_cvt_pk_bf16_f32 v20, v16, v17
  v_cvt_pk_bf16_f32 v21, v18, v19
  v_lshlrev_b32 v16, 16, v20
  v_and_b32 v17, 0xffff0000, v20
  v_lshlrev_b32 v18, 16, v21
  v_and_b32 v19, 0xffff0000, v21
  v_mul_f32 v16, s41, v16
  v_mul_f32 v17, s41, v17
  v_mul_f32 v18, s41, v18
  v_mul_f32 v19, s41, v19
  v_cvt_pk_bf16_f32 v20, v16, v17
  v_cvt_pk_bf16_f32 v21, v18, v19
  v_lshlrev_b32 v16, 16, v20
  v_and_b32 v17, 0xffff0000, v20
  v_lshlrev_b32 v18, 16, v21
  v_and_b32 v19, 0xffff0000, v21
  v_and_b32 v2, 15, v0
  v_lshlrev_b32 v22, 16, v132
  v_and_b32 v23, 0xffff0000, v132
  v_lshlrev_b32 v24, 16, v133
  v_and_b32 v25, 0xffff0000, v133
  v_add_f32 v22, v22, v16
  v_add_f32 v23, v23, v17
  v_add_f32 v24, v24, v18
  v_add_f32 v25, v25, v19
  v_cvt_pk_bf16_f32 v20, v22, v23
  v_cvt_pk_bf16_f32 v21, v24, v25
  s_sub_u32 s35, s34, 0
  v_cmp_eq_u32 vcc, s35, v2
  s_nop 1
  v_cndmask_b32 v132, v132, v20, vcc
  v_cndmask_b32 v133, v133, v21, vcc
  v_lshlrev_b32 v22, 16, v134
  v_and_b32 v23, 0xffff0000, v134
  v_lshlrev_b32 v24, 16, v135
  v_and_b32 v25, 0xffff0000, v135
  v_add_f32 v22, v22, v16
  v_add_f32 v23, v23, v17
  v_add_f32 v24, v24, v18
  v_add_f32 v25, v25, v19
  v_cvt_pk_bf16_f32 v20, v22, v23
  v_cvt_pk_bf16_f32 v21, v24, v25
  s_sub_u32 s35, s34, 16
  v_cmp_eq_u32 vcc, s35, v2
  s_nop 1
  v_cndmask_b32 v134, v134, v20, vcc
  v_cndmask_b32 v135, v135, v21, vcc
  s_branch mk_ffnret
mk_fin:
mk_end:
  s_endpgm
.section .rodata,"a"
.p2align 6
.amdhsa_kernel gated_mix__memory_aug_recurrent_mem_tr__moe_arch_mod__prompt_kernel
  .amdhsa_next_free_vgpr 512
  .amdhsa_next_free_sgpr 96
  .amdhsa_accum_offset 256
  .amdhsa_group_segment_fixed_size 0
  .amdhsa_kernarg_size 128
  .amdhsa_user_sgpr_count 2
  .amdhsa_user_sgpr_kernarg_segment_ptr 1
  .amdhsa_system_sgpr_workgroup_id_x 1
.end_amdhsa_kernel
```
